```python
import torch

def _softmax(x, axis=-1):
    return torch.softmax(x, dim=axis)
def _gelu(x):
    return torch.nn.functional.gelu(x, approximate="tanh")
def _silu(x):
    return torch.nn.functional.silu(x)
def _sigmoid(x):
    return torch.sigmoid(x)
def _layernorm(x, axis=-1, eps=1e-5):
    m = x.mean(dim=axis, keepdim=True)
    v = x.var(dim=axis, keepdim=True, unbiased=False)
    return (x - m) / torch.sqrt(v + eps)
def _scatter_add(tgt, idx, src, axis=0):
    return tgt.clone().index_add_(axis, idx, src)
def _segment_sum(src, seg, n):
    out = torch.zeros((n,) + src.shape[1:], dtype=src.dtype)
    return out.index_add_(0, seg, src)
def _pad(x, pw):
    flat = tuple(v for pair in reversed(pw) for v in pair)
    return torch.nn.functional.pad(x, flat)

kernel_name = 'interleave_layers__linear_kernel_hedgehog__dense_activation_squared_relu__prompt'

def setup_inputs():

    _w = (lambda a: (lambda t: t.to(torch.bfloat16) if t.is_floating_point() else t)(torch.as_tensor(a)))
    def _A_setup():
        B, S, D, H = 1, 2048, 576, 32
        Dh = D // H
        return {
            "x": _w((lambda *s: torch.randn(*s, dtype=torch.bfloat16) * 0.05)(B, S, D)),
            "wqkv": _w((lambda *s: torch.randn(*s, dtype=torch.bfloat16) * 0.2)(D, 3 * D)),
            "w_phi": _w((lambda *s: torch.randn(*s, dtype=torch.bfloat16) * 0.2)(H, Dh, Dh) * (Dh ** -0.5)),
            "wo": _w((lambda *s: torch.randn(*s, dtype=torch.bfloat16) * 0.1)(D, D)),
        }
    _A_in = _A_setup()

    def _B_setup():
        B, S, D, F = 1, 2048, 576, 4608
        return {
            "x": _w((lambda *s: torch.randn(*s, dtype=torch.bfloat16) * 0.05)(B, S, D)),
            "w1": _w((lambda *s: torch.randn(*s, dtype=torch.bfloat16) * 0.05)(D, F)),
            "b1": _w((lambda *s: torch.randn(*s, dtype=torch.bfloat16) * 0.2)(F)),
            "w2": _w((lambda *s: torch.randn(*s, dtype=torch.bfloat16) * 0.05)(F, D)),
            "b2": _w((lambda *s: torch.randn(*s, dtype=torch.bfloat16) * 1.6)(D)),
        }
    _B_in = _B_setup()

    return {
        "A_x": _A_in["x"],
        "A_wqkv": _A_in["wqkv"],
        "A_w_phi": _A_in["w_phi"],
        "A_wo": _A_in["wo"],
        "B_x": _B_in["x"],
        "B_w1": _B_in["w1"],
        "B_b1": _B_in["b1"],
        "B_w2": _B_in["w2"],
        "B_b2": _B_in["b2"],
    }

def reference(A_x, A_wqkv, A_w_phi, A_wo, B_x, B_w1, B_b1, B_w2, B_b2):
    def _A_ref(x, wqkv, w_phi, wo):
        B, S, D = x.shape
        H = 32; Dh = D // H
        qkv = (lambda x, *d: x.permute(*d))((x @ wqkv).reshape(B, S, 3, H, Dh), 2, 0, 3, 1, 4)
        q, k, v = qkv[0], qkv[1], qkv[2]
        pq = torch.einsum("bhsd,hdf->bhsf", q, w_phi)
        pk = torch.einsum("bhsd,hdf->bhsf", k, w_phi)
        phi_q = torch.concatenate([_softmax(pq, axis=-1), _softmax(-pq, axis=-1)], axis=-1)
        phi_k = torch.concatenate([_softmax(pk, axis=-1), _softmax(-pk, axis=-1)], axis=-1)
        kv = torch.einsum("bhsf,bhsd->bhfd", phi_k, v)
        z  = torch.einsum("bhsf->bhf", phi_k)
        num = torch.einsum("bhqf,bhfd->bhqd", phi_q, kv)
        den = torch.einsum("bhqf,bhf->bhq", phi_q, z)[..., None] + 1e-6
        o = num / den
        return (lambda x, *d: x.permute(*d))(o, 0, 2, 1, 3).reshape(B, S, D) @ wo

    def _B_ref(x, w1, b1, w2, b2):
        h = torch.einsum("bsd,df->bsf", x, w1) + b1
        zero = torch.zeros_like(h)
        r = torch.where(h > zero, h, zero)
        h = r * r
        out = torch.einsum("bsf,fd->bsd", h, w2) + b2
        return out

    x = A_x
    x = x + _A_ref(_layernorm(x, axis=-1), A_wqkv, A_w_phi, A_wo)
    x = x + _B_ref(_layernorm(x, axis=-1), B_w1, B_b1, B_w2, B_b2)
    x = x + _A_ref(_layernorm(x, axis=-1), A_wqkv, A_w_phi, A_wo)
    x = x + _B_ref(_layernorm(x, axis=-1), B_w1, B_b1, B_w2, B_b2)
    return x
```

```asm
; @launch kernel=k1_l0_kernel grid=(256,1,1) block=(256,1,1) lds=163840
; @launch kernel=ko_l0_kernel grid=(256,1,1) block=(256,1,1) lds=24576
; @launch kernel=k2_l0_kernel grid=(164,1,1) block=(256,1,1) lds=147456
; @launch kernel=k3_l0_kernel grid=(256,1,1) block=(256,1,1) lds=163840
; @launch kernel=k4_l0_kernel grid=(256,1,1) block=(256,1,1) lds=147456
; @launch kernel=k4r_l0_kernel grid=(576,1,1) block=(256,1,1) lds=0
; @launch kernel=k1_l1_kernel grid=(256,1,1) block=(256,1,1) lds=163840
; @launch kernel=ko_l1_kernel grid=(256,1,1) block=(256,1,1) lds=24576
; @launch kernel=k2_l1_kernel grid=(164,1,1) block=(256,1,1) lds=147456
; @launch kernel=k3_l1_kernel grid=(256,1,1) block=(256,1,1) lds=163840
; @launch kernel=k4_l1_kernel grid=(256,1,1) block=(256,1,1) lds=147456
; @launch kernel=k4r_l1_kernel grid=(576,1,1) block=(256,1,1) lds=0
.amdgcn_target "amdgcn-amd-amdhsa--gfx950"
.text
.globl k1_l0_kernel
.p2align 8
.type k1_l0_kernel,@function
k1_l0_kernel:
s_mov_b32 s92, 0
s_branch k1_body
.globl k1_l1_kernel
.p2align 8
.type k1_l1_kernel,@function
k1_l1_kernel:
s_mov_b32 s92, 1
s_branch k1_body
.p2align 6
k1_body:
s_cmp_ge_u32 s2, 256
s_cbranch_scc1 k1_end
s_load_dwordx16 s[32:47], s[0:1], 0
s_load_dwordx8 s[48:55], s[0:1], 64
v_and_b32 v1, 63, v0
v_lshrrev_b32 v2, 4, v1
v_and_b32 v3, 15, v1
v_lshrrev_b32 v4, 6, v0
s_nop 0
v_readfirstlane_b32 s3, v4
v_lshrrev_b32 v5, 1, v2
v_lshlrev_b32 v5, 8, v5
v_lshl_add_u32 v5, v3, 4, v5
v_and_b32 v6, 1, v2
v_lshl_add_u32 v26, v6, 3, v5
s_waitcnt lgkmcnt(0)
s_mov_b32 s16, s54
s_and_b32 s17, s55, 0xffff
s_mov_b32 s18, 67108864
s_mov_b32 s19, 0x20000
s_cmp_ge_u32 s2, 192
s_cbranch_scc1 k1_pf
s_mov_b32 s64, 0x15555556
s_mul_hi_u32 s58, s2, s64
s_mul_i32 s64, s58, 12
s_sub_u32 s59, s2, s64
s_add_u32 s64, s32, 0
s_addc_u32 s65, s33, 0
s_add_u32 s66, s54, 14680064
s_addc_u32 s67, s55, 0
s_cmp_eq_u32 s92, 0
s_cselect_b32 s8, s64, s66
s_cselect_b32 s9, s65, s67
s_and_b32 s9, s9, 0xffff
s_mov_b32 s10, 2359296
s_mov_b32 s11, 0x20000
s_mov_b32 s12, s34
s_and_b32 s13, s35, 0xffff
s_mov_b32 s14, 1990656
s_mov_b32 s15, 0x20000
s_mov_b32 s20, s36
s_and_b32 s21, s37, 0xffff
s_mov_b32 s22, 20736
s_mov_b32 s23, 0x20000
s_lshl_b32 s67, s59, 2
s_lshl_b32 s68, s59, 3
s_sub_u32 s68, s68, 64
s_cmp_ge_u32 s59, 8
s_cselect_b32 s69, s68, s67
v_lshlrev_b32 v5, 6, v0
v_add_u32 v5, 147456, v5
v_mov_b32 v208, 0
v_mov_b32 v209, 0
v_mov_b32 v210, 0
v_mov_b32 v211, 0
ds_write_b128 v5, v[208:211] offset:0
ds_write_b128 v5, v[208:211] offset:16
ds_write_b128 v5, v[208:211] offset:32
ds_write_b128 v5, v[208:211] offset:48
s_mul_i32 s70, s69, 648
v_add_u32 v216, 0, v0
v_lshlrev_b32 v212, 2, v216
v_cmp_gt_u32 vcc, 1296, v216
v_mov_b32 v213, 2147418112
s_nop 0
v_cndmask_b32 v212, v213, v212, vcc
buffer_load_dword v224, v212, s[20:23], s70 offen
v_mul_u32_u24 v212, 6473, v216
v_lshrrev_b32 v212, 20, v212
v_mul_u32_u24 v213, 162, v212
v_sub_u32 v213, v216, v213
v_mul_u32_u24 v214, 7282, v213
v_lshrrev_b32 v214, 16, v214
v_mul_u32_u24 v215, 9, v214
v_sub_u32 v215, v213, v215
v_lshl_add_u32 v214, v212, 1, v214
v_lshlrev_b32 v214, 6, v214
v_lshl_add_u32 v214, v212, 11, v214
v_lshl_add_u32 v214, v215, 2, v214
v_add_u32 v232, 147456, v214
v_add_u32 v217, 256, v0
v_lshlrev_b32 v212, 2, v217
v_cmp_gt_u32 vcc, 1296, v217
v_mov_b32 v213, 2147418112
s_nop 0
v_cndmask_b32 v212, v213, v212, vcc
buffer_load_dword v225, v212, s[20:23], s70 offen
v_mul_u32_u24 v212, 6473, v217
v_lshrrev_b32 v212, 20, v212
v_mul_u32_u24 v213, 162, v212
v_sub_u32 v213, v217, v213
v_mul_u32_u24 v214, 7282, v213
v_lshrrev_b32 v214, 16, v214
v_mul_u32_u24 v215, 9, v214
v_sub_u32 v215, v213, v215
v_lshl_add_u32 v214, v212, 1, v214
v_lshlrev_b32 v214, 6, v214
v_lshl_add_u32 v214, v212, 11, v214
v_lshl_add_u32 v214, v215, 2, v214
v_add_u32 v233, 147456, v214
v_add_u32 v218, 512, v0
v_lshlrev_b32 v212, 2, v218
v_cmp_gt_u32 vcc, 1296, v218
v_mov_b32 v213, 2147418112
s_nop 0
v_cndmask_b32 v212, v213, v212, vcc
buffer_load_dword v226, v212, s[20:23], s70 offen
v_mul_u32_u24 v212, 6473, v218
v_lshrrev_b32 v212, 20, v212
v_mul_u32_u24 v213, 162, v212
v_sub_u32 v213, v218, v213
v_mul_u32_u24 v214, 7282, v213
v_lshrrev_b32 v214, 16, v214
v_mul_u32_u24 v215, 9, v214
v_sub_u32 v215, v213, v215
v_lshl_add_u32 v214, v212, 1, v214
v_lshlrev_b32 v214, 6, v214
v_lshl_add_u32 v214, v212, 11, v214
v_lshl_add_u32 v214, v215, 2, v214
v_add_u32 v234, 147456, v214
v_add_u32 v219, 768, v0
v_lshlrev_b32 v212, 2, v219
v_cmp_gt_u32 vcc, 1296, v219
v_mov_b32 v213, 2147418112
s_nop 0
v_cndmask_b32 v212, v213, v212, vcc
buffer_load_dword v227, v212, s[20:23], s70 offen
v_mul_u32_u24 v212, 6473, v219
v_lshrrev_b32 v212, 20, v212
v_mul_u32_u24 v213, 162, v212
v_sub_u32 v213, v219, v213
v_mul_u32_u24 v214, 7282, v213
v_lshrrev_b32 v214, 16, v214
v_mul_u32_u24 v215, 9, v214
v_sub_u32 v215, v213, v215
v_lshl_add_u32 v214, v212, 1, v214
v_lshlrev_b32 v214, 6, v214
v_lshl_add_u32 v214, v212, 11, v214
v_lshl_add_u32 v214, v215, 2, v214
v_add_u32 v235, 147456, v214
v_add_u32 v220, 1024, v0
v_lshlrev_b32 v212, 2, v220
v_cmp_gt_u32 vcc, 1296, v220
v_mov_b32 v213, 2147418112
s_nop 0
v_cndmask_b32 v212, v213, v212, vcc
buffer_load_dword v228, v212, s[20:23], s70 offen
v_mul_u32_u24 v212, 6473, v220
v_lshrrev_b32 v212, 20, v212
v_mul_u32_u24 v213, 162, v212
v_sub_u32 v213, v220, v213
v_mul_u32_u24 v214, 7282, v213
v_lshrrev_b32 v214, 16, v214
v_mul_u32_u24 v215, 9, v214
v_sub_u32 v215, v213, v215
v_lshl_add_u32 v214, v212, 1, v214
v_lshlrev_b32 v214, 6, v214
v_lshl_add_u32 v214, v212, 11, v214
v_lshl_add_u32 v214, v215, 2, v214
v_add_u32 v236, 147456, v214
v_add_u32 v221, 1280, v0
v_lshlrev_b32 v212, 2, v221
v_cmp_gt_u32 vcc, 1296, v221
v_mov_b32 v213, 2147418112
s_nop 0
v_cndmask_b32 v212, v213, v212, vcc
buffer_load_dword v229, v212, s[20:23], s70 offen
v_mul_u32_u24 v212, 6473, v221
v_lshrrev_b32 v212, 20, v212
v_mul_u32_u24 v213, 162, v212
v_sub_u32 v213, v221, v213
v_mul_u32_u24 v214, 7282, v213
v_lshrrev_b32 v214, 16, v214
v_mul_u32_u24 v215, 9, v214
v_sub_u32 v215, v213, v215
v_lshl_add_u32 v214, v212, 1, v214
v_lshlrev_b32 v214, 6, v214
v_lshl_add_u32 v214, v212, 11, v214
v_lshl_add_u32 v214, v215, 2, v214
v_add_u32 v237, 147456, v214
v_mov_b32 v213, 163836
v_cndmask_b32 v237, v213, v237, vcc
s_lshl_b32 s70, s58, 3
s_lshl_b32 s71, s3, 1
s_add_u32 s70, s70, s71
s_lshl_b32 s71, s70, 4
v_and_b32 v5, 7, v3
v_add_u32 v5, s71, v5
v_mul_u32_u24 v5, 1152, v5
v_lshl_add_u32 v5, v2, 4, v5
v_lshrrev_b32 v6, 3, v3
v_lshl_add_u32 v5, v6, 6, v5
v_lshlrev_b32 v6, 4, v1
s_mul_i32 s72, s70, 18432
s_cmp_eq_u32 s92, 0
s_cselect_b32 s73, 64, 1024
s_cselect_b32 s74, 0, s72
s_mov_b32 s79, 1024
s_cselect_b32 s79, 9216, s79
s_cselect_b64 s[76:77], -1, 0
v_cndmask_b32 v27, v6, v5, s[76:77]
s_mov_b32 s75, 18432
v_mov_b32 v244, 0x3f803f80
v_mov_b32 v245, 0x3f803f80
v_mov_b32 v246, 0x3f803f80
v_mov_b32 v247, 0x3f803f80
s_mov_b32 s82, 0x3f803f80
v_mov_b32 v248, 0
v_mov_b32 v249, 0
v_mov_b32 v250, 0
v_mov_b32 v251, 0
s_cmp_ge_u32 s59, 8
s_cbranch_scc0 k1_kv
s_sub_u32 s65, s59, 8
s_mul_i32 s66, s65, 288
s_and_b32 s66, s66, 0xffffff80
s_lshl_b32 s67, s65, 1
s_mul_i32 s78, s73, 0
s_add_u32 s78, s78, s74
buffer_load_dwordx4 v[32:35], v27, s[8:11], s78 offen
s_mul_i32 s78, s73, 0
s_add_u32 s78, s78, s74
s_add_u32 s78, s78, s79
buffer_load_dwordx4 v[36:39], v27, s[8:11], s78 offen
s_mul_i32 s78, s73, 0
s_add_u32 s78, s78, s74
s_add_u32 s78, s78, s75
buffer_load_dwordx4 v[104:107], v27, s[8:11], s78 offen
s_mul_i32 s78, s73, 0
s_add_u32 s78, s78, s74
s_add_u32 s78, s78, s75
s_add_u32 s78, s78, s79
buffer_load_dwordx4 v[108:111], v27, s[8:11], s78 offen
s_mul_i32 s78, s73, 2
s_add_u32 s78, s78, s74
buffer_load_dwordx4 v[40:43], v27, s[8:11], s78 offen
s_mul_i32 s78, s73, 2
s_add_u32 s78, s78, s74
s_add_u32 s78, s78, s79
buffer_load_dwordx4 v[44:47], v27, s[8:11], s78 offen
s_mul_i32 s78, s73, 2
s_add_u32 s78, s78, s74
s_add_u32 s78, s78, s75
buffer_load_dwordx4 v[112:115], v27, s[8:11], s78 offen
s_mul_i32 s78, s73, 2
s_add_u32 s78, s78, s74
s_add_u32 s78, s78, s75
s_add_u32 s78, s78, s79
buffer_load_dwordx4 v[116:119], v27, s[8:11], s78 offen
s_mul_i32 s78, s73, 4
s_add_u32 s78, s78, s74
buffer_load_dwordx4 v[48:51], v27, s[8:11], s78 offen
s_mul_i32 s78, s73, 4
s_add_u32 s78, s78, s74
s_add_u32 s78, s78, s79
buffer_load_dwordx4 v[52:55], v27, s[8:11], s78 offen
s_mul_i32 s78, s73, 4
s_add_u32 s78, s78, s74
s_add_u32 s78, s78, s75
buffer_load_dwordx4 v[120:123], v27, s[8:11], s78 offen
s_mul_i32 s78, s73, 4
s_add_u32 s78, s78, s74
s_add_u32 s78, s78, s75
s_add_u32 s78, s78, s79
buffer_load_dwordx4 v[124:127], v27, s[8:11], s78 offen
v_lshrrev_b32 v208, 3, v1
s_mov_b32 s89, 3456
v_mul_lo_u32 v209, v208, s89
v_bfe_u32 v210, v1, 4, 1
v_lshlrev_b32 v210, 1, v210
v_and_b32 v211, 7, v1
v_xor_b32 v211, v211, v210
v_lshl_add_u32 v16, v211, 4, v209
v_xor_b32 v211, 4, v211
v_lshl_add_u32 v17, v211, 4, v209
s_mul_i32 s56, s3, 3072
s_and_b32 s89, s3, 1
s_cmp_eq_u32 s89, 1
s_cselect_b64 s[90:91], -1, 0
v_mov_b32 v208, v16
v_cndmask_b32 v16, v16, v17, s[90:91]
v_cndmask_b32 v17, v17, v208, s[90:91]
s_mul_i32 s61, s3, 82944
s_add_u32 s84, s66, s61
s_add_u32 s85, s66, s61
s_add_u32 s85, s85, 128
s_add_u32 s86, s66, s61
s_add_u32 s86, s86, 256
s_add_u32 s57, s84, 0
s_add_u32 m0, s56, 0
s_nop 0
buffer_load_dwordx4 v16, s[12:15], s57 offen lds
s_add_u32 s57, s85, 0
s_add_u32 m0, s56, 12288
s_nop 0
buffer_load_dwordx4 v16, s[12:15], s57 offen lds
s_add_u32 s57, s86, 0
s_add_u32 m0, s56, 24576
s_nop 0
buffer_load_dwordx4 v16, s[12:15], s57 offen lds
s_add_u32 s57, s84, 27648
s_add_u32 m0, s56, 1024
s_nop 0
buffer_load_dwordx4 v17, s[12:15], s57 offen lds
s_add_u32 s57, s85, 27648
s_add_u32 m0, s56, 13312
s_nop 0
buffer_load_dwordx4 v17, s[12:15], s57 offen lds
s_add_u32 s57, s86, 27648
s_add_u32 m0, s56, 25600
s_nop 0
buffer_load_dwordx4 v17, s[12:15], s57 offen lds
s_add_u32 s57, s84, 55296
s_add_u32 m0, s56, 2048
s_nop 0
buffer_load_dwordx4 v16, s[12:15], s57 offen lds
s_add_u32 s57, s85, 55296
s_add_u32 m0, s56, 14336
s_nop 0
buffer_load_dwordx4 v16, s[12:15], s57 offen lds
s_add_u32 s57, s86, 55296
s_add_u32 m0, s56, 26624
s_nop 0
buffer_load_dwordx4 v16, s[12:15], s57 offen lds
s_add_u32 s57, s84, 331776
s_add_u32 m0, s56, 36864
s_nop 0
buffer_load_dwordx4 v16, s[12:15], s57 offen lds
s_add_u32 s57, s85, 331776
s_add_u32 m0, s56, 49152
s_nop 0
buffer_load_dwordx4 v16, s[12:15], s57 offen lds
s_add_u32 s57, s86, 331776
s_add_u32 m0, s56, 61440
s_nop 0
buffer_load_dwordx4 v16, s[12:15], s57 offen lds
s_add_u32 s57, s84, 359424
s_add_u32 m0, s56, 37888
s_nop 0
buffer_load_dwordx4 v17, s[12:15], s57 offen lds
s_add_u32 s57, s85, 359424
s_add_u32 m0, s56, 50176
s_nop 0
buffer_load_dwordx4 v17, s[12:15], s57 offen lds
s_add_u32 s57, s86, 359424
s_add_u32 m0, s56, 62464
s_nop 0
buffer_load_dwordx4 v17, s[12:15], s57 offen lds
s_add_u32 s57, s84, 387072
s_add_u32 m0, s56, 38912
s_nop 0
buffer_load_dwordx4 v16, s[12:15], s57 offen lds
s_add_u32 s57, s85, 387072
s_add_u32 m0, s56, 51200
s_nop 0
buffer_load_dwordx4 v16, s[12:15], s57 offen lds
s_add_u32 s57, s86, 387072
s_add_u32 m0, s56, 63488
s_nop 0
buffer_load_dwordx4 v16, s[12:15], s57 offen lds
s_waitcnt lgkmcnt(0)
s_barrier
s_waitcnt vmcnt(30)
ds_write_b32 v232, v224
ds_write_b32 v233, v225
ds_write_b32 v234, v226
ds_write_b32 v235, v227
ds_write_b32 v236, v228
ds_write_b32 v237, v229
v_lshrrev_b32 v208, 2, v3
v_bfe_u32 v209, v3, 3, 1
v_and_b32 v210, 1, v2
v_lshl_or_b32 v209, v210, 1, v209
v_lshlrev_b32 v209, 1, v209
v_lshl_add_u32 v208, v2, 3, v208
v_bfe_u32 v211, v3, 1, 1
v_add_u32 v211, s67, v211
v_lshrrev_b32 v212, 3, v211
v_and_b32 v211, 7, v211
v_xor_b32 v211, v211, v209
v_lshlrev_b32 v208, 7, v208
v_lshl_add_u32 v208, v211, 4, v208
v_mul_u32_u24 v212, 12288, v212
v_add_u32 v208, v208, v212
v_and_b32 v210, 1, v3
v_lshl_add_u32 v8, v210, 3, v208
v_lshrrev_b32 v208, 2, v3
v_bfe_u32 v209, v3, 3, 1
v_and_b32 v210, 1, v2
v_lshl_or_b32 v209, v210, 1, v209
v_lshlrev_b32 v209, 1, v209
v_lshl_add_u32 v208, v2, 3, v208
v_bfe_u32 v211, v3, 1, 1
v_add_u32 v211, s67, v211
v_add_u32 v211, 2, v211
v_lshrrev_b32 v212, 3, v211
v_and_b32 v211, 7, v211
v_xor_b32 v211, v211, v209
v_lshlrev_b32 v208, 7, v208
v_lshl_add_u32 v208, v211, 4, v208
v_mul_u32_u24 v212, 12288, v212
v_add_u32 v208, v208, v212
v_and_b32 v210, 1, v3
v_lshl_add_u32 v9, v210, 3, v208
v_lshrrev_b32 v208, 2, v3
v_bfe_u32 v209, v3, 3, 1
v_and_b32 v210, 1, v2
v_lshl_or_b32 v209, v210, 1, v209
v_lshlrev_b32 v209, 1, v209
v_lshl_add_u32 v208, v2, 3, v208
v_bfe_u32 v211, v3, 1, 1
v_add_u32 v211, s67, v211
v_add_u32 v211, 4, v211
v_lshrrev_b32 v212, 3, v211
v_and_b32 v211, 7, v211
v_xor_b32 v211, v211, v209
v_lshlrev_b32 v208, 7, v208
v_lshl_add_u32 v208, v211, 4, v208
v_mul_u32_u24 v212, 12288, v212
v_add_u32 v208, v208, v212
v_and_b32 v210, 1, v3
v_lshl_add_u32 v10, v210, 3, v208
v_lshrrev_b32 v208, 2, v3
v_bfe_u32 v209, v3, 3, 1
v_and_b32 v210, 1, v2
v_lshl_or_b32 v209, v210, 1, v209
v_lshlrev_b32 v209, 1, v209
v_lshl_add_u32 v208, v2, 3, v208
v_bfe_u32 v211, v3, 1, 1
v_add_u32 v211, s67, v211
v_add_u32 v211, 6, v211
v_lshrrev_b32 v212, 3, v211
v_and_b32 v211, 7, v211
v_xor_b32 v211, v211, v209
v_lshlrev_b32 v208, 7, v208
v_lshl_add_u32 v208, v211, 4, v208
v_mul_u32_u24 v212, 12288, v212
v_add_u32 v208, v208, v212
v_and_b32 v210, 1, v3
v_lshl_add_u32 v11, v210, 3, v208
s_waitcnt vmcnt(9)
s_barrier
ds_read_b64_tr_b16 v[176:177], v8 offset:0
ds_read_b64_tr_b16 v[178:179], v8 offset:512
ds_read_b64_tr_b16 v[180:181], v9 offset:0
ds_read_b64_tr_b16 v[182:183], v9 offset:512
ds_read_b64_tr_b16 v[184:185], v10 offset:0
ds_read_b64_tr_b16 v[186:187], v10 offset:512
ds_read_b64_tr_b16 v[188:189], v11 offset:0
ds_read_b64_tr_b16 v[190:191], v11 offset:512
ds_read_b64_tr_b16 v[192:193], v8 offset:12288
ds_read_b64_tr_b16 v[194:195], v8 offset:12800
ds_read_b64_tr_b16 v[196:197], v9 offset:12288
ds_read_b64_tr_b16 v[198:199], v9 offset:12800
s_mov_b64 exec, s[76:77]
v_mov_b32 v240, v36
v_mov_b32 v241, v37
v_mov_b32 v242, v38
v_mov_b32 v243, v39
v_mov_b32_dpp v36, v32 row_ror:8 row_mask:0xf bank_mask:0x3
v_mov_b32_dpp v37, v33 row_ror:8 row_mask:0xf bank_mask:0x3
v_mov_b32_dpp v38, v34 row_ror:8 row_mask:0xf bank_mask:0x3
v_mov_b32_dpp v39, v35 row_ror:8 row_mask:0xf bank_mask:0x3
v_mov_b32_dpp v32, v240 row_ror:8 row_mask:0xf bank_mask:0xc
v_mov_b32_dpp v33, v241 row_ror:8 row_mask:0xf bank_mask:0xc
v_mov_b32_dpp v34, v242 row_ror:8 row_mask:0xf bank_mask:0xc
v_mov_b32_dpp v35, v243 row_ror:8 row_mask:0xf bank_mask:0xc
v_mov_b32 v240, v108
v_mov_b32 v241, v109
v_mov_b32 v242, v110
v_mov_b32 v243, v111
v_mov_b32_dpp v108, v104 row_ror:8 row_mask:0xf bank_mask:0x3
v_mov_b32_dpp v109, v105 row_ror:8 row_mask:0xf bank_mask:0x3
v_mov_b32_dpp v110, v106 row_ror:8 row_mask:0xf bank_mask:0x3
v_mov_b32_dpp v111, v107 row_ror:8 row_mask:0xf bank_mask:0x3
v_mov_b32_dpp v104, v240 row_ror:8 row_mask:0xf bank_mask:0xc
v_mov_b32_dpp v105, v241 row_ror:8 row_mask:0xf bank_mask:0xc
v_mov_b32_dpp v106, v242 row_ror:8 row_mask:0xf bank_mask:0xc
v_mov_b32_dpp v107, v243 row_ror:8 row_mask:0xf bank_mask:0xc
v_mov_b32 v240, v44
v_mov_b32 v241, v45
v_mov_b32 v242, v46
v_mov_b32 v243, v47
v_mov_b32_dpp v44, v40 row_ror:8 row_mask:0xf bank_mask:0x3
v_mov_b32_dpp v45, v41 row_ror:8 row_mask:0xf bank_mask:0x3
v_mov_b32_dpp v46, v42 row_ror:8 row_mask:0xf bank_mask:0x3
v_mov_b32_dpp v47, v43 row_ror:8 row_mask:0xf bank_mask:0x3
v_mov_b32_dpp v40, v240 row_ror:8 row_mask:0xf bank_mask:0xc
v_mov_b32_dpp v41, v241 row_ror:8 row_mask:0xf bank_mask:0xc
v_mov_b32_dpp v42, v242 row_ror:8 row_mask:0xf bank_mask:0xc
v_mov_b32_dpp v43, v243 row_ror:8 row_mask:0xf bank_mask:0xc
v_mov_b32 v240, v116
v_mov_b32 v241, v117
v_mov_b32 v242, v118
v_mov_b32 v243, v119
v_mov_b32_dpp v116, v112 row_ror:8 row_mask:0xf bank_mask:0x3
v_mov_b32_dpp v117, v113 row_ror:8 row_mask:0xf bank_mask:0x3
v_mov_b32_dpp v118, v114 row_ror:8 row_mask:0xf bank_mask:0x3
v_mov_b32_dpp v119, v115 row_ror:8 row_mask:0xf bank_mask:0x3
v_mov_b32_dpp v112, v240 row_ror:8 row_mask:0xf bank_mask:0xc
v_mov_b32_dpp v113, v241 row_ror:8 row_mask:0xf bank_mask:0xc
v_mov_b32_dpp v114, v242 row_ror:8 row_mask:0xf bank_mask:0xc
v_mov_b32_dpp v115, v243 row_ror:8 row_mask:0xf bank_mask:0xc
s_mov_b64 exec, -1
ds_read_b64_tr_b16 v[200:201], v10 offset:12288
ds_read_b64_tr_b16 v[202:203], v10 offset:12800
s_waitcnt lgkmcnt(12)
v_mfma_f32_16x16x32_bf16 a[0:3], v[176:179], v[32:35], 0
s_mul_i32 s78, s73, 6
s_add_u32 s78, s78, s74
buffer_load_dwordx4 v[56:59], v27, s[8:11], s78 offen
v_mfma_f32_16x16x32_bf16 a[36:39], v[176:179], v[104:107], 0
v_mfma_f32_16x16x32_bf16 a[72:75], v[176:179], v[244:247], 0
ds_read_b64_tr_b16 v[204:205], v11 offset:12288
ds_read_b64_tr_b16 v[206:207], v11 offset:12800
s_waitcnt lgkmcnt(12)
v_mfma_f32_16x16x32_bf16 a[4:7], v[180:183], v[32:35], 0
v_mfma_f32_16x16x32_bf16 a[40:43], v[180:183], v[104:107], 0
s_mul_i32 s78, s73, 6
s_add_u32 s78, s78, s74
s_add_u32 s78, s78, s79
buffer_load_dwordx4 v[60:63], v27, s[8:11], s78 offen
v_mfma_f32_16x16x32_bf16 a[76:79], v[180:183], v[244:247], 0
ds_read_b64_tr_b16 v[176:177], v8 offset:24576
ds_read_b64_tr_b16 v[178:179], v8 offset:25088
s_waitcnt lgkmcnt(12)
v_mfma_f32_16x16x32_bf16 a[8:11], v[184:187], v[32:35], 0
v_mfma_f32_16x16x32_bf16 a[44:47], v[184:187], v[104:107], 0
s_mul_i32 s78, s73, 6
s_add_u32 s78, s78, s74
s_add_u32 s78, s78, s75
buffer_load_dwordx4 v[128:131], v27, s[8:11], s78 offen
v_mfma_f32_16x16x32_bf16 a[80:83], v[184:187], v[244:247], 0
ds_read_b64_tr_b16 v[180:181], v8 offset:4096
ds_read_b64_tr_b16 v[182:183], v8 offset:4608
s_waitcnt lgkmcnt(12)
v_mfma_f32_16x16x32_bf16 a[12:15], v[188:191], v[32:35], 0
v_mfma_f32_16x16x32_bf16 a[48:51], v[188:191], v[104:107], 0
v_mfma_f32_16x16x32_bf16 a[84:87], v[188:191], v[244:247], 0
ds_read_b64_tr_b16 v[184:185], v9 offset:4096
ds_read_b64_tr_b16 v[186:187], v9 offset:4608
s_waitcnt lgkmcnt(12)
v_mfma_f32_16x16x32_bf16 a[16:19], v[192:195], v[32:35], 0
s_mul_i32 s78, s73, 6
s_add_u32 s78, s78, s74
s_add_u32 s78, s78, s75
s_add_u32 s78, s78, s79
buffer_load_dwordx4 v[132:135], v27, s[8:11], s78 offen
v_mfma_f32_16x16x32_bf16 a[52:55], v[192:195], v[104:107], 0
v_mfma_f32_16x16x32_bf16 a[88:91], v[192:195], v[244:247], 0
ds_read_b64_tr_b16 v[188:189], v10 offset:4096
ds_read_b64_tr_b16 v[190:191], v10 offset:4608
s_waitcnt lgkmcnt(12)
v_mfma_f32_16x16x32_bf16 a[20:23], v[196:199], v[32:35], 0
s_mul_i32 s78, s73, 8
s_add_u32 s78, s78, s74
buffer_load_dwordx4 v[64:67], v27, s[8:11], s78 offen
v_mfma_f32_16x16x32_bf16 a[56:59], v[196:199], v[104:107], 0
v_mfma_f32_16x16x32_bf16 a[92:95], v[196:199], v[244:247], 0
ds_read_b64_tr_b16 v[192:193], v11 offset:4096
ds_read_b64_tr_b16 v[194:195], v11 offset:4608
s_waitcnt lgkmcnt(12)
v_mfma_f32_16x16x32_bf16 a[24:27], v[200:203], v[32:35], 0
s_mul_i32 s78, s73, 8
s_add_u32 s78, s78, s74
s_add_u32 s78, s78, s79
buffer_load_dwordx4 v[68:71], v27, s[8:11], s78 offen
v_mfma_f32_16x16x32_bf16 a[60:63], v[200:203], v[104:107], 0
v_mfma_f32_16x16x32_bf16 a[96:99], v[200:203], v[244:247], 0
ds_read_b64_tr_b16 v[196:197], v8 offset:16384
ds_read_b64_tr_b16 v[198:199], v8 offset:16896
s_waitcnt lgkmcnt(12)
v_mfma_f32_16x16x32_bf16 a[28:31], v[204:207], v[32:35], 0
v_mfma_f32_16x16x32_bf16 a[64:67], v[204:207], v[104:107], 0
s_mul_i32 s78, s73, 8
s_add_u32 s78, s78, s74
s_add_u32 s78, s78, s75
buffer_load_dwordx4 v[136:139], v27, s[8:11], s78 offen
v_mfma_f32_16x16x32_bf16 a[100:103], v[204:207], v[244:247], 0
ds_read_b64_tr_b16 v[200:201], v9 offset:16384
ds_read_b64_tr_b16 v[202:203], v9 offset:16896
s_waitcnt lgkmcnt(12)
v_mfma_f32_16x16x32_bf16 a[32:35], v[176:179], v[32:35], 0
v_mfma_f32_16x16x32_bf16 a[68:71], v[176:179], v[104:107], 0
s_mul_i32 s78, s73, 8
s_add_u32 s78, s78, s74
s_add_u32 s78, s78, s75
s_add_u32 s78, s78, s79
buffer_load_dwordx4 v[140:143], v27, s[8:11], s78 offen
v_mfma_f32_16x16x32_bf16 a[104:107], v[176:179], v[244:247], 0
ds_read_b64_tr_b16 v[204:205], v10 offset:16384
ds_read_b64_tr_b16 v[206:207], v10 offset:16896
s_waitcnt lgkmcnt(12)
v_mfma_f32_16x16x32_bf16 a[0:3], v[180:183], v[36:39], a[0:3]
v_mfma_f32_16x16x32_bf16 a[36:39], v[180:183], v[108:111], a[36:39]
s_add_u32 s57, s84, 663552
s_add_u32 m0, s56, 73728
s_nop 0
buffer_load_dwordx4 v16, s[12:15], s57 offen lds
v_mfma_f32_16x16x32_bf16 a[72:75], v[180:183], v[244:247], a[72:75]
ds_read_b64_tr_b16 v[176:177], v11 offset:16384
ds_read_b64_tr_b16 v[178:179], v11 offset:16896
s_waitcnt lgkmcnt(12)
v_mfma_f32_16x16x32_bf16 a[4:7], v[184:187], v[36:39], a[4:7]
v_mfma_f32_16x16x32_bf16 a[40:43], v[184:187], v[108:111], a[40:43]
v_mfma_f32_16x16x32_bf16 a[76:79], v[184:187], v[244:247], a[76:79]
ds_read_b64_tr_b16 v[180:181], v8 offset:28672
ds_read_b64_tr_b16 v[182:183], v8 offset:29184
s_waitcnt lgkmcnt(12)
v_mfma_f32_16x16x32_bf16 a[8:11], v[188:191], v[36:39], a[8:11]
s_add_u32 s57, s85, 663552
s_add_u32 m0, s56, 86016
s_nop 0
buffer_load_dwordx4 v16, s[12:15], s57 offen lds
v_mfma_f32_16x16x32_bf16 a[44:47], v[188:191], v[108:111], a[44:47]
v_mfma_f32_16x16x32_bf16 a[80:83], v[188:191], v[244:247], a[80:83]
ds_read_b64_tr_b16 v[184:185], v8 offset:8192
ds_read_b64_tr_b16 v[186:187], v8 offset:8704
s_waitcnt lgkmcnt(12)
v_mfma_f32_16x16x32_bf16 a[12:15], v[192:195], v[36:39], a[12:15]
s_add_u32 s57, s86, 663552
s_add_u32 m0, s56, 98304
s_nop 0
buffer_load_dwordx4 v16, s[12:15], s57 offen lds
v_mfma_f32_16x16x32_bf16 a[48:51], v[192:195], v[108:111], a[48:51]
v_mfma_f32_16x16x32_bf16 a[84:87], v[192:195], v[244:247], a[84:87]
ds_read_b64_tr_b16 v[188:189], v9 offset:8192
ds_read_b64_tr_b16 v[190:191], v9 offset:8704
s_waitcnt lgkmcnt(12)
v_mfma_f32_16x16x32_bf16 a[16:19], v[196:199], v[36:39], a[16:19]
s_add_u32 s57, s84, 691200
s_add_u32 m0, s56, 74752
s_nop 0
buffer_load_dwordx4 v17, s[12:15], s57 offen lds
v_mfma_f32_16x16x32_bf16 a[52:55], v[196:199], v[108:111], a[52:55]
v_mfma_f32_16x16x32_bf16 a[88:91], v[196:199], v[244:247], a[88:91]
ds_read_b64_tr_b16 v[192:193], v10 offset:8192
ds_read_b64_tr_b16 v[194:195], v10 offset:8704
s_waitcnt lgkmcnt(12)
v_mfma_f32_16x16x32_bf16 a[20:23], v[200:203], v[36:39], a[20:23]
v_mfma_f32_16x16x32_bf16 a[56:59], v[200:203], v[108:111], a[56:59]
s_add_u32 s57, s85, 691200
s_add_u32 m0, s56, 87040
s_nop 0
buffer_load_dwordx4 v17, s[12:15], s57 offen lds
v_mfma_f32_16x16x32_bf16 a[92:95], v[200:203], v[244:247], a[92:95]
ds_read_b64_tr_b16 v[196:197], v11 offset:8192
ds_read_b64_tr_b16 v[198:199], v11 offset:8704
s_waitcnt lgkmcnt(12)
v_mfma_f32_16x16x32_bf16 a[24:27], v[204:207], v[36:39], a[24:27]
v_mfma_f32_16x16x32_bf16 a[60:63], v[204:207], v[108:111], a[60:63]
s_add_u32 s57, s86, 691200
s_add_u32 m0, s56, 99328
s_nop 0
buffer_load_dwordx4 v17, s[12:15], s57 offen lds
v_mfma_f32_16x16x32_bf16 a[96:99], v[204:207], v[244:247], a[96:99]
ds_read_b64_tr_b16 v[200:201], v8 offset:20480
ds_read_b64_tr_b16 v[202:203], v8 offset:20992
s_waitcnt lgkmcnt(12)
v_mfma_f32_16x16x32_bf16 a[28:31], v[176:179], v[36:39], a[28:31]
v_mfma_f32_16x16x32_bf16 a[64:67], v[176:179], v[108:111], a[64:67]
s_add_u32 s57, s84, 718848
s_add_u32 m0, s56, 75776
s_nop 0
buffer_load_dwordx4 v16, s[12:15], s57 offen lds
v_mfma_f32_16x16x32_bf16 a[100:103], v[176:179], v[244:247], a[100:103]
ds_read_b64_tr_b16 v[204:205], v9 offset:20480
ds_read_b64_tr_b16 v[206:207], v9 offset:20992
s_waitcnt lgkmcnt(12)
v_mfma_f32_16x16x32_bf16 a[32:35], v[180:183], v[36:39], a[32:35]
v_mfma_f32_16x16x32_bf16 a[68:71], v[180:183], v[108:111], a[68:71]
v_mfma_f32_16x16x32_bf16 a[104:107], v[180:183], v[244:247], a[104:107]
ds_read_b64_tr_b16 v[176:177], v10 offset:20480
ds_read_b64_tr_b16 v[178:179], v10 offset:20992
s_waitcnt lgkmcnt(12)
v_mfma_f32_16x16x32_bf16 a[0:3], v[184:187], v[40:43], a[0:3]
s_add_u32 s57, s85, 718848
s_add_u32 m0, s56, 88064
s_nop 0
buffer_load_dwordx4 v16, s[12:15], s57 offen lds
v_mfma_f32_16x16x32_bf16 a[36:39], v[184:187], v[112:115], a[36:39]
v_mfma_f32_16x16x32_bf16 a[72:75], v[184:187], v[244:247], a[72:75]
ds_read_b64_tr_b16 v[180:181], v11 offset:20480
ds_read_b64_tr_b16 v[182:183], v11 offset:20992
s_waitcnt lgkmcnt(12)
v_mfma_f32_16x16x32_bf16 a[4:7], v[188:191], v[40:43], a[4:7]
s_add_u32 s57, s86, 718848
s_add_u32 m0, s56, 100352
s_nop 0
buffer_load_dwordx4 v16, s[12:15], s57 offen lds
v_mfma_f32_16x16x32_bf16 a[40:43], v[188:191], v[112:115], a[40:43]
v_mfma_f32_16x16x32_bf16 a[76:79], v[188:191], v[244:247], a[76:79]
ds_read_b64_tr_b16 v[184:185], v8 offset:32768
ds_read_b64_tr_b16 v[186:187], v8 offset:33280
s_waitcnt lgkmcnt(12)
v_mfma_f32_16x16x32_bf16 a[8:11], v[192:195], v[40:43], a[8:11]
v_mfma_f32_16x16x32_bf16 a[44:47], v[192:195], v[112:115], a[44:47]
v_mfma_f32_16x16x32_bf16 a[80:83], v[192:195], v[244:247], a[80:83]
s_waitcnt vmcnt(17)
s_barrier
v_add_u32 v8, 36864, v8
v_add_u32 v9, 36864, v9
v_add_u32 v10, 36864, v10
v_add_u32 v11, 36864, v11
ds_read_b64_tr_b16 v[188:189], v8 offset:0
ds_read_b64_tr_b16 v[190:191], v8 offset:512
s_waitcnt lgkmcnt(12)
v_mfma_f32_16x16x32_bf16 a[12:15], v[196:199], v[40:43], a[12:15]
v_mfma_f32_16x16x32_bf16 a[48:51], v[196:199], v[112:115], a[48:51]
v_mfma_f32_16x16x32_bf16 a[84:87], v[196:199], v[244:247], a[84:87]
ds_read_b64_tr_b16 v[192:193], v9 offset:0
ds_read_b64_tr_b16 v[194:195], v9 offset:512
s_waitcnt lgkmcnt(12)
v_mfma_f32_16x16x32_bf16 a[16:19], v[200:203], v[40:43], a[16:19]
v_mfma_f32_16x16x32_bf16 a[52:55], v[200:203], v[112:115], a[52:55]
v_mfma_f32_16x16x32_bf16 a[88:91], v[200:203], v[244:247], a[88:91]
ds_read_b64_tr_b16 v[196:197], v10 offset:0
ds_read_b64_tr_b16 v[198:199], v10 offset:512
s_waitcnt lgkmcnt(12)
v_mfma_f32_16x16x32_bf16 a[20:23], v[204:207], v[40:43], a[20:23]
v_mfma_f32_16x16x32_bf16 a[56:59], v[204:207], v[112:115], a[56:59]
v_mfma_f32_16x16x32_bf16 a[92:95], v[204:207], v[244:247], a[92:95]
ds_read_b64_tr_b16 v[200:201], v11 offset:0
ds_read_b64_tr_b16 v[202:203], v11 offset:512
s_waitcnt lgkmcnt(12)
v_mfma_f32_16x16x32_bf16 a[24:27], v[176:179], v[40:43], a[24:27]
v_mfma_f32_16x16x32_bf16 a[60:63], v[176:179], v[112:115], a[60:63]
v_mfma_f32_16x16x32_bf16 a[96:99], v[176:179], v[244:247], a[96:99]
ds_read_b64_tr_b16 v[204:205], v8 offset:12288
ds_read_b64_tr_b16 v[206:207], v8 offset:12800
s_waitcnt lgkmcnt(12)
v_mfma_f32_16x16x32_bf16 a[28:31], v[180:183], v[40:43], a[28:31]
v_mfma_f32_16x16x32_bf16 a[64:67], v[180:183], v[112:115], a[64:67]
v_mfma_f32_16x16x32_bf16 a[100:103], v[180:183], v[244:247], a[100:103]
ds_read_b64_tr_b16 v[176:177], v9 offset:12288
ds_read_b64_tr_b16 v[178:179], v9 offset:12800
s_waitcnt lgkmcnt(12)
v_mfma_f32_16x16x32_bf16 a[32:35], v[184:187], v[40:43], a[32:35]
v_mfma_f32_16x16x32_bf16 a[68:71], v[184:187], v[112:115], a[68:71]
v_mfma_f32_16x16x32_bf16 a[104:107], v[184:187], v[244:247], a[104:107]
s_mov_b64 exec, s[76:77]
v_mov_b32 v240, v52
v_mov_b32 v241, v53
v_mov_b32 v242, v54
v_mov_b32 v243, v55
v_mov_b32_dpp v52, v48 row_ror:8 row_mask:0xf bank_mask:0x3
v_mov_b32_dpp v53, v49 row_ror:8 row_mask:0xf bank_mask:0x3
v_mov_b32_dpp v54, v50 row_ror:8 row_mask:0xf bank_mask:0x3
v_mov_b32_dpp v55, v51 row_ror:8 row_mask:0xf bank_mask:0x3
v_mov_b32_dpp v48, v240 row_ror:8 row_mask:0xf bank_mask:0xc
v_mov_b32_dpp v49, v241 row_ror:8 row_mask:0xf bank_mask:0xc
v_mov_b32_dpp v50, v242 row_ror:8 row_mask:0xf bank_mask:0xc
v_mov_b32_dpp v51, v243 row_ror:8 row_mask:0xf bank_mask:0xc
v_mov_b32 v240, v124
v_mov_b32 v241, v125
v_mov_b32 v242, v126
v_mov_b32 v243, v127
v_mov_b32_dpp v124, v120 row_ror:8 row_mask:0xf bank_mask:0x3
v_mov_b32_dpp v125, v121 row_ror:8 row_mask:0xf bank_mask:0x3
v_mov_b32_dpp v126, v122 row_ror:8 row_mask:0xf bank_mask:0x3
v_mov_b32_dpp v127, v123 row_ror:8 row_mask:0xf bank_mask:0x3
v_mov_b32_dpp v120, v240 row_ror:8 row_mask:0xf bank_mask:0xc
v_mov_b32_dpp v121, v241 row_ror:8 row_mask:0xf bank_mask:0xc
v_mov_b32_dpp v122, v242 row_ror:8 row_mask:0xf bank_mask:0xc
v_mov_b32_dpp v123, v243 row_ror:8 row_mask:0xf bank_mask:0xc
s_mov_b64 exec, -1
ds_read_b64_tr_b16 v[180:181], v10 offset:12288
ds_read_b64_tr_b16 v[182:183], v10 offset:12800
s_waitcnt lgkmcnt(12)
v_mfma_f32_16x16x32_bf16 a[0:3], v[188:191], v[44:47], a[0:3]
s_mul_i32 s78, s73, 10
s_add_u32 s78, s78, s74
buffer_load_dwordx4 v[72:75], v27, s[8:11], s78 offen
v_mfma_f32_16x16x32_bf16 a[36:39], v[188:191], v[116:119], a[36:39]
v_mfma_f32_16x16x32_bf16 a[72:75], v[188:191], v[244:247], a[72:75]
ds_read_b64_tr_b16 v[184:185], v11 offset:12288
ds_read_b64_tr_b16 v[186:187], v11 offset:12800
s_waitcnt lgkmcnt(12)
v_mfma_f32_16x16x32_bf16 a[4:7], v[192:195], v[44:47], a[4:7]
v_mfma_f32_16x16x32_bf16 a[40:43], v[192:195], v[116:119], a[40:43]
v_mfma_f32_16x16x32_bf16 a[76:79], v[192:195], v[244:247], a[76:79]
ds_read_b64_tr_b16 v[188:189], v8 offset:24576
ds_read_b64_tr_b16 v[190:191], v8 offset:25088
s_waitcnt lgkmcnt(12)
v_mfma_f32_16x16x32_bf16 a[8:11], v[196:199], v[44:47], a[8:11]
s_mul_i32 s78, s73, 10
s_add_u32 s78, s78, s74
s_add_u32 s78, s78, s79
buffer_load_dwordx4 v[76:79], v27, s[8:11], s78 offen
v_mfma_f32_16x16x32_bf16 a[44:47], v[196:199], v[116:119], a[44:47]
v_mfma_f32_16x16x32_bf16 a[80:83], v[196:199], v[244:247], a[80:83]
ds_read_b64_tr_b16 v[192:193], v8 offset:4096
ds_read_b64_tr_b16 v[194:195], v8 offset:4608
s_waitcnt lgkmcnt(12)
v_mfma_f32_16x16x32_bf16 a[12:15], v[200:203], v[44:47], a[12:15]
v_mfma_f32_16x16x32_bf16 a[48:51], v[200:203], v[116:119], a[48:51]
s_mul_i32 s78, s73, 10
s_add_u32 s78, s78, s74
s_add_u32 s78, s78, s75
buffer_load_dwordx4 v[144:147], v27, s[8:11], s78 offen
v_mfma_f32_16x16x32_bf16 a[84:87], v[200:203], v[244:247], a[84:87]
ds_read_b64_tr_b16 v[196:197], v9 offset:4096
ds_read_b64_tr_b16 v[198:199], v9 offset:4608
s_waitcnt lgkmcnt(12)
v_mfma_f32_16x16x32_bf16 a[16:19], v[204:207], v[44:47], a[16:19]
v_mfma_f32_16x16x32_bf16 a[52:55], v[204:207], v[116:119], a[52:55]
v_mfma_f32_16x16x32_bf16 a[88:91], v[204:207], v[244:247], a[88:91]
ds_read_b64_tr_b16 v[200:201], v10 offset:4096
ds_read_b64_tr_b16 v[202:203], v10 offset:4608
s_waitcnt lgkmcnt(12)
v_mfma_f32_16x16x32_bf16 a[20:23], v[176:179], v[44:47], a[20:23]
s_mul_i32 s78, s73, 10
s_add_u32 s78, s78, s74
s_add_u32 s78, s78, s75
s_add_u32 s78, s78, s79
buffer_load_dwordx4 v[148:151], v27, s[8:11], s78 offen
v_mfma_f32_16x16x32_bf16 a[56:59], v[176:179], v[116:119], a[56:59]
v_mfma_f32_16x16x32_bf16 a[92:95], v[176:179], v[244:247], a[92:95]
ds_read_b64_tr_b16 v[204:205], v11 offset:4096
ds_read_b64_tr_b16 v[206:207], v11 offset:4608
s_waitcnt lgkmcnt(12)
v_mfma_f32_16x16x32_bf16 a[24:27], v[180:183], v[44:47], a[24:27]
v_mfma_f32_16x16x32_bf16 a[60:63], v[180:183], v[116:119], a[60:63]
s_add_u32 s57, s84, 995328
s_add_u32 m0, s56, 110592
s_nop 0
buffer_load_dwordx4 v16, s[12:15], s57 offen lds
v_mfma_f32_16x16x32_bf16 a[96:99], v[180:183], v[244:247], a[96:99]
ds_read_b64_tr_b16 v[176:177], v8 offset:16384
ds_read_b64_tr_b16 v[178:179], v8 offset:16896
s_waitcnt lgkmcnt(12)
v_mfma_f32_16x16x32_bf16 a[28:31], v[184:187], v[44:47], a[28:31]
v_mfma_f32_16x16x32_bf16 a[64:67], v[184:187], v[116:119], a[64:67]
v_mfma_f32_16x16x32_bf16 a[100:103], v[184:187], v[244:247], a[100:103]
ds_read_b64_tr_b16 v[180:181], v9 offset:16384
ds_read_b64_tr_b16 v[182:183], v9 offset:16896
s_waitcnt lgkmcnt(12)
v_mfma_f32_16x16x32_bf16 a[32:35], v[188:191], v[44:47], a[32:35]
s_add_u32 s57, s85, 995328
s_add_u32 m0, s56, 122880
s_nop 0
buffer_load_dwordx4 v16, s[12:15], s57 offen lds
v_mfma_f32_16x16x32_bf16 a[68:71], v[188:191], v[116:119], a[68:71]
v_mfma_f32_16x16x32_bf16 a[104:107], v[188:191], v[244:247], a[104:107]
ds_read_b64_tr_b16 v[184:185], v10 offset:16384
ds_read_b64_tr_b16 v[186:187], v10 offset:16896
s_waitcnt lgkmcnt(12)
v_mfma_f32_16x16x32_bf16 a[0:3], v[192:195], v[48:51], a[0:3]
v_mfma_f32_16x16x32_bf16 a[36:39], v[192:195], v[120:123], a[36:39]
s_add_u32 s57, s86, 995328
s_add_u32 m0, s56, 135168
s_nop 0
buffer_load_dwordx4 v16, s[12:15], s57 offen lds
v_mfma_f32_16x16x32_bf16 a[72:75], v[192:195], v[244:247], a[72:75]
ds_read_b64_tr_b16 v[188:189], v11 offset:16384
ds_read_b64_tr_b16 v[190:191], v11 offset:16896
s_waitcnt lgkmcnt(12)
v_mfma_f32_16x16x32_bf16 a[4:7], v[196:199], v[48:51], a[4:7]
v_mfma_f32_16x16x32_bf16 a[40:43], v[196:199], v[120:123], a[40:43]
v_mfma_f32_16x16x32_bf16 a[76:79], v[196:199], v[244:247], a[76:79]
ds_read_b64_tr_b16 v[192:193], v8 offset:28672
ds_read_b64_tr_b16 v[194:195], v8 offset:29184
s_waitcnt lgkmcnt(12)
v_mfma_f32_16x16x32_bf16 a[8:11], v[200:203], v[48:51], a[8:11]
s_add_u32 s57, s84, 1022976
s_add_u32 m0, s56, 111616
s_nop 0
buffer_load_dwordx4 v17, s[12:15], s57 offen lds
v_mfma_f32_16x16x32_bf16 a[44:47], v[200:203], v[120:123], a[44:47]
v_mfma_f32_16x16x32_bf16 a[80:83], v[200:203], v[244:247], a[80:83]
ds_read_b64_tr_b16 v[196:197], v8 offset:8192
ds_read_b64_tr_b16 v[198:199], v8 offset:8704
s_waitcnt lgkmcnt(12)
v_mfma_f32_16x16x32_bf16 a[12:15], v[204:207], v[48:51], a[12:15]
v_mfma_f32_16x16x32_bf16 a[48:51], v[204:207], v[120:123], a[48:51]
s_add_u32 s57, s85, 1022976
s_add_u32 m0, s56, 123904
s_nop 0
buffer_load_dwordx4 v17, s[12:15], s57 offen lds
v_mfma_f32_16x16x32_bf16 a[84:87], v[204:207], v[244:247], a[84:87]
ds_read_b64_tr_b16 v[200:201], v9 offset:8192
ds_read_b64_tr_b16 v[202:203], v9 offset:8704
s_waitcnt lgkmcnt(12)
v_mfma_f32_16x16x32_bf16 a[16:19], v[176:179], v[48:51], a[16:19]
v_mfma_f32_16x16x32_bf16 a[52:55], v[176:179], v[120:123], a[52:55]
v_mfma_f32_16x16x32_bf16 a[88:91], v[176:179], v[244:247], a[88:91]
ds_read_b64_tr_b16 v[204:205], v10 offset:8192
ds_read_b64_tr_b16 v[206:207], v10 offset:8704
s_waitcnt lgkmcnt(12)
v_mfma_f32_16x16x32_bf16 a[20:23], v[180:183], v[48:51], a[20:23]
s_add_u32 s57, s86, 1022976
s_add_u32 m0, s56, 136192
s_nop 0
buffer_load_dwordx4 v17, s[12:15], s57 offen lds
v_mfma_f32_16x16x32_bf16 a[56:59], v[180:183], v[120:123], a[56:59]
v_mfma_f32_16x16x32_bf16 a[92:95], v[180:183], v[244:247], a[92:95]
ds_read_b64_tr_b16 v[176:177], v11 offset:8192
ds_read_b64_tr_b16 v[178:179], v11 offset:8704
s_waitcnt lgkmcnt(12)
v_mfma_f32_16x16x32_bf16 a[24:27], v[184:187], v[48:51], a[24:27]
v_mfma_f32_16x16x32_bf16 a[60:63], v[184:187], v[120:123], a[60:63]
s_add_u32 s57, s84, 1050624
s_add_u32 m0, s56, 112640
s_nop 0
buffer_load_dwordx4 v16, s[12:15], s57 offen lds
v_mfma_f32_16x16x32_bf16 a[96:99], v[184:187], v[244:247], a[96:99]
ds_read_b64_tr_b16 v[180:181], v8 offset:20480
ds_read_b64_tr_b16 v[182:183], v8 offset:20992
s_waitcnt lgkmcnt(12)
v_mfma_f32_16x16x32_bf16 a[28:31], v[188:191], v[48:51], a[28:31]
v_mfma_f32_16x16x32_bf16 a[64:67], v[188:191], v[120:123], a[64:67]
v_mfma_f32_16x16x32_bf16 a[100:103], v[188:191], v[244:247], a[100:103]
ds_read_b64_tr_b16 v[184:185], v9 offset:20480
ds_read_b64_tr_b16 v[186:187], v9 offset:20992
s_waitcnt lgkmcnt(12)
v_mfma_f32_16x16x32_bf16 a[32:35], v[192:195], v[48:51], a[32:35]
s_add_u32 s57, s85, 1050624
s_add_u32 m0, s56, 124928
s_nop 0
buffer_load_dwordx4 v16, s[12:15], s57 offen lds
v_mfma_f32_16x16x32_bf16 a[68:71], v[192:195], v[120:123], a[68:71]
v_mfma_f32_16x16x32_bf16 a[104:107], v[192:195], v[244:247], a[104:107]
ds_read_b64_tr_b16 v[188:189], v10 offset:20480
ds_read_b64_tr_b16 v[190:191], v10 offset:20992
s_waitcnt lgkmcnt(12)
v_mfma_f32_16x16x32_bf16 a[0:3], v[196:199], v[52:55], a[0:3]
v_mfma_f32_16x16x32_bf16 a[36:39], v[196:199], v[124:127], a[36:39]
s_add_u32 s57, s86, 1050624
s_add_u32 m0, s56, 137216
s_nop 0
buffer_load_dwordx4 v16, s[12:15], s57 offen lds
v_mfma_f32_16x16x32_bf16 a[72:75], v[196:199], v[244:247], a[72:75]
ds_read_b64_tr_b16 v[192:193], v11 offset:20480
ds_read_b64_tr_b16 v[194:195], v11 offset:20992
s_waitcnt lgkmcnt(12)
v_mfma_f32_16x16x32_bf16 a[4:7], v[200:203], v[52:55], a[4:7]
v_mfma_f32_16x16x32_bf16 a[40:43], v[200:203], v[124:127], a[40:43]
v_mfma_f32_16x16x32_bf16 a[76:79], v[200:203], v[244:247], a[76:79]
ds_read_b64_tr_b16 v[196:197], v8 offset:32768
ds_read_b64_tr_b16 v[198:199], v8 offset:33280
s_waitcnt lgkmcnt(12)
v_mfma_f32_16x16x32_bf16 a[8:11], v[204:207], v[52:55], a[8:11]
v_mfma_f32_16x16x32_bf16 a[44:47], v[204:207], v[124:127], a[44:47]
v_mfma_f32_16x16x32_bf16 a[80:83], v[204:207], v[244:247], a[80:83]
s_waitcnt vmcnt(13)
s_barrier
v_add_u32 v8, 36864, v8
v_add_u32 v9, 36864, v9
v_add_u32 v10, 36864, v10
v_add_u32 v11, 36864, v11
ds_read_b64_tr_b16 v[200:201], v8 offset:0
ds_read_b64_tr_b16 v[202:203], v8 offset:512
s_waitcnt lgkmcnt(12)
v_mfma_f32_16x16x32_bf16 a[12:15], v[176:179], v[52:55], a[12:15]
v_mfma_f32_16x16x32_bf16 a[48:51], v[176:179], v[124:127], a[48:51]
v_mfma_f32_16x16x32_bf16 a[84:87], v[176:179], v[244:247], a[84:87]
ds_read_b64_tr_b16 v[204:205], v9 offset:0
ds_read_b64_tr_b16 v[206:207], v9 offset:512
s_waitcnt lgkmcnt(12)
v_mfma_f32_16x16x32_bf16 a[16:19], v[180:183], v[52:55], a[16:19]
v_mfma_f32_16x16x32_bf16 a[52:55], v[180:183], v[124:127], a[52:55]
v_mfma_f32_16x16x32_bf16 a[88:91], v[180:183], v[244:247], a[88:91]
ds_read_b64_tr_b16 v[176:177], v10 offset:0
ds_read_b64_tr_b16 v[178:179], v10 offset:512
s_waitcnt lgkmcnt(12)
v_mfma_f32_16x16x32_bf16 a[20:23], v[184:187], v[52:55], a[20:23]
v_mfma_f32_16x16x32_bf16 a[56:59], v[184:187], v[124:127], a[56:59]
v_mfma_f32_16x16x32_bf16 a[92:95], v[184:187], v[244:247], a[92:95]
ds_read_b64_tr_b16 v[180:181], v11 offset:0
ds_read_b64_tr_b16 v[182:183], v11 offset:512
s_waitcnt lgkmcnt(12)
v_mfma_f32_16x16x32_bf16 a[24:27], v[188:191], v[52:55], a[24:27]
v_mfma_f32_16x16x32_bf16 a[60:63], v[188:191], v[124:127], a[60:63]
v_mfma_f32_16x16x32_bf16 a[96:99], v[188:191], v[244:247], a[96:99]
ds_read_b64_tr_b16 v[184:185], v8 offset:12288
ds_read_b64_tr_b16 v[186:187], v8 offset:12800
s_waitcnt lgkmcnt(12)
v_mfma_f32_16x16x32_bf16 a[28:31], v[192:195], v[52:55], a[28:31]
v_mfma_f32_16x16x32_bf16 a[64:67], v[192:195], v[124:127], a[64:67]
v_mfma_f32_16x16x32_bf16 a[100:103], v[192:195], v[244:247], a[100:103]
ds_read_b64_tr_b16 v[188:189], v9 offset:12288
ds_read_b64_tr_b16 v[190:191], v9 offset:12800
s_waitcnt lgkmcnt(12)
v_mfma_f32_16x16x32_bf16 a[32:35], v[196:199], v[52:55], a[32:35]
v_mfma_f32_16x16x32_bf16 a[68:71], v[196:199], v[124:127], a[68:71]
v_mfma_f32_16x16x32_bf16 a[104:107], v[196:199], v[244:247], a[104:107]
s_mov_b64 exec, s[76:77]
v_mov_b32 v240, v60
v_mov_b32 v241, v61
v_mov_b32 v242, v62
v_mov_b32 v243, v63
v_mov_b32_dpp v60, v56 row_ror:8 row_mask:0xf bank_mask:0x3
v_mov_b32_dpp v61, v57 row_ror:8 row_mask:0xf bank_mask:0x3
v_mov_b32_dpp v62, v58 row_ror:8 row_mask:0xf bank_mask:0x3
v_mov_b32_dpp v63, v59 row_ror:8 row_mask:0xf bank_mask:0x3
v_mov_b32_dpp v56, v240 row_ror:8 row_mask:0xf bank_mask:0xc
v_mov_b32_dpp v57, v241 row_ror:8 row_mask:0xf bank_mask:0xc
v_mov_b32_dpp v58, v242 row_ror:8 row_mask:0xf bank_mask:0xc
v_mov_b32_dpp v59, v243 row_ror:8 row_mask:0xf bank_mask:0xc
v_mov_b32 v240, v132
v_mov_b32 v241, v133
v_mov_b32 v242, v134
v_mov_b32 v243, v135
v_mov_b32_dpp v132, v128 row_ror:8 row_mask:0xf bank_mask:0x3
v_mov_b32_dpp v133, v129 row_ror:8 row_mask:0xf bank_mask:0x3
v_mov_b32_dpp v134, v130 row_ror:8 row_mask:0xf bank_mask:0x3
v_mov_b32_dpp v135, v131 row_ror:8 row_mask:0xf bank_mask:0x3
v_mov_b32_dpp v128, v240 row_ror:8 row_mask:0xf bank_mask:0xc
v_mov_b32_dpp v129, v241 row_ror:8 row_mask:0xf bank_mask:0xc
v_mov_b32_dpp v130, v242 row_ror:8 row_mask:0xf bank_mask:0xc
v_mov_b32_dpp v131, v243 row_ror:8 row_mask:0xf bank_mask:0xc
v_mov_b32 v240, v68
v_mov_b32 v241, v69
v_mov_b32 v242, v70
v_mov_b32 v243, v71
v_mov_b32_dpp v68, v64 row_ror:8 row_mask:0xf bank_mask:0x3
v_mov_b32_dpp v69, v65 row_ror:8 row_mask:0xf bank_mask:0x3
v_mov_b32_dpp v70, v66 row_ror:8 row_mask:0xf bank_mask:0x3
v_mov_b32_dpp v71, v67 row_ror:8 row_mask:0xf bank_mask:0x3
v_mov_b32_dpp v64, v240 row_ror:8 row_mask:0xf bank_mask:0xc
v_mov_b32_dpp v65, v241 row_ror:8 row_mask:0xf bank_mask:0xc
v_mov_b32_dpp v66, v242 row_ror:8 row_mask:0xf bank_mask:0xc
v_mov_b32_dpp v67, v243 row_ror:8 row_mask:0xf bank_mask:0xc
v_mov_b32 v240, v140
v_mov_b32 v241, v141
v_mov_b32 v242, v142
v_mov_b32 v243, v143
v_mov_b32_dpp v140, v136 row_ror:8 row_mask:0xf bank_mask:0x3
v_mov_b32_dpp v141, v137 row_ror:8 row_mask:0xf bank_mask:0x3
v_mov_b32_dpp v142, v138 row_ror:8 row_mask:0xf bank_mask:0x3
v_mov_b32_dpp v143, v139 row_ror:8 row_mask:0xf bank_mask:0x3
v_mov_b32_dpp v136, v240 row_ror:8 row_mask:0xf bank_mask:0xc
v_mov_b32_dpp v137, v241 row_ror:8 row_mask:0xf bank_mask:0xc
v_mov_b32_dpp v138, v242 row_ror:8 row_mask:0xf bank_mask:0xc
v_mov_b32_dpp v139, v243 row_ror:8 row_mask:0xf bank_mask:0xc
s_mov_b64 exec, -1
ds_read_b64_tr_b16 v[192:193], v10 offset:12288
ds_read_b64_tr_b16 v[194:195], v10 offset:12800
s_waitcnt lgkmcnt(12)
v_mfma_f32_16x16x32_bf16 a[0:3], v[200:203], v[56:59], a[0:3]
s_mul_i32 s78, s73, 12
s_add_u32 s78, s78, s74
buffer_load_dwordx4 v[80:83], v27, s[8:11], s78 offen
v_mfma_f32_16x16x32_bf16 a[36:39], v[200:203], v[128:131], a[36:39]
v_mfma_f32_16x16x32_bf16 a[72:75], v[200:203], v[244:247], a[72:75]
ds_read_b64_tr_b16 v[196:197], v11 offset:12288
ds_read_b64_tr_b16 v[198:199], v11 offset:12800
s_waitcnt lgkmcnt(12)
v_mfma_f32_16x16x32_bf16 a[4:7], v[204:207], v[56:59], a[4:7]
v_mfma_f32_16x16x32_bf16 a[40:43], v[204:207], v[128:131], a[40:43]
s_mul_i32 s78, s73, 12
s_add_u32 s78, s78, s74
s_add_u32 s78, s78, s79
buffer_load_dwordx4 v[84:87], v27, s[8:11], s78 offen
v_mfma_f32_16x16x32_bf16 a[76:79], v[204:207], v[244:247], a[76:79]
ds_read_b64_tr_b16 v[200:201], v8 offset:24576
ds_read_b64_tr_b16 v[202:203], v8 offset:25088
s_waitcnt lgkmcnt(12)
v_mfma_f32_16x16x32_bf16 a[8:11], v[176:179], v[56:59], a[8:11]
v_mfma_f32_16x16x32_bf16 a[44:47], v[176:179], v[128:131], a[44:47]
s_mul_i32 s78, s73, 12
s_add_u32 s78, s78, s74
s_add_u32 s78, s78, s75
buffer_load_dwordx4 v[152:155], v27, s[8:11], s78 offen
v_mfma_f32_16x16x32_bf16 a[80:83], v[176:179], v[244:247], a[80:83]
ds_read_b64_tr_b16 v[204:205], v8 offset:4096
ds_read_b64_tr_b16 v[206:207], v8 offset:4608
s_waitcnt lgkmcnt(12)
v_mfma_f32_16x16x32_bf16 a[12:15], v[180:183], v[56:59], a[12:15]
v_mfma_f32_16x16x32_bf16 a[48:51], v[180:183], v[128:131], a[48:51]
v_mfma_f32_16x16x32_bf16 a[84:87], v[180:183], v[244:247], a[84:87]
ds_read_b64_tr_b16 v[176:177], v9 offset:4096
ds_read_b64_tr_b16 v[178:179], v9 offset:4608
s_waitcnt lgkmcnt(12)
v_mfma_f32_16x16x32_bf16 a[16:19], v[184:187], v[56:59], a[16:19]
s_mul_i32 s78, s73, 12
s_add_u32 s78, s78, s74
s_add_u32 s78, s78, s75
s_add_u32 s78, s78, s79
buffer_load_dwordx4 v[156:159], v27, s[8:11], s78 offen
v_mfma_f32_16x16x32_bf16 a[52:55], v[184:187], v[128:131], a[52:55]
v_mfma_f32_16x16x32_bf16 a[88:91], v[184:187], v[244:247], a[88:91]
ds_read_b64_tr_b16 v[180:181], v10 offset:4096
ds_read_b64_tr_b16 v[182:183], v10 offset:4608
s_waitcnt lgkmcnt(12)
v_mfma_f32_16x16x32_bf16 a[20:23], v[188:191], v[56:59], a[20:23]
s_mul_i32 s78, s73, 14
s_add_u32 s78, s78, s74
buffer_load_dwordx4 v[88:91], v27, s[8:11], s78 offen
v_mfma_f32_16x16x32_bf16 a[56:59], v[188:191], v[128:131], a[56:59]
v_mfma_f32_16x16x32_bf16 a[92:95], v[188:191], v[244:247], a[92:95]
ds_read_b64_tr_b16 v[184:185], v11 offset:4096
ds_read_b64_tr_b16 v[186:187], v11 offset:4608
s_waitcnt lgkmcnt(12)
v_mfma_f32_16x16x32_bf16 a[24:27], v[192:195], v[56:59], a[24:27]
s_mul_i32 s78, s73, 14
s_add_u32 s78, s78, s74
s_add_u32 s78, s78, s79
buffer_load_dwordx4 v[92:95], v27, s[8:11], s78 offen
v_mfma_f32_16x16x32_bf16 a[60:63], v[192:195], v[128:131], a[60:63]
v_mfma_f32_16x16x32_bf16 a[96:99], v[192:195], v[244:247], a[96:99]
ds_read_b64_tr_b16 v[188:189], v8 offset:16384
ds_read_b64_tr_b16 v[190:191], v8 offset:16896
s_waitcnt lgkmcnt(12)
v_mfma_f32_16x16x32_bf16 a[28:31], v[196:199], v[56:59], a[28:31]
v_mfma_f32_16x16x32_bf16 a[64:67], v[196:199], v[128:131], a[64:67]
s_mul_i32 s78, s73, 14
s_add_u32 s78, s78, s74
s_add_u32 s78, s78, s75
buffer_load_dwordx4 v[160:163], v27, s[8:11], s78 offen
v_mfma_f32_16x16x32_bf16 a[100:103], v[196:199], v[244:247], a[100:103]
ds_read_b64_tr_b16 v[192:193], v9 offset:16384
ds_read_b64_tr_b16 v[194:195], v9 offset:16896
s_waitcnt lgkmcnt(12)
v_mfma_f32_16x16x32_bf16 a[32:35], v[200:203], v[56:59], a[32:35]
v_mfma_f32_16x16x32_bf16 a[68:71], v[200:203], v[128:131], a[68:71]
s_mul_i32 s78, s73, 14
s_add_u32 s78, s78, s74
s_add_u32 s78, s78, s75
s_add_u32 s78, s78, s79
buffer_load_dwordx4 v[164:167], v27, s[8:11], s78 offen
v_mfma_f32_16x16x32_bf16 a[104:107], v[200:203], v[244:247], a[104:107]
ds_read_b64_tr_b16 v[196:197], v10 offset:16384
ds_read_b64_tr_b16 v[198:199], v10 offset:16896
s_waitcnt lgkmcnt(12)
v_mfma_f32_16x16x32_bf16 a[0:3], v[204:207], v[60:63], a[0:3]
v_mfma_f32_16x16x32_bf16 a[36:39], v[204:207], v[132:135], a[36:39]
s_add_u32 s57, s84, 1327104
s_add_u32 m0, s56, 0
s_nop 0
buffer_load_dwordx4 v16, s[12:15], s57 offen lds
v_mfma_f32_16x16x32_bf16 a[72:75], v[204:207], v[244:247], a[72:75]
ds_read_b64_tr_b16 v[200:201], v11 offset:16384
ds_read_b64_tr_b16 v[202:203], v11 offset:16896
s_waitcnt lgkmcnt(12)
v_mfma_f32_16x16x32_bf16 a[4:7], v[176:179], v[60:63], a[4:7]
v_mfma_f32_16x16x32_bf16 a[40:43], v[176:179], v[132:135], a[40:43]
v_mfma_f32_16x16x32_bf16 a[76:79], v[176:179], v[244:247], a[76:79]
ds_read_b64_tr_b16 v[204:205], v8 offset:28672
ds_read_b64_tr_b16 v[206:207], v8 offset:29184
s_waitcnt lgkmcnt(12)
v_mfma_f32_16x16x32_bf16 a[8:11], v[180:183], v[60:63], a[8:11]
s_add_u32 s57, s85, 1327104
s_add_u32 m0, s56, 12288
s_nop 0
buffer_load_dwordx4 v16, s[12:15], s57 offen lds
v_mfma_f32_16x16x32_bf16 a[44:47], v[180:183], v[132:135], a[44:47]
v_mfma_f32_16x16x32_bf16 a[80:83], v[180:183], v[244:247], a[80:83]
ds_read_b64_tr_b16 v[176:177], v8 offset:8192
ds_read_b64_tr_b16 v[178:179], v8 offset:8704
s_waitcnt lgkmcnt(12)
v_mfma_f32_16x16x32_bf16 a[12:15], v[184:187], v[60:63], a[12:15]
s_add_u32 s57, s86, 1327104
s_add_u32 m0, s56, 24576
s_nop 0
buffer_load_dwordx4 v16, s[12:15], s57 offen lds
v_mfma_f32_16x16x32_bf16 a[48:51], v[184:187], v[132:135], a[48:51]
v_mfma_f32_16x16x32_bf16 a[84:87], v[184:187], v[244:247], a[84:87]
ds_read_b64_tr_b16 v[180:181], v9 offset:8192
ds_read_b64_tr_b16 v[182:183], v9 offset:8704
s_waitcnt lgkmcnt(12)
v_mfma_f32_16x16x32_bf16 a[16:19], v[188:191], v[60:63], a[16:19]
s_add_u32 s57, s84, 1354752
s_add_u32 m0, s56, 1024
s_nop 0
buffer_load_dwordx4 v17, s[12:15], s57 offen lds
v_mfma_f32_16x16x32_bf16 a[52:55], v[188:191], v[132:135], a[52:55]
v_mfma_f32_16x16x32_bf16 a[88:91], v[188:191], v[244:247], a[88:91]
ds_read_b64_tr_b16 v[184:185], v10 offset:8192
ds_read_b64_tr_b16 v[186:187], v10 offset:8704
s_waitcnt lgkmcnt(12)
v_mfma_f32_16x16x32_bf16 a[20:23], v[192:195], v[60:63], a[20:23]
v_mfma_f32_16x16x32_bf16 a[56:59], v[192:195], v[132:135], a[56:59]
s_add_u32 s57, s85, 1354752
s_add_u32 m0, s56, 13312
s_nop 0
buffer_load_dwordx4 v17, s[12:15], s57 offen lds
v_mfma_f32_16x16x32_bf16 a[92:95], v[192:195], v[244:247], a[92:95]
ds_read_b64_tr_b16 v[188:189], v11 offset:8192
ds_read_b64_tr_b16 v[190:191], v11 offset:8704
s_waitcnt lgkmcnt(12)
v_mfma_f32_16x16x32_bf16 a[24:27], v[196:199], v[60:63], a[24:27]
v_mfma_f32_16x16x32_bf16 a[60:63], v[196:199], v[132:135], a[60:63]
s_add_u32 s57, s86, 1354752
s_add_u32 m0, s56, 25600
s_nop 0
buffer_load_dwordx4 v17, s[12:15], s57 offen lds
v_mfma_f32_16x16x32_bf16 a[96:99], v[196:199], v[244:247], a[96:99]
ds_read_b64_tr_b16 v[192:193], v8 offset:20480
ds_read_b64_tr_b16 v[194:195], v8 offset:20992
s_waitcnt lgkmcnt(12)
v_mfma_f32_16x16x32_bf16 a[28:31], v[200:203], v[60:63], a[28:31]
v_mfma_f32_16x16x32_bf16 a[64:67], v[200:203], v[132:135], a[64:67]
s_add_u32 s57, s84, 1382400
s_add_u32 m0, s56, 2048
s_nop 0
buffer_load_dwordx4 v16, s[12:15], s57 offen lds
v_mfma_f32_16x16x32_bf16 a[100:103], v[200:203], v[244:247], a[100:103]
ds_read_b64_tr_b16 v[196:197], v9 offset:20480
ds_read_b64_tr_b16 v[198:199], v9 offset:20992
s_waitcnt lgkmcnt(12)
v_mfma_f32_16x16x32_bf16 a[32:35], v[204:207], v[60:63], a[32:35]
v_mfma_f32_16x16x32_bf16 a[68:71], v[204:207], v[132:135], a[68:71]
v_mfma_f32_16x16x32_bf16 a[104:107], v[204:207], v[244:247], a[104:107]
ds_read_b64_tr_b16 v[200:201], v10 offset:20480
ds_read_b64_tr_b16 v[202:203], v10 offset:20992
s_waitcnt lgkmcnt(12)
v_mfma_f32_16x16x32_bf16 a[0:3], v[176:179], v[64:67], a[0:3]
s_add_u32 s57, s85, 1382400
s_add_u32 m0, s56, 14336
s_nop 0
buffer_load_dwordx4 v16, s[12:15], s57 offen lds
v_mfma_f32_16x16x32_bf16 a[36:39], v[176:179], v[136:139], a[36:39]
v_mfma_f32_16x16x32_bf16 a[72:75], v[176:179], v[244:247], a[72:75]
ds_read_b64_tr_b16 v[204:205], v11 offset:20480
ds_read_b64_tr_b16 v[206:207], v11 offset:20992
s_waitcnt lgkmcnt(12)
v_mfma_f32_16x16x32_bf16 a[4:7], v[180:183], v[64:67], a[4:7]
s_add_u32 s57, s86, 1382400
s_add_u32 m0, s56, 26624
s_nop 0
buffer_load_dwordx4 v16, s[12:15], s57 offen lds
v_mfma_f32_16x16x32_bf16 a[40:43], v[180:183], v[136:139], a[40:43]
v_mfma_f32_16x16x32_bf16 a[76:79], v[180:183], v[244:247], a[76:79]
ds_read_b64_tr_b16 v[176:177], v8 offset:32768
ds_read_b64_tr_b16 v[178:179], v8 offset:33280
s_waitcnt lgkmcnt(12)
v_mfma_f32_16x16x32_bf16 a[8:11], v[184:187], v[64:67], a[8:11]
v_mfma_f32_16x16x32_bf16 a[44:47], v[184:187], v[136:139], a[44:47]
v_mfma_f32_16x16x32_bf16 a[80:83], v[184:187], v[244:247], a[80:83]
s_waitcnt vmcnt(17)
s_barrier
v_add_u32 v8, 36864, v8
v_add_u32 v9, 36864, v9
v_add_u32 v10, 36864, v10
v_add_u32 v11, 36864, v11
ds_read_b64_tr_b16 v[180:181], v8 offset:0
ds_read_b64_tr_b16 v[182:183], v8 offset:512
s_waitcnt lgkmcnt(12)
v_mfma_f32_16x16x32_bf16 a[12:15], v[188:191], v[64:67], a[12:15]
v_mfma_f32_16x16x32_bf16 a[48:51], v[188:191], v[136:139], a[48:51]
v_mfma_f32_16x16x32_bf16 a[84:87], v[188:191], v[244:247], a[84:87]
ds_read_b64_tr_b16 v[184:185], v9 offset:0
ds_read_b64_tr_b16 v[186:187], v9 offset:512
s_waitcnt lgkmcnt(12)
v_mfma_f32_16x16x32_bf16 a[16:19], v[192:195], v[64:67], a[16:19]
v_mfma_f32_16x16x32_bf16 a[52:55], v[192:195], v[136:139], a[52:55]
v_mfma_f32_16x16x32_bf16 a[88:91], v[192:195], v[244:247], a[88:91]
ds_read_b64_tr_b16 v[188:189], v10 offset:0
ds_read_b64_tr_b16 v[190:191], v10 offset:512
s_waitcnt lgkmcnt(12)
v_mfma_f32_16x16x32_bf16 a[20:23], v[196:199], v[64:67], a[20:23]
v_mfma_f32_16x16x32_bf16 a[56:59], v[196:199], v[136:139], a[56:59]
v_mfma_f32_16x16x32_bf16 a[92:95], v[196:199], v[244:247], a[92:95]
ds_read_b64_tr_b16 v[192:193], v11 offset:0
ds_read_b64_tr_b16 v[194:195], v11 offset:512
s_waitcnt lgkmcnt(12)
v_mfma_f32_16x16x32_bf16 a[24:27], v[200:203], v[64:67], a[24:27]
v_mfma_f32_16x16x32_bf16 a[60:63], v[200:203], v[136:139], a[60:63]
v_mfma_f32_16x16x32_bf16 a[96:99], v[200:203], v[244:247], a[96:99]
ds_read_b64_tr_b16 v[196:197], v8 offset:12288
ds_read_b64_tr_b16 v[198:199], v8 offset:12800
s_waitcnt lgkmcnt(12)
v_mfma_f32_16x16x32_bf16 a[28:31], v[204:207], v[64:67], a[28:31]
v_mfma_f32_16x16x32_bf16 a[64:67], v[204:207], v[136:139], a[64:67]
v_mfma_f32_16x16x32_bf16 a[100:103], v[204:207], v[244:247], a[100:103]
ds_read_b64_tr_b16 v[200:201], v9 offset:12288
ds_read_b64_tr_b16 v[202:203], v9 offset:12800
s_waitcnt lgkmcnt(12)
v_mfma_f32_16x16x32_bf16 a[32:35], v[176:179], v[64:67], a[32:35]
v_mfma_f32_16x16x32_bf16 a[68:71], v[176:179], v[136:139], a[68:71]
v_mfma_f32_16x16x32_bf16 a[104:107], v[176:179], v[244:247], a[104:107]
s_mov_b64 exec, s[76:77]
v_mov_b32 v240, v76
v_mov_b32 v241, v77
v_mov_b32 v242, v78
v_mov_b32 v243, v79
v_mov_b32_dpp v76, v72 row_ror:8 row_mask:0xf bank_mask:0x3
v_mov_b32_dpp v77, v73 row_ror:8 row_mask:0xf bank_mask:0x3
v_mov_b32_dpp v78, v74 row_ror:8 row_mask:0xf bank_mask:0x3
v_mov_b32_dpp v79, v75 row_ror:8 row_mask:0xf bank_mask:0x3
v_mov_b32_dpp v72, v240 row_ror:8 row_mask:0xf bank_mask:0xc
v_mov_b32_dpp v73, v241 row_ror:8 row_mask:0xf bank_mask:0xc
v_mov_b32_dpp v74, v242 row_ror:8 row_mask:0xf bank_mask:0xc
v_mov_b32_dpp v75, v243 row_ror:8 row_mask:0xf bank_mask:0xc
v_mov_b32 v240, v148
v_mov_b32 v241, v149
v_mov_b32 v242, v150
v_mov_b32 v243, v151
v_mov_b32_dpp v148, v144 row_ror:8 row_mask:0xf bank_mask:0x3
v_mov_b32_dpp v149, v145 row_ror:8 row_mask:0xf bank_mask:0x3
v_mov_b32_dpp v150, v146 row_ror:8 row_mask:0xf bank_mask:0x3
v_mov_b32_dpp v151, v147 row_ror:8 row_mask:0xf bank_mask:0x3
v_mov_b32_dpp v144, v240 row_ror:8 row_mask:0xf bank_mask:0xc
v_mov_b32_dpp v145, v241 row_ror:8 row_mask:0xf bank_mask:0xc
v_mov_b32_dpp v146, v242 row_ror:8 row_mask:0xf bank_mask:0xc
v_mov_b32_dpp v147, v243 row_ror:8 row_mask:0xf bank_mask:0xc
s_mov_b64 exec, -1
ds_read_b64_tr_b16 v[204:205], v10 offset:12288
ds_read_b64_tr_b16 v[206:207], v10 offset:12800
s_waitcnt lgkmcnt(12)
v_mfma_f32_16x16x32_bf16 a[0:3], v[180:183], v[68:71], a[0:3]
s_mul_i32 s78, s73, 16
s_add_u32 s78, s78, s74
buffer_load_dwordx4 v[96:99], v27, s[8:11], s78 offen
v_mfma_f32_16x16x32_bf16 a[36:39], v[180:183], v[140:143], a[36:39]
v_mfma_f32_16x16x32_bf16 a[72:75], v[180:183], v[244:247], a[72:75]
ds_read_b64_tr_b16 v[176:177], v11 offset:12288
ds_read_b64_tr_b16 v[178:179], v11 offset:12800
s_waitcnt lgkmcnt(12)
v_mfma_f32_16x16x32_bf16 a[4:7], v[184:187], v[68:71], a[4:7]
v_mfma_f32_16x16x32_bf16 a[40:43], v[184:187], v[140:143], a[40:43]
v_mfma_f32_16x16x32_bf16 a[76:79], v[184:187], v[244:247], a[76:79]
ds_read_b64_tr_b16 v[180:181], v8 offset:24576
ds_read_b64_tr_b16 v[182:183], v8 offset:25088
s_waitcnt lgkmcnt(12)
v_mfma_f32_16x16x32_bf16 a[8:11], v[188:191], v[68:71], a[8:11]
s_mul_i32 s78, s73, 16
s_add_u32 s78, s78, s74
s_add_u32 s78, s78, s79
buffer_load_dwordx4 v[100:103], v27, s[8:11], s78 offen
v_mfma_f32_16x16x32_bf16 a[44:47], v[188:191], v[140:143], a[44:47]
v_mfma_f32_16x16x32_bf16 a[80:83], v[188:191], v[244:247], a[80:83]
ds_read_b64_tr_b16 v[184:185], v8 offset:4096
ds_read_b64_tr_b16 v[186:187], v8 offset:4608
s_waitcnt lgkmcnt(12)
v_mfma_f32_16x16x32_bf16 a[12:15], v[192:195], v[68:71], a[12:15]
v_mfma_f32_16x16x32_bf16 a[48:51], v[192:195], v[140:143], a[48:51]
s_mul_i32 s78, s73, 16
s_add_u32 s78, s78, s74
s_add_u32 s78, s78, s75
buffer_load_dwordx4 v[168:171], v27, s[8:11], s78 offen
v_mfma_f32_16x16x32_bf16 a[84:87], v[192:195], v[244:247], a[84:87]
ds_read_b64_tr_b16 v[188:189], v9 offset:4096
ds_read_b64_tr_b16 v[190:191], v9 offset:4608
s_waitcnt lgkmcnt(12)
v_mfma_f32_16x16x32_bf16 a[16:19], v[196:199], v[68:71], a[16:19]
v_mfma_f32_16x16x32_bf16 a[52:55], v[196:199], v[140:143], a[52:55]
v_mfma_f32_16x16x32_bf16 a[88:91], v[196:199], v[244:247], a[88:91]
ds_read_b64_tr_b16 v[192:193], v10 offset:4096
ds_read_b64_tr_b16 v[194:195], v10 offset:4608
s_waitcnt lgkmcnt(12)
v_mfma_f32_16x16x32_bf16 a[20:23], v[200:203], v[68:71], a[20:23]
s_mul_i32 s78, s73, 16
s_add_u32 s78, s78, s74
s_add_u32 s78, s78, s75
s_add_u32 s78, s78, s79
buffer_load_dwordx4 v[172:175], v27, s[8:11], s78 offen
v_mfma_f32_16x16x32_bf16 a[56:59], v[200:203], v[140:143], a[56:59]
v_mfma_f32_16x16x32_bf16 a[92:95], v[200:203], v[244:247], a[92:95]
ds_read_b64_tr_b16 v[196:197], v11 offset:4096
ds_read_b64_tr_b16 v[198:199], v11 offset:4608
s_waitcnt lgkmcnt(12)
v_mfma_f32_16x16x32_bf16 a[24:27], v[204:207], v[68:71], a[24:27]
v_mfma_f32_16x16x32_bf16 a[60:63], v[204:207], v[140:143], a[60:63]
s_add_u32 s57, s84, 1658880
s_add_u32 m0, s56, 36864
s_nop 0
buffer_load_dwordx4 v16, s[12:15], s57 offen lds
v_mfma_f32_16x16x32_bf16 a[96:99], v[204:207], v[244:247], a[96:99]
ds_read_b64_tr_b16 v[200:201], v8 offset:16384
ds_read_b64_tr_b16 v[202:203], v8 offset:16896
s_waitcnt lgkmcnt(12)
v_mfma_f32_16x16x32_bf16 a[28:31], v[176:179], v[68:71], a[28:31]
v_mfma_f32_16x16x32_bf16 a[64:67], v[176:179], v[140:143], a[64:67]
v_mfma_f32_16x16x32_bf16 a[100:103], v[176:179], v[244:247], a[100:103]
ds_read_b64_tr_b16 v[204:205], v9 offset:16384
ds_read_b64_tr_b16 v[206:207], v9 offset:16896
s_waitcnt lgkmcnt(12)
v_mfma_f32_16x16x32_bf16 a[32:35], v[180:183], v[68:71], a[32:35]
s_add_u32 s57, s85, 1658880
s_add_u32 m0, s56, 49152
s_nop 0
buffer_load_dwordx4 v16, s[12:15], s57 offen lds
v_mfma_f32_16x16x32_bf16 a[68:71], v[180:183], v[140:143], a[68:71]
v_mfma_f32_16x16x32_bf16 a[104:107], v[180:183], v[244:247], a[104:107]
ds_read_b64_tr_b16 v[176:177], v10 offset:16384
ds_read_b64_tr_b16 v[178:179], v10 offset:16896
s_waitcnt lgkmcnt(12)
v_mfma_f32_16x16x32_bf16 a[0:3], v[184:187], v[72:75], a[0:3]
v_mfma_f32_16x16x32_bf16 a[36:39], v[184:187], v[144:147], a[36:39]
s_add_u32 s57, s86, 1658880
s_add_u32 m0, s56, 61440
s_nop 0
buffer_load_dwordx4 v16, s[12:15], s57 offen lds
v_mfma_f32_16x16x32_bf16 a[72:75], v[184:187], v[244:247], a[72:75]
ds_read_b64_tr_b16 v[180:181], v11 offset:16384
ds_read_b64_tr_b16 v[182:183], v11 offset:16896
s_waitcnt lgkmcnt(12)
v_mfma_f32_16x16x32_bf16 a[4:7], v[188:191], v[72:75], a[4:7]
v_mfma_f32_16x16x32_bf16 a[40:43], v[188:191], v[144:147], a[40:43]
v_mfma_f32_16x16x32_bf16 a[76:79], v[188:191], v[244:247], a[76:79]
ds_read_b64_tr_b16 v[184:185], v8 offset:28672
ds_read_b64_tr_b16 v[186:187], v8 offset:29184
s_waitcnt lgkmcnt(12)
v_mfma_f32_16x16x32_bf16 a[8:11], v[192:195], v[72:75], a[8:11]
s_add_u32 s57, s84, 1686528
s_add_u32 m0, s56, 37888
s_nop 0
buffer_load_dwordx4 v17, s[12:15], s57 offen lds
v_mfma_f32_16x16x32_bf16 a[44:47], v[192:195], v[144:147], a[44:47]
v_mfma_f32_16x16x32_bf16 a[80:83], v[192:195], v[244:247], a[80:83]
ds_read_b64_tr_b16 v[188:189], v8 offset:8192
ds_read_b64_tr_b16 v[190:191], v8 offset:8704
s_waitcnt lgkmcnt(12)
v_mfma_f32_16x16x32_bf16 a[12:15], v[196:199], v[72:75], a[12:15]
v_mfma_f32_16x16x32_bf16 a[48:51], v[196:199], v[144:147], a[48:51]
s_add_u32 s57, s85, 1686528
s_add_u32 m0, s56, 50176
s_nop 0
buffer_load_dwordx4 v17, s[12:15], s57 offen lds
v_mfma_f32_16x16x32_bf16 a[84:87], v[196:199], v[244:247], a[84:87]
ds_read_b64_tr_b16 v[192:193], v9 offset:8192
ds_read_b64_tr_b16 v[194:195], v9 offset:8704
s_waitcnt lgkmcnt(12)
v_mfma_f32_16x16x32_bf16 a[16:19], v[200:203], v[72:75], a[16:19]
v_mfma_f32_16x16x32_bf16 a[52:55], v[200:203], v[144:147], a[52:55]
v_mfma_f32_16x16x32_bf16 a[88:91], v[200:203], v[244:247], a[88:91]
ds_read_b64_tr_b16 v[196:197], v10 offset:8192
ds_read_b64_tr_b16 v[198:199], v10 offset:8704
s_waitcnt lgkmcnt(12)
v_mfma_f32_16x16x32_bf16 a[20:23], v[204:207], v[72:75], a[20:23]
s_add_u32 s57, s86, 1686528
s_add_u32 m0, s56, 62464
s_nop 0
buffer_load_dwordx4 v17, s[12:15], s57 offen lds
v_mfma_f32_16x16x32_bf16 a[56:59], v[204:207], v[144:147], a[56:59]
v_mfma_f32_16x16x32_bf16 a[92:95], v[204:207], v[244:247], a[92:95]
ds_read_b64_tr_b16 v[200:201], v11 offset:8192
ds_read_b64_tr_b16 v[202:203], v11 offset:8704
s_waitcnt lgkmcnt(12)
v_mfma_f32_16x16x32_bf16 a[24:27], v[176:179], v[72:75], a[24:27]
v_mfma_f32_16x16x32_bf16 a[60:63], v[176:179], v[144:147], a[60:63]
s_add_u32 s57, s84, 1714176
s_add_u32 m0, s56, 38912
s_nop 0
buffer_load_dwordx4 v16, s[12:15], s57 offen lds
v_mfma_f32_16x16x32_bf16 a[96:99], v[176:179], v[244:247], a[96:99]
ds_read_b64_tr_b16 v[204:205], v8 offset:20480
ds_read_b64_tr_b16 v[206:207], v8 offset:20992
s_waitcnt lgkmcnt(12)
v_mfma_f32_16x16x32_bf16 a[28:31], v[180:183], v[72:75], a[28:31]
v_mfma_f32_16x16x32_bf16 a[64:67], v[180:183], v[144:147], a[64:67]
v_mfma_f32_16x16x32_bf16 a[100:103], v[180:183], v[244:247], a[100:103]
ds_read_b64_tr_b16 v[176:177], v9 offset:20480
ds_read_b64_tr_b16 v[178:179], v9 offset:20992
s_waitcnt lgkmcnt(12)
v_mfma_f32_16x16x32_bf16 a[32:35], v[184:187], v[72:75], a[32:35]
s_add_u32 s57, s85, 1714176
s_add_u32 m0, s56, 51200
s_nop 0
buffer_load_dwordx4 v16, s[12:15], s57 offen lds
v_mfma_f32_16x16x32_bf16 a[68:71], v[184:187], v[144:147], a[68:71]
v_mfma_f32_16x16x32_bf16 a[104:107], v[184:187], v[244:247], a[104:107]
ds_read_b64_tr_b16 v[180:181], v10 offset:20480
ds_read_b64_tr_b16 v[182:183], v10 offset:20992
s_waitcnt lgkmcnt(12)
v_mfma_f32_16x16x32_bf16 a[0:3], v[188:191], v[76:79], a[0:3]
v_mfma_f32_16x16x32_bf16 a[36:39], v[188:191], v[148:151], a[36:39]
s_add_u32 s57, s86, 1714176
s_add_u32 m0, s56, 63488
s_nop 0
buffer_load_dwordx4 v16, s[12:15], s57 offen lds
v_mfma_f32_16x16x32_bf16 a[72:75], v[188:191], v[244:247], a[72:75]
ds_read_b64_tr_b16 v[184:185], v11 offset:20480
ds_read_b64_tr_b16 v[186:187], v11 offset:20992
s_waitcnt lgkmcnt(12)
v_mfma_f32_16x16x32_bf16 a[4:7], v[192:195], v[76:79], a[4:7]
v_mfma_f32_16x16x32_bf16 a[40:43], v[192:195], v[148:151], a[40:43]
v_mfma_f32_16x16x32_bf16 a[76:79], v[192:195], v[244:247], a[76:79]
ds_read_b64_tr_b16 v[188:189], v8 offset:32768
ds_read_b64_tr_b16 v[190:191], v8 offset:33280
s_waitcnt lgkmcnt(12)
v_mfma_f32_16x16x32_bf16 a[8:11], v[196:199], v[76:79], a[8:11]
v_mfma_f32_16x16x32_bf16 a[44:47], v[196:199], v[148:151], a[44:47]
v_mfma_f32_16x16x32_bf16 a[80:83], v[196:199], v[244:247], a[80:83]
s_waitcnt vmcnt(13)
s_barrier
v_subrev_u32 v8, 110592, v8
v_subrev_u32 v9, 110592, v9
v_subrev_u32 v10, 110592, v10
v_subrev_u32 v11, 110592, v11
ds_read_b64_tr_b16 v[192:193], v8 offset:0
ds_read_b64_tr_b16 v[194:195], v8 offset:512
s_waitcnt lgkmcnt(12)
v_mfma_f32_16x16x32_bf16 a[12:15], v[200:203], v[76:79], a[12:15]
v_mfma_f32_16x16x32_bf16 a[48:51], v[200:203], v[148:151], a[48:51]
v_mfma_f32_16x16x32_bf16 a[84:87], v[200:203], v[244:247], a[84:87]
ds_read_b64_tr_b16 v[196:197], v9 offset:0
ds_read_b64_tr_b16 v[198:199], v9 offset:512
s_waitcnt lgkmcnt(12)
v_mfma_f32_16x16x32_bf16 a[16:19], v[204:207], v[76:79], a[16:19]
v_mfma_f32_16x16x32_bf16 a[52:55], v[204:207], v[148:151], a[52:55]
v_mfma_f32_16x16x32_bf16 a[88:91], v[204:207], v[244:247], a[88:91]
ds_read_b64_tr_b16 v[200:201], v10 offset:0
ds_read_b64_tr_b16 v[202:203], v10 offset:512
s_waitcnt lgkmcnt(12)
v_mfma_f32_16x16x32_bf16 a[20:23], v[176:179], v[76:79], a[20:23]
v_mfma_f32_16x16x32_bf16 a[56:59], v[176:179], v[148:151], a[56:59]
v_mfma_f32_16x16x32_bf16 a[92:95], v[176:179], v[244:247], a[92:95]
ds_read_b64_tr_b16 v[204:205], v11 offset:0
ds_read_b64_tr_b16 v[206:207], v11 offset:512
s_waitcnt lgkmcnt(12)
v_mfma_f32_16x16x32_bf16 a[24:27], v[180:183], v[76:79], a[24:27]
v_mfma_f32_16x16x32_bf16 a[60:63], v[180:183], v[148:151], a[60:63]
v_mfma_f32_16x16x32_bf16 a[96:99], v[180:183], v[244:247], a[96:99]
ds_read_b64_tr_b16 v[176:177], v8 offset:12288
ds_read_b64_tr_b16 v[178:179], v8 offset:12800
s_waitcnt lgkmcnt(12)
v_mfma_f32_16x16x32_bf16 a[28:31], v[184:187], v[76:79], a[28:31]
v_mfma_f32_16x16x32_bf16 a[64:67], v[184:187], v[148:151], a[64:67]
v_mfma_f32_16x16x32_bf16 a[100:103], v[184:187], v[244:247], a[100:103]
ds_read_b64_tr_b16 v[180:181], v9 offset:12288
ds_read_b64_tr_b16 v[182:183], v9 offset:12800
s_waitcnt lgkmcnt(12)
v_mfma_f32_16x16x32_bf16 a[32:35], v[188:191], v[76:79], a[32:35]
v_mfma_f32_16x16x32_bf16 a[68:71], v[188:191], v[148:151], a[68:71]
v_mfma_f32_16x16x32_bf16 a[104:107], v[188:191], v[244:247], a[104:107]
s_mov_b64 exec, s[76:77]
v_mov_b32 v240, v84
v_mov_b32 v241, v85
v_mov_b32 v242, v86
v_mov_b32 v243, v87
v_mov_b32_dpp v84, v80 row_ror:8 row_mask:0xf bank_mask:0x3
v_mov_b32_dpp v85, v81 row_ror:8 row_mask:0xf bank_mask:0x3
v_mov_b32_dpp v86, v82 row_ror:8 row_mask:0xf bank_mask:0x3
v_mov_b32_dpp v87, v83 row_ror:8 row_mask:0xf bank_mask:0x3
v_mov_b32_dpp v80, v240 row_ror:8 row_mask:0xf bank_mask:0xc
v_mov_b32_dpp v81, v241 row_ror:8 row_mask:0xf bank_mask:0xc
v_mov_b32_dpp v82, v242 row_ror:8 row_mask:0xf bank_mask:0xc
v_mov_b32_dpp v83, v243 row_ror:8 row_mask:0xf bank_mask:0xc
v_mov_b32 v240, v156
v_mov_b32 v241, v157
v_mov_b32 v242, v158
v_mov_b32 v243, v159
v_mov_b32_dpp v156, v152 row_ror:8 row_mask:0xf bank_mask:0x3
v_mov_b32_dpp v157, v153 row_ror:8 row_mask:0xf bank_mask:0x3
v_mov_b32_dpp v158, v154 row_ror:8 row_mask:0xf bank_mask:0x3
v_mov_b32_dpp v159, v155 row_ror:8 row_mask:0xf bank_mask:0x3
v_mov_b32_dpp v152, v240 row_ror:8 row_mask:0xf bank_mask:0xc
v_mov_b32_dpp v153, v241 row_ror:8 row_mask:0xf bank_mask:0xc
v_mov_b32_dpp v154, v242 row_ror:8 row_mask:0xf bank_mask:0xc
v_mov_b32_dpp v155, v243 row_ror:8 row_mask:0xf bank_mask:0xc
v_mov_b32 v240, v92
v_mov_b32 v241, v93
v_mov_b32 v242, v94
v_mov_b32 v243, v95
v_mov_b32_dpp v92, v88 row_ror:8 row_mask:0xf bank_mask:0x3
v_mov_b32_dpp v93, v89 row_ror:8 row_mask:0xf bank_mask:0x3
v_mov_b32_dpp v94, v90 row_ror:8 row_mask:0xf bank_mask:0x3
v_mov_b32_dpp v95, v91 row_ror:8 row_mask:0xf bank_mask:0x3
v_mov_b32_dpp v88, v240 row_ror:8 row_mask:0xf bank_mask:0xc
v_mov_b32_dpp v89, v241 row_ror:8 row_mask:0xf bank_mask:0xc
v_mov_b32_dpp v90, v242 row_ror:8 row_mask:0xf bank_mask:0xc
v_mov_b32_dpp v91, v243 row_ror:8 row_mask:0xf bank_mask:0xc
v_mov_b32 v240, v164
v_mov_b32 v241, v165
v_mov_b32 v242, v166
v_mov_b32 v243, v167
v_mov_b32_dpp v164, v160 row_ror:8 row_mask:0xf bank_mask:0x3
v_mov_b32_dpp v165, v161 row_ror:8 row_mask:0xf bank_mask:0x3
v_mov_b32_dpp v166, v162 row_ror:8 row_mask:0xf bank_mask:0x3
v_mov_b32_dpp v167, v163 row_ror:8 row_mask:0xf bank_mask:0x3
v_mov_b32_dpp v160, v240 row_ror:8 row_mask:0xf bank_mask:0xc
v_mov_b32_dpp v161, v241 row_ror:8 row_mask:0xf bank_mask:0xc
v_mov_b32_dpp v162, v242 row_ror:8 row_mask:0xf bank_mask:0xc
v_mov_b32_dpp v163, v243 row_ror:8 row_mask:0xf bank_mask:0xc
s_mov_b64 exec, -1
ds_read_b64_tr_b16 v[184:185], v10 offset:12288
ds_read_b64_tr_b16 v[186:187], v10 offset:12800
s_waitcnt lgkmcnt(12)
v_mfma_f32_16x16x32_bf16 a[0:3], v[192:195], v[80:83], a[0:3]
v_mfma_f32_16x16x32_bf16 a[36:39], v[192:195], v[152:155], a[36:39]
v_mfma_f32_16x16x32_bf16 a[72:75], v[192:195], v[244:247], a[72:75]
ds_read_b64_tr_b16 v[188:189], v11 offset:12288
ds_read_b64_tr_b16 v[190:191], v11 offset:12800
s_waitcnt lgkmcnt(12)
v_mfma_f32_16x16x32_bf16 a[4:7], v[196:199], v[80:83], a[4:7]
v_mfma_f32_16x16x32_bf16 a[40:43], v[196:199], v[152:155], a[40:43]
v_mfma_f32_16x16x32_bf16 a[76:79], v[196:199], v[244:247], a[76:79]
ds_read_b64_tr_b16 v[192:193], v8 offset:24576
ds_read_b64_tr_b16 v[194:195], v8 offset:25088
s_waitcnt lgkmcnt(12)
v_mfma_f32_16x16x32_bf16 a[8:11], v[200:203], v[80:83], a[8:11]
v_mfma_f32_16x16x32_bf16 a[44:47], v[200:203], v[152:155], a[44:47]
v_mfma_f32_16x16x32_bf16 a[80:83], v[200:203], v[244:247], a[80:83]
ds_read_b64_tr_b16 v[196:197], v8 offset:4096
ds_read_b64_tr_b16 v[198:199], v8 offset:4608
s_waitcnt lgkmcnt(12)
v_mfma_f32_16x16x32_bf16 a[12:15], v[204:207], v[80:83], a[12:15]
v_mfma_f32_16x16x32_bf16 a[48:51], v[204:207], v[152:155], a[48:51]
v_mfma_f32_16x16x32_bf16 a[84:87], v[204:207], v[244:247], a[84:87]
ds_read_b64_tr_b16 v[200:201], v9 offset:4096
ds_read_b64_tr_b16 v[202:203], v9 offset:4608
s_waitcnt lgkmcnt(12)
v_mfma_f32_16x16x32_bf16 a[16:19], v[176:179], v[80:83], a[16:19]
v_mfma_f32_16x16x32_bf16 a[52:55], v[176:179], v[152:155], a[52:55]
v_mfma_f32_16x16x32_bf16 a[88:91], v[176:179], v[244:247], a[88:91]
ds_read_b64_tr_b16 v[204:205], v10 offset:4096
ds_read_b64_tr_b16 v[206:207], v10 offset:4608
s_waitcnt lgkmcnt(12)
v_mfma_f32_16x16x32_bf16 a[20:23], v[180:183], v[80:83], a[20:23]
v_mfma_f32_16x16x32_bf16 a[56:59], v[180:183], v[152:155], a[56:59]
v_mfma_f32_16x16x32_bf16 a[92:95], v[180:183], v[244:247], a[92:95]
ds_read_b64_tr_b16 v[176:177], v11 offset:4096
ds_read_b64_tr_b16 v[178:179], v11 offset:4608
s_waitcnt lgkmcnt(12)
v_mfma_f32_16x16x32_bf16 a[24:27], v[184:187], v[80:83], a[24:27]
v_mfma_f32_16x16x32_bf16 a[60:63], v[184:187], v[152:155], a[60:63]
v_mfma_f32_16x16x32_bf16 a[96:99], v[184:187], v[244:247], a[96:99]
ds_read_b64_tr_b16 v[180:181], v8 offset:16384
ds_read_b64_tr_b16 v[182:183], v8 offset:16896
s_waitcnt lgkmcnt(12)
v_mfma_f32_16x16x32_bf16 a[28:31], v[188:191], v[80:83], a[28:31]
v_mfma_f32_16x16x32_bf16 a[64:67], v[188:191], v[152:155], a[64:67]
v_mfma_f32_16x16x32_bf16 a[100:103], v[188:191], v[244:247], a[100:103]
ds_read_b64_tr_b16 v[184:185], v9 offset:16384
ds_read_b64_tr_b16 v[186:187], v9 offset:16896
s_waitcnt lgkmcnt(12)
v_mfma_f32_16x16x32_bf16 a[32:35], v[192:195], v[80:83], a[32:35]
v_mfma_f32_16x16x32_bf16 a[68:71], v[192:195], v[152:155], a[68:71]
v_mfma_f32_16x16x32_bf16 a[104:107], v[192:195], v[244:247], a[104:107]
ds_read_b64_tr_b16 v[188:189], v10 offset:16384
ds_read_b64_tr_b16 v[190:191], v10 offset:16896
s_waitcnt lgkmcnt(12)
v_mfma_f32_16x16x32_bf16 a[0:3], v[196:199], v[84:87], a[0:3]
v_mfma_f32_16x16x32_bf16 a[36:39], v[196:199], v[156:159], a[36:39]
v_mfma_f32_16x16x32_bf16 a[72:75], v[196:199], v[244:247], a[72:75]
ds_read_b64_tr_b16 v[192:193], v11 offset:16384
ds_read_b64_tr_b16 v[194:195], v11 offset:16896
s_waitcnt lgkmcnt(12)
v_mfma_f32_16x16x32_bf16 a[4:7], v[200:203], v[84:87], a[4:7]
v_mfma_f32_16x16x32_bf16 a[40:43], v[200:203], v[156:159], a[40:43]
v_mfma_f32_16x16x32_bf16 a[76:79], v[200:203], v[244:247], a[76:79]
ds_read_b64_tr_b16 v[196:197], v8 offset:28672
ds_read_b64_tr_b16 v[198:199], v8 offset:29184
s_waitcnt lgkmcnt(12)
v_mfma_f32_16x16x32_bf16 a[8:11], v[204:207], v[84:87], a[8:11]
v_mfma_f32_16x16x32_bf16 a[44:47], v[204:207], v[156:159], a[44:47]
v_mfma_f32_16x16x32_bf16 a[80:83], v[204:207], v[244:247], a[80:83]
ds_read_b64_tr_b16 v[200:201], v8 offset:8192
ds_read_b64_tr_b16 v[202:203], v8 offset:8704
s_waitcnt lgkmcnt(12)
v_mfma_f32_16x16x32_bf16 a[12:15], v[176:179], v[84:87], a[12:15]
v_mfma_f32_16x16x32_bf16 a[48:51], v[176:179], v[156:159], a[48:51]
v_mfma_f32_16x16x32_bf16 a[84:87], v[176:179], v[244:247], a[84:87]
ds_read_b64_tr_b16 v[204:205], v9 offset:8192
ds_read_b64_tr_b16 v[206:207], v9 offset:8704
s_waitcnt lgkmcnt(12)
v_mfma_f32_16x16x32_bf16 a[16:19], v[180:183], v[84:87], a[16:19]
v_mfma_f32_16x16x32_bf16 a[52:55], v[180:183], v[156:159], a[52:55]
v_mfma_f32_16x16x32_bf16 a[88:91], v[180:183], v[244:247], a[88:91]
ds_read_b64_tr_b16 v[176:177], v10 offset:8192
ds_read_b64_tr_b16 v[178:179], v10 offset:8704
s_waitcnt lgkmcnt(12)
v_mfma_f32_16x16x32_bf16 a[20:23], v[184:187], v[84:87], a[20:23]
v_mfma_f32_16x16x32_bf16 a[56:59], v[184:187], v[156:159], a[56:59]
v_mfma_f32_16x16x32_bf16 a[92:95], v[184:187], v[244:247], a[92:95]
ds_read_b64_tr_b16 v[180:181], v11 offset:8192
ds_read_b64_tr_b16 v[182:183], v11 offset:8704
s_waitcnt lgkmcnt(12)
v_mfma_f32_16x16x32_bf16 a[24:27], v[188:191], v[84:87], a[24:27]
v_mfma_f32_16x16x32_bf16 a[60:63], v[188:191], v[156:159], a[60:63]
v_mfma_f32_16x16x32_bf16 a[96:99], v[188:191], v[244:247], a[96:99]
ds_read_b64_tr_b16 v[184:185], v8 offset:20480
ds_read_b64_tr_b16 v[186:187], v8 offset:20992
s_waitcnt lgkmcnt(12)
v_mfma_f32_16x16x32_bf16 a[28:31], v[192:195], v[84:87], a[28:31]
v_mfma_f32_16x16x32_bf16 a[64:67], v[192:195], v[156:159], a[64:67]
v_mfma_f32_16x16x32_bf16 a[100:103], v[192:195], v[244:247], a[100:103]
ds_read_b64_tr_b16 v[188:189], v9 offset:20480
ds_read_b64_tr_b16 v[190:191], v9 offset:20992
s_waitcnt lgkmcnt(12)
v_mfma_f32_16x16x32_bf16 a[32:35], v[196:199], v[84:87], a[32:35]
v_mfma_f32_16x16x32_bf16 a[68:71], v[196:199], v[156:159], a[68:71]
v_mfma_f32_16x16x32_bf16 a[104:107], v[196:199], v[244:247], a[104:107]
ds_read_b64_tr_b16 v[192:193], v10 offset:20480
ds_read_b64_tr_b16 v[194:195], v10 offset:20992
s_waitcnt lgkmcnt(12)
v_mfma_f32_16x16x32_bf16 a[0:3], v[200:203], v[88:91], a[0:3]
v_mfma_f32_16x16x32_bf16 a[36:39], v[200:203], v[160:163], a[36:39]
v_mfma_f32_16x16x32_bf16 a[72:75], v[200:203], v[244:247], a[72:75]
ds_read_b64_tr_b16 v[196:197], v11 offset:20480
ds_read_b64_tr_b16 v[198:199], v11 offset:20992
s_waitcnt lgkmcnt(12)
v_mfma_f32_16x16x32_bf16 a[4:7], v[204:207], v[88:91], a[4:7]
v_mfma_f32_16x16x32_bf16 a[40:43], v[204:207], v[160:163], a[40:43]
v_mfma_f32_16x16x32_bf16 a[76:79], v[204:207], v[244:247], a[76:79]
ds_read_b64_tr_b16 v[200:201], v8 offset:32768
ds_read_b64_tr_b16 v[202:203], v8 offset:33280
s_waitcnt lgkmcnt(12)
v_mfma_f32_16x16x32_bf16 a[8:11], v[176:179], v[88:91], a[8:11]
v_mfma_f32_16x16x32_bf16 a[44:47], v[176:179], v[160:163], a[44:47]
v_mfma_f32_16x16x32_bf16 a[80:83], v[176:179], v[244:247], a[80:83]
s_waitcnt vmcnt(0)
s_barrier
v_add_u32 v8, 36864, v8
v_add_u32 v9, 36864, v9
v_add_u32 v10, 36864, v10
v_add_u32 v11, 36864, v11
ds_read_b64_tr_b16 v[204:205], v8 offset:0
ds_read_b64_tr_b16 v[206:207], v8 offset:512
s_waitcnt lgkmcnt(12)
v_mfma_f32_16x16x32_bf16 a[12:15], v[180:183], v[88:91], a[12:15]
v_mfma_f32_16x16x32_bf16 a[48:51], v[180:183], v[160:163], a[48:51]
v_mfma_f32_16x16x32_bf16 a[84:87], v[180:183], v[244:247], a[84:87]
ds_read_b64_tr_b16 v[176:177], v9 offset:0
ds_read_b64_tr_b16 v[178:179], v9 offset:512
s_waitcnt lgkmcnt(12)
v_mfma_f32_16x16x32_bf16 a[16:19], v[184:187], v[88:91], a[16:19]
v_mfma_f32_16x16x32_bf16 a[52:55], v[184:187], v[160:163], a[52:55]
v_mfma_f32_16x16x32_bf16 a[88:91], v[184:187], v[244:247], a[88:91]
ds_read_b64_tr_b16 v[180:181], v10 offset:0
ds_read_b64_tr_b16 v[182:183], v10 offset:512
s_waitcnt lgkmcnt(12)
v_mfma_f32_16x16x32_bf16 a[20:23], v[188:191], v[88:91], a[20:23]
v_mfma_f32_16x16x32_bf16 a[56:59], v[188:191], v[160:163], a[56:59]
v_mfma_f32_16x16x32_bf16 a[92:95], v[188:191], v[244:247], a[92:95]
ds_read_b64_tr_b16 v[184:185], v11 offset:0
ds_read_b64_tr_b16 v[186:187], v11 offset:512
s_waitcnt lgkmcnt(12)
v_mfma_f32_16x16x32_bf16 a[24:27], v[192:195], v[88:91], a[24:27]
v_mfma_f32_16x16x32_bf16 a[60:63], v[192:195], v[160:163], a[60:63]
v_mfma_f32_16x16x32_bf16 a[96:99], v[192:195], v[244:247], a[96:99]
ds_read_b64_tr_b16 v[188:189], v8 offset:12288
ds_read_b64_tr_b16 v[190:191], v8 offset:12800
s_waitcnt lgkmcnt(12)
v_mfma_f32_16x16x32_bf16 a[28:31], v[196:199], v[88:91], a[28:31]
v_mfma_f32_16x16x32_bf16 a[64:67], v[196:199], v[160:163], a[64:67]
v_mfma_f32_16x16x32_bf16 a[100:103], v[196:199], v[244:247], a[100:103]
ds_read_b64_tr_b16 v[192:193], v9 offset:12288
ds_read_b64_tr_b16 v[194:195], v9 offset:12800
s_waitcnt lgkmcnt(12)
v_mfma_f32_16x16x32_bf16 a[32:35], v[200:203], v[88:91], a[32:35]
v_mfma_f32_16x16x32_bf16 a[68:71], v[200:203], v[160:163], a[68:71]
v_mfma_f32_16x16x32_bf16 a[104:107], v[200:203], v[244:247], a[104:107]
s_mov_b64 exec, s[76:77]
v_mov_b32 v240, v100
v_mov_b32 v241, v101
v_mov_b32 v242, v102
v_mov_b32 v243, v103
v_mov_b32_dpp v100, v96 row_ror:8 row_mask:0xf bank_mask:0x3
v_mov_b32_dpp v101, v97 row_ror:8 row_mask:0xf bank_mask:0x3
v_mov_b32_dpp v102, v98 row_ror:8 row_mask:0xf bank_mask:0x3
v_mov_b32_dpp v103, v99 row_ror:8 row_mask:0xf bank_mask:0x3
v_mov_b32_dpp v96, v240 row_ror:8 row_mask:0xf bank_mask:0xc
v_mov_b32_dpp v97, v241 row_ror:8 row_mask:0xf bank_mask:0xc
v_mov_b32_dpp v98, v242 row_ror:8 row_mask:0xf bank_mask:0xc
v_mov_b32_dpp v99, v243 row_ror:8 row_mask:0xf bank_mask:0xc
v_mov_b32 v240, v172
v_mov_b32 v241, v173
v_mov_b32 v242, v174
v_mov_b32 v243, v175
v_mov_b32_dpp v172, v168 row_ror:8 row_mask:0xf bank_mask:0x3
v_mov_b32_dpp v173, v169 row_ror:8 row_mask:0xf bank_mask:0x3
v_mov_b32_dpp v174, v170 row_ror:8 row_mask:0xf bank_mask:0x3
v_mov_b32_dpp v175, v171 row_ror:8 row_mask:0xf bank_mask:0x3
v_mov_b32_dpp v168, v240 row_ror:8 row_mask:0xf bank_mask:0xc
v_mov_b32_dpp v169, v241 row_ror:8 row_mask:0xf bank_mask:0xc
v_mov_b32_dpp v170, v242 row_ror:8 row_mask:0xf bank_mask:0xc
v_mov_b32_dpp v171, v243 row_ror:8 row_mask:0xf bank_mask:0xc
s_mov_b64 exec, -1
ds_read_b64_tr_b16 v[196:197], v10 offset:12288
ds_read_b64_tr_b16 v[198:199], v10 offset:12800
s_waitcnt lgkmcnt(12)
v_mfma_f32_16x16x32_bf16 a[0:3], v[204:207], v[92:95], a[0:3]
v_mfma_f32_16x16x32_bf16 a[36:39], v[204:207], v[164:167], a[36:39]
v_mfma_f32_16x16x32_bf16 a[72:75], v[204:207], v[244:247], a[72:75]
ds_read_b64_tr_b16 v[200:201], v11 offset:12288
ds_read_b64_tr_b16 v[202:203], v11 offset:12800
s_waitcnt lgkmcnt(12)
v_mfma_f32_16x16x32_bf16 a[4:7], v[176:179], v[92:95], a[4:7]
v_mfma_f32_16x16x32_bf16 a[40:43], v[176:179], v[164:167], a[40:43]
v_mfma_f32_16x16x32_bf16 a[76:79], v[176:179], v[244:247], a[76:79]
ds_read_b64_tr_b16 v[204:205], v8 offset:24576
ds_read_b64_tr_b16 v[206:207], v8 offset:25088
s_waitcnt lgkmcnt(12)
v_mfma_f32_16x16x32_bf16 a[8:11], v[180:183], v[92:95], a[8:11]
v_mfma_f32_16x16x32_bf16 a[44:47], v[180:183], v[164:167], a[44:47]
v_mfma_f32_16x16x32_bf16 a[80:83], v[180:183], v[244:247], a[80:83]
ds_read_b64_tr_b16 v[176:177], v8 offset:4096
ds_read_b64_tr_b16 v[178:179], v8 offset:4608
s_waitcnt lgkmcnt(12)
v_mfma_f32_16x16x32_bf16 a[12:15], v[184:187], v[92:95], a[12:15]
v_mfma_f32_16x16x32_bf16 a[48:51], v[184:187], v[164:167], a[48:51]
v_mfma_f32_16x16x32_bf16 a[84:87], v[184:187], v[244:247], a[84:87]
ds_read_b64_tr_b16 v[180:181], v9 offset:4096
ds_read_b64_tr_b16 v[182:183], v9 offset:4608
s_waitcnt lgkmcnt(12)
v_mfma_f32_16x16x32_bf16 a[16:19], v[188:191], v[92:95], a[16:19]
v_mfma_f32_16x16x32_bf16 a[52:55], v[188:191], v[164:167], a[52:55]
v_mfma_f32_16x16x32_bf16 a[88:91], v[188:191], v[244:247], a[88:91]
ds_read_b64_tr_b16 v[184:185], v10 offset:4096
ds_read_b64_tr_b16 v[186:187], v10 offset:4608
s_waitcnt lgkmcnt(12)
v_mfma_f32_16x16x32_bf16 a[20:23], v[192:195], v[92:95], a[20:23]
v_mfma_f32_16x16x32_bf16 a[56:59], v[192:195], v[164:167], a[56:59]
v_mfma_f32_16x16x32_bf16 a[92:95], v[192:195], v[244:247], a[92:95]
ds_read_b64_tr_b16 v[188:189], v11 offset:4096
ds_read_b64_tr_b16 v[190:191], v11 offset:4608
s_waitcnt lgkmcnt(12)
v_mfma_f32_16x16x32_bf16 a[24:27], v[196:199], v[92:95], a[24:27]
v_mfma_f32_16x16x32_bf16 a[60:63], v[196:199], v[164:167], a[60:63]
v_mfma_f32_16x16x32_bf16 a[96:99], v[196:199], v[244:247], a[96:99]
ds_read_b64_tr_b16 v[192:193], v8 offset:16384
ds_read_b64_tr_b16 v[194:195], v8 offset:16896
s_waitcnt lgkmcnt(12)
v_mfma_f32_16x16x32_bf16 a[28:31], v[200:203], v[92:95], a[28:31]
v_mfma_f32_16x16x32_bf16 a[64:67], v[200:203], v[164:167], a[64:67]
v_mfma_f32_16x16x32_bf16 a[100:103], v[200:203], v[244:247], a[100:103]
ds_read_b64_tr_b16 v[196:197], v9 offset:16384
ds_read_b64_tr_b16 v[198:199], v9 offset:16896
s_waitcnt lgkmcnt(12)
v_mfma_f32_16x16x32_bf16 a[32:35], v[204:207], v[92:95], a[32:35]
v_mfma_f32_16x16x32_bf16 a[68:71], v[204:207], v[164:167], a[68:71]
v_mfma_f32_16x16x32_bf16 a[104:107], v[204:207], v[244:247], a[104:107]
ds_read_b64_tr_b16 v[200:201], v10 offset:16384
ds_read_b64_tr_b16 v[202:203], v10 offset:16896
s_waitcnt lgkmcnt(12)
v_mfma_f32_16x16x32_bf16 a[0:3], v[176:179], v[96:99], a[0:3]
v_mfma_f32_16x16x32_bf16 a[36:39], v[176:179], v[168:171], a[36:39]
v_mfma_f32_16x16x32_bf16 a[72:75], v[176:179], v[244:247], a[72:75]
ds_read_b64_tr_b16 v[204:205], v11 offset:16384
ds_read_b64_tr_b16 v[206:207], v11 offset:16896
s_waitcnt lgkmcnt(12)
v_mfma_f32_16x16x32_bf16 a[4:7], v[180:183], v[96:99], a[4:7]
v_mfma_f32_16x16x32_bf16 a[40:43], v[180:183], v[168:171], a[40:43]
v_mfma_f32_16x16x32_bf16 a[76:79], v[180:183], v[244:247], a[76:79]
ds_read_b64_tr_b16 v[176:177], v8 offset:28672
ds_read_b64_tr_b16 v[178:179], v8 offset:29184
s_waitcnt lgkmcnt(12)
v_mfma_f32_16x16x32_bf16 a[8:11], v[184:187], v[96:99], a[8:11]
v_mfma_f32_16x16x32_bf16 a[44:47], v[184:187], v[168:171], a[44:47]
v_mfma_f32_16x16x32_bf16 a[80:83], v[184:187], v[244:247], a[80:83]
ds_read_b64_tr_b16 v[180:181], v8 offset:8192
ds_read_b64_tr_b16 v[182:183], v8 offset:8704
s_waitcnt lgkmcnt(12)
v_mfma_f32_16x16x32_bf16 a[12:15], v[188:191], v[96:99], a[12:15]
v_mfma_f32_16x16x32_bf16 a[48:51], v[188:191], v[168:171], a[48:51]
v_mfma_f32_16x16x32_bf16 a[84:87], v[188:191], v[244:247], a[84:87]
ds_read_b64_tr_b16 v[184:185], v9 offset:8192
ds_read_b64_tr_b16 v[186:187], v9 offset:8704
s_waitcnt lgkmcnt(12)
v_mfma_f32_16x16x32_bf16 a[16:19], v[192:195], v[96:99], a[16:19]
v_mfma_f32_16x16x32_bf16 a[52:55], v[192:195], v[168:171], a[52:55]
v_mfma_f32_16x16x32_bf16 a[88:91], v[192:195], v[244:247], a[88:91]
ds_read_b64_tr_b16 v[188:189], v10 offset:8192
ds_read_b64_tr_b16 v[190:191], v10 offset:8704
s_waitcnt lgkmcnt(12)
v_mfma_f32_16x16x32_bf16 a[20:23], v[196:199], v[96:99], a[20:23]
v_mfma_f32_16x16x32_bf16 a[56:59], v[196:199], v[168:171], a[56:59]
v_mfma_f32_16x16x32_bf16 a[92:95], v[196:199], v[244:247], a[92:95]
ds_read_b64_tr_b16 v[192:193], v11 offset:8192
ds_read_b64_tr_b16 v[194:195], v11 offset:8704
s_waitcnt lgkmcnt(12)
v_mfma_f32_16x16x32_bf16 a[24:27], v[200:203], v[96:99], a[24:27]
v_mfma_f32_16x16x32_bf16 a[60:63], v[200:203], v[168:171], a[60:63]
v_mfma_f32_16x16x32_bf16 a[96:99], v[200:203], v[244:247], a[96:99]
ds_read_b64_tr_b16 v[196:197], v8 offset:20480
ds_read_b64_tr_b16 v[198:199], v8 offset:20992
s_waitcnt lgkmcnt(12)
v_mfma_f32_16x16x32_bf16 a[28:31], v[204:207], v[96:99], a[28:31]
v_mfma_f32_16x16x32_bf16 a[64:67], v[204:207], v[168:171], a[64:67]
v_mfma_f32_16x16x32_bf16 a[100:103], v[204:207], v[244:247], a[100:103]
ds_read_b64_tr_b16 v[200:201], v9 offset:20480
ds_read_b64_tr_b16 v[202:203], v9 offset:20992
s_waitcnt lgkmcnt(12)
v_mfma_f32_16x16x32_bf16 a[32:35], v[176:179], v[96:99], a[32:35]
v_mfma_f32_16x16x32_bf16 a[68:71], v[176:179], v[168:171], a[68:71]
v_mfma_f32_16x16x32_bf16 a[104:107], v[176:179], v[244:247], a[104:107]
ds_read_b64_tr_b16 v[204:205], v10 offset:20480
ds_read_b64_tr_b16 v[206:207], v10 offset:20992
s_waitcnt lgkmcnt(12)
v_mfma_f32_16x16x32_bf16 a[0:3], v[180:183], v[100:103], a[0:3]
v_mfma_f32_16x16x32_bf16 a[36:39], v[180:183], v[172:175], a[36:39]
v_mfma_f32_16x16x32_bf16 a[72:75], v[180:183], v[244:247], a[72:75]
ds_read_b64_tr_b16 v[176:177], v11 offset:20480
ds_read_b64_tr_b16 v[178:179], v11 offset:20992
s_waitcnt lgkmcnt(12)
v_mfma_f32_16x16x32_bf16 a[4:7], v[184:187], v[100:103], a[4:7]
v_mfma_f32_16x16x32_bf16 a[40:43], v[184:187], v[172:175], a[40:43]
v_mfma_f32_16x16x32_bf16 a[76:79], v[184:187], v[244:247], a[76:79]
ds_read_b64_tr_b16 v[180:181], v8 offset:32768
ds_read_b64_tr_b16 v[182:183], v8 offset:33280
s_waitcnt lgkmcnt(12)
v_mfma_f32_16x16x32_bf16 a[8:11], v[188:191], v[100:103], a[8:11]
v_mfma_f32_16x16x32_bf16 a[44:47], v[188:191], v[172:175], a[44:47]
v_mfma_f32_16x16x32_bf16 a[80:83], v[188:191], v[244:247], a[80:83]
s_waitcnt lgkmcnt(10)
v_mfma_f32_16x16x32_bf16 a[12:15], v[192:195], v[100:103], a[12:15]
v_mfma_f32_16x16x32_bf16 a[48:51], v[192:195], v[172:175], a[48:51]
v_mfma_f32_16x16x32_bf16 a[84:87], v[192:195], v[244:247], a[84:87]
s_waitcnt lgkmcnt(8)
v_mfma_f32_16x16x32_bf16 a[16:19], v[196:199], v[100:103], a[16:19]
v_mfma_f32_16x16x32_bf16 a[52:55], v[196:199], v[172:175], a[52:55]
v_mfma_f32_16x16x32_bf16 a[88:91], v[196:199], v[244:247], a[88:91]
s_waitcnt lgkmcnt(6)
v_mfma_f32_16x16x32_bf16 a[20:23], v[200:203], v[100:103], a[20:23]
v_mfma_f32_16x16x32_bf16 a[56:59], v[200:203], v[172:175], a[56:59]
v_mfma_f32_16x16x32_bf16 a[92:95], v[200:203], v[244:247], a[92:95]
s_waitcnt lgkmcnt(4)
v_mfma_f32_16x16x32_bf16 a[24:27], v[204:207], v[100:103], a[24:27]
v_mfma_f32_16x16x32_bf16 a[60:63], v[204:207], v[172:175], a[60:63]
v_mfma_f32_16x16x32_bf16 a[96:99], v[204:207], v[244:247], a[96:99]
s_waitcnt lgkmcnt(2)
v_mfma_f32_16x16x32_bf16 a[28:31], v[176:179], v[100:103], a[28:31]
v_mfma_f32_16x16x32_bf16 a[64:67], v[176:179], v[172:175], a[64:67]
v_mfma_f32_16x16x32_bf16 a[100:103], v[176:179], v[244:247], a[100:103]
s_waitcnt lgkmcnt(0)
v_mfma_f32_16x16x32_bf16 a[32:35], v[180:183], v[100:103], a[32:35]
v_mfma_f32_16x16x32_bf16 a[68:71], v[180:183], v[172:175], a[68:71]
v_mfma_f32_16x16x32_bf16 a[104:107], v[180:183], v[244:247], a[104:107]
v_dot2_f32_bf16 v248, v32, s82, v248
v_dot2_f32_bf16 v250, v32, v32, v250
v_dot2_f32_bf16 v249, v104, s82, v249
v_dot2_f32_bf16 v251, v104, v104, v251
v_dot2_f32_bf16 v248, v33, s82, v248
v_dot2_f32_bf16 v250, v33, v33, v250
v_dot2_f32_bf16 v249, v105, s82, v249
v_dot2_f32_bf16 v251, v105, v105, v251
v_dot2_f32_bf16 v248, v34, s82, v248
v_dot2_f32_bf16 v250, v34, v34, v250
v_dot2_f32_bf16 v249, v106, s82, v249
v_dot2_f32_bf16 v251, v106, v106, v251
v_dot2_f32_bf16 v248, v35, s82, v248
v_dot2_f32_bf16 v250, v35, v35, v250
v_dot2_f32_bf16 v249, v107, s82, v249
v_dot2_f32_bf16 v251, v107, v107, v251
v_dot2_f32_bf16 v248, v36, s82, v248
v_dot2_f32_bf16 v250, v36, v36, v250
v_dot2_f32_bf16 v249, v108, s82, v249
v_dot2_f32_bf16 v251, v108, v108, v251
v_dot2_f32_bf16 v248, v37, s82, v248
v_dot2_f32_bf16 v250, v37, v37, v250
v_dot2_f32_bf16 v249, v109, s82, v249
v_dot2_f32_bf16 v251, v109, v109, v251
v_dot2_f32_bf16 v248, v38, s82, v248
v_dot2_f32_bf16 v250, v38, v38, v250
v_dot2_f32_bf16 v249, v110, s82, v249
v_dot2_f32_bf16 v251, v110, v110, v251
v_dot2_f32_bf16 v248, v39, s82, v248
v_dot2_f32_bf16 v250, v39, v39, v250
v_dot2_f32_bf16 v249, v111, s82, v249
v_dot2_f32_bf16 v251, v111, v111, v251
v_dot2_f32_bf16 v248, v40, s82, v248
v_dot2_f32_bf16 v250, v40, v40, v250
v_dot2_f32_bf16 v249, v112, s82, v249
v_dot2_f32_bf16 v251, v112, v112, v251
v_dot2_f32_bf16 v248, v41, s82, v248
v_dot2_f32_bf16 v250, v41, v41, v250
v_dot2_f32_bf16 v249, v113, s82, v249
v_dot2_f32_bf16 v251, v113, v113, v251
v_dot2_f32_bf16 v248, v42, s82, v248
v_dot2_f32_bf16 v250, v42, v42, v250
v_dot2_f32_bf16 v249, v114, s82, v249
v_dot2_f32_bf16 v251, v114, v114, v251
v_dot2_f32_bf16 v248, v43, s82, v248
v_dot2_f32_bf16 v250, v43, v43, v250
v_dot2_f32_bf16 v249, v115, s82, v249
v_dot2_f32_bf16 v251, v115, v115, v251
v_dot2_f32_bf16 v248, v44, s82, v248
v_dot2_f32_bf16 v250, v44, v44, v250
v_dot2_f32_bf16 v249, v116, s82, v249
v_dot2_f32_bf16 v251, v116, v116, v251
v_dot2_f32_bf16 v248, v45, s82, v248
v_dot2_f32_bf16 v250, v45, v45, v250
v_dot2_f32_bf16 v249, v117, s82, v249
v_dot2_f32_bf16 v251, v117, v117, v251
v_dot2_f32_bf16 v248, v46, s82, v248
v_dot2_f32_bf16 v250, v46, v46, v250
v_dot2_f32_bf16 v249, v118, s82, v249
v_dot2_f32_bf16 v251, v118, v118, v251
v_dot2_f32_bf16 v248, v47, s82, v248
v_dot2_f32_bf16 v250, v47, v47, v250
v_dot2_f32_bf16 v249, v119, s82, v249
v_dot2_f32_bf16 v251, v119, v119, v251
v_dot2_f32_bf16 v248, v48, s82, v248
v_dot2_f32_bf16 v250, v48, v48, v250
v_dot2_f32_bf16 v249, v120, s82, v249
v_dot2_f32_bf16 v251, v120, v120, v251
v_dot2_f32_bf16 v248, v49, s82, v248
v_dot2_f32_bf16 v250, v49, v49, v250
v_dot2_f32_bf16 v249, v121, s82, v249
v_dot2_f32_bf16 v251, v121, v121, v251
v_dot2_f32_bf16 v248, v50, s82, v248
v_dot2_f32_bf16 v250, v50, v50, v250
v_dot2_f32_bf16 v249, v122, s82, v249
v_dot2_f32_bf16 v251, v122, v122, v251
v_dot2_f32_bf16 v248, v51, s82, v248
v_dot2_f32_bf16 v250, v51, v51, v250
v_dot2_f32_bf16 v249, v123, s82, v249
v_dot2_f32_bf16 v251, v123, v123, v251
v_dot2_f32_bf16 v248, v52, s82, v248
v_dot2_f32_bf16 v250, v52, v52, v250
v_dot2_f32_bf16 v249, v124, s82, v249
v_dot2_f32_bf16 v251, v124, v124, v251
v_dot2_f32_bf16 v248, v53, s82, v248
v_dot2_f32_bf16 v250, v53, v53, v250
v_dot2_f32_bf16 v249, v125, s82, v249
v_dot2_f32_bf16 v251, v125, v125, v251
v_dot2_f32_bf16 v248, v54, s82, v248
v_dot2_f32_bf16 v250, v54, v54, v250
v_dot2_f32_bf16 v249, v126, s82, v249
v_dot2_f32_bf16 v251, v126, v126, v251
v_dot2_f32_bf16 v248, v55, s82, v248
v_dot2_f32_bf16 v250, v55, v55, v250
v_dot2_f32_bf16 v249, v127, s82, v249
v_dot2_f32_bf16 v251, v127, v127, v251
v_dot2_f32_bf16 v248, v56, s82, v248
v_dot2_f32_bf16 v250, v56, v56, v250
v_dot2_f32_bf16 v249, v128, s82, v249
v_dot2_f32_bf16 v251, v128, v128, v251
v_dot2_f32_bf16 v248, v57, s82, v248
v_dot2_f32_bf16 v250, v57, v57, v250
v_dot2_f32_bf16 v249, v129, s82, v249
v_dot2_f32_bf16 v251, v129, v129, v251
v_dot2_f32_bf16 v248, v58, s82, v248
v_dot2_f32_bf16 v250, v58, v58, v250
v_dot2_f32_bf16 v249, v130, s82, v249
v_dot2_f32_bf16 v251, v130, v130, v251
v_dot2_f32_bf16 v248, v59, s82, v248
v_dot2_f32_bf16 v250, v59, v59, v250
v_dot2_f32_bf16 v249, v131, s82, v249
v_dot2_f32_bf16 v251, v131, v131, v251
v_dot2_f32_bf16 v248, v60, s82, v248
v_dot2_f32_bf16 v250, v60, v60, v250
v_dot2_f32_bf16 v249, v132, s82, v249
v_dot2_f32_bf16 v251, v132, v132, v251
v_dot2_f32_bf16 v248, v61, s82, v248
v_dot2_f32_bf16 v250, v61, v61, v250
v_dot2_f32_bf16 v249, v133, s82, v249
v_dot2_f32_bf16 v251, v133, v133, v251
v_dot2_f32_bf16 v248, v62, s82, v248
v_dot2_f32_bf16 v250, v62, v62, v250
v_dot2_f32_bf16 v249, v134, s82, v249
v_dot2_f32_bf16 v251, v134, v134, v251
v_dot2_f32_bf16 v248, v63, s82, v248
v_dot2_f32_bf16 v250, v63, v63, v250
v_dot2_f32_bf16 v249, v135, s82, v249
v_dot2_f32_bf16 v251, v135, v135, v251
v_dot2_f32_bf16 v248, v64, s82, v248
v_dot2_f32_bf16 v250, v64, v64, v250
v_dot2_f32_bf16 v249, v136, s82, v249
v_dot2_f32_bf16 v251, v136, v136, v251
v_dot2_f32_bf16 v248, v65, s82, v248
v_dot2_f32_bf16 v250, v65, v65, v250
v_dot2_f32_bf16 v249, v137, s82, v249
v_dot2_f32_bf16 v251, v137, v137, v251
v_dot2_f32_bf16 v248, v66, s82, v248
v_dot2_f32_bf16 v250, v66, v66, v250
v_dot2_f32_bf16 v249, v138, s82, v249
v_dot2_f32_bf16 v251, v138, v138, v251
v_dot2_f32_bf16 v248, v67, s82, v248
v_dot2_f32_bf16 v250, v67, v67, v250
v_dot2_f32_bf16 v249, v139, s82, v249
v_dot2_f32_bf16 v251, v139, v139, v251
v_dot2_f32_bf16 v248, v68, s82, v248
v_dot2_f32_bf16 v250, v68, v68, v250
v_dot2_f32_bf16 v249, v140, s82, v249
v_dot2_f32_bf16 v251, v140, v140, v251
v_dot2_f32_bf16 v248, v69, s82, v248
v_dot2_f32_bf16 v250, v69, v69, v250
v_dot2_f32_bf16 v249, v141, s82, v249
v_dot2_f32_bf16 v251, v141, v141, v251
v_dot2_f32_bf16 v248, v70, s82, v248
v_dot2_f32_bf16 v250, v70, v70, v250
v_dot2_f32_bf16 v249, v142, s82, v249
v_dot2_f32_bf16 v251, v142, v142, v251
v_dot2_f32_bf16 v248, v71, s82, v248
v_dot2_f32_bf16 v250, v71, v71, v250
v_dot2_f32_bf16 v249, v143, s82, v249
v_dot2_f32_bf16 v251, v143, v143, v251
v_dot2_f32_bf16 v248, v72, s82, v248
v_dot2_f32_bf16 v250, v72, v72, v250
v_dot2_f32_bf16 v249, v144, s82, v249
v_dot2_f32_bf16 v251, v144, v144, v251
v_dot2_f32_bf16 v248, v73, s82, v248
v_dot2_f32_bf16 v250, v73, v73, v250
v_dot2_f32_bf16 v249, v145, s82, v249
v_dot2_f32_bf16 v251, v145, v145, v251
v_dot2_f32_bf16 v248, v74, s82, v248
v_dot2_f32_bf16 v250, v74, v74, v250
v_dot2_f32_bf16 v249, v146, s82, v249
v_dot2_f32_bf16 v251, v146, v146, v251
v_dot2_f32_bf16 v248, v75, s82, v248
v_dot2_f32_bf16 v250, v75, v75, v250
v_dot2_f32_bf16 v249, v147, s82, v249
v_dot2_f32_bf16 v251, v147, v147, v251
v_dot2_f32_bf16 v248, v76, s82, v248
v_dot2_f32_bf16 v250, v76, v76, v250
v_dot2_f32_bf16 v249, v148, s82, v249
v_dot2_f32_bf16 v251, v148, v148, v251
v_dot2_f32_bf16 v248, v77, s82, v248
v_dot2_f32_bf16 v250, v77, v77, v250
v_dot2_f32_bf16 v249, v149, s82, v249
v_dot2_f32_bf16 v251, v149, v149, v251
v_dot2_f32_bf16 v248, v78, s82, v248
v_dot2_f32_bf16 v250, v78, v78, v250
v_dot2_f32_bf16 v249, v150, s82, v249
v_dot2_f32_bf16 v251, v150, v150, v251
v_dot2_f32_bf16 v248, v79, s82, v248
v_dot2_f32_bf16 v250, v79, v79, v250
v_dot2_f32_bf16 v249, v151, s82, v249
v_dot2_f32_bf16 v251, v151, v151, v251
v_dot2_f32_bf16 v248, v80, s82, v248
v_dot2_f32_bf16 v250, v80, v80, v250
v_dot2_f32_bf16 v249, v152, s82, v249
v_dot2_f32_bf16 v251, v152, v152, v251
v_dot2_f32_bf16 v248, v81, s82, v248
v_dot2_f32_bf16 v250, v81, v81, v250
v_dot2_f32_bf16 v249, v153, s82, v249
v_dot2_f32_bf16 v251, v153, v153, v251
v_dot2_f32_bf16 v248, v82, s82, v248
v_dot2_f32_bf16 v250, v82, v82, v250
v_dot2_f32_bf16 v249, v154, s82, v249
v_dot2_f32_bf16 v251, v154, v154, v251
v_dot2_f32_bf16 v248, v83, s82, v248
v_dot2_f32_bf16 v250, v83, v83, v250
v_dot2_f32_bf16 v249, v155, s82, v249
v_dot2_f32_bf16 v251, v155, v155, v251
v_dot2_f32_bf16 v248, v84, s82, v248
v_dot2_f32_bf16 v250, v84, v84, v250
v_dot2_f32_bf16 v249, v156, s82, v249
v_dot2_f32_bf16 v251, v156, v156, v251
v_dot2_f32_bf16 v248, v85, s82, v248
v_dot2_f32_bf16 v250, v85, v85, v250
v_dot2_f32_bf16 v249, v157, s82, v249
v_dot2_f32_bf16 v251, v157, v157, v251
v_dot2_f32_bf16 v248, v86, s82, v248
v_dot2_f32_bf16 v250, v86, v86, v250
v_dot2_f32_bf16 v249, v158, s82, v249
v_dot2_f32_bf16 v251, v158, v158, v251
v_dot2_f32_bf16 v248, v87, s82, v248
v_dot2_f32_bf16 v250, v87, v87, v250
v_dot2_f32_bf16 v249, v159, s82, v249
v_dot2_f32_bf16 v251, v159, v159, v251
v_dot2_f32_bf16 v248, v88, s82, v248
v_dot2_f32_bf16 v250, v88, v88, v250
v_dot2_f32_bf16 v249, v160, s82, v249
v_dot2_f32_bf16 v251, v160, v160, v251
v_dot2_f32_bf16 v248, v89, s82, v248
v_dot2_f32_bf16 v250, v89, v89, v250
v_dot2_f32_bf16 v249, v161, s82, v249
v_dot2_f32_bf16 v251, v161, v161, v251
v_dot2_f32_bf16 v248, v90, s82, v248
v_dot2_f32_bf16 v250, v90, v90, v250
v_dot2_f32_bf16 v249, v162, s82, v249
v_dot2_f32_bf16 v251, v162, v162, v251
v_dot2_f32_bf16 v248, v91, s82, v248
v_dot2_f32_bf16 v250, v91, v91, v250
v_dot2_f32_bf16 v249, v163, s82, v249
v_dot2_f32_bf16 v251, v163, v163, v251
v_dot2_f32_bf16 v248, v92, s82, v248
v_dot2_f32_bf16 v250, v92, v92, v250
v_dot2_f32_bf16 v249, v164, s82, v249
v_dot2_f32_bf16 v251, v164, v164, v251
v_dot2_f32_bf16 v248, v93, s82, v248
v_dot2_f32_bf16 v250, v93, v93, v250
v_dot2_f32_bf16 v249, v165, s82, v249
v_dot2_f32_bf16 v251, v165, v165, v251
v_dot2_f32_bf16 v248, v94, s82, v248
v_dot2_f32_bf16 v250, v94, v94, v250
v_dot2_f32_bf16 v249, v166, s82, v249
v_dot2_f32_bf16 v251, v166, v166, v251
v_dot2_f32_bf16 v248, v95, s82, v248
v_dot2_f32_bf16 v250, v95, v95, v250
v_dot2_f32_bf16 v249, v167, s82, v249
v_dot2_f32_bf16 v251, v167, v167, v251
v_dot2_f32_bf16 v248, v96, s82, v248
v_dot2_f32_bf16 v250, v96, v96, v250
v_dot2_f32_bf16 v249, v168, s82, v249
v_dot2_f32_bf16 v251, v168, v168, v251
v_dot2_f32_bf16 v248, v97, s82, v248
v_dot2_f32_bf16 v250, v97, v97, v250
v_dot2_f32_bf16 v249, v169, s82, v249
v_dot2_f32_bf16 v251, v169, v169, v251
v_dot2_f32_bf16 v248, v98, s82, v248
v_dot2_f32_bf16 v250, v98, v98, v250
v_dot2_f32_bf16 v249, v170, s82, v249
v_dot2_f32_bf16 v251, v170, v170, v251
v_dot2_f32_bf16 v248, v99, s82, v248
v_dot2_f32_bf16 v250, v99, v99, v250
v_dot2_f32_bf16 v249, v171, s82, v249
v_dot2_f32_bf16 v251, v171, v171, v251
v_dot2_f32_bf16 v248, v100, s82, v248
v_dot2_f32_bf16 v250, v100, v100, v250
v_dot2_f32_bf16 v249, v172, s82, v249
v_dot2_f32_bf16 v251, v172, v172, v251
v_dot2_f32_bf16 v248, v101, s82, v248
v_dot2_f32_bf16 v250, v101, v101, v250
v_dot2_f32_bf16 v249, v173, s82, v249
v_dot2_f32_bf16 v251, v173, v173, v251
v_dot2_f32_bf16 v248, v102, s82, v248
v_dot2_f32_bf16 v250, v102, v102, v250
v_dot2_f32_bf16 v249, v174, s82, v249
v_dot2_f32_bf16 v251, v174, v174, v251
v_dot2_f32_bf16 v248, v103, s82, v248
v_dot2_f32_bf16 v250, v103, v103, v250
v_dot2_f32_bf16 v249, v175, s82, v249
v_dot2_f32_bf16 v251, v175, v175, v251
s_nop 3
v_permlane32_swap_b32 v248, v250
v_add_f32 v248, v248, v250
v_mov_b32 v240, v248
s_nop 1
v_permlane16_swap_b32 v248, v240
v_add_f32 v248, v248, v240
v_mov_b32 v250, v248
s_nop 1
v_permlane32_swap_b32 v248, v250
v_mul_f32 v248, 0x3ae38e39, v248
v_mul_f32 v250, 0x3ae38e39, v250
v_fma_f32 v250, -v248, v248, v250
v_max_f32 v250, 0, v250
v_add_f32 v250, 0x3727c5ac, v250
v_rsq_f32 v252, v250
s_nop 0
v_mul_f32 v254, v248, v252
v_sub_f32 v254, 0, v254
v_permlane32_swap_b32 v249, v251
v_add_f32 v249, v249, v251
v_mov_b32 v240, v249
s_nop 1
v_permlane16_swap_b32 v249, v240
v_add_f32 v249, v249, v240
v_mov_b32 v251, v249
s_nop 1
v_permlane32_swap_b32 v249, v251
v_mul_f32 v249, 0x3ae38e39, v249
v_mul_f32 v251, 0x3ae38e39, v251
v_fma_f32 v251, -v249, v249, v251
v_max_f32 v251, 0, v251
v_add_f32 v251, 0x3727c5ac, v251
v_rsq_f32 v253, v251
s_nop 0
v_mul_f32 v255, v249, v253
v_sub_f32 v255, 0, v255
s_nop 7
v_accvgpr_read_b32 v208, a72
v_accvgpr_read_b32 v209, a73
v_accvgpr_read_b32 v210, a74
v_accvgpr_read_b32 v211, a75
v_accvgpr_read_b32 v212, a0
v_accvgpr_read_b32 v213, a1
v_accvgpr_read_b32 v214, a2
v_accvgpr_read_b32 v215, a3
v_pk_mul_f32 v[212:213], v[212:213], v[252:253] op_sel:[0,0] op_sel_hi:[1,0]
v_pk_mul_f32 v[214:215], v[214:215], v[252:253] op_sel:[0,0] op_sel_hi:[1,0]
v_pk_fma_f32 v[212:213], v[208:209], v[254:255], v[212:213] op_sel:[0,0,0] op_sel_hi:[1,0,1]
v_pk_fma_f32 v[214:215], v[210:211], v[254:255], v[214:215] op_sel:[0,0,0] op_sel_hi:[1,0,1]
v_cvt_pk_bf16_f32 v32, v212, v213
v_cvt_pk_bf16_f32 v33, v214, v215
v_accvgpr_read_b32 v216, a36
v_accvgpr_read_b32 v217, a37
v_accvgpr_read_b32 v218, a38
v_accvgpr_read_b32 v219, a39
v_pk_mul_f32 v[216:217], v[216:217], v[252:253] op_sel:[0,1] op_sel_hi:[1,1]
v_pk_mul_f32 v[218:219], v[218:219], v[252:253] op_sel:[0,1] op_sel_hi:[1,1]
v_pk_fma_f32 v[216:217], v[208:209], v[254:255], v[216:217] op_sel:[0,1,0] op_sel_hi:[1,1,1]
v_pk_fma_f32 v[218:219], v[210:211], v[254:255], v[218:219] op_sel:[0,1,0] op_sel_hi:[1,1,1]
v_cvt_pk_bf16_f32 v50, v216, v217
v_cvt_pk_bf16_f32 v51, v218, v219
v_accvgpr_read_b32 v224, a76
v_accvgpr_read_b32 v225, a77
v_accvgpr_read_b32 v226, a78
v_accvgpr_read_b32 v227, a79
v_accvgpr_read_b32 v228, a4
v_accvgpr_read_b32 v229, a5
v_accvgpr_read_b32 v230, a6
v_accvgpr_read_b32 v231, a7
v_pk_mul_f32 v[228:229], v[228:229], v[252:253] op_sel:[0,0] op_sel_hi:[1,0]
v_pk_mul_f32 v[230:231], v[230:231], v[252:253] op_sel:[0,0] op_sel_hi:[1,0]
v_pk_fma_f32 v[228:229], v[224:225], v[254:255], v[228:229] op_sel:[0,0,0] op_sel_hi:[1,0,1]
v_pk_fma_f32 v[230:231], v[226:227], v[254:255], v[230:231] op_sel:[0,0,0] op_sel_hi:[1,0,1]
v_cvt_pk_bf16_f32 v34, v228, v229
v_cvt_pk_bf16_f32 v35, v230, v231
v_accvgpr_read_b32 v232, a40
v_accvgpr_read_b32 v233, a41
v_accvgpr_read_b32 v234, a42
v_accvgpr_read_b32 v235, a43
v_pk_mul_f32 v[232:233], v[232:233], v[252:253] op_sel:[0,1] op_sel_hi:[1,1]
v_pk_mul_f32 v[234:235], v[234:235], v[252:253] op_sel:[0,1] op_sel_hi:[1,1]
v_pk_fma_f32 v[232:233], v[224:225], v[254:255], v[232:233] op_sel:[0,1,0] op_sel_hi:[1,1,1]
v_pk_fma_f32 v[234:235], v[226:227], v[254:255], v[234:235] op_sel:[0,1,0] op_sel_hi:[1,1,1]
v_cvt_pk_bf16_f32 v52, v232, v233
v_cvt_pk_bf16_f32 v53, v234, v235
v_accvgpr_read_b32 v208, a80
v_accvgpr_read_b32 v209, a81
v_accvgpr_read_b32 v210, a82
v_accvgpr_read_b32 v211, a83
v_accvgpr_read_b32 v212, a8
v_accvgpr_read_b32 v213, a9
v_accvgpr_read_b32 v214, a10
v_accvgpr_read_b32 v215, a11
v_pk_mul_f32 v[212:213], v[212:213], v[252:253] op_sel:[0,0] op_sel_hi:[1,0]
v_pk_mul_f32 v[214:215], v[214:215], v[252:253] op_sel:[0,0] op_sel_hi:[1,0]
v_pk_fma_f32 v[212:213], v[208:209], v[254:255], v[212:213] op_sel:[0,0,0] op_sel_hi:[1,0,1]
v_pk_fma_f32 v[214:215], v[210:211], v[254:255], v[214:215] op_sel:[0,0,0] op_sel_hi:[1,0,1]
v_cvt_pk_bf16_f32 v36, v212, v213
v_cvt_pk_bf16_f32 v37, v214, v215
v_accvgpr_read_b32 v216, a44
v_accvgpr_read_b32 v217, a45
v_accvgpr_read_b32 v218, a46
v_accvgpr_read_b32 v219, a47
v_pk_mul_f32 v[216:217], v[216:217], v[252:253] op_sel:[0,1] op_sel_hi:[1,1]
v_pk_mul_f32 v[218:219], v[218:219], v[252:253] op_sel:[0,1] op_sel_hi:[1,1]
v_pk_fma_f32 v[216:217], v[208:209], v[254:255], v[216:217] op_sel:[0,1,0] op_sel_hi:[1,1,1]
v_pk_fma_f32 v[218:219], v[210:211], v[254:255], v[218:219] op_sel:[0,1,0] op_sel_hi:[1,1,1]
v_cvt_pk_bf16_f32 v54, v216, v217
v_cvt_pk_bf16_f32 v55, v218, v219
v_accvgpr_read_b32 v224, a84
v_accvgpr_read_b32 v225, a85
v_accvgpr_read_b32 v226, a86
v_accvgpr_read_b32 v227, a87
v_accvgpr_read_b32 v228, a12
v_accvgpr_read_b32 v229, a13
v_accvgpr_read_b32 v230, a14
v_accvgpr_read_b32 v231, a15
v_pk_mul_f32 v[228:229], v[228:229], v[252:253] op_sel:[0,0] op_sel_hi:[1,0]
v_pk_mul_f32 v[230:231], v[230:231], v[252:253] op_sel:[0,0] op_sel_hi:[1,0]
v_pk_fma_f32 v[228:229], v[224:225], v[254:255], v[228:229] op_sel:[0,0,0] op_sel_hi:[1,0,1]
v_pk_fma_f32 v[230:231], v[226:227], v[254:255], v[230:231] op_sel:[0,0,0] op_sel_hi:[1,0,1]
v_cvt_pk_bf16_f32 v38, v228, v229
v_cvt_pk_bf16_f32 v39, v230, v231
v_accvgpr_read_b32 v232, a48
v_accvgpr_read_b32 v233, a49
v_accvgpr_read_b32 v234, a50
v_accvgpr_read_b32 v235, a51
v_pk_mul_f32 v[232:233], v[232:233], v[252:253] op_sel:[0,1] op_sel_hi:[1,1]
v_pk_mul_f32 v[234:235], v[234:235], v[252:253] op_sel:[0,1] op_sel_hi:[1,1]
v_pk_fma_f32 v[232:233], v[224:225], v[254:255], v[232:233] op_sel:[0,1,0] op_sel_hi:[1,1,1]
v_pk_fma_f32 v[234:235], v[226:227], v[254:255], v[234:235] op_sel:[0,1,0] op_sel_hi:[1,1,1]
v_cvt_pk_bf16_f32 v56, v232, v233
v_cvt_pk_bf16_f32 v57, v234, v235
v_accvgpr_read_b32 v208, a88
v_accvgpr_read_b32 v209, a89
v_accvgpr_read_b32 v210, a90
v_accvgpr_read_b32 v211, a91
v_accvgpr_read_b32 v212, a16
v_accvgpr_read_b32 v213, a17
v_accvgpr_read_b32 v214, a18
v_accvgpr_read_b32 v215, a19
v_pk_mul_f32 v[212:213], v[212:213], v[252:253] op_sel:[0,0] op_sel_hi:[1,0]
v_pk_mul_f32 v[214:215], v[214:215], v[252:253] op_sel:[0,0] op_sel_hi:[1,0]
v_pk_fma_f32 v[212:213], v[208:209], v[254:255], v[212:213] op_sel:[0,0,0] op_sel_hi:[1,0,1]
v_pk_fma_f32 v[214:215], v[210:211], v[254:255], v[214:215] op_sel:[0,0,0] op_sel_hi:[1,0,1]
v_cvt_pk_bf16_f32 v40, v212, v213
v_cvt_pk_bf16_f32 v41, v214, v215
v_accvgpr_read_b32 v216, a52
v_accvgpr_read_b32 v217, a53
v_accvgpr_read_b32 v218, a54
v_accvgpr_read_b32 v219, a55
v_pk_mul_f32 v[216:217], v[216:217], v[252:253] op_sel:[0,1] op_sel_hi:[1,1]
v_pk_mul_f32 v[218:219], v[218:219], v[252:253] op_sel:[0,1] op_sel_hi:[1,1]
v_pk_fma_f32 v[216:217], v[208:209], v[254:255], v[216:217] op_sel:[0,1,0] op_sel_hi:[1,1,1]
v_pk_fma_f32 v[218:219], v[210:211], v[254:255], v[218:219] op_sel:[0,1,0] op_sel_hi:[1,1,1]
v_cvt_pk_bf16_f32 v58, v216, v217
v_cvt_pk_bf16_f32 v59, v218, v219
v_accvgpr_read_b32 v224, a92
v_accvgpr_read_b32 v225, a93
v_accvgpr_read_b32 v226, a94
v_accvgpr_read_b32 v227, a95
v_accvgpr_read_b32 v228, a20
v_accvgpr_read_b32 v229, a21
v_accvgpr_read_b32 v230, a22
v_accvgpr_read_b32 v231, a23
v_pk_mul_f32 v[228:229], v[228:229], v[252:253] op_sel:[0,0] op_sel_hi:[1,0]
v_pk_mul_f32 v[230:231], v[230:231], v[252:253] op_sel:[0,0] op_sel_hi:[1,0]
v_pk_fma_f32 v[228:229], v[224:225], v[254:255], v[228:229] op_sel:[0,0,0] op_sel_hi:[1,0,1]
v_pk_fma_f32 v[230:231], v[226:227], v[254:255], v[230:231] op_sel:[0,0,0] op_sel_hi:[1,0,1]
v_cvt_pk_bf16_f32 v42, v228, v229
v_cvt_pk_bf16_f32 v43, v230, v231
v_accvgpr_read_b32 v232, a56
v_accvgpr_read_b32 v233, a57
v_accvgpr_read_b32 v234, a58
v_accvgpr_read_b32 v235, a59
v_pk_mul_f32 v[232:233], v[232:233], v[252:253] op_sel:[0,1] op_sel_hi:[1,1]
v_pk_mul_f32 v[234:235], v[234:235], v[252:253] op_sel:[0,1] op_sel_hi:[1,1]
v_pk_fma_f32 v[232:233], v[224:225], v[254:255], v[232:233] op_sel:[0,1,0] op_sel_hi:[1,1,1]
v_pk_fma_f32 v[234:235], v[226:227], v[254:255], v[234:235] op_sel:[0,1,0] op_sel_hi:[1,1,1]
v_cvt_pk_bf16_f32 v60, v232, v233
v_cvt_pk_bf16_f32 v61, v234, v235
v_accvgpr_read_b32 v208, a96
v_accvgpr_read_b32 v209, a97
v_accvgpr_read_b32 v210, a98
v_accvgpr_read_b32 v211, a99
v_accvgpr_read_b32 v212, a24
v_accvgpr_read_b32 v213, a25
v_accvgpr_read_b32 v214, a26
v_accvgpr_read_b32 v215, a27
v_pk_mul_f32 v[212:213], v[212:213], v[252:253] op_sel:[0,0] op_sel_hi:[1,0]
v_pk_mul_f32 v[214:215], v[214:215], v[252:253] op_sel:[0,0] op_sel_hi:[1,0]
v_pk_fma_f32 v[212:213], v[208:209], v[254:255], v[212:213] op_sel:[0,0,0] op_sel_hi:[1,0,1]
v_pk_fma_f32 v[214:215], v[210:211], v[254:255], v[214:215] op_sel:[0,0,0] op_sel_hi:[1,0,1]
v_cvt_pk_bf16_f32 v44, v212, v213
v_cvt_pk_bf16_f32 v45, v214, v215
v_accvgpr_read_b32 v216, a60
v_accvgpr_read_b32 v217, a61
v_accvgpr_read_b32 v218, a62
v_accvgpr_read_b32 v219, a63
v_pk_mul_f32 v[216:217], v[216:217], v[252:253] op_sel:[0,1] op_sel_hi:[1,1]
v_pk_mul_f32 v[218:219], v[218:219], v[252:253] op_sel:[0,1] op_sel_hi:[1,1]
v_pk_fma_f32 v[216:217], v[208:209], v[254:255], v[216:217] op_sel:[0,1,0] op_sel_hi:[1,1,1]
v_pk_fma_f32 v[218:219], v[210:211], v[254:255], v[218:219] op_sel:[0,1,0] op_sel_hi:[1,1,1]
v_cvt_pk_bf16_f32 v62, v216, v217
v_cvt_pk_bf16_f32 v63, v218, v219
v_accvgpr_read_b32 v224, a100
v_accvgpr_read_b32 v225, a101
v_accvgpr_read_b32 v226, a102
v_accvgpr_read_b32 v227, a103
v_accvgpr_read_b32 v228, a28
v_accvgpr_read_b32 v229, a29
v_accvgpr_read_b32 v230, a30
v_accvgpr_read_b32 v231, a31
v_pk_mul_f32 v[228:229], v[228:229], v[252:253] op_sel:[0,0] op_sel_hi:[1,0]
v_pk_mul_f32 v[230:231], v[230:231], v[252:253] op_sel:[0,0] op_sel_hi:[1,0]
v_pk_fma_f32 v[228:229], v[224:225], v[254:255], v[228:229] op_sel:[0,0,0] op_sel_hi:[1,0,1]
v_pk_fma_f32 v[230:231], v[226:227], v[254:255], v[230:231] op_sel:[0,0,0] op_sel_hi:[1,0,1]
v_cvt_pk_bf16_f32 v46, v228, v229
v_cvt_pk_bf16_f32 v47, v230, v231
v_accvgpr_read_b32 v232, a64
v_accvgpr_read_b32 v233, a65
v_accvgpr_read_b32 v234, a66
v_accvgpr_read_b32 v235, a67
v_pk_mul_f32 v[232:233], v[232:233], v[252:253] op_sel:[0,1] op_sel_hi:[1,1]
v_pk_mul_f32 v[234:235], v[234:235], v[252:253] op_sel:[0,1] op_sel_hi:[1,1]
v_pk_fma_f32 v[232:233], v[224:225], v[254:255], v[232:233] op_sel:[0,1,0] op_sel_hi:[1,1,1]
v_pk_fma_f32 v[234:235], v[226:227], v[254:255], v[234:235] op_sel:[0,1,0] op_sel_hi:[1,1,1]
v_cvt_pk_bf16_f32 v64, v232, v233
v_cvt_pk_bf16_f32 v65, v234, v235
v_accvgpr_read_b32 v208, a104
v_accvgpr_read_b32 v209, a105
v_accvgpr_read_b32 v210, a106
v_accvgpr_read_b32 v211, a107
v_accvgpr_read_b32 v212, a32
v_accvgpr_read_b32 v213, a33
v_accvgpr_read_b32 v214, a34
v_accvgpr_read_b32 v215, a35
v_pk_mul_f32 v[212:213], v[212:213], v[252:253] op_sel:[0,0] op_sel_hi:[1,0]
v_pk_mul_f32 v[214:215], v[214:215], v[252:253] op_sel:[0,0] op_sel_hi:[1,0]
v_pk_fma_f32 v[212:213], v[208:209], v[254:255], v[212:213] op_sel:[0,0,0] op_sel_hi:[1,0,1]
v_pk_fma_f32 v[214:215], v[210:211], v[254:255], v[214:215] op_sel:[0,0,0] op_sel_hi:[1,0,1]
v_cvt_pk_bf16_f32 v48, v212, v213
v_cvt_pk_bf16_f32 v49, v214, v215
v_accvgpr_read_b32 v216, a68
v_accvgpr_read_b32 v217, a69
v_accvgpr_read_b32 v218, a70
v_accvgpr_read_b32 v219, a71
v_pk_mul_f32 v[216:217], v[216:217], v[252:253] op_sel:[0,1] op_sel_hi:[1,1]
v_pk_mul_f32 v[218:219], v[218:219], v[252:253] op_sel:[0,1] op_sel_hi:[1,1]
v_pk_fma_f32 v[216:217], v[208:209], v[254:255], v[216:217] op_sel:[0,1,0] op_sel_hi:[1,1,1]
v_pk_fma_f32 v[218:219], v[210:211], v[254:255], v[218:219] op_sel:[0,1,0] op_sel_hi:[1,1,1]
v_cvt_pk_bf16_f32 v66, v216, v217
v_cvt_pk_bf16_f32 v67, v218, v219
s_mov_b32 s78, 0xffff
s_mov_b32 s79, 0x0
s_mov_b32 s80, 0x3fb8aa3b
s_mov_b32 s81, 0x3fb8aa3b
v_lshrrev_b32 v5, 2, v3
v_lshl_add_u32 v5, v2, 2, v5
v_lshlrev_b32 v5, 6, v5
v_and_b32 v6, 3, v3
v_lshl_add_u32 v5, v6, 3, v5
v_add_u32 v5, 147456, v5
ds_read_b64_tr_b16 v[112:113], v5 offset:0
ds_read_b64_tr_b16 v[114:115], v5 offset:1024
ds_read_b64_tr_b16 v[116:117], v5 offset:32
ds_read_b64_tr_b16 v[118:119], v5 offset:1056
ds_read_b64_tr_b16 v[120:121], v5 offset:2048
ds_read_b64_tr_b16 v[122:123], v5 offset:3072
ds_read_b64_tr_b16 v[124:125], v5 offset:2080
ds_read_b64_tr_b16 v[126:127], v5 offset:3104
ds_read_b64_tr_b16 v[128:129], v5 offset:4096
ds_read_b64_tr_b16 v[130:131], v5 offset:5120
ds_read_b64_tr_b16 v[132:133], v5 offset:4128
ds_read_b64_tr_b16 v[134:135], v5 offset:5152
ds_read_b64_tr_b16 v[136:137], v5 offset:6144
ds_read_b64_tr_b16 v[138:139], v5 offset:7168
ds_read_b64_tr_b16 v[140:141], v5 offset:6176
ds_read_b64_tr_b16 v[142:143], v5 offset:7200
ds_read_b64_tr_b16 v[144:145], v5 offset:8192
ds_read_b64_tr_b16 v[146:147], v5 offset:9216
ds_read_b64_tr_b16 v[148:149], v5 offset:8224
ds_read_b64_tr_b16 v[150:151], v5 offset:9248
ds_read_b64_tr_b16 v[152:153], v5 offset:10240
ds_read_b64_tr_b16 v[154:155], v5 offset:11264
ds_read_b64_tr_b16 v[156:157], v5 offset:10272
ds_read_b64_tr_b16 v[158:159], v5 offset:11296
ds_read_b64_tr_b16 v[160:161], v5 offset:12288
ds_read_b64_tr_b16 v[162:163], v5 offset:13312
ds_read_b64_tr_b16 v[164:165], v5 offset:12320
ds_read_b64_tr_b16 v[166:167], v5 offset:13344
ds_read_b64_tr_b16 v[168:169], v5 offset:14336
ds_read_b64_tr_b16 v[170:171], v5 offset:15360
ds_read_b64_tr_b16 v[172:173], v5 offset:14368
ds_read_b64_tr_b16 v[174:175], v5 offset:15392
s_waitcnt lgkmcnt(0)
s_lshl_b32 s77, s58, 3
s_lshl_b32 s76, s3, 1
s_add_u32 s77, s77, s76
s_lshl_b32 s77, s77, 5
s_add_u32 s77, s77, s69
v_lshlrev_b32 v68, 4, v1
v_lshlrev_b32 v69, 3, v3
v_mov_b32 v70, 2147418112
v_cndmask_b32 v69, v70, v69, s[78:79]
v_mfma_f32_16x16x32_bf16 v[72:75], v[112:115], v[32:35], 0
v_mfma_f32_16x16x32_bf16 v[176:179], v[112:115], v[50:53], 0
v_mfma_f32_16x16x32_bf16 v[76:79], v[116:119], v[32:35], 0
v_mfma_f32_16x16x32_bf16 v[180:183], v[116:119], v[50:53], 0
s_nop 7
v_cndmask_b32 v88, v72, v76, s[78:79]
v_cndmask_b32 v192, v176, v180, s[78:79]
v_cndmask_b32 v89, v72, v77, s[78:79]
v_cndmask_b32 v193, v176, v181, s[78:79]
v_max3_f32 v92, v72, v73, v74
v_max3_f32 v196, v176, v177, v178
v_max3_f32 v94, -v72, -v73, -v74
v_max3_f32 v198, -v176, -v177, -v178
v_max3_f32 v92, v92, v75, v88
v_max3_f32 v196, v196, v179, v192
v_max3_f32 v94, v94, -v75, -v88
v_max3_f32 v198, v198, -v179, -v192
v_max_f32 v92, v92, v89
v_max_f32 v196, v196, v193
v_max3_f32 v94, v94, -v89, -v89
v_max3_f32 v198, v198, -v193, -v193
s_nop 0
v_permlane32_swap_b32 v92, v94
v_permlane32_swap_b32 v196, v198
v_max_f32 v92, v92, v94
v_max_f32 v196, v196, v198
v_mov_b32 v90, v92
v_mov_b32 v194, v196
s_nop 0
v_permlane16_swap_b32 v92, v90
v_permlane16_swap_b32 v196, v194
v_max_f32 v92, v92, v90
v_max_f32 v196, v196, v194
v_mov_b32 v94, v92
v_mov_b32 v198, v196
s_nop 0
v_permlane32_swap_b32 v92, v94
v_permlane32_swap_b32 v196, v198
v_mul_f32 v92, s80, v92
v_mul_f32 v196, s80, v196
v_mul_f32 v94, s80, v94
v_mul_f32 v198, s80, v198
v_pk_fma_f32 v[96:97], v[72:73], s[80:81], v[92:93] op_sel_hi:[1,1,0] neg_lo:[0,0,1] neg_hi:[0,0,1]
v_pk_fma_f32 v[200:201], v[176:177], s[80:81], v[196:197] op_sel_hi:[1,1,0] neg_lo:[0,0,1] neg_hi:[0,0,1]
v_pk_fma_f32 v[102:103], v[72:73], s[80:81], v[94:95] op_sel_hi:[1,1,0] neg_lo:[1,0,1] neg_hi:[1,0,1]
v_pk_fma_f32 v[206:207], v[176:177], s[80:81], v[198:199] op_sel_hi:[1,1,0] neg_lo:[1,0,1] neg_hi:[1,0,1]
v_pk_fma_f32 v[98:99], v[74:75], s[80:81], v[92:93] op_sel_hi:[1,1,0] neg_lo:[0,0,1] neg_hi:[0,0,1]
v_pk_fma_f32 v[202:203], v[178:179], s[80:81], v[196:197] op_sel_hi:[1,1,0] neg_lo:[0,0,1] neg_hi:[0,0,1]
v_pk_fma_f32 v[104:105], v[74:75], s[80:81], v[94:95] op_sel_hi:[1,1,0] neg_lo:[1,0,1] neg_hi:[1,0,1]
v_pk_fma_f32 v[208:209], v[178:179], s[80:81], v[198:199] op_sel_hi:[1,1,0] neg_lo:[1,0,1] neg_hi:[1,0,1]
v_pk_fma_f32 v[100:101], v[76:77], s[80:81], v[92:93] op_sel_hi:[1,1,0] neg_lo:[0,0,1] neg_hi:[0,0,1]
v_pk_fma_f32 v[204:205], v[180:181], s[80:81], v[196:197] op_sel_hi:[1,1,0] neg_lo:[0,0,1] neg_hi:[0,0,1]
v_pk_fma_f32 v[106:107], v[76:77], s[80:81], v[94:95] op_sel_hi:[1,1,0] neg_lo:[1,0,1] neg_hi:[1,0,1]
v_pk_fma_f32 v[210:211], v[180:181], s[80:81], v[198:199] op_sel_hi:[1,1,0] neg_lo:[1,0,1] neg_hi:[1,0,1]
v_exp_f32 v96, v96
v_exp_f32 v200, v200
v_exp_f32 v102, v102
v_exp_f32 v206, v206
v_exp_f32 v97, v97
v_exp_f32 v201, v201
v_exp_f32 v103, v103
v_exp_f32 v207, v207
v_exp_f32 v98, v98
v_exp_f32 v202, v202
v_exp_f32 v104, v104
v_exp_f32 v208, v208
v_exp_f32 v99, v99
v_exp_f32 v203, v203
v_exp_f32 v105, v105
v_exp_f32 v209, v209
v_exp_f32 v100, v100
v_exp_f32 v204, v204
v_exp_f32 v106, v106
v_exp_f32 v210, v210
v_exp_f32 v101, v101
v_exp_f32 v205, v205
v_exp_f32 v107, v107
v_exp_f32 v211, v211
v_cndmask_b32 v100, 0, v100, s[78:79]
v_cndmask_b32 v204, 0, v204, s[78:79]
v_cndmask_b32 v106, 0, v106, s[78:79]
v_cndmask_b32 v210, 0, v210, s[78:79]
v_cndmask_b32 v101, 0, v101, s[78:79]
v_cndmask_b32 v205, 0, v205, s[78:79]
v_cndmask_b32 v107, 0, v107, s[78:79]
v_cndmask_b32 v211, 0, v211, s[78:79]
v_pk_add_f32 v[108:109], v[96:97], v[98:99]
v_pk_add_f32 v[212:213], v[200:201], v[202:203]
v_pk_add_f32 v[108:109], v[108:109], v[100:101]
v_pk_add_f32 v[212:213], v[212:213], v[204:205]
v_add_f32 v108, v108, v109
v_add_f32 v212, v212, v213
v_pk_add_f32 v[110:111], v[102:103], v[104:105]
v_pk_add_f32 v[214:215], v[206:207], v[208:209]
v_pk_add_f32 v[110:111], v[110:111], v[106:107]
v_pk_add_f32 v[214:215], v[214:215], v[210:211]
v_add_f32 v110, v110, v111
v_add_f32 v214, v214, v215
s_nop 0
v_permlane32_swap_b32 v108, v110
v_permlane32_swap_b32 v212, v214
v_add_f32 v108, v108, v110
v_add_f32 v212, v212, v214
v_mov_b32 v90, v108
v_mov_b32 v194, v212
s_nop 0
v_permlane16_swap_b32 v108, v90
v_permlane16_swap_b32 v212, v194
v_add_f32 v108, v108, v90
v_add_f32 v212, v212, v194
v_mov_b32 v110, v108
v_mov_b32 v214, v212
s_nop 0
v_permlane32_swap_b32 v108, v110
v_permlane32_swap_b32 v212, v214
v_rcp_f32 v108, v108
v_rcp_f32 v212, v212
v_rcp_f32 v110, v110
v_rcp_f32 v214, v214
v_pk_mul_f32 v[96:97], v[96:97], v[108:109] op_sel_hi:[1,0]
v_pk_mul_f32 v[200:201], v[200:201], v[212:213] op_sel_hi:[1,0]
v_pk_mul_f32 v[102:103], v[102:103], v[110:111] op_sel_hi:[1,0]
v_pk_mul_f32 v[206:207], v[206:207], v[214:215] op_sel_hi:[1,0]
v_pk_mul_f32 v[98:99], v[98:99], v[108:109] op_sel_hi:[1,0]
v_pk_mul_f32 v[202:203], v[202:203], v[212:213] op_sel_hi:[1,0]
v_pk_mul_f32 v[104:105], v[104:105], v[110:111] op_sel_hi:[1,0]
v_pk_mul_f32 v[208:209], v[208:209], v[214:215] op_sel_hi:[1,0]
v_pk_mul_f32 v[100:101], v[100:101], v[108:109] op_sel_hi:[1,0]
v_pk_mul_f32 v[204:205], v[204:205], v[212:213] op_sel_hi:[1,0]
v_pk_mul_f32 v[106:107], v[106:107], v[110:111] op_sel_hi:[1,0]
v_pk_mul_f32 v[210:211], v[210:211], v[214:215] op_sel_hi:[1,0]
v_cvt_pk_bf16_f32 v80, v96, v97
v_cvt_pk_bf16_f32 v184, v200, v201
v_cvt_pk_bf16_f32 v81, v98, v99
v_cvt_pk_bf16_f32 v185, v202, v203
v_cvt_pk_bf16_f32 v82, v102, v103
v_cvt_pk_bf16_f32 v186, v206, v207
v_cvt_pk_bf16_f32 v83, v104, v105
v_cvt_pk_bf16_f32 v187, v208, v209
v_cvt_pk_bf16_f32 v84, v100, v101
v_cvt_pk_bf16_f32 v188, v204, v205
v_cvt_pk_bf16_f32 v85, v106, v107
v_cvt_pk_bf16_f32 v189, v210, v211
s_add_u32 s82, s77, 0
s_add_u32 s86, s77, 32
s_lshl_b32 s83, s82, 10
s_lshl_b32 s87, s86, 10
s_lshl_b32 s84, s82, 7
s_lshl_b32 s88, s86, 7
s_add_u32 s84, s84, 4194304
s_add_u32 s88, s88, 4194304
buffer_store_dwordx4 v[80:83], v68, s[16:19], s83 offen sc1
buffer_store_dwordx4 v[184:187], v68, s[16:19], s87 offen sc1
buffer_store_dwordx2 v[84:85], v69, s[16:19], s84 offen
buffer_store_dwordx2 v[188:189], v69, s[16:19], s88 offen
v_mfma_f32_16x16x32_bf16 v[72:75], v[120:123], v[34:37], 0
v_mfma_f32_16x16x32_bf16 v[176:179], v[120:123], v[52:55], 0
v_mfma_f32_16x16x32_bf16 v[76:79], v[124:127], v[34:37], 0
v_mfma_f32_16x16x32_bf16 v[180:183], v[124:127], v[52:55], 0
s_nop 7
v_cndmask_b32 v88, v72, v76, s[78:79]
v_cndmask_b32 v192, v176, v180, s[78:79]
v_cndmask_b32 v89, v72, v77, s[78:79]
v_cndmask_b32 v193, v176, v181, s[78:79]
v_max3_f32 v92, v72, v73, v74
v_max3_f32 v196, v176, v177, v178
v_max3_f32 v94, -v72, -v73, -v74
v_max3_f32 v198, -v176, -v177, -v178
v_max3_f32 v92, v92, v75, v88
v_max3_f32 v196, v196, v179, v192
v_max3_f32 v94, v94, -v75, -v88
v_max3_f32 v198, v198, -v179, -v192
v_max_f32 v92, v92, v89
v_max_f32 v196, v196, v193
v_max3_f32 v94, v94, -v89, -v89
v_max3_f32 v198, v198, -v193, -v193
s_nop 0
v_permlane32_swap_b32 v92, v94
v_permlane32_swap_b32 v196, v198
v_max_f32 v92, v92, v94
v_max_f32 v196, v196, v198
v_mov_b32 v90, v92
v_mov_b32 v194, v196
s_nop 0
v_permlane16_swap_b32 v92, v90
v_permlane16_swap_b32 v196, v194
v_max_f32 v92, v92, v90
v_max_f32 v196, v196, v194
v_mov_b32 v94, v92
v_mov_b32 v198, v196
s_nop 0
v_permlane32_swap_b32 v92, v94
v_permlane32_swap_b32 v196, v198
v_mul_f32 v92, s80, v92
v_mul_f32 v196, s80, v196
v_mul_f32 v94, s80, v94
v_mul_f32 v198, s80, v198
v_pk_fma_f32 v[96:97], v[72:73], s[80:81], v[92:93] op_sel_hi:[1,1,0] neg_lo:[0,0,1] neg_hi:[0,0,1]
v_pk_fma_f32 v[200:201], v[176:177], s[80:81], v[196:197] op_sel_hi:[1,1,0] neg_lo:[0,0,1] neg_hi:[0,0,1]
v_pk_fma_f32 v[102:103], v[72:73], s[80:81], v[94:95] op_sel_hi:[1,1,0] neg_lo:[1,0,1] neg_hi:[1,0,1]
v_pk_fma_f32 v[206:207], v[176:177], s[80:81], v[198:199] op_sel_hi:[1,1,0] neg_lo:[1,0,1] neg_hi:[1,0,1]
v_pk_fma_f32 v[98:99], v[74:75], s[80:81], v[92:93] op_sel_hi:[1,1,0] neg_lo:[0,0,1] neg_hi:[0,0,1]
v_pk_fma_f32 v[202:203], v[178:179], s[80:81], v[196:197] op_sel_hi:[1,1,0] neg_lo:[0,0,1] neg_hi:[0,0,1]
v_pk_fma_f32 v[104:105], v[74:75], s[80:81], v[94:95] op_sel_hi:[1,1,0] neg_lo:[1,0,1] neg_hi:[1,0,1]
v_pk_fma_f32 v[208:209], v[178:179], s[80:81], v[198:199] op_sel_hi:[1,1,0] neg_lo:[1,0,1] neg_hi:[1,0,1]
v_pk_fma_f32 v[100:101], v[76:77], s[80:81], v[92:93] op_sel_hi:[1,1,0] neg_lo:[0,0,1] neg_hi:[0,0,1]
v_pk_fma_f32 v[204:205], v[180:181], s[80:81], v[196:197] op_sel_hi:[1,1,0] neg_lo:[0,0,1] neg_hi:[0,0,1]
v_pk_fma_f32 v[106:107], v[76:77], s[80:81], v[94:95] op_sel_hi:[1,1,0] neg_lo:[1,0,1] neg_hi:[1,0,1]
v_pk_fma_f32 v[210:211], v[180:181], s[80:81], v[198:199] op_sel_hi:[1,1,0] neg_lo:[1,0,1] neg_hi:[1,0,1]
v_exp_f32 v96, v96
v_exp_f32 v200, v200
v_exp_f32 v102, v102
v_exp_f32 v206, v206
v_exp_f32 v97, v97
v_exp_f32 v201, v201
v_exp_f32 v103, v103
v_exp_f32 v207, v207
v_exp_f32 v98, v98
v_exp_f32 v202, v202
v_exp_f32 v104, v104
v_exp_f32 v208, v208
v_exp_f32 v99, v99
v_exp_f32 v203, v203
v_exp_f32 v105, v105
v_exp_f32 v209, v209
v_exp_f32 v100, v100
v_exp_f32 v204, v204
v_exp_f32 v106, v106
v_exp_f32 v210, v210
v_exp_f32 v101, v101
v_exp_f32 v205, v205
v_exp_f32 v107, v107
v_exp_f32 v211, v211
v_cndmask_b32 v100, 0, v100, s[78:79]
v_cndmask_b32 v204, 0, v204, s[78:79]
v_cndmask_b32 v106, 0, v106, s[78:79]
v_cndmask_b32 v210, 0, v210, s[78:79]
v_cndmask_b32 v101, 0, v101, s[78:79]
v_cndmask_b32 v205, 0, v205, s[78:79]
v_cndmask_b32 v107, 0, v107, s[78:79]
v_cndmask_b32 v211, 0, v211, s[78:79]
v_pk_add_f32 v[108:109], v[96:97], v[98:99]
v_pk_add_f32 v[212:213], v[200:201], v[202:203]
v_pk_add_f32 v[108:109], v[108:109], v[100:101]
v_pk_add_f32 v[212:213], v[212:213], v[204:205]
v_add_f32 v108, v108, v109
v_add_f32 v212, v212, v213
v_pk_add_f32 v[110:111], v[102:103], v[104:105]
v_pk_add_f32 v[214:215], v[206:207], v[208:209]
v_pk_add_f32 v[110:111], v[110:111], v[106:107]
v_pk_add_f32 v[214:215], v[214:215], v[210:211]
v_add_f32 v110, v110, v111
v_add_f32 v214, v214, v215
s_nop 0
v_permlane32_swap_b32 v108, v110
v_permlane32_swap_b32 v212, v214
v_add_f32 v108, v108, v110
v_add_f32 v212, v212, v214
v_mov_b32 v90, v108
v_mov_b32 v194, v212
s_nop 0
v_permlane16_swap_b32 v108, v90
v_permlane16_swap_b32 v212, v194
v_add_f32 v108, v108, v90
v_add_f32 v212, v212, v194
v_mov_b32 v110, v108
v_mov_b32 v214, v212
s_nop 0
v_permlane32_swap_b32 v108, v110
v_permlane32_swap_b32 v212, v214
v_rcp_f32 v108, v108
v_rcp_f32 v212, v212
v_rcp_f32 v110, v110
v_rcp_f32 v214, v214
v_pk_mul_f32 v[96:97], v[96:97], v[108:109] op_sel_hi:[1,0]
v_pk_mul_f32 v[200:201], v[200:201], v[212:213] op_sel_hi:[1,0]
v_pk_mul_f32 v[102:103], v[102:103], v[110:111] op_sel_hi:[1,0]
v_pk_mul_f32 v[206:207], v[206:207], v[214:215] op_sel_hi:[1,0]
v_pk_mul_f32 v[98:99], v[98:99], v[108:109] op_sel_hi:[1,0]
v_pk_mul_f32 v[202:203], v[202:203], v[212:213] op_sel_hi:[1,0]
v_pk_mul_f32 v[104:105], v[104:105], v[110:111] op_sel_hi:[1,0]
v_pk_mul_f32 v[208:209], v[208:209], v[214:215] op_sel_hi:[1,0]
v_pk_mul_f32 v[100:101], v[100:101], v[108:109] op_sel_hi:[1,0]
v_pk_mul_f32 v[204:205], v[204:205], v[212:213] op_sel_hi:[1,0]
v_pk_mul_f32 v[106:107], v[106:107], v[110:111] op_sel_hi:[1,0]
v_pk_mul_f32 v[210:211], v[210:211], v[214:215] op_sel_hi:[1,0]
v_cvt_pk_bf16_f32 v80, v96, v97
v_cvt_pk_bf16_f32 v184, v200, v201
v_cvt_pk_bf16_f32 v81, v98, v99
v_cvt_pk_bf16_f32 v185, v202, v203
v_cvt_pk_bf16_f32 v82, v102, v103
v_cvt_pk_bf16_f32 v186, v206, v207
v_cvt_pk_bf16_f32 v83, v104, v105
v_cvt_pk_bf16_f32 v187, v208, v209
v_cvt_pk_bf16_f32 v84, v100, v101
v_cvt_pk_bf16_f32 v188, v204, v205
v_cvt_pk_bf16_f32 v85, v106, v107
v_cvt_pk_bf16_f32 v189, v210, v211
s_add_u32 s82, s77, 1
s_add_u32 s86, s77, 33
s_lshl_b32 s83, s82, 10
s_lshl_b32 s87, s86, 10
s_lshl_b32 s84, s82, 7
s_lshl_b32 s88, s86, 7
s_add_u32 s84, s84, 4194304
s_add_u32 s88, s88, 4194304
buffer_store_dwordx4 v[80:83], v68, s[16:19], s83 offen sc1
buffer_store_dwordx4 v[184:187], v68, s[16:19], s87 offen sc1
buffer_store_dwordx2 v[84:85], v69, s[16:19], s84 offen
buffer_store_dwordx2 v[188:189], v69, s[16:19], s88 offen
v_mfma_f32_16x16x32_bf16 v[72:75], v[128:131], v[36:39], 0
v_mfma_f32_16x16x32_bf16 v[176:179], v[128:131], v[54:57], 0
v_mfma_f32_16x16x32_bf16 v[76:79], v[132:135], v[36:39], 0
v_mfma_f32_16x16x32_bf16 v[180:183], v[132:135], v[54:57], 0
s_nop 7
v_cndmask_b32 v88, v72, v76, s[78:79]
v_cndmask_b32 v192, v176, v180, s[78:79]
v_cndmask_b32 v89, v72, v77, s[78:79]
v_cndmask_b32 v193, v176, v181, s[78:79]
v_max3_f32 v92, v72, v73, v74
v_max3_f32 v196, v176, v177, v178
v_max3_f32 v94, -v72, -v73, -v74
v_max3_f32 v198, -v176, -v177, -v178
v_max3_f32 v92, v92, v75, v88
v_max3_f32 v196, v196, v179, v192
v_max3_f32 v94, v94, -v75, -v88
v_max3_f32 v198, v198, -v179, -v192
v_max_f32 v92, v92, v89
v_max_f32 v196, v196, v193
v_max3_f32 v94, v94, -v89, -v89
v_max3_f32 v198, v198, -v193, -v193
s_nop 0
v_permlane32_swap_b32 v92, v94
v_permlane32_swap_b32 v196, v198
v_max_f32 v92, v92, v94
v_max_f32 v196, v196, v198
v_mov_b32 v90, v92
v_mov_b32 v194, v196
s_nop 0
v_permlane16_swap_b32 v92, v90
v_permlane16_swap_b32 v196, v194
v_max_f32 v92, v92, v90
v_max_f32 v196, v196, v194
v_mov_b32 v94, v92
v_mov_b32 v198, v196
s_nop 0
v_permlane32_swap_b32 v92, v94
v_permlane32_swap_b32 v196, v198
v_mul_f32 v92, s80, v92
v_mul_f32 v196, s80, v196
v_mul_f32 v94, s80, v94
v_mul_f32 v198, s80, v198
v_pk_fma_f32 v[96:97], v[72:73], s[80:81], v[92:93] op_sel_hi:[1,1,0] neg_lo:[0,0,1] neg_hi:[0,0,1]
v_pk_fma_f32 v[200:201], v[176:177], s[80:81], v[196:197] op_sel_hi:[1,1,0] neg_lo:[0,0,1] neg_hi:[0,0,1]
v_pk_fma_f32 v[102:103], v[72:73], s[80:81], v[94:95] op_sel_hi:[1,1,0] neg_lo:[1,0,1] neg_hi:[1,0,1]
v_pk_fma_f32 v[206:207], v[176:177], s[80:81], v[198:199] op_sel_hi:[1,1,0] neg_lo:[1,0,1] neg_hi:[1,0,1]
v_pk_fma_f32 v[98:99], v[74:75], s[80:81], v[92:93] op_sel_hi:[1,1,0] neg_lo:[0,0,1] neg_hi:[0,0,1]
v_pk_fma_f32 v[202:203], v[178:179], s[80:81], v[196:197] op_sel_hi:[1,1,0] neg_lo:[0,0,1] neg_hi:[0,0,1]
v_pk_fma_f32 v[104:105], v[74:75], s[80:81], v[94:95] op_sel_hi:[1,1,0] neg_lo:[1,0,1] neg_hi:[1,0,1]
v_pk_fma_f32 v[208:209], v[178:179], s[80:81], v[198:199] op_sel_hi:[1,1,0] neg_lo:[1,0,1] neg_hi:[1,0,1]
v_pk_fma_f32 v[100:101], v[76:77], s[80:81], v[92:93] op_sel_hi:[1,1,0] neg_lo:[0,0,1] neg_hi:[0,0,1]
v_pk_fma_f32 v[204:205], v[180:181], s[80:81], v[196:197] op_sel_hi:[1,1,0] neg_lo:[0,0,1] neg_hi:[0,0,1]
v_pk_fma_f32 v[106:107], v[76:77], s[80:81], v[94:95] op_sel_hi:[1,1,0] neg_lo:[1,0,1] neg_hi:[1,0,1]
v_pk_fma_f32 v[210:211], v[180:181], s[80:81], v[198:199] op_sel_hi:[1,1,0] neg_lo:[1,0,1] neg_hi:[1,0,1]
v_exp_f32 v96, v96
v_exp_f32 v200, v200
v_exp_f32 v102, v102
v_exp_f32 v206, v206
v_exp_f32 v97, v97
v_exp_f32 v201, v201
v_exp_f32 v103, v103
v_exp_f32 v207, v207
v_exp_f32 v98, v98
v_exp_f32 v202, v202
v_exp_f32 v104, v104
v_exp_f32 v208, v208
v_exp_f32 v99, v99
v_exp_f32 v203, v203
v_exp_f32 v105, v105
v_exp_f32 v209, v209
v_exp_f32 v100, v100
v_exp_f32 v204, v204
v_exp_f32 v106, v106
v_exp_f32 v210, v210
v_exp_f32 v101, v101
v_exp_f32 v205, v205
v_exp_f32 v107, v107
v_exp_f32 v211, v211
v_cndmask_b32 v100, 0, v100, s[78:79]
v_cndmask_b32 v204, 0, v204, s[78:79]
v_cndmask_b32 v106, 0, v106, s[78:79]
v_cndmask_b32 v210, 0, v210, s[78:79]
v_cndmask_b32 v101, 0, v101, s[78:79]
v_cndmask_b32 v205, 0, v205, s[78:79]
v_cndmask_b32 v107, 0, v107, s[78:79]
v_cndmask_b32 v211, 0, v211, s[78:79]
v_pk_add_f32 v[108:109], v[96:97], v[98:99]
v_pk_add_f32 v[212:213], v[200:201], v[202:203]
v_pk_add_f32 v[108:109], v[108:109], v[100:101]
v_pk_add_f32 v[212:213], v[212:213], v[204:205]
v_add_f32 v108, v108, v109
v_add_f32 v212, v212, v213
v_pk_add_f32 v[110:111], v[102:103], v[104:105]
v_pk_add_f32 v[214:215], v[206:207], v[208:209]
v_pk_add_f32 v[110:111], v[110:111], v[106:107]
v_pk_add_f32 v[214:215], v[214:215], v[210:211]
v_add_f32 v110, v110, v111
v_add_f32 v214, v214, v215
s_nop 0
v_permlane32_swap_b32 v108, v110
v_permlane32_swap_b32 v212, v214
v_add_f32 v108, v108, v110
v_add_f32 v212, v212, v214
v_mov_b32 v90, v108
v_mov_b32 v194, v212
s_nop 0
v_permlane16_swap_b32 v108, v90
v_permlane16_swap_b32 v212, v194
v_add_f32 v108, v108, v90
v_add_f32 v212, v212, v194
v_mov_b32 v110, v108
v_mov_b32 v214, v212
s_nop 0
v_permlane32_swap_b32 v108, v110
v_permlane32_swap_b32 v212, v214
v_rcp_f32 v108, v108
v_rcp_f32 v212, v212
v_rcp_f32 v110, v110
v_rcp_f32 v214, v214
v_pk_mul_f32 v[96:97], v[96:97], v[108:109] op_sel_hi:[1,0]
v_pk_mul_f32 v[200:201], v[200:201], v[212:213] op_sel_hi:[1,0]
v_pk_mul_f32 v[102:103], v[102:103], v[110:111] op_sel_hi:[1,0]
v_pk_mul_f32 v[206:207], v[206:207], v[214:215] op_sel_hi:[1,0]
v_pk_mul_f32 v[98:99], v[98:99], v[108:109] op_sel_hi:[1,0]
v_pk_mul_f32 v[202:203], v[202:203], v[212:213] op_sel_hi:[1,0]
v_pk_mul_f32 v[104:105], v[104:105], v[110:111] op_sel_hi:[1,0]
v_pk_mul_f32 v[208:209], v[208:209], v[214:215] op_sel_hi:[1,0]
v_pk_mul_f32 v[100:101], v[100:101], v[108:109] op_sel_hi:[1,0]
v_pk_mul_f32 v[204:205], v[204:205], v[212:213] op_sel_hi:[1,0]
v_pk_mul_f32 v[106:107], v[106:107], v[110:111] op_sel_hi:[1,0]
v_pk_mul_f32 v[210:211], v[210:211], v[214:215] op_sel_hi:[1,0]
v_cvt_pk_bf16_f32 v80, v96, v97
v_cvt_pk_bf16_f32 v184, v200, v201
v_cvt_pk_bf16_f32 v81, v98, v99
v_cvt_pk_bf16_f32 v185, v202, v203
v_cvt_pk_bf16_f32 v82, v102, v103
v_cvt_pk_bf16_f32 v186, v206, v207
v_cvt_pk_bf16_f32 v83, v104, v105
v_cvt_pk_bf16_f32 v187, v208, v209
v_cvt_pk_bf16_f32 v84, v100, v101
v_cvt_pk_bf16_f32 v188, v204, v205
v_cvt_pk_bf16_f32 v85, v106, v107
v_cvt_pk_bf16_f32 v189, v210, v211
s_add_u32 s82, s77, 2
s_add_u32 s86, s77, 34
s_lshl_b32 s83, s82, 10
s_lshl_b32 s87, s86, 10
s_lshl_b32 s84, s82, 7
s_lshl_b32 s88, s86, 7
s_add_u32 s84, s84, 4194304
s_add_u32 s88, s88, 4194304
buffer_store_dwordx4 v[80:83], v68, s[16:19], s83 offen sc1
buffer_store_dwordx4 v[184:187], v68, s[16:19], s87 offen sc1
buffer_store_dwordx2 v[84:85], v69, s[16:19], s84 offen
buffer_store_dwordx2 v[188:189], v69, s[16:19], s88 offen
v_mfma_f32_16x16x32_bf16 v[72:75], v[136:139], v[38:41], 0
v_mfma_f32_16x16x32_bf16 v[176:179], v[136:139], v[56:59], 0
v_mfma_f32_16x16x32_bf16 v[76:79], v[140:143], v[38:41], 0
v_mfma_f32_16x16x32_bf16 v[180:183], v[140:143], v[56:59], 0
s_nop 7
v_cndmask_b32 v88, v72, v76, s[78:79]
v_cndmask_b32 v192, v176, v180, s[78:79]
v_cndmask_b32 v89, v72, v77, s[78:79]
v_cndmask_b32 v193, v176, v181, s[78:79]
v_max3_f32 v92, v72, v73, v74
v_max3_f32 v196, v176, v177, v178
v_max3_f32 v94, -v72, -v73, -v74
v_max3_f32 v198, -v176, -v177, -v178
v_max3_f32 v92, v92, v75, v88
v_max3_f32 v196, v196, v179, v192
v_max3_f32 v94, v94, -v75, -v88
v_max3_f32 v198, v198, -v179, -v192
v_max_f32 v92, v92, v89
v_max_f32 v196, v196, v193
v_max3_f32 v94, v94, -v89, -v89
v_max3_f32 v198, v198, -v193, -v193
s_nop 0
v_permlane32_swap_b32 v92, v94
v_permlane32_swap_b32 v196, v198
v_max_f32 v92, v92, v94
v_max_f32 v196, v196, v198
v_mov_b32 v90, v92
v_mov_b32 v194, v196
s_nop 0
v_permlane16_swap_b32 v92, v90
v_permlane16_swap_b32 v196, v194
v_max_f32 v92, v92, v90
v_max_f32 v196, v196, v194
v_mov_b32 v94, v92
v_mov_b32 v198, v196
s_nop 0
v_permlane32_swap_b32 v92, v94
v_permlane32_swap_b32 v196, v198
v_mul_f32 v92, s80, v92
v_mul_f32 v196, s80, v196
v_mul_f32 v94, s80, v94
v_mul_f32 v198, s80, v198
v_pk_fma_f32 v[96:97], v[72:73], s[80:81], v[92:93] op_sel_hi:[1,1,0] neg_lo:[0,0,1] neg_hi:[0,0,1]
v_pk_fma_f32 v[200:201], v[176:177], s[80:81], v[196:197] op_sel_hi:[1,1,0] neg_lo:[0,0,1] neg_hi:[0,0,1]
v_pk_fma_f32 v[102:103], v[72:73], s[80:81], v[94:95] op_sel_hi:[1,1,0] neg_lo:[1,0,1] neg_hi:[1,0,1]
v_pk_fma_f32 v[206:207], v[176:177], s[80:81], v[198:199] op_sel_hi:[1,1,0] neg_lo:[1,0,1] neg_hi:[1,0,1]
v_pk_fma_f32 v[98:99], v[74:75], s[80:81], v[92:93] op_sel_hi:[1,1,0] neg_lo:[0,0,1] neg_hi:[0,0,1]
v_pk_fma_f32 v[202:203], v[178:179], s[80:81], v[196:197] op_sel_hi:[1,1,0] neg_lo:[0,0,1] neg_hi:[0,0,1]
v_pk_fma_f32 v[104:105], v[74:75], s[80:81], v[94:95] op_sel_hi:[1,1,0] neg_lo:[1,0,1] neg_hi:[1,0,1]
v_pk_fma_f32 v[208:209], v[178:179], s[80:81], v[198:199] op_sel_hi:[1,1,0] neg_lo:[1,0,1] neg_hi:[1,0,1]
v_pk_fma_f32 v[100:101], v[76:77], s[80:81], v[92:93] op_sel_hi:[1,1,0] neg_lo:[0,0,1] neg_hi:[0,0,1]
v_pk_fma_f32 v[204:205], v[180:181], s[80:81], v[196:197] op_sel_hi:[1,1,0] neg_lo:[0,0,1] neg_hi:[0,0,1]
v_pk_fma_f32 v[106:107], v[76:77], s[80:81], v[94:95] op_sel_hi:[1,1,0] neg_lo:[1,0,1] neg_hi:[1,0,1]
v_pk_fma_f32 v[210:211], v[180:181], s[80:81], v[198:199] op_sel_hi:[1,1,0] neg_lo:[1,0,1] neg_hi:[1,0,1]
v_exp_f32 v96, v96
v_exp_f32 v200, v200
v_exp_f32 v102, v102
v_exp_f32 v206, v206
v_exp_f32 v97, v97
v_exp_f32 v201, v201
v_exp_f32 v103, v103
v_exp_f32 v207, v207
v_exp_f32 v98, v98
v_exp_f32 v202, v202
v_exp_f32 v104, v104
v_exp_f32 v208, v208
v_exp_f32 v99, v99
v_exp_f32 v203, v203
v_exp_f32 v105, v105
v_exp_f32 v209, v209
v_exp_f32 v100, v100
v_exp_f32 v204, v204
v_exp_f32 v106, v106
v_exp_f32 v210, v210
v_exp_f32 v101, v101
v_exp_f32 v205, v205
v_exp_f32 v107, v107
v_exp_f32 v211, v211
v_cndmask_b32 v100, 0, v100, s[78:79]
v_cndmask_b32 v204, 0, v204, s[78:79]
v_cndmask_b32 v106, 0, v106, s[78:79]
v_cndmask_b32 v210, 0, v210, s[78:79]
v_cndmask_b32 v101, 0, v101, s[78:79]
v_cndmask_b32 v205, 0, v205, s[78:79]
v_cndmask_b32 v107, 0, v107, s[78:79]
v_cndmask_b32 v211, 0, v211, s[78:79]
v_pk_add_f32 v[108:109], v[96:97], v[98:99]
v_pk_add_f32 v[212:213], v[200:201], v[202:203]
v_pk_add_f32 v[108:109], v[108:109], v[100:101]
v_pk_add_f32 v[212:213], v[212:213], v[204:205]
v_add_f32 v108, v108, v109
v_add_f32 v212, v212, v213
v_pk_add_f32 v[110:111], v[102:103], v[104:105]
v_pk_add_f32 v[214:215], v[206:207], v[208:209]
v_pk_add_f32 v[110:111], v[110:111], v[106:107]
v_pk_add_f32 v[214:215], v[214:215], v[210:211]
v_add_f32 v110, v110, v111
v_add_f32 v214, v214, v215
s_nop 0
v_permlane32_swap_b32 v108, v110
v_permlane32_swap_b32 v212, v214
v_add_f32 v108, v108, v110
v_add_f32 v212, v212, v214
v_mov_b32 v90, v108
v_mov_b32 v194, v212
s_nop 0
v_permlane16_swap_b32 v108, v90
v_permlane16_swap_b32 v212, v194
v_add_f32 v108, v108, v90
v_add_f32 v212, v212, v194
v_mov_b32 v110, v108
v_mov_b32 v214, v212
s_nop 0
v_permlane32_swap_b32 v108, v110
v_permlane32_swap_b32 v212, v214
v_rcp_f32 v108, v108
v_rcp_f32 v212, v212
v_rcp_f32 v110, v110
v_rcp_f32 v214, v214
v_pk_mul_f32 v[96:97], v[96:97], v[108:109] op_sel_hi:[1,0]
v_pk_mul_f32 v[200:201], v[200:201], v[212:213] op_sel_hi:[1,0]
v_pk_mul_f32 v[102:103], v[102:103], v[110:111] op_sel_hi:[1,0]
v_pk_mul_f32 v[206:207], v[206:207], v[214:215] op_sel_hi:[1,0]
v_pk_mul_f32 v[98:99], v[98:99], v[108:109] op_sel_hi:[1,0]
v_pk_mul_f32 v[202:203], v[202:203], v[212:213] op_sel_hi:[1,0]
v_pk_mul_f32 v[104:105], v[104:105], v[110:111] op_sel_hi:[1,0]
v_pk_mul_f32 v[208:209], v[208:209], v[214:215] op_sel_hi:[1,0]
v_pk_mul_f32 v[100:101], v[100:101], v[108:109] op_sel_hi:[1,0]
v_pk_mul_f32 v[204:205], v[204:205], v[212:213] op_sel_hi:[1,0]
v_pk_mul_f32 v[106:107], v[106:107], v[110:111] op_sel_hi:[1,0]
v_pk_mul_f32 v[210:211], v[210:211], v[214:215] op_sel_hi:[1,0]
v_cvt_pk_bf16_f32 v80, v96, v97
v_cvt_pk_bf16_f32 v184, v200, v201
v_cvt_pk_bf16_f32 v81, v98, v99
v_cvt_pk_bf16_f32 v185, v202, v203
v_cvt_pk_bf16_f32 v82, v102, v103
v_cvt_pk_bf16_f32 v186, v206, v207
v_cvt_pk_bf16_f32 v83, v104, v105
v_cvt_pk_bf16_f32 v187, v208, v209
v_cvt_pk_bf16_f32 v84, v100, v101
v_cvt_pk_bf16_f32 v188, v204, v205
v_cvt_pk_bf16_f32 v85, v106, v107
v_cvt_pk_bf16_f32 v189, v210, v211
s_add_u32 s82, s77, 3
s_add_u32 s86, s77, 35
s_lshl_b32 s83, s82, 10
s_lshl_b32 s87, s86, 10
s_lshl_b32 s84, s82, 7
s_lshl_b32 s88, s86, 7
s_add_u32 s84, s84, 4194304
s_add_u32 s88, s88, 4194304
buffer_store_dwordx4 v[80:83], v68, s[16:19], s83 offen sc1
buffer_store_dwordx4 v[184:187], v68, s[16:19], s87 offen sc1
buffer_store_dwordx2 v[84:85], v69, s[16:19], s84 offen
buffer_store_dwordx2 v[188:189], v69, s[16:19], s88 offen
v_mfma_f32_16x16x32_bf16 v[72:75], v[144:147], v[40:43], 0
v_mfma_f32_16x16x32_bf16 v[176:179], v[144:147], v[58:61], 0
v_mfma_f32_16x16x32_bf16 v[76:79], v[148:151], v[40:43], 0
v_mfma_f32_16x16x32_bf16 v[180:183], v[148:151], v[58:61], 0
s_nop 7
v_cndmask_b32 v88, v72, v76, s[78:79]
v_cndmask_b32 v192, v176, v180, s[78:79]
v_cndmask_b32 v89, v72, v77, s[78:79]
v_cndmask_b32 v193, v176, v181, s[78:79]
v_max3_f32 v92, v72, v73, v74
v_max3_f32 v196, v176, v177, v178
v_max3_f32 v94, -v72, -v73, -v74
v_max3_f32 v198, -v176, -v177, -v178
v_max3_f32 v92, v92, v75, v88
v_max3_f32 v196, v196, v179, v192
v_max3_f32 v94, v94, -v75, -v88
v_max3_f32 v198, v198, -v179, -v192
v_max_f32 v92, v92, v89
v_max_f32 v196, v196, v193
v_max3_f32 v94, v94, -v89, -v89
v_max3_f32 v198, v198, -v193, -v193
s_nop 0
v_permlane32_swap_b32 v92, v94
v_permlane32_swap_b32 v196, v198
v_max_f32 v92, v92, v94
v_max_f32 v196, v196, v198
v_mov_b32 v90, v92
v_mov_b32 v194, v196
s_nop 0
v_permlane16_swap_b32 v92, v90
v_permlane16_swap_b32 v196, v194
v_max_f32 v92, v92, v90
v_max_f32 v196, v196, v194
v_mov_b32 v94, v92
v_mov_b32 v198, v196
s_nop 0
v_permlane32_swap_b32 v92, v94
v_permlane32_swap_b32 v196, v198
v_mul_f32 v92, s80, v92
v_mul_f32 v196, s80, v196
v_mul_f32 v94, s80, v94
v_mul_f32 v198, s80, v198
v_pk_fma_f32 v[96:97], v[72:73], s[80:81], v[92:93] op_sel_hi:[1,1,0] neg_lo:[0,0,1] neg_hi:[0,0,1]
v_pk_fma_f32 v[200:201], v[176:177], s[80:81], v[196:197] op_sel_hi:[1,1,0] neg_lo:[0,0,1] neg_hi:[0,0,1]
v_pk_fma_f32 v[102:103], v[72:73], s[80:81], v[94:95] op_sel_hi:[1,1,0] neg_lo:[1,0,1] neg_hi:[1,0,1]
v_pk_fma_f32 v[206:207], v[176:177], s[80:81], v[198:199] op_sel_hi:[1,1,0] neg_lo:[1,0,1] neg_hi:[1,0,1]
v_pk_fma_f32 v[98:99], v[74:75], s[80:81], v[92:93] op_sel_hi:[1,1,0] neg_lo:[0,0,1] neg_hi:[0,0,1]
v_pk_fma_f32 v[202:203], v[178:179], s[80:81], v[196:197] op_sel_hi:[1,1,0] neg_lo:[0,0,1] neg_hi:[0,0,1]
v_pk_fma_f32 v[104:105], v[74:75], s[80:81], v[94:95] op_sel_hi:[1,1,0] neg_lo:[1,0,1] neg_hi:[1,0,1]
v_pk_fma_f32 v[208:209], v[178:179], s[80:81], v[198:199] op_sel_hi:[1,1,0] neg_lo:[1,0,1] neg_hi:[1,0,1]
v_pk_fma_f32 v[100:101], v[76:77], s[80:81], v[92:93] op_sel_hi:[1,1,0] neg_lo:[0,0,1] neg_hi:[0,0,1]
v_pk_fma_f32 v[204:205], v[180:181], s[80:81], v[196:197] op_sel_hi:[1,1,0] neg_lo:[0,0,1] neg_hi:[0,0,1]
v_pk_fma_f32 v[106:107], v[76:77], s[80:81], v[94:95] op_sel_hi:[1,1,0] neg_lo:[1,0,1] neg_hi:[1,0,1]
v_pk_fma_f32 v[210:211], v[180:181], s[80:81], v[198:199] op_sel_hi:[1,1,0] neg_lo:[1,0,1] neg_hi:[1,0,1]
v_exp_f32 v96, v96
v_exp_f32 v200, v200
v_exp_f32 v102, v102
v_exp_f32 v206, v206
v_exp_f32 v97, v97
v_exp_f32 v201, v201
v_exp_f32 v103, v103
v_exp_f32 v207, v207
v_exp_f32 v98, v98
v_exp_f32 v202, v202
v_exp_f32 v104, v104
v_exp_f32 v208, v208
v_exp_f32 v99, v99
v_exp_f32 v203, v203
v_exp_f32 v105, v105
v_exp_f32 v209, v209
v_exp_f32 v100, v100
v_exp_f32 v204, v204
v_exp_f32 v106, v106
v_exp_f32 v210, v210
v_exp_f32 v101, v101
v_exp_f32 v205, v205
v_exp_f32 v107, v107
v_exp_f32 v211, v211
v_cndmask_b32 v100, 0, v100, s[78:79]
v_cndmask_b32 v204, 0, v204, s[78:79]
v_cndmask_b32 v106, 0, v106, s[78:79]
v_cndmask_b32 v210, 0, v210, s[78:79]
v_cndmask_b32 v101, 0, v101, s[78:79]
v_cndmask_b32 v205, 0, v205, s[78:79]
v_cndmask_b32 v107, 0, v107, s[78:79]
v_cndmask_b32 v211, 0, v211, s[78:79]
v_pk_add_f32 v[108:109], v[96:97], v[98:99]
v_pk_add_f32 v[212:213], v[200:201], v[202:203]
v_pk_add_f32 v[108:109], v[108:109], v[100:101]
v_pk_add_f32 v[212:213], v[212:213], v[204:205]
v_add_f32 v108, v108, v109
v_add_f32 v212, v212, v213
v_pk_add_f32 v[110:111], v[102:103], v[104:105]
v_pk_add_f32 v[214:215], v[206:207], v[208:209]
v_pk_add_f32 v[110:111], v[110:111], v[106:107]
v_pk_add_f32 v[214:215], v[214:215], v[210:211]
v_add_f32 v110, v110, v111
v_add_f32 v214, v214, v215
s_nop 0
v_permlane32_swap_b32 v108, v110
v_permlane32_swap_b32 v212, v214
v_add_f32 v108, v108, v110
v_add_f32 v212, v212, v214
v_mov_b32 v90, v108
v_mov_b32 v194, v212
s_nop 0
v_permlane16_swap_b32 v108, v90
v_permlane16_swap_b32 v212, v194
v_add_f32 v108, v108, v90
v_add_f32 v212, v212, v194
v_mov_b32 v110, v108
v_mov_b32 v214, v212
s_nop 0
v_permlane32_swap_b32 v108, v110
v_permlane32_swap_b32 v212, v214
v_rcp_f32 v108, v108
v_rcp_f32 v212, v212
v_rcp_f32 v110, v110
v_rcp_f32 v214, v214
v_pk_mul_f32 v[96:97], v[96:97], v[108:109] op_sel_hi:[1,0]
v_pk_mul_f32 v[200:201], v[200:201], v[212:213] op_sel_hi:[1,0]
v_pk_mul_f32 v[102:103], v[102:103], v[110:111] op_sel_hi:[1,0]
v_pk_mul_f32 v[206:207], v[206:207], v[214:215] op_sel_hi:[1,0]
v_pk_mul_f32 v[98:99], v[98:99], v[108:109] op_sel_hi:[1,0]
v_pk_mul_f32 v[202:203], v[202:203], v[212:213] op_sel_hi:[1,0]
v_pk_mul_f32 v[104:105], v[104:105], v[110:111] op_sel_hi:[1,0]
v_pk_mul_f32 v[208:209], v[208:209], v[214:215] op_sel_hi:[1,0]
v_pk_mul_f32 v[100:101], v[100:101], v[108:109] op_sel_hi:[1,0]
v_pk_mul_f32 v[204:205], v[204:205], v[212:213] op_sel_hi:[1,0]
v_pk_mul_f32 v[106:107], v[106:107], v[110:111] op_sel_hi:[1,0]
v_pk_mul_f32 v[210:211], v[210:211], v[214:215] op_sel_hi:[1,0]
v_cvt_pk_bf16_f32 v80, v96, v97
v_cvt_pk_bf16_f32 v184, v200, v201
v_cvt_pk_bf16_f32 v81, v98, v99
v_cvt_pk_bf16_f32 v185, v202, v203
v_cvt_pk_bf16_f32 v82, v102, v103
v_cvt_pk_bf16_f32 v186, v206, v207
v_cvt_pk_bf16_f32 v83, v104, v105
v_cvt_pk_bf16_f32 v187, v208, v209
v_cvt_pk_bf16_f32 v84, v100, v101
v_cvt_pk_bf16_f32 v188, v204, v205
v_cvt_pk_bf16_f32 v85, v106, v107
v_cvt_pk_bf16_f32 v189, v210, v211
s_add_u32 s82, s77, 4
s_add_u32 s86, s77, 36
s_lshl_b32 s83, s82, 10
s_lshl_b32 s87, s86, 10
s_lshl_b32 s84, s82, 7
s_lshl_b32 s88, s86, 7
s_add_u32 s84, s84, 4194304
s_add_u32 s88, s88, 4194304
buffer_store_dwordx4 v[80:83], v68, s[16:19], s83 offen sc1
buffer_store_dwordx4 v[184:187], v68, s[16:19], s87 offen sc1
buffer_store_dwordx2 v[84:85], v69, s[16:19], s84 offen
buffer_store_dwordx2 v[188:189], v69, s[16:19], s88 offen
v_mfma_f32_16x16x32_bf16 v[72:75], v[152:155], v[42:45], 0
v_mfma_f32_16x16x32_bf16 v[176:179], v[152:155], v[60:63], 0
v_mfma_f32_16x16x32_bf16 v[76:79], v[156:159], v[42:45], 0
v_mfma_f32_16x16x32_bf16 v[180:183], v[156:159], v[60:63], 0
s_nop 7
v_cndmask_b32 v88, v72, v76, s[78:79]
v_cndmask_b32 v192, v176, v180, s[78:79]
v_cndmask_b32 v89, v72, v77, s[78:79]
v_cndmask_b32 v193, v176, v181, s[78:79]
v_max3_f32 v92, v72, v73, v74
v_max3_f32 v196, v176, v177, v178
v_max3_f32 v94, -v72, -v73, -v74
v_max3_f32 v198, -v176, -v177, -v178
v_max3_f32 v92, v92, v75, v88
v_max3_f32 v196, v196, v179, v192
v_max3_f32 v94, v94, -v75, -v88
v_max3_f32 v198, v198, -v179, -v192
v_max_f32 v92, v92, v89
v_max_f32 v196, v196, v193
v_max3_f32 v94, v94, -v89, -v89
v_max3_f32 v198, v198, -v193, -v193
s_nop 0
v_permlane32_swap_b32 v92, v94
v_permlane32_swap_b32 v196, v198
v_max_f32 v92, v92, v94
v_max_f32 v196, v196, v198
v_mov_b32 v90, v92
v_mov_b32 v194, v196
s_nop 0
v_permlane16_swap_b32 v92, v90
v_permlane16_swap_b32 v196, v194
v_max_f32 v92, v92, v90
v_max_f32 v196, v196, v194
v_mov_b32 v94, v92
v_mov_b32 v198, v196
s_nop 0
v_permlane32_swap_b32 v92, v94
v_permlane32_swap_b32 v196, v198
v_mul_f32 v92, s80, v92
v_mul_f32 v196, s80, v196
v_mul_f32 v94, s80, v94
v_mul_f32 v198, s80, v198
v_pk_fma_f32 v[96:97], v[72:73], s[80:81], v[92:93] op_sel_hi:[1,1,0] neg_lo:[0,0,1] neg_hi:[0,0,1]
v_pk_fma_f32 v[200:201], v[176:177], s[80:81], v[196:197] op_sel_hi:[1,1,0] neg_lo:[0,0,1] neg_hi:[0,0,1]
v_pk_fma_f32 v[102:103], v[72:73], s[80:81], v[94:95] op_sel_hi:[1,1,0] neg_lo:[1,0,1] neg_hi:[1,0,1]
v_pk_fma_f32 v[206:207], v[176:177], s[80:81], v[198:199] op_sel_hi:[1,1,0] neg_lo:[1,0,1] neg_hi:[1,0,1]
v_pk_fma_f32 v[98:99], v[74:75], s[80:81], v[92:93] op_sel_hi:[1,1,0] neg_lo:[0,0,1] neg_hi:[0,0,1]
v_pk_fma_f32 v[202:203], v[178:179], s[80:81], v[196:197] op_sel_hi:[1,1,0] neg_lo:[0,0,1] neg_hi:[0,0,1]
v_pk_fma_f32 v[104:105], v[74:75], s[80:81], v[94:95] op_sel_hi:[1,1,0] neg_lo:[1,0,1] neg_hi:[1,0,1]
v_pk_fma_f32 v[208:209], v[178:179], s[80:81], v[198:199] op_sel_hi:[1,1,0] neg_lo:[1,0,1] neg_hi:[1,0,1]
v_pk_fma_f32 v[100:101], v[76:77], s[80:81], v[92:93] op_sel_hi:[1,1,0] neg_lo:[0,0,1] neg_hi:[0,0,1]
v_pk_fma_f32 v[204:205], v[180:181], s[80:81], v[196:197] op_sel_hi:[1,1,0] neg_lo:[0,0,1] neg_hi:[0,0,1]
v_pk_fma_f32 v[106:107], v[76:77], s[80:81], v[94:95] op_sel_hi:[1,1,0] neg_lo:[1,0,1] neg_hi:[1,0,1]
v_pk_fma_f32 v[210:211], v[180:181], s[80:81], v[198:199] op_sel_hi:[1,1,0] neg_lo:[1,0,1] neg_hi:[1,0,1]
v_exp_f32 v96, v96
v_exp_f32 v200, v200
v_exp_f32 v102, v102
v_exp_f32 v206, v206
v_exp_f32 v97, v97
v_exp_f32 v201, v201
v_exp_f32 v103, v103
v_exp_f32 v207, v207
v_exp_f32 v98, v98
v_exp_f32 v202, v202
v_exp_f32 v104, v104
v_exp_f32 v208, v208
v_exp_f32 v99, v99
v_exp_f32 v203, v203
v_exp_f32 v105, v105
v_exp_f32 v209, v209
v_exp_f32 v100, v100
v_exp_f32 v204, v204
v_exp_f32 v106, v106
v_exp_f32 v210, v210
v_exp_f32 v101, v101
v_exp_f32 v205, v205
v_exp_f32 v107, v107
v_exp_f32 v211, v211
v_cndmask_b32 v100, 0, v100, s[78:79]
v_cndmask_b32 v204, 0, v204, s[78:79]
v_cndmask_b32 v106, 0, v106, s[78:79]
v_cndmask_b32 v210, 0, v210, s[78:79]
v_cndmask_b32 v101, 0, v101, s[78:79]
v_cndmask_b32 v205, 0, v205, s[78:79]
v_cndmask_b32 v107, 0, v107, s[78:79]
v_cndmask_b32 v211, 0, v211, s[78:79]
v_pk_add_f32 v[108:109], v[96:97], v[98:99]
v_pk_add_f32 v[212:213], v[200:201], v[202:203]
v_pk_add_f32 v[108:109], v[108:109], v[100:101]
v_pk_add_f32 v[212:213], v[212:213], v[204:205]
v_add_f32 v108, v108, v109
v_add_f32 v212, v212, v213
v_pk_add_f32 v[110:111], v[102:103], v[104:105]
v_pk_add_f32 v[214:215], v[206:207], v[208:209]
v_pk_add_f32 v[110:111], v[110:111], v[106:107]
v_pk_add_f32 v[214:215], v[214:215], v[210:211]
v_add_f32 v110, v110, v111
v_add_f32 v214, v214, v215
s_nop 0
v_permlane32_swap_b32 v108, v110
v_permlane32_swap_b32 v212, v214
v_add_f32 v108, v108, v110
v_add_f32 v212, v212, v214
v_mov_b32 v90, v108
v_mov_b32 v194, v212
s_nop 0
v_permlane16_swap_b32 v108, v90
v_permlane16_swap_b32 v212, v194
v_add_f32 v108, v108, v90
v_add_f32 v212, v212, v194
v_mov_b32 v110, v108
v_mov_b32 v214, v212
s_nop 0
v_permlane32_swap_b32 v108, v110
v_permlane32_swap_b32 v212, v214
v_rcp_f32 v108, v108
v_rcp_f32 v212, v212
v_rcp_f32 v110, v110
v_rcp_f32 v214, v214
v_pk_mul_f32 v[96:97], v[96:97], v[108:109] op_sel_hi:[1,0]
v_pk_mul_f32 v[200:201], v[200:201], v[212:213] op_sel_hi:[1,0]
v_pk_mul_f32 v[102:103], v[102:103], v[110:111] op_sel_hi:[1,0]
v_pk_mul_f32 v[206:207], v[206:207], v[214:215] op_sel_hi:[1,0]
v_pk_mul_f32 v[98:99], v[98:99], v[108:109] op_sel_hi:[1,0]
v_pk_mul_f32 v[202:203], v[202:203], v[212:213] op_sel_hi:[1,0]
v_pk_mul_f32 v[104:105], v[104:105], v[110:111] op_sel_hi:[1,0]
v_pk_mul_f32 v[208:209], v[208:209], v[214:215] op_sel_hi:[1,0]
v_pk_mul_f32 v[100:101], v[100:101], v[108:109] op_sel_hi:[1,0]
v_pk_mul_f32 v[204:205], v[204:205], v[212:213] op_sel_hi:[1,0]
v_pk_mul_f32 v[106:107], v[106:107], v[110:111] op_sel_hi:[1,0]
v_pk_mul_f32 v[210:211], v[210:211], v[214:215] op_sel_hi:[1,0]
v_cvt_pk_bf16_f32 v80, v96, v97
v_cvt_pk_bf16_f32 v184, v200, v201
v_cvt_pk_bf16_f32 v81, v98, v99
v_cvt_pk_bf16_f32 v185, v202, v203
v_cvt_pk_bf16_f32 v82, v102, v103
v_cvt_pk_bf16_f32 v186, v206, v207
v_cvt_pk_bf16_f32 v83, v104, v105
v_cvt_pk_bf16_f32 v187, v208, v209
v_cvt_pk_bf16_f32 v84, v100, v101
v_cvt_pk_bf16_f32 v188, v204, v205
v_cvt_pk_bf16_f32 v85, v106, v107
v_cvt_pk_bf16_f32 v189, v210, v211
s_add_u32 s82, s77, 5
s_add_u32 s86, s77, 37
s_lshl_b32 s83, s82, 10
s_lshl_b32 s87, s86, 10
s_lshl_b32 s84, s82, 7
s_lshl_b32 s88, s86, 7
s_add_u32 s84, s84, 4194304
s_add_u32 s88, s88, 4194304
buffer_store_dwordx4 v[80:83], v68, s[16:19], s83 offen sc1
buffer_store_dwordx4 v[184:187], v68, s[16:19], s87 offen sc1
buffer_store_dwordx2 v[84:85], v69, s[16:19], s84 offen
buffer_store_dwordx2 v[188:189], v69, s[16:19], s88 offen
v_mfma_f32_16x16x32_bf16 v[72:75], v[160:163], v[44:47], 0
v_mfma_f32_16x16x32_bf16 v[176:179], v[160:163], v[62:65], 0
v_mfma_f32_16x16x32_bf16 v[76:79], v[164:167], v[44:47], 0
v_mfma_f32_16x16x32_bf16 v[180:183], v[164:167], v[62:65], 0
s_nop 7
v_cndmask_b32 v88, v72, v76, s[78:79]
v_cndmask_b32 v192, v176, v180, s[78:79]
v_cndmask_b32 v89, v72, v77, s[78:79]
v_cndmask_b32 v193, v176, v181, s[78:79]
v_max3_f32 v92, v72, v73, v74
v_max3_f32 v196, v176, v177, v178
v_max3_f32 v94, -v72, -v73, -v74
v_max3_f32 v198, -v176, -v177, -v178
v_max3_f32 v92, v92, v75, v88
v_max3_f32 v196, v196, v179, v192
v_max3_f32 v94, v94, -v75, -v88
v_max3_f32 v198, v198, -v179, -v192
v_max_f32 v92, v92, v89
v_max_f32 v196, v196, v193
v_max3_f32 v94, v94, -v89, -v89
v_max3_f32 v198, v198, -v193, -v193
s_nop 0
v_permlane32_swap_b32 v92, v94
v_permlane32_swap_b32 v196, v198
v_max_f32 v92, v92, v94
v_max_f32 v196, v196, v198
v_mov_b32 v90, v92
v_mov_b32 v194, v196
s_nop 0
v_permlane16_swap_b32 v92, v90
v_permlane16_swap_b32 v196, v194
v_max_f32 v92, v92, v90
v_max_f32 v196, v196, v194
v_mov_b32 v94, v92
v_mov_b32 v198, v196
s_nop 0
v_permlane32_swap_b32 v92, v94
v_permlane32_swap_b32 v196, v198
v_mul_f32 v92, s80, v92
v_mul_f32 v196, s80, v196
v_mul_f32 v94, s80, v94
v_mul_f32 v198, s80, v198
v_pk_fma_f32 v[96:97], v[72:73], s[80:81], v[92:93] op_sel_hi:[1,1,0] neg_lo:[0,0,1] neg_hi:[0,0,1]
v_pk_fma_f32 v[200:201], v[176:177], s[80:81], v[196:197] op_sel_hi:[1,1,0] neg_lo:[0,0,1] neg_hi:[0,0,1]
v_pk_fma_f32 v[102:103], v[72:73], s[80:81], v[94:95] op_sel_hi:[1,1,0] neg_lo:[1,0,1] neg_hi:[1,0,1]
v_pk_fma_f32 v[206:207], v[176:177], s[80:81], v[198:199] op_sel_hi:[1,1,0] neg_lo:[1,0,1] neg_hi:[1,0,1]
v_pk_fma_f32 v[98:99], v[74:75], s[80:81], v[92:93] op_sel_hi:[1,1,0] neg_lo:[0,0,1] neg_hi:[0,0,1]
v_pk_fma_f32 v[202:203], v[178:179], s[80:81], v[196:197] op_sel_hi:[1,1,0] neg_lo:[0,0,1] neg_hi:[0,0,1]
v_pk_fma_f32 v[104:105], v[74:75], s[80:81], v[94:95] op_sel_hi:[1,1,0] neg_lo:[1,0,1] neg_hi:[1,0,1]
v_pk_fma_f32 v[208:209], v[178:179], s[80:81], v[198:199] op_sel_hi:[1,1,0] neg_lo:[1,0,1] neg_hi:[1,0,1]
v_pk_fma_f32 v[100:101], v[76:77], s[80:81], v[92:93] op_sel_hi:[1,1,0] neg_lo:[0,0,1] neg_hi:[0,0,1]
v_pk_fma_f32 v[204:205], v[180:181], s[80:81], v[196:197] op_sel_hi:[1,1,0] neg_lo:[0,0,1] neg_hi:[0,0,1]
v_pk_fma_f32 v[106:107], v[76:77], s[80:81], v[94:95] op_sel_hi:[1,1,0] neg_lo:[1,0,1] neg_hi:[1,0,1]
v_pk_fma_f32 v[210:211], v[180:181], s[80:81], v[198:199] op_sel_hi:[1,1,0] neg_lo:[1,0,1] neg_hi:[1,0,1]
v_exp_f32 v96, v96
v_exp_f32 v200, v200
v_exp_f32 v102, v102
v_exp_f32 v206, v206
v_exp_f32 v97, v97
v_exp_f32 v201, v201
v_exp_f32 v103, v103
v_exp_f32 v207, v207
v_exp_f32 v98, v98
v_exp_f32 v202, v202
v_exp_f32 v104, v104
v_exp_f32 v208, v208
v_exp_f32 v99, v99
v_exp_f32 v203, v203
v_exp_f32 v105, v105
v_exp_f32 v209, v209
v_exp_f32 v100, v100
v_exp_f32 v204, v204
v_exp_f32 v106, v106
v_exp_f32 v210, v210
v_exp_f32 v101, v101
v_exp_f32 v205, v205
v_exp_f32 v107, v107
v_exp_f32 v211, v211
v_cndmask_b32 v100, 0, v100, s[78:79]
v_cndmask_b32 v204, 0, v204, s[78:79]
v_cndmask_b32 v106, 0, v106, s[78:79]
v_cndmask_b32 v210, 0, v210, s[78:79]
v_cndmask_b32 v101, 0, v101, s[78:79]
v_cndmask_b32 v205, 0, v205, s[78:79]
v_cndmask_b32 v107, 0, v107, s[78:79]
v_cndmask_b32 v211, 0, v211, s[78:79]
v_pk_add_f32 v[108:109], v[96:97], v[98:99]
v_pk_add_f32 v[212:213], v[200:201], v[202:203]
v_pk_add_f32 v[108:109], v[108:109], v[100:101]
v_pk_add_f32 v[212:213], v[212:213], v[204:205]
v_add_f32 v108, v108, v109
v_add_f32 v212, v212, v213
v_pk_add_f32 v[110:111], v[102:103], v[104:105]
v_pk_add_f32 v[214:215], v[206:207], v[208:209]
v_pk_add_f32 v[110:111], v[110:111], v[106:107]
v_pk_add_f32 v[214:215], v[214:215], v[210:211]
v_add_f32 v110, v110, v111
v_add_f32 v214, v214, v215
s_nop 0
v_permlane32_swap_b32 v108, v110
v_permlane32_swap_b32 v212, v214
v_add_f32 v108, v108, v110
v_add_f32 v212, v212, v214
v_mov_b32 v90, v108
v_mov_b32 v194, v212
s_nop 0
v_permlane16_swap_b32 v108, v90
v_permlane16_swap_b32 v212, v194
v_add_f32 v108, v108, v90
v_add_f32 v212, v212, v194
v_mov_b32 v110, v108
v_mov_b32 v214, v212
s_nop 0
v_permlane32_swap_b32 v108, v110
v_permlane32_swap_b32 v212, v214
v_rcp_f32 v108, v108
v_rcp_f32 v212, v212
v_rcp_f32 v110, v110
v_rcp_f32 v214, v214
v_pk_mul_f32 v[96:97], v[96:97], v[108:109] op_sel_hi:[1,0]
v_pk_mul_f32 v[200:201], v[200:201], v[212:213] op_sel_hi:[1,0]
v_pk_mul_f32 v[102:103], v[102:103], v[110:111] op_sel_hi:[1,0]
v_pk_mul_f32 v[206:207], v[206:207], v[214:215] op_sel_hi:[1,0]
v_pk_mul_f32 v[98:99], v[98:99], v[108:109] op_sel_hi:[1,0]
v_pk_mul_f32 v[202:203], v[202:203], v[212:213] op_sel_hi:[1,0]
v_pk_mul_f32 v[104:105], v[104:105], v[110:111] op_sel_hi:[1,0]
v_pk_mul_f32 v[208:209], v[208:209], v[214:215] op_sel_hi:[1,0]
v_pk_mul_f32 v[100:101], v[100:101], v[108:109] op_sel_hi:[1,0]
v_pk_mul_f32 v[204:205], v[204:205], v[212:213] op_sel_hi:[1,0]
v_pk_mul_f32 v[106:107], v[106:107], v[110:111] op_sel_hi:[1,0]
v_pk_mul_f32 v[210:211], v[210:211], v[214:215] op_sel_hi:[1,0]
v_cvt_pk_bf16_f32 v80, v96, v97
v_cvt_pk_bf16_f32 v184, v200, v201
v_cvt_pk_bf16_f32 v81, v98, v99
v_cvt_pk_bf16_f32 v185, v202, v203
v_cvt_pk_bf16_f32 v82, v102, v103
v_cvt_pk_bf16_f32 v186, v206, v207
v_cvt_pk_bf16_f32 v83, v104, v105
v_cvt_pk_bf16_f32 v187, v208, v209
v_cvt_pk_bf16_f32 v84, v100, v101
v_cvt_pk_bf16_f32 v188, v204, v205
v_cvt_pk_bf16_f32 v85, v106, v107
v_cvt_pk_bf16_f32 v189, v210, v211
s_add_u32 s82, s77, 6
s_add_u32 s86, s77, 38
s_lshl_b32 s83, s82, 10
s_lshl_b32 s87, s86, 10
s_lshl_b32 s84, s82, 7
s_lshl_b32 s88, s86, 7
s_add_u32 s84, s84, 4194304
s_add_u32 s88, s88, 4194304
buffer_store_dwordx4 v[80:83], v68, s[16:19], s83 offen sc1
buffer_store_dwordx4 v[184:187], v68, s[16:19], s87 offen sc1
buffer_store_dwordx2 v[84:85], v69, s[16:19], s84 offen
buffer_store_dwordx2 v[188:189], v69, s[16:19], s88 offen
v_mfma_f32_16x16x32_bf16 v[72:75], v[168:171], v[46:49], 0
v_mfma_f32_16x16x32_bf16 v[176:179], v[168:171], v[64:67], 0
v_mfma_f32_16x16x32_bf16 v[76:79], v[172:175], v[46:49], 0
v_mfma_f32_16x16x32_bf16 v[180:183], v[172:175], v[64:67], 0
s_nop 7
v_cndmask_b32 v88, v72, v76, s[78:79]
v_cndmask_b32 v192, v176, v180, s[78:79]
v_cndmask_b32 v89, v72, v77, s[78:79]
v_cndmask_b32 v193, v176, v181, s[78:79]
v_max3_f32 v92, v72, v73, v74
v_max3_f32 v196, v176, v177, v178
v_max3_f32 v94, -v72, -v73, -v74
v_max3_f32 v198, -v176, -v177, -v178
v_max3_f32 v92, v92, v75, v88
v_max3_f32 v196, v196, v179, v192
v_max3_f32 v94, v94, -v75, -v88
v_max3_f32 v198, v198, -v179, -v192
v_max_f32 v92, v92, v89
v_max_f32 v196, v196, v193
v_max3_f32 v94, v94, -v89, -v89
v_max3_f32 v198, v198, -v193, -v193
s_nop 0
v_permlane32_swap_b32 v92, v94
v_permlane32_swap_b32 v196, v198
v_max_f32 v92, v92, v94
v_max_f32 v196, v196, v198
v_mov_b32 v90, v92
v_mov_b32 v194, v196
s_nop 0
v_permlane16_swap_b32 v92, v90
v_permlane16_swap_b32 v196, v194
v_max_f32 v92, v92, v90
v_max_f32 v196, v196, v194
v_mov_b32 v94, v92
v_mov_b32 v198, v196
s_nop 0
v_permlane32_swap_b32 v92, v94
v_permlane32_swap_b32 v196, v198
v_mul_f32 v92, s80, v92
v_mul_f32 v196, s80, v196
v_mul_f32 v94, s80, v94
v_mul_f32 v198, s80, v198
v_pk_fma_f32 v[96:97], v[72:73], s[80:81], v[92:93] op_sel_hi:[1,1,0] neg_lo:[0,0,1] neg_hi:[0,0,1]
v_pk_fma_f32 v[200:201], v[176:177], s[80:81], v[196:197] op_sel_hi:[1,1,0] neg_lo:[0,0,1] neg_hi:[0,0,1]
v_pk_fma_f32 v[102:103], v[72:73], s[80:81], v[94:95] op_sel_hi:[1,1,0] neg_lo:[1,0,1] neg_hi:[1,0,1]
v_pk_fma_f32 v[206:207], v[176:177], s[80:81], v[198:199] op_sel_hi:[1,1,0] neg_lo:[1,0,1] neg_hi:[1,0,1]
v_pk_fma_f32 v[98:99], v[74:75], s[80:81], v[92:93] op_sel_hi:[1,1,0] neg_lo:[0,0,1] neg_hi:[0,0,1]
v_pk_fma_f32 v[202:203], v[178:179], s[80:81], v[196:197] op_sel_hi:[1,1,0] neg_lo:[0,0,1] neg_hi:[0,0,1]
v_pk_fma_f32 v[104:105], v[74:75], s[80:81], v[94:95] op_sel_hi:[1,1,0] neg_lo:[1,0,1] neg_hi:[1,0,1]
v_pk_fma_f32 v[208:209], v[178:179], s[80:81], v[198:199] op_sel_hi:[1,1,0] neg_lo:[1,0,1] neg_hi:[1,0,1]
v_pk_fma_f32 v[100:101], v[76:77], s[80:81], v[92:93] op_sel_hi:[1,1,0] neg_lo:[0,0,1] neg_hi:[0,0,1]
v_pk_fma_f32 v[204:205], v[180:181], s[80:81], v[196:197] op_sel_hi:[1,1,0] neg_lo:[0,0,1] neg_hi:[0,0,1]
v_pk_fma_f32 v[106:107], v[76:77], s[80:81], v[94:95] op_sel_hi:[1,1,0] neg_lo:[1,0,1] neg_hi:[1,0,1]
v_pk_fma_f32 v[210:211], v[180:181], s[80:81], v[198:199] op_sel_hi:[1,1,0] neg_lo:[1,0,1] neg_hi:[1,0,1]
v_exp_f32 v96, v96
v_exp_f32 v200, v200
v_exp_f32 v102, v102
v_exp_f32 v206, v206
v_exp_f32 v97, v97
v_exp_f32 v201, v201
v_exp_f32 v103, v103
v_exp_f32 v207, v207
v_exp_f32 v98, v98
v_exp_f32 v202, v202
v_exp_f32 v104, v104
v_exp_f32 v208, v208
v_exp_f32 v99, v99
v_exp_f32 v203, v203
v_exp_f32 v105, v105
v_exp_f32 v209, v209
v_exp_f32 v100, v100
v_exp_f32 v204, v204
v_exp_f32 v106, v106
v_exp_f32 v210, v210
v_exp_f32 v101, v101
v_exp_f32 v205, v205
v_exp_f32 v107, v107
v_exp_f32 v211, v211
v_cndmask_b32 v100, 0, v100, s[78:79]
v_cndmask_b32 v204, 0, v204, s[78:79]
v_cndmask_b32 v106, 0, v106, s[78:79]
v_cndmask_b32 v210, 0, v210, s[78:79]
v_cndmask_b32 v101, 0, v101, s[78:79]
v_cndmask_b32 v205, 0, v205, s[78:79]
v_cndmask_b32 v107, 0, v107, s[78:79]
v_cndmask_b32 v211, 0, v211, s[78:79]
v_pk_add_f32 v[108:109], v[96:97], v[98:99]
v_pk_add_f32 v[212:213], v[200:201], v[202:203]
v_pk_add_f32 v[108:109], v[108:109], v[100:101]
v_pk_add_f32 v[212:213], v[212:213], v[204:205]
v_add_f32 v108, v108, v109
v_add_f32 v212, v212, v213
v_pk_add_f32 v[110:111], v[102:103], v[104:105]
v_pk_add_f32 v[214:215], v[206:207], v[208:209]
v_pk_add_f32 v[110:111], v[110:111], v[106:107]
v_pk_add_f32 v[214:215], v[214:215], v[210:211]
v_add_f32 v110, v110, v111
v_add_f32 v214, v214, v215
s_nop 0
v_permlane32_swap_b32 v108, v110
v_permlane32_swap_b32 v212, v214
v_add_f32 v108, v108, v110
v_add_f32 v212, v212, v214
v_mov_b32 v90, v108
v_mov_b32 v194, v212
s_nop 0
v_permlane16_swap_b32 v108, v90
v_permlane16_swap_b32 v212, v194
v_add_f32 v108, v108, v90
v_add_f32 v212, v212, v194
v_mov_b32 v110, v108
v_mov_b32 v214, v212
s_nop 0
v_permlane32_swap_b32 v108, v110
v_permlane32_swap_b32 v212, v214
v_rcp_f32 v108, v108
v_rcp_f32 v212, v212
v_rcp_f32 v110, v110
v_rcp_f32 v214, v214
v_pk_mul_f32 v[96:97], v[96:97], v[108:109] op_sel_hi:[1,0]
v_pk_mul_f32 v[200:201], v[200:201], v[212:213] op_sel_hi:[1,0]
v_pk_mul_f32 v[102:103], v[102:103], v[110:111] op_sel_hi:[1,0]
v_pk_mul_f32 v[206:207], v[206:207], v[214:215] op_sel_hi:[1,0]
v_pk_mul_f32 v[98:99], v[98:99], v[108:109] op_sel_hi:[1,0]
v_pk_mul_f32 v[202:203], v[202:203], v[212:213] op_sel_hi:[1,0]
v_pk_mul_f32 v[104:105], v[104:105], v[110:111] op_sel_hi:[1,0]
v_pk_mul_f32 v[208:209], v[208:209], v[214:215] op_sel_hi:[1,0]
v_pk_mul_f32 v[100:101], v[100:101], v[108:109] op_sel_hi:[1,0]
v_pk_mul_f32 v[204:205], v[204:205], v[212:213] op_sel_hi:[1,0]
v_pk_mul_f32 v[106:107], v[106:107], v[110:111] op_sel_hi:[1,0]
v_pk_mul_f32 v[210:211], v[210:211], v[214:215] op_sel_hi:[1,0]
v_cvt_pk_bf16_f32 v80, v96, v97
v_cvt_pk_bf16_f32 v184, v200, v201
v_cvt_pk_bf16_f32 v81, v98, v99
v_cvt_pk_bf16_f32 v185, v202, v203
v_cvt_pk_bf16_f32 v82, v102, v103
v_cvt_pk_bf16_f32 v186, v206, v207
v_cvt_pk_bf16_f32 v83, v104, v105
v_cvt_pk_bf16_f32 v187, v208, v209
v_cvt_pk_bf16_f32 v84, v100, v101
v_cvt_pk_bf16_f32 v188, v204, v205
v_cvt_pk_bf16_f32 v85, v106, v107
v_cvt_pk_bf16_f32 v189, v210, v211
s_add_u32 s82, s77, 7
s_add_u32 s86, s77, 39
s_lshl_b32 s83, s82, 10
s_lshl_b32 s87, s86, 10
s_lshl_b32 s84, s82, 7
s_lshl_b32 s88, s86, 7
s_add_u32 s84, s84, 4194304
s_add_u32 s88, s88, 4194304
buffer_store_dwordx4 v[80:83], v68, s[16:19], s83 offen sc1
buffer_store_dwordx4 v[184:187], v68, s[16:19], s87 offen sc1
buffer_store_dwordx2 v[84:85], v69, s[16:19], s84 offen
buffer_store_dwordx2 v[188:189], v69, s[16:19], s88 offen
s_branch k1_end
k1_kv:
s_mul_i32 s65, s59, 144
s_and_b32 s66, s65, 0xffffff80
s_sub_u32 s67, s65, s66
s_lshr_b32 s67, s67, 4
s_add_u32 s66, s66, 1152
s_mul_i32 s78, s73, 0
s_add_u32 s78, s78, s74
buffer_load_dwordx4 v[32:35], v27, s[8:11], s78 offen
s_mul_i32 s78, s73, 0
s_add_u32 s78, s78, s74
s_add_u32 s78, s78, s79
buffer_load_dwordx4 v[36:39], v27, s[8:11], s78 offen
s_mul_i32 s78, s73, 0
s_add_u32 s78, s78, s74
s_add_u32 s78, s78, s75
buffer_load_dwordx4 v[104:107], v27, s[8:11], s78 offen
s_mul_i32 s78, s73, 0
s_add_u32 s78, s78, s74
s_add_u32 s78, s78, s75
s_add_u32 s78, s78, s79
buffer_load_dwordx4 v[108:111], v27, s[8:11], s78 offen
s_mul_i32 s78, s73, 2
s_add_u32 s78, s78, s74
buffer_load_dwordx4 v[40:43], v27, s[8:11], s78 offen
s_mul_i32 s78, s73, 2
s_add_u32 s78, s78, s74
s_add_u32 s78, s78, s79
buffer_load_dwordx4 v[44:47], v27, s[8:11], s78 offen
s_mul_i32 s78, s73, 2
s_add_u32 s78, s78, s74
s_add_u32 s78, s78, s75
buffer_load_dwordx4 v[112:115], v27, s[8:11], s78 offen
s_mul_i32 s78, s73, 2
s_add_u32 s78, s78, s74
s_add_u32 s78, s78, s75
s_add_u32 s78, s78, s79
buffer_load_dwordx4 v[116:119], v27, s[8:11], s78 offen
v_lshrrev_b32 v208, 3, v1
s_mov_b32 s89, 3456
v_mul_lo_u32 v209, v208, s89
v_bfe_u32 v210, v1, 4, 1
v_lshlrev_b32 v210, 1, v210
v_and_b32 v211, 7, v1
v_xor_b32 v211, v211, v210
v_lshl_add_u32 v16, v211, 4, v209
v_xor_b32 v211, 4, v211
v_lshl_add_u32 v17, v211, 4, v209
s_mul_i32 s56, s3, 2048
s_mul_i32 s61, s3, 55296
s_add_u32 s84, s66, s61
s_add_u32 s85, s66, s61
s_add_u32 s85, s85, 128
s_add_u32 s86, s66, s61
s_add_u32 s86, s86, 256
s_add_u32 s87, s66, s61
s_add_u32 s87, s87, 384
s_add_u32 s86, s84, 1152
s_add_u32 s87, s85, 1152
s_add_u32 s57, s84, 0
s_add_u32 m0, s56, 0
s_nop 0
buffer_load_dwordx4 v16, s[12:15], s57 offen lds
s_add_u32 s57, s85, 0
s_add_u32 m0, s56, 8192
s_nop 0
buffer_load_dwordx4 v16, s[12:15], s57 offen lds
s_add_u32 s57, s86, 0
s_add_u32 m0, s56, 16384
s_nop 0
buffer_load_dwordx4 v16, s[12:15], s57 offen lds
s_add_u32 s57, s87, 0
s_add_u32 m0, s56, 24576
s_nop 0
buffer_load_dwordx4 v16, s[12:15], s57 offen lds
s_add_u32 s57, s84, 27648
s_add_u32 m0, s56, 1024
s_nop 0
buffer_load_dwordx4 v17, s[12:15], s57 offen lds
s_add_u32 s57, s85, 27648
s_add_u32 m0, s56, 9216
s_nop 0
buffer_load_dwordx4 v17, s[12:15], s57 offen lds
s_add_u32 s57, s86, 27648
s_add_u32 m0, s56, 17408
s_nop 0
buffer_load_dwordx4 v17, s[12:15], s57 offen lds
s_add_u32 s57, s87, 27648
s_add_u32 m0, s56, 25600
s_nop 0
buffer_load_dwordx4 v17, s[12:15], s57 offen lds
s_add_u32 s57, s84, 221184
s_add_u32 m0, s56, 32768
s_nop 0
buffer_load_dwordx4 v16, s[12:15], s57 offen lds
s_add_u32 s57, s85, 221184
s_add_u32 m0, s56, 40960
s_nop 0
buffer_load_dwordx4 v16, s[12:15], s57 offen lds
s_add_u32 s57, s86, 221184
s_add_u32 m0, s56, 49152
s_nop 0
buffer_load_dwordx4 v16, s[12:15], s57 offen lds
s_add_u32 s57, s87, 221184
s_add_u32 m0, s56, 57344
s_nop 0
buffer_load_dwordx4 v16, s[12:15], s57 offen lds
s_add_u32 s57, s84, 248832
s_add_u32 m0, s56, 33792
s_nop 0
buffer_load_dwordx4 v17, s[12:15], s57 offen lds
s_add_u32 s57, s85, 248832
s_add_u32 m0, s56, 41984
s_nop 0
buffer_load_dwordx4 v17, s[12:15], s57 offen lds
s_add_u32 s57, s86, 248832
s_add_u32 m0, s56, 50176
s_nop 0
buffer_load_dwordx4 v17, s[12:15], s57 offen lds
s_add_u32 s57, s87, 248832
s_add_u32 m0, s56, 58368
s_nop 0
buffer_load_dwordx4 v17, s[12:15], s57 offen lds
s_waitcnt lgkmcnt(0)
s_barrier
s_waitcnt vmcnt(24)
ds_write_b32 v232, v224
ds_write_b32 v233, v225
ds_write_b32 v234, v226
ds_write_b32 v235, v227
ds_write_b32 v236, v228
ds_write_b32 v237, v229
v_lshrrev_b32 v208, 2, v3
v_bfe_u32 v209, v3, 3, 1
v_and_b32 v210, 1, v2
v_lshl_or_b32 v209, v210, 1, v209
v_lshlrev_b32 v209, 1, v209
v_lshl_add_u32 v208, v2, 3, v208
v_lshrrev_b32 v211, 1, v3
v_and_b32 v211, 1, v211
v_add_u32 v211, s67, v211
v_lshrrev_b32 v212, 3, v211
v_and_b32 v211, 7, v211
v_xor_b32 v211, v211, v209
v_lshlrev_b32 v208, 7, v208
v_lshl_add_u32 v208, v211, 4, v208
v_mul_u32_u24 v212, 8192, v212
v_add_u32 v208, v208, v212
v_and_b32 v210, 1, v3
v_lshl_add_u32 v8, v210, 3, v208
v_lshrrev_b32 v208, 2, v3
v_bfe_u32 v209, v3, 3, 1
v_and_b32 v210, 1, v2
v_lshl_or_b32 v209, v210, 1, v209
v_lshlrev_b32 v209, 1, v209
v_lshl_add_u32 v208, v2, 3, v208
v_lshrrev_b32 v211, 1, v3
v_and_b32 v211, 1, v211
v_add_u32 v211, 2, v211
v_add_u32 v211, s67, v211
v_lshrrev_b32 v212, 3, v211
v_and_b32 v211, 7, v211
v_xor_b32 v211, v211, v209
v_lshlrev_b32 v208, 7, v208
v_lshl_add_u32 v208, v211, 4, v208
v_mul_u32_u24 v212, 8192, v212
v_add_u32 v208, v208, v212
v_and_b32 v210, 1, v3
v_lshl_add_u32 v9, v210, 3, v208
v_lshrrev_b32 v208, 2, v3
v_bfe_u32 v209, v3, 3, 1
v_and_b32 v210, 1, v2
v_lshl_or_b32 v209, v210, 1, v209
v_lshlrev_b32 v209, 1, v209
v_lshl_add_u32 v208, v2, 3, v208
v_lshrrev_b32 v211, 1, v3
v_and_b32 v211, 1, v211
v_add_u32 v211, 4, v211
v_add_u32 v211, s67, v211
v_lshrrev_b32 v212, 3, v211
v_and_b32 v211, 7, v211
v_xor_b32 v211, v211, v209
v_lshlrev_b32 v208, 7, v208
v_lshl_add_u32 v208, v211, 4, v208
v_mul_u32_u24 v212, 8192, v212
v_add_u32 v208, v208, v212
v_and_b32 v210, 1, v3
v_lshl_add_u32 v10, v210, 3, v208
v_lshrrev_b32 v208, 2, v3
v_bfe_u32 v209, v3, 3, 1
v_and_b32 v210, 1, v2
v_lshl_or_b32 v209, v210, 1, v209
v_lshlrev_b32 v209, 1, v209
v_lshl_add_u32 v208, v2, 3, v208
v_lshrrev_b32 v211, 1, v3
v_and_b32 v211, 1, v211
v_add_u32 v211, 6, v211
v_add_u32 v211, s67, v211
v_lshrrev_b32 v212, 3, v211
v_and_b32 v211, 7, v211
v_xor_b32 v211, v211, v209
v_lshlrev_b32 v208, 7, v208
v_lshl_add_u32 v208, v211, 4, v208
v_mul_u32_u24 v212, 8192, v212
v_add_u32 v208, v208, v212
v_and_b32 v210, 1, v3
v_lshl_add_u32 v11, v210, 3, v208
v_lshrrev_b32 v208, 2, v3
v_bfe_u32 v209, v3, 3, 1
v_and_b32 v210, 1, v2
v_lshl_or_b32 v209, v210, 1, v209
v_lshlrev_b32 v209, 1, v209
v_lshl_add_u32 v208, v2, 3, v208
v_lshrrev_b32 v211, 1, v3
v_and_b32 v211, 1, v211
v_lshlrev_b32 v211, 3, v211
v_add_u32 v211, 8, v211
v_add_u32 v211, s67, v211
v_lshrrev_b32 v212, 3, v211
v_and_b32 v211, 7, v211
v_xor_b32 v211, v211, v209
v_lshlrev_b32 v208, 7, v208
v_lshl_add_u32 v208, v211, 4, v208
v_mul_u32_u24 v212, 8192, v212
v_add_u32 v208, v208, v212
v_and_b32 v210, 1, v3
v_lshl_add_u32 v12, v210, 3, v208
v_lshrrev_b32 v208, 2, v3
v_bfe_u32 v209, v3, 3, 1
v_and_b32 v210, 1, v2
v_lshl_or_b32 v209, v210, 1, v209
v_lshlrev_b32 v209, 1, v209
v_lshl_add_u32 v208, v2, 3, v208
v_lshrrev_b32 v211, 1, v3
v_and_b32 v211, 1, v211
v_add_u32 v211, 17, v211
v_add_u32 v211, s67, v211
v_lshrrev_b32 v212, 3, v211
v_and_b32 v211, 7, v211
v_xor_b32 v211, v211, v209
v_lshlrev_b32 v208, 7, v208
v_lshl_add_u32 v208, v211, 4, v208
v_mul_u32_u24 v212, 8192, v212
v_add_u32 v208, v208, v212
v_and_b32 v210, 1, v3
v_lshl_add_u32 v13, v210, 3, v208
v_lshrrev_b32 v208, 2, v3
v_bfe_u32 v209, v3, 3, 1
v_and_b32 v210, 1, v2
v_lshl_or_b32 v209, v210, 1, v209
v_lshlrev_b32 v209, 1, v209
v_lshl_add_u32 v208, v2, 3, v208
v_lshrrev_b32 v211, 1, v3
v_and_b32 v211, 1, v211
v_add_u32 v211, 19, v211
v_add_u32 v211, s67, v211
v_lshrrev_b32 v212, 3, v211
v_and_b32 v211, 7, v211
v_xor_b32 v211, v211, v209
v_lshlrev_b32 v208, 7, v208
v_lshl_add_u32 v208, v211, 4, v208
v_mul_u32_u24 v212, 8192, v212
v_add_u32 v208, v208, v212
v_and_b32 v210, 1, v3
v_lshl_add_u32 v14, v210, 3, v208
v_lshrrev_b32 v208, 2, v3
v_bfe_u32 v209, v3, 3, 1
v_and_b32 v210, 1, v2
v_lshl_or_b32 v209, v210, 1, v209
v_lshlrev_b32 v209, 1, v209
v_lshl_add_u32 v208, v2, 3, v208
v_lshrrev_b32 v211, 1, v3
v_and_b32 v211, 1, v211
v_add_u32 v211, 21, v211
v_add_u32 v211, s67, v211
v_lshrrev_b32 v212, 3, v211
v_and_b32 v211, 7, v211
v_xor_b32 v211, v211, v209
v_lshlrev_b32 v208, 7, v208
v_lshl_add_u32 v208, v211, 4, v208
v_mul_u32_u24 v212, 8192, v212
v_add_u32 v208, v208, v212
v_and_b32 v210, 1, v3
v_lshl_add_u32 v15, v210, 3, v208
v_lshrrev_b32 v208, 2, v3
v_bfe_u32 v209, v3, 3, 1
v_and_b32 v210, 1, v2
v_lshl_or_b32 v209, v210, 1, v209
v_lshlrev_b32 v209, 1, v209
v_lshl_add_u32 v208, v2, 3, v208
v_lshrrev_b32 v211, 1, v3
v_and_b32 v211, 1, v211
v_add_u32 v211, 23, v211
v_add_u32 v211, s67, v211
v_lshrrev_b32 v212, 3, v211
v_and_b32 v211, 7, v211
v_xor_b32 v211, v211, v209
v_lshlrev_b32 v208, 7, v208
v_lshl_add_u32 v208, v211, 4, v208
v_mul_u32_u24 v212, 8192, v212
v_add_u32 v208, v208, v212
v_and_b32 v210, 1, v3
v_lshl_add_u32 v29, v210, 3, v208
s_waitcnt vmcnt(8)
s_barrier
ds_read_b64_tr_b16 v[176:177], v8 offset:0
ds_read_b64_tr_b16 v[178:179], v8 offset:512
ds_read_b64_tr_b16 v[180:181], v9 offset:0
ds_read_b64_tr_b16 v[182:183], v9 offset:512
ds_read_b64_tr_b16 v[184:185], v10 offset:0
ds_read_b64_tr_b16 v[186:187], v10 offset:512
ds_read_b64_tr_b16 v[188:189], v11 offset:0
ds_read_b64_tr_b16 v[190:191], v11 offset:512
ds_read_b64_tr_b16 v[192:193], v12 offset:0
ds_read_b64_tr_b16 v[194:195], v12 offset:512
ds_read_b64_tr_b16 v[196:197], v13 offset:0
ds_read_b64_tr_b16 v[198:199], v13 offset:512
s_mov_b64 exec, s[76:77]
v_mov_b32 v240, v36
v_mov_b32 v241, v37
v_mov_b32 v242, v38
v_mov_b32 v243, v39
v_mov_b32_dpp v36, v32 row_ror:8 row_mask:0xf bank_mask:0x3
v_mov_b32_dpp v37, v33 row_ror:8 row_mask:0xf bank_mask:0x3
v_mov_b32_dpp v38, v34 row_ror:8 row_mask:0xf bank_mask:0x3
v_mov_b32_dpp v39, v35 row_ror:8 row_mask:0xf bank_mask:0x3
v_mov_b32_dpp v32, v240 row_ror:8 row_mask:0xf bank_mask:0xc
v_mov_b32_dpp v33, v241 row_ror:8 row_mask:0xf bank_mask:0xc
v_mov_b32_dpp v34, v242 row_ror:8 row_mask:0xf bank_mask:0xc
v_mov_b32_dpp v35, v243 row_ror:8 row_mask:0xf bank_mask:0xc
v_mov_b32 v240, v108
v_mov_b32 v241, v109
v_mov_b32 v242, v110
v_mov_b32 v243, v111
v_mov_b32_dpp v108, v104 row_ror:8 row_mask:0xf bank_mask:0x3
v_mov_b32_dpp v109, v105 row_ror:8 row_mask:0xf bank_mask:0x3
v_mov_b32_dpp v110, v106 row_ror:8 row_mask:0xf bank_mask:0x3
v_mov_b32_dpp v111, v107 row_ror:8 row_mask:0xf bank_mask:0x3
v_mov_b32_dpp v104, v240 row_ror:8 row_mask:0xf bank_mask:0xc
v_mov_b32_dpp v105, v241 row_ror:8 row_mask:0xf bank_mask:0xc
v_mov_b32_dpp v106, v242 row_ror:8 row_mask:0xf bank_mask:0xc
v_mov_b32_dpp v107, v243 row_ror:8 row_mask:0xf bank_mask:0xc
s_mov_b64 exec, -1
ds_read_b64_tr_b16 v[200:201], v14 offset:0
ds_read_b64_tr_b16 v[202:203], v14 offset:512
s_waitcnt lgkmcnt(12)
v_mfma_f32_16x16x32_bf16 a[0:3], v[176:179], v[32:35], 0
s_mul_i32 s78, s73, 4
s_add_u32 s78, s78, s74
buffer_load_dwordx4 v[48:51], v27, s[8:11], s78 offen
v_mfma_f32_16x16x32_bf16 a[36:39], v[176:179], v[104:107], 0
v_mfma_f32_16x16x32_bf16 a[72:75], v[176:179], v[244:247], 0
ds_read_b64_tr_b16 v[204:205], v15 offset:0
ds_read_b64_tr_b16 v[206:207], v15 offset:512
s_waitcnt lgkmcnt(12)
v_mfma_f32_16x16x32_bf16 a[4:7], v[180:183], v[32:35], 0
s_mul_i32 s78, s73, 4
s_add_u32 s78, s78, s74
s_add_u32 s78, s78, s79
buffer_load_dwordx4 v[52:55], v27, s[8:11], s78 offen
v_mfma_f32_16x16x32_bf16 a[40:43], v[180:183], v[104:107], 0
v_mfma_f32_16x16x32_bf16 a[76:79], v[180:183], v[244:247], 0
ds_read_b64_tr_b16 v[176:177], v29 offset:0
ds_read_b64_tr_b16 v[178:179], v29 offset:512
s_waitcnt lgkmcnt(12)
v_mfma_f32_16x16x32_bf16 a[8:11], v[184:187], v[32:35], 0
s_mul_i32 s78, s73, 4
s_add_u32 s78, s78, s74
s_add_u32 s78, s78, s75
buffer_load_dwordx4 v[120:123], v27, s[8:11], s78 offen
v_mfma_f32_16x16x32_bf16 a[44:47], v[184:187], v[104:107], 0
v_mfma_f32_16x16x32_bf16 a[80:83], v[184:187], v[244:247], 0
ds_read_b64_tr_b16 v[180:181], v8 offset:4096
ds_read_b64_tr_b16 v[182:183], v8 offset:4608
s_waitcnt lgkmcnt(12)
v_mfma_f32_16x16x32_bf16 a[12:15], v[188:191], v[32:35], 0
s_mul_i32 s78, s73, 4
s_add_u32 s78, s78, s74
s_add_u32 s78, s78, s75
s_add_u32 s78, s78, s79
buffer_load_dwordx4 v[124:127], v27, s[8:11], s78 offen
v_mfma_f32_16x16x32_bf16 a[48:51], v[188:191], v[104:107], 0
v_mfma_f32_16x16x32_bf16 a[84:87], v[188:191], v[244:247], 0
ds_read_b64_tr_b16 v[184:185], v9 offset:4096
ds_read_b64_tr_b16 v[186:187], v9 offset:4608
s_waitcnt lgkmcnt(12)
v_mfma_f32_16x16x32_bf16 a[16:19], v[192:195], v[32:35], 0
s_add_u32 s57, s84, 442368
s_add_u32 m0, s56, 65536
s_nop 0
buffer_load_dwordx4 v16, s[12:15], s57 offen lds
v_mfma_f32_16x16x32_bf16 a[52:55], v[192:195], v[104:107], 0
v_mfma_f32_16x16x32_bf16 a[88:91], v[192:195], v[244:247], 0
ds_read_b64_tr_b16 v[188:189], v10 offset:4096
ds_read_b64_tr_b16 v[190:191], v10 offset:4608
s_waitcnt lgkmcnt(12)
v_mfma_f32_16x16x32_bf16 a[20:23], v[196:199], v[32:35], 0
s_add_u32 s57, s85, 442368
s_add_u32 m0, s56, 73728
s_nop 0
buffer_load_dwordx4 v16, s[12:15], s57 offen lds
v_mfma_f32_16x16x32_bf16 a[56:59], v[196:199], v[104:107], 0
s_add_u32 s57, s86, 442368
s_add_u32 m0, s56, 81920
s_nop 0
buffer_load_dwordx4 v16, s[12:15], s57 offen lds
v_mfma_f32_16x16x32_bf16 a[92:95], v[196:199], v[244:247], 0
ds_read_b64_tr_b16 v[192:193], v11 offset:4096
ds_read_b64_tr_b16 v[194:195], v11 offset:4608
s_waitcnt lgkmcnt(12)
v_mfma_f32_16x16x32_bf16 a[24:27], v[200:203], v[32:35], 0
v_mfma_f32_16x16x32_bf16 a[60:63], v[200:203], v[104:107], 0
s_add_u32 s57, s87, 442368
s_add_u32 m0, s56, 90112
s_nop 0
buffer_load_dwordx4 v16, s[12:15], s57 offen lds
v_mfma_f32_16x16x32_bf16 a[96:99], v[200:203], v[244:247], 0
ds_read_b64_tr_b16 v[196:197], v12 offset:4096
ds_read_b64_tr_b16 v[198:199], v12 offset:4608
s_waitcnt lgkmcnt(12)
v_mfma_f32_16x16x32_bf16 a[28:31], v[204:207], v[32:35], 0
v_mfma_f32_16x16x32_bf16 a[64:67], v[204:207], v[104:107], 0
s_add_u32 s57, s84, 470016
s_add_u32 m0, s56, 66560
s_nop 0
buffer_load_dwordx4 v17, s[12:15], s57 offen lds
v_mfma_f32_16x16x32_bf16 a[100:103], v[204:207], v[244:247], 0
ds_read_b64_tr_b16 v[200:201], v13 offset:4096
ds_read_b64_tr_b16 v[202:203], v13 offset:4608
s_waitcnt lgkmcnt(12)
v_mfma_f32_16x16x32_bf16 a[32:35], v[176:179], v[32:35], 0
v_mfma_f32_16x16x32_bf16 a[68:71], v[176:179], v[104:107], 0
s_add_u32 s57, s85, 470016
s_add_u32 m0, s56, 74752
s_nop 0
buffer_load_dwordx4 v17, s[12:15], s57 offen lds
v_mfma_f32_16x16x32_bf16 a[104:107], v[176:179], v[244:247], 0
ds_read_b64_tr_b16 v[204:205], v14 offset:4096
ds_read_b64_tr_b16 v[206:207], v14 offset:4608
s_waitcnt lgkmcnt(12)
v_mfma_f32_16x16x32_bf16 a[0:3], v[180:183], v[36:39], a[0:3]
v_mfma_f32_16x16x32_bf16 a[36:39], v[180:183], v[108:111], a[36:39]
s_add_u32 s57, s86, 470016
s_add_u32 m0, s56, 82944
s_nop 0
buffer_load_dwordx4 v17, s[12:15], s57 offen lds
v_mfma_f32_16x16x32_bf16 a[72:75], v[180:183], v[244:247], a[72:75]
ds_read_b64_tr_b16 v[176:177], v15 offset:4096
ds_read_b64_tr_b16 v[178:179], v15 offset:4608
s_waitcnt lgkmcnt(12)
v_mfma_f32_16x16x32_bf16 a[4:7], v[184:187], v[36:39], a[4:7]
v_mfma_f32_16x16x32_bf16 a[40:43], v[184:187], v[108:111], a[40:43]
s_add_u32 s57, s87, 470016
s_add_u32 m0, s56, 91136
s_nop 0
buffer_load_dwordx4 v17, s[12:15], s57 offen lds
v_mfma_f32_16x16x32_bf16 a[76:79], v[184:187], v[244:247], a[76:79]
ds_read_b64_tr_b16 v[180:181], v29 offset:4096
ds_read_b64_tr_b16 v[182:183], v29 offset:4608
s_waitcnt lgkmcnt(12)
v_mfma_f32_16x16x32_bf16 a[8:11], v[188:191], v[36:39], a[8:11]
v_mfma_f32_16x16x32_bf16 a[44:47], v[188:191], v[108:111], a[44:47]
v_mfma_f32_16x16x32_bf16 a[80:83], v[188:191], v[244:247], a[80:83]
s_waitcnt vmcnt(12)
s_barrier
v_add_u32 v8, 32768, v8
v_add_u32 v9, 32768, v9
v_add_u32 v10, 32768, v10
v_add_u32 v11, 32768, v11
v_add_u32 v12, 32768, v12
v_add_u32 v13, 32768, v13
v_add_u32 v14, 32768, v14
v_add_u32 v15, 32768, v15
v_add_u32 v29, 32768, v29
ds_read_b64_tr_b16 v[184:185], v8 offset:0
ds_read_b64_tr_b16 v[186:187], v8 offset:512
s_waitcnt lgkmcnt(12)
v_mfma_f32_16x16x32_bf16 a[12:15], v[192:195], v[36:39], a[12:15]
v_mfma_f32_16x16x32_bf16 a[48:51], v[192:195], v[108:111], a[48:51]
v_mfma_f32_16x16x32_bf16 a[84:87], v[192:195], v[244:247], a[84:87]
ds_read_b64_tr_b16 v[188:189], v9 offset:0
ds_read_b64_tr_b16 v[190:191], v9 offset:512
s_waitcnt lgkmcnt(12)
v_mfma_f32_16x16x32_bf16 a[16:19], v[196:199], v[36:39], a[16:19]
v_mfma_f32_16x16x32_bf16 a[52:55], v[196:199], v[108:111], a[52:55]
v_mfma_f32_16x16x32_bf16 a[88:91], v[196:199], v[244:247], a[88:91]
ds_read_b64_tr_b16 v[192:193], v10 offset:0
ds_read_b64_tr_b16 v[194:195], v10 offset:512
s_waitcnt lgkmcnt(12)
v_mfma_f32_16x16x32_bf16 a[20:23], v[200:203], v[36:39], a[20:23]
v_mfma_f32_16x16x32_bf16 a[56:59], v[200:203], v[108:111], a[56:59]
v_mfma_f32_16x16x32_bf16 a[92:95], v[200:203], v[244:247], a[92:95]
ds_read_b64_tr_b16 v[196:197], v11 offset:0
ds_read_b64_tr_b16 v[198:199], v11 offset:512
s_waitcnt lgkmcnt(12)
v_mfma_f32_16x16x32_bf16 a[24:27], v[204:207], v[36:39], a[24:27]
v_mfma_f32_16x16x32_bf16 a[60:63], v[204:207], v[108:111], a[60:63]
v_mfma_f32_16x16x32_bf16 a[96:99], v[204:207], v[244:247], a[96:99]
ds_read_b64_tr_b16 v[200:201], v12 offset:0
ds_read_b64_tr_b16 v[202:203], v12 offset:512
s_waitcnt lgkmcnt(12)
v_mfma_f32_16x16x32_bf16 a[28:31], v[176:179], v[36:39], a[28:31]
v_mfma_f32_16x16x32_bf16 a[64:67], v[176:179], v[108:111], a[64:67]
v_mfma_f32_16x16x32_bf16 a[100:103], v[176:179], v[244:247], a[100:103]
ds_read_b64_tr_b16 v[204:205], v13 offset:0
ds_read_b64_tr_b16 v[206:207], v13 offset:512
s_waitcnt lgkmcnt(12)
v_mfma_f32_16x16x32_bf16 a[32:35], v[180:183], v[36:39], a[32:35]
v_mfma_f32_16x16x32_bf16 a[68:71], v[180:183], v[108:111], a[68:71]
v_mfma_f32_16x16x32_bf16 a[104:107], v[180:183], v[244:247], a[104:107]
s_mov_b64 exec, s[76:77]
v_mov_b32 v240, v44
v_mov_b32 v241, v45
v_mov_b32 v242, v46
v_mov_b32 v243, v47
v_mov_b32_dpp v44, v40 row_ror:8 row_mask:0xf bank_mask:0x3
v_mov_b32_dpp v45, v41 row_ror:8 row_mask:0xf bank_mask:0x3
v_mov_b32_dpp v46, v42 row_ror:8 row_mask:0xf bank_mask:0x3
v_mov_b32_dpp v47, v43 row_ror:8 row_mask:0xf bank_mask:0x3
v_mov_b32_dpp v40, v240 row_ror:8 row_mask:0xf bank_mask:0xc
v_mov_b32_dpp v41, v241 row_ror:8 row_mask:0xf bank_mask:0xc
v_mov_b32_dpp v42, v242 row_ror:8 row_mask:0xf bank_mask:0xc
v_mov_b32_dpp v43, v243 row_ror:8 row_mask:0xf bank_mask:0xc
v_mov_b32 v240, v116
v_mov_b32 v241, v117
v_mov_b32 v242, v118
v_mov_b32 v243, v119
v_mov_b32_dpp v116, v112 row_ror:8 row_mask:0xf bank_mask:0x3
v_mov_b32_dpp v117, v113 row_ror:8 row_mask:0xf bank_mask:0x3
v_mov_b32_dpp v118, v114 row_ror:8 row_mask:0xf bank_mask:0x3
v_mov_b32_dpp v119, v115 row_ror:8 row_mask:0xf bank_mask:0x3
v_mov_b32_dpp v112, v240 row_ror:8 row_mask:0xf bank_mask:0xc
v_mov_b32_dpp v113, v241 row_ror:8 row_mask:0xf bank_mask:0xc
v_mov_b32_dpp v114, v242 row_ror:8 row_mask:0xf bank_mask:0xc
v_mov_b32_dpp v115, v243 row_ror:8 row_mask:0xf bank_mask:0xc
s_mov_b64 exec, -1
ds_read_b64_tr_b16 v[176:177], v14 offset:0
ds_read_b64_tr_b16 v[178:179], v14 offset:512
s_waitcnt lgkmcnt(12)
v_mfma_f32_16x16x32_bf16 a[0:3], v[184:187], v[40:43], a[0:3]
s_mul_i32 s78, s73, 6
s_add_u32 s78, s78, s74
buffer_load_dwordx4 v[56:59], v27, s[8:11], s78 offen
v_mfma_f32_16x16x32_bf16 a[36:39], v[184:187], v[112:115], a[36:39]
v_mfma_f32_16x16x32_bf16 a[72:75], v[184:187], v[244:247], a[72:75]
ds_read_b64_tr_b16 v[180:181], v15 offset:0
ds_read_b64_tr_b16 v[182:183], v15 offset:512
s_waitcnt lgkmcnt(12)
v_mfma_f32_16x16x32_bf16 a[4:7], v[188:191], v[40:43], a[4:7]
s_mul_i32 s78, s73, 6
s_add_u32 s78, s78, s74
s_add_u32 s78, s78, s79
buffer_load_dwordx4 v[60:63], v27, s[8:11], s78 offen
v_mfma_f32_16x16x32_bf16 a[40:43], v[188:191], v[112:115], a[40:43]
v_mfma_f32_16x16x32_bf16 a[76:79], v[188:191], v[244:247], a[76:79]
ds_read_b64_tr_b16 v[184:185], v29 offset:0
ds_read_b64_tr_b16 v[186:187], v29 offset:512
s_waitcnt lgkmcnt(12)
v_mfma_f32_16x16x32_bf16 a[8:11], v[192:195], v[40:43], a[8:11]
s_mul_i32 s78, s73, 6
s_add_u32 s78, s78, s74
s_add_u32 s78, s78, s75
buffer_load_dwordx4 v[128:131], v27, s[8:11], s78 offen
v_mfma_f32_16x16x32_bf16 a[44:47], v[192:195], v[112:115], a[44:47]
v_mfma_f32_16x16x32_bf16 a[80:83], v[192:195], v[244:247], a[80:83]
ds_read_b64_tr_b16 v[188:189], v8 offset:4096
ds_read_b64_tr_b16 v[190:191], v8 offset:4608
s_waitcnt lgkmcnt(12)
v_mfma_f32_16x16x32_bf16 a[12:15], v[196:199], v[40:43], a[12:15]
s_mul_i32 s78, s73, 6
s_add_u32 s78, s78, s74
s_add_u32 s78, s78, s75
s_add_u32 s78, s78, s79
buffer_load_dwordx4 v[132:135], v27, s[8:11], s78 offen
v_mfma_f32_16x16x32_bf16 a[48:51], v[196:199], v[112:115], a[48:51]
v_mfma_f32_16x16x32_bf16 a[84:87], v[196:199], v[244:247], a[84:87]
ds_read_b64_tr_b16 v[192:193], v9 offset:4096
ds_read_b64_tr_b16 v[194:195], v9 offset:4608
s_waitcnt lgkmcnt(12)
v_mfma_f32_16x16x32_bf16 a[16:19], v[200:203], v[40:43], a[16:19]
s_add_u32 s57, s84, 663552
s_add_u32 m0, s56, 98304
s_nop 0
buffer_load_dwordx4 v16, s[12:15], s57 offen lds
v_mfma_f32_16x16x32_bf16 a[52:55], v[200:203], v[112:115], a[52:55]
v_mfma_f32_16x16x32_bf16 a[88:91], v[200:203], v[244:247], a[88:91]
ds_read_b64_tr_b16 v[196:197], v10 offset:4096
ds_read_b64_tr_b16 v[198:199], v10 offset:4608
s_waitcnt lgkmcnt(12)
v_mfma_f32_16x16x32_bf16 a[20:23], v[204:207], v[40:43], a[20:23]
s_add_u32 s57, s85, 663552
s_add_u32 m0, s56, 106496
s_nop 0
buffer_load_dwordx4 v16, s[12:15], s57 offen lds
v_mfma_f32_16x16x32_bf16 a[56:59], v[204:207], v[112:115], a[56:59]
s_add_u32 s57, s86, 663552
s_add_u32 m0, s56, 114688
s_nop 0
buffer_load_dwordx4 v16, s[12:15], s57 offen lds
v_mfma_f32_16x16x32_bf16 a[92:95], v[204:207], v[244:247], a[92:95]
ds_read_b64_tr_b16 v[200:201], v11 offset:4096
ds_read_b64_tr_b16 v[202:203], v11 offset:4608
s_waitcnt lgkmcnt(12)
v_mfma_f32_16x16x32_bf16 a[24:27], v[176:179], v[40:43], a[24:27]
v_mfma_f32_16x16x32_bf16 a[60:63], v[176:179], v[112:115], a[60:63]
s_add_u32 s57, s87, 663552
s_add_u32 m0, s56, 122880
s_nop 0
buffer_load_dwordx4 v16, s[12:15], s57 offen lds
v_mfma_f32_16x16x32_bf16 a[96:99], v[176:179], v[244:247], a[96:99]
ds_read_b64_tr_b16 v[204:205], v12 offset:4096
ds_read_b64_tr_b16 v[206:207], v12 offset:4608
s_waitcnt lgkmcnt(12)
v_mfma_f32_16x16x32_bf16 a[28:31], v[180:183], v[40:43], a[28:31]
v_mfma_f32_16x16x32_bf16 a[64:67], v[180:183], v[112:115], a[64:67]
s_add_u32 s57, s84, 691200
s_add_u32 m0, s56, 99328
s_nop 0
buffer_load_dwordx4 v17, s[12:15], s57 offen lds
v_mfma_f32_16x16x32_bf16 a[100:103], v[180:183], v[244:247], a[100:103]
ds_read_b64_tr_b16 v[176:177], v13 offset:4096
ds_read_b64_tr_b16 v[178:179], v13 offset:4608
s_waitcnt lgkmcnt(12)
v_mfma_f32_16x16x32_bf16 a[32:35], v[184:187], v[40:43], a[32:35]
v_mfma_f32_16x16x32_bf16 a[68:71], v[184:187], v[112:115], a[68:71]
s_add_u32 s57, s85, 691200
s_add_u32 m0, s56, 107520
s_nop 0
buffer_load_dwordx4 v17, s[12:15], s57 offen lds
v_mfma_f32_16x16x32_bf16 a[104:107], v[184:187], v[244:247], a[104:107]
ds_read_b64_tr_b16 v[180:181], v14 offset:4096
ds_read_b64_tr_b16 v[182:183], v14 offset:4608
s_waitcnt lgkmcnt(12)
v_mfma_f32_16x16x32_bf16 a[0:3], v[188:191], v[44:47], a[0:3]
v_mfma_f32_16x16x32_bf16 a[36:39], v[188:191], v[116:119], a[36:39]
s_add_u32 s57, s86, 691200
s_add_u32 m0, s56, 115712
s_nop 0
buffer_load_dwordx4 v17, s[12:15], s57 offen lds
v_mfma_f32_16x16x32_bf16 a[72:75], v[188:191], v[244:247], a[72:75]
ds_read_b64_tr_b16 v[184:185], v15 offset:4096
ds_read_b64_tr_b16 v[186:187], v15 offset:4608
s_waitcnt lgkmcnt(12)
v_mfma_f32_16x16x32_bf16 a[4:7], v[192:195], v[44:47], a[4:7]
v_mfma_f32_16x16x32_bf16 a[40:43], v[192:195], v[116:119], a[40:43]
s_add_u32 s57, s87, 691200
s_add_u32 m0, s56, 123904
s_nop 0
buffer_load_dwordx4 v17, s[12:15], s57 offen lds
v_mfma_f32_16x16x32_bf16 a[76:79], v[192:195], v[244:247], a[76:79]
ds_read_b64_tr_b16 v[188:189], v29 offset:4096
ds_read_b64_tr_b16 v[190:191], v29 offset:4608
s_waitcnt lgkmcnt(12)
v_mfma_f32_16x16x32_bf16 a[8:11], v[196:199], v[44:47], a[8:11]
v_mfma_f32_16x16x32_bf16 a[44:47], v[196:199], v[116:119], a[44:47]
v_mfma_f32_16x16x32_bf16 a[80:83], v[196:199], v[244:247], a[80:83]
s_waitcnt vmcnt(12)
s_barrier
v_add_u32 v8, 32768, v8
v_add_u32 v9, 32768, v9
v_add_u32 v10, 32768, v10
v_add_u32 v11, 32768, v11
v_add_u32 v12, 32768, v12
v_add_u32 v13, 32768, v13
v_add_u32 v14, 32768, v14
v_add_u32 v15, 32768, v15
v_add_u32 v29, 32768, v29
ds_read_b64_tr_b16 v[192:193], v8 offset:0
ds_read_b64_tr_b16 v[194:195], v8 offset:512
s_waitcnt lgkmcnt(12)
v_mfma_f32_16x16x32_bf16 a[12:15], v[200:203], v[44:47], a[12:15]
v_mfma_f32_16x16x32_bf16 a[48:51], v[200:203], v[116:119], a[48:51]
v_mfma_f32_16x16x32_bf16 a[84:87], v[200:203], v[244:247], a[84:87]
ds_read_b64_tr_b16 v[196:197], v9 offset:0
ds_read_b64_tr_b16 v[198:199], v9 offset:512
s_waitcnt lgkmcnt(12)
v_mfma_f32_16x16x32_bf16 a[16:19], v[204:207], v[44:47], a[16:19]
v_mfma_f32_16x16x32_bf16 a[52:55], v[204:207], v[116:119], a[52:55]
v_mfma_f32_16x16x32_bf16 a[88:91], v[204:207], v[244:247], a[88:91]
ds_read_b64_tr_b16 v[200:201], v10 offset:0
ds_read_b64_tr_b16 v[202:203], v10 offset:512
s_waitcnt lgkmcnt(12)
v_mfma_f32_16x16x32_bf16 a[20:23], v[176:179], v[44:47], a[20:23]
v_mfma_f32_16x16x32_bf16 a[56:59], v[176:179], v[116:119], a[56:59]
v_mfma_f32_16x16x32_bf16 a[92:95], v[176:179], v[244:247], a[92:95]
ds_read_b64_tr_b16 v[204:205], v11 offset:0
ds_read_b64_tr_b16 v[206:207], v11 offset:512
s_waitcnt lgkmcnt(12)
v_mfma_f32_16x16x32_bf16 a[24:27], v[180:183], v[44:47], a[24:27]
v_mfma_f32_16x16x32_bf16 a[60:63], v[180:183], v[116:119], a[60:63]
v_mfma_f32_16x16x32_bf16 a[96:99], v[180:183], v[244:247], a[96:99]
ds_read_b64_tr_b16 v[176:177], v12 offset:0
ds_read_b64_tr_b16 v[178:179], v12 offset:512
s_waitcnt lgkmcnt(12)
v_mfma_f32_16x16x32_bf16 a[28:31], v[184:187], v[44:47], a[28:31]
v_mfma_f32_16x16x32_bf16 a[64:67], v[184:187], v[116:119], a[64:67]
v_mfma_f32_16x16x32_bf16 a[100:103], v[184:187], v[244:247], a[100:103]
ds_read_b64_tr_b16 v[180:181], v13 offset:0
ds_read_b64_tr_b16 v[182:183], v13 offset:512
s_waitcnt lgkmcnt(12)
v_mfma_f32_16x16x32_bf16 a[32:35], v[188:191], v[44:47], a[32:35]
v_mfma_f32_16x16x32_bf16 a[68:71], v[188:191], v[116:119], a[68:71]
v_mfma_f32_16x16x32_bf16 a[104:107], v[188:191], v[244:247], a[104:107]
s_mov_b64 exec, s[76:77]
v_mov_b32 v240, v52
v_mov_b32 v241, v53
v_mov_b32 v242, v54
v_mov_b32 v243, v55
v_mov_b32_dpp v52, v48 row_ror:8 row_mask:0xf bank_mask:0x3
v_mov_b32_dpp v53, v49 row_ror:8 row_mask:0xf bank_mask:0x3
v_mov_b32_dpp v54, v50 row_ror:8 row_mask:0xf bank_mask:0x3
v_mov_b32_dpp v55, v51 row_ror:8 row_mask:0xf bank_mask:0x3
v_mov_b32_dpp v48, v240 row_ror:8 row_mask:0xf bank_mask:0xc
v_mov_b32_dpp v49, v241 row_ror:8 row_mask:0xf bank_mask:0xc
v_mov_b32_dpp v50, v242 row_ror:8 row_mask:0xf bank_mask:0xc
v_mov_b32_dpp v51, v243 row_ror:8 row_mask:0xf bank_mask:0xc
v_mov_b32 v240, v124
v_mov_b32 v241, v125
v_mov_b32 v242, v126
v_mov_b32 v243, v127
v_mov_b32_dpp v124, v120 row_ror:8 row_mask:0xf bank_mask:0x3
v_mov_b32_dpp v125, v121 row_ror:8 row_mask:0xf bank_mask:0x3
v_mov_b32_dpp v126, v122 row_ror:8 row_mask:0xf bank_mask:0x3
v_mov_b32_dpp v127, v123 row_ror:8 row_mask:0xf bank_mask:0x3
v_mov_b32_dpp v120, v240 row_ror:8 row_mask:0xf bank_mask:0xc
v_mov_b32_dpp v121, v241 row_ror:8 row_mask:0xf bank_mask:0xc
v_mov_b32_dpp v122, v242 row_ror:8 row_mask:0xf bank_mask:0xc
v_mov_b32_dpp v123, v243 row_ror:8 row_mask:0xf bank_mask:0xc
s_mov_b64 exec, -1
ds_read_b64_tr_b16 v[184:185], v14 offset:0
ds_read_b64_tr_b16 v[186:187], v14 offset:512
s_waitcnt lgkmcnt(12)
v_mfma_f32_16x16x32_bf16 a[0:3], v[192:195], v[48:51], a[0:3]
s_mul_i32 s78, s73, 8
s_add_u32 s78, s78, s74
buffer_load_dwordx4 v[64:67], v27, s[8:11], s78 offen
v_mfma_f32_16x16x32_bf16 a[36:39], v[192:195], v[120:123], a[36:39]
v_mfma_f32_16x16x32_bf16 a[72:75], v[192:195], v[244:247], a[72:75]
ds_read_b64_tr_b16 v[188:189], v15 offset:0
ds_read_b64_tr_b16 v[190:191], v15 offset:512
s_waitcnt lgkmcnt(12)
v_mfma_f32_16x16x32_bf16 a[4:7], v[196:199], v[48:51], a[4:7]
s_mul_i32 s78, s73, 8
s_add_u32 s78, s78, s74
s_add_u32 s78, s78, s79
buffer_load_dwordx4 v[68:71], v27, s[8:11], s78 offen
v_mfma_f32_16x16x32_bf16 a[40:43], v[196:199], v[120:123], a[40:43]
v_mfma_f32_16x16x32_bf16 a[76:79], v[196:199], v[244:247], a[76:79]
ds_read_b64_tr_b16 v[192:193], v29 offset:0
ds_read_b64_tr_b16 v[194:195], v29 offset:512
s_waitcnt lgkmcnt(12)
v_mfma_f32_16x16x32_bf16 a[8:11], v[200:203], v[48:51], a[8:11]
s_mul_i32 s78, s73, 8
s_add_u32 s78, s78, s74
s_add_u32 s78, s78, s75
buffer_load_dwordx4 v[136:139], v27, s[8:11], s78 offen
v_mfma_f32_16x16x32_bf16 a[44:47], v[200:203], v[120:123], a[44:47]
v_mfma_f32_16x16x32_bf16 a[80:83], v[200:203], v[244:247], a[80:83]
ds_read_b64_tr_b16 v[196:197], v8 offset:4096
ds_read_b64_tr_b16 v[198:199], v8 offset:4608
s_waitcnt lgkmcnt(12)
v_mfma_f32_16x16x32_bf16 a[12:15], v[204:207], v[48:51], a[12:15]
s_mul_i32 s78, s73, 8
s_add_u32 s78, s78, s74
s_add_u32 s78, s78, s75
s_add_u32 s78, s78, s79
buffer_load_dwordx4 v[140:143], v27, s[8:11], s78 offen
v_mfma_f32_16x16x32_bf16 a[48:51], v[204:207], v[120:123], a[48:51]
v_mfma_f32_16x16x32_bf16 a[84:87], v[204:207], v[244:247], a[84:87]
ds_read_b64_tr_b16 v[200:201], v9 offset:4096
ds_read_b64_tr_b16 v[202:203], v9 offset:4608
s_waitcnt lgkmcnt(12)
v_mfma_f32_16x16x32_bf16 a[16:19], v[176:179], v[48:51], a[16:19]
s_add_u32 s57, s84, 884736
s_add_u32 m0, s56, 0
s_nop 0
buffer_load_dwordx4 v16, s[12:15], s57 offen lds
v_mfma_f32_16x16x32_bf16 a[52:55], v[176:179], v[120:123], a[52:55]
v_mfma_f32_16x16x32_bf16 a[88:91], v[176:179], v[244:247], a[88:91]
ds_read_b64_tr_b16 v[204:205], v10 offset:4096
ds_read_b64_tr_b16 v[206:207], v10 offset:4608
s_waitcnt lgkmcnt(12)
v_mfma_f32_16x16x32_bf16 a[20:23], v[180:183], v[48:51], a[20:23]
s_add_u32 s57, s85, 884736
s_add_u32 m0, s56, 8192
s_nop 0
buffer_load_dwordx4 v16, s[12:15], s57 offen lds
v_mfma_f32_16x16x32_bf16 a[56:59], v[180:183], v[120:123], a[56:59]
s_add_u32 s57, s86, 884736
s_add_u32 m0, s56, 16384
s_nop 0
buffer_load_dwordx4 v16, s[12:15], s57 offen lds
v_mfma_f32_16x16x32_bf16 a[92:95], v[180:183], v[244:247], a[92:95]
ds_read_b64_tr_b16 v[176:177], v11 offset:4096
ds_read_b64_tr_b16 v[178:179], v11 offset:4608
s_waitcnt lgkmcnt(12)
v_mfma_f32_16x16x32_bf16 a[24:27], v[184:187], v[48:51], a[24:27]
v_mfma_f32_16x16x32_bf16 a[60:63], v[184:187], v[120:123], a[60:63]
s_add_u32 s57, s87, 884736
s_add_u32 m0, s56, 24576
s_nop 0
buffer_load_dwordx4 v16, s[12:15], s57 offen lds
v_mfma_f32_16x16x32_bf16 a[96:99], v[184:187], v[244:247], a[96:99]
ds_read_b64_tr_b16 v[180:181], v12 offset:4096
ds_read_b64_tr_b16 v[182:183], v12 offset:4608
s_waitcnt lgkmcnt(12)
v_mfma_f32_16x16x32_bf16 a[28:31], v[188:191], v[48:51], a[28:31]
v_mfma_f32_16x16x32_bf16 a[64:67], v[188:191], v[120:123], a[64:67]
s_add_u32 s57, s84, 912384
s_add_u32 m0, s56, 1024
s_nop 0
buffer_load_dwordx4 v17, s[12:15], s57 offen lds
v_mfma_f32_16x16x32_bf16 a[100:103], v[188:191], v[244:247], a[100:103]
ds_read_b64_tr_b16 v[184:185], v13 offset:4096
ds_read_b64_tr_b16 v[186:187], v13 offset:4608
s_waitcnt lgkmcnt(12)
v_mfma_f32_16x16x32_bf16 a[32:35], v[192:195], v[48:51], a[32:35]
v_mfma_f32_16x16x32_bf16 a[68:71], v[192:195], v[120:123], a[68:71]
s_add_u32 s57, s85, 912384
s_add_u32 m0, s56, 9216
s_nop 0
buffer_load_dwordx4 v17, s[12:15], s57 offen lds
v_mfma_f32_16x16x32_bf16 a[104:107], v[192:195], v[244:247], a[104:107]
ds_read_b64_tr_b16 v[188:189], v14 offset:4096
ds_read_b64_tr_b16 v[190:191], v14 offset:4608
s_waitcnt lgkmcnt(12)
v_mfma_f32_16x16x32_bf16 a[0:3], v[196:199], v[52:55], a[0:3]
v_mfma_f32_16x16x32_bf16 a[36:39], v[196:199], v[124:127], a[36:39]
s_add_u32 s57, s86, 912384
s_add_u32 m0, s56, 17408
s_nop 0
buffer_load_dwordx4 v17, s[12:15], s57 offen lds
v_mfma_f32_16x16x32_bf16 a[72:75], v[196:199], v[244:247], a[72:75]
ds_read_b64_tr_b16 v[192:193], v15 offset:4096
ds_read_b64_tr_b16 v[194:195], v15 offset:4608
s_waitcnt lgkmcnt(12)
v_mfma_f32_16x16x32_bf16 a[4:7], v[200:203], v[52:55], a[4:7]
v_mfma_f32_16x16x32_bf16 a[40:43], v[200:203], v[124:127], a[40:43]
s_add_u32 s57, s87, 912384
s_add_u32 m0, s56, 25600
s_nop 0
buffer_load_dwordx4 v17, s[12:15], s57 offen lds
v_mfma_f32_16x16x32_bf16 a[76:79], v[200:203], v[244:247], a[76:79]
ds_read_b64_tr_b16 v[196:197], v29 offset:4096
ds_read_b64_tr_b16 v[198:199], v29 offset:4608
s_waitcnt lgkmcnt(12)
v_mfma_f32_16x16x32_bf16 a[8:11], v[204:207], v[52:55], a[8:11]
v_mfma_f32_16x16x32_bf16 a[44:47], v[204:207], v[124:127], a[44:47]
v_mfma_f32_16x16x32_bf16 a[80:83], v[204:207], v[244:247], a[80:83]
s_waitcnt vmcnt(12)
s_barrier
v_add_u32 v8, 32768, v8
v_add_u32 v9, 32768, v9
v_add_u32 v10, 32768, v10
v_add_u32 v11, 32768, v11
v_add_u32 v12, 32768, v12
v_add_u32 v13, 32768, v13
v_add_u32 v14, 32768, v14
v_add_u32 v15, 32768, v15
v_add_u32 v29, 32768, v29
ds_read_b64_tr_b16 v[200:201], v8 offset:0
ds_read_b64_tr_b16 v[202:203], v8 offset:512
s_waitcnt lgkmcnt(12)
v_mfma_f32_16x16x32_bf16 a[12:15], v[176:179], v[52:55], a[12:15]
v_mfma_f32_16x16x32_bf16 a[48:51], v[176:179], v[124:127], a[48:51]
v_mfma_f32_16x16x32_bf16 a[84:87], v[176:179], v[244:247], a[84:87]
ds_read_b64_tr_b16 v[204:205], v9 offset:0
ds_read_b64_tr_b16 v[206:207], v9 offset:512
s_waitcnt lgkmcnt(12)
v_mfma_f32_16x16x32_bf16 a[16:19], v[180:183], v[52:55], a[16:19]
v_mfma_f32_16x16x32_bf16 a[52:55], v[180:183], v[124:127], a[52:55]
v_mfma_f32_16x16x32_bf16 a[88:91], v[180:183], v[244:247], a[88:91]
ds_read_b64_tr_b16 v[176:177], v10 offset:0
ds_read_b64_tr_b16 v[178:179], v10 offset:512
s_waitcnt lgkmcnt(12)
v_mfma_f32_16x16x32_bf16 a[20:23], v[184:187], v[52:55], a[20:23]
v_mfma_f32_16x16x32_bf16 a[56:59], v[184:187], v[124:127], a[56:59]
v_mfma_f32_16x16x32_bf16 a[92:95], v[184:187], v[244:247], a[92:95]
ds_read_b64_tr_b16 v[180:181], v11 offset:0
ds_read_b64_tr_b16 v[182:183], v11 offset:512
s_waitcnt lgkmcnt(12)
v_mfma_f32_16x16x32_bf16 a[24:27], v[188:191], v[52:55], a[24:27]
v_mfma_f32_16x16x32_bf16 a[60:63], v[188:191], v[124:127], a[60:63]
v_mfma_f32_16x16x32_bf16 a[96:99], v[188:191], v[244:247], a[96:99]
ds_read_b64_tr_b16 v[184:185], v12 offset:0
ds_read_b64_tr_b16 v[186:187], v12 offset:512
s_waitcnt lgkmcnt(12)
v_mfma_f32_16x16x32_bf16 a[28:31], v[192:195], v[52:55], a[28:31]
v_mfma_f32_16x16x32_bf16 a[64:67], v[192:195], v[124:127], a[64:67]
v_mfma_f32_16x16x32_bf16 a[100:103], v[192:195], v[244:247], a[100:103]
ds_read_b64_tr_b16 v[188:189], v13 offset:0
ds_read_b64_tr_b16 v[190:191], v13 offset:512
s_waitcnt lgkmcnt(12)
v_mfma_f32_16x16x32_bf16 a[32:35], v[196:199], v[52:55], a[32:35]
v_mfma_f32_16x16x32_bf16 a[68:71], v[196:199], v[124:127], a[68:71]
v_mfma_f32_16x16x32_bf16 a[104:107], v[196:199], v[244:247], a[104:107]
s_mov_b64 exec, s[76:77]
v_mov_b32 v240, v60
v_mov_b32 v241, v61
v_mov_b32 v242, v62
v_mov_b32 v243, v63
v_mov_b32_dpp v60, v56 row_ror:8 row_mask:0xf bank_mask:0x3
v_mov_b32_dpp v61, v57 row_ror:8 row_mask:0xf bank_mask:0x3
v_mov_b32_dpp v62, v58 row_ror:8 row_mask:0xf bank_mask:0x3
v_mov_b32_dpp v63, v59 row_ror:8 row_mask:0xf bank_mask:0x3
v_mov_b32_dpp v56, v240 row_ror:8 row_mask:0xf bank_mask:0xc
v_mov_b32_dpp v57, v241 row_ror:8 row_mask:0xf bank_mask:0xc
v_mov_b32_dpp v58, v242 row_ror:8 row_mask:0xf bank_mask:0xc
v_mov_b32_dpp v59, v243 row_ror:8 row_mask:0xf bank_mask:0xc
v_mov_b32 v240, v132
v_mov_b32 v241, v133
v_mov_b32 v242, v134
v_mov_b32 v243, v135
v_mov_b32_dpp v132, v128 row_ror:8 row_mask:0xf bank_mask:0x3
v_mov_b32_dpp v133, v129 row_ror:8 row_mask:0xf bank_mask:0x3
v_mov_b32_dpp v134, v130 row_ror:8 row_mask:0xf bank_mask:0x3
v_mov_b32_dpp v135, v131 row_ror:8 row_mask:0xf bank_mask:0x3
v_mov_b32_dpp v128, v240 row_ror:8 row_mask:0xf bank_mask:0xc
v_mov_b32_dpp v129, v241 row_ror:8 row_mask:0xf bank_mask:0xc
v_mov_b32_dpp v130, v242 row_ror:8 row_mask:0xf bank_mask:0xc
v_mov_b32_dpp v131, v243 row_ror:8 row_mask:0xf bank_mask:0xc
s_mov_b64 exec, -1
ds_read_b64_tr_b16 v[192:193], v14 offset:0
ds_read_b64_tr_b16 v[194:195], v14 offset:512
s_waitcnt lgkmcnt(12)
v_mfma_f32_16x16x32_bf16 a[0:3], v[200:203], v[56:59], a[0:3]
s_mul_i32 s78, s73, 10
s_add_u32 s78, s78, s74
buffer_load_dwordx4 v[72:75], v27, s[8:11], s78 offen
v_mfma_f32_16x16x32_bf16 a[36:39], v[200:203], v[128:131], a[36:39]
v_mfma_f32_16x16x32_bf16 a[72:75], v[200:203], v[244:247], a[72:75]
ds_read_b64_tr_b16 v[196:197], v15 offset:0
ds_read_b64_tr_b16 v[198:199], v15 offset:512
s_waitcnt lgkmcnt(12)
v_mfma_f32_16x16x32_bf16 a[4:7], v[204:207], v[56:59], a[4:7]
s_mul_i32 s78, s73, 10
s_add_u32 s78, s78, s74
s_add_u32 s78, s78, s79
buffer_load_dwordx4 v[76:79], v27, s[8:11], s78 offen
v_mfma_f32_16x16x32_bf16 a[40:43], v[204:207], v[128:131], a[40:43]
v_mfma_f32_16x16x32_bf16 a[76:79], v[204:207], v[244:247], a[76:79]
ds_read_b64_tr_b16 v[200:201], v29 offset:0
ds_read_b64_tr_b16 v[202:203], v29 offset:512
s_waitcnt lgkmcnt(12)
v_mfma_f32_16x16x32_bf16 a[8:11], v[176:179], v[56:59], a[8:11]
s_mul_i32 s78, s73, 10
s_add_u32 s78, s78, s74
s_add_u32 s78, s78, s75
buffer_load_dwordx4 v[144:147], v27, s[8:11], s78 offen
v_mfma_f32_16x16x32_bf16 a[44:47], v[176:179], v[128:131], a[44:47]
v_mfma_f32_16x16x32_bf16 a[80:83], v[176:179], v[244:247], a[80:83]
ds_read_b64_tr_b16 v[204:205], v8 offset:4096
ds_read_b64_tr_b16 v[206:207], v8 offset:4608
s_waitcnt lgkmcnt(12)
v_mfma_f32_16x16x32_bf16 a[12:15], v[180:183], v[56:59], a[12:15]
s_mul_i32 s78, s73, 10
s_add_u32 s78, s78, s74
s_add_u32 s78, s78, s75
s_add_u32 s78, s78, s79
buffer_load_dwordx4 v[148:151], v27, s[8:11], s78 offen
v_mfma_f32_16x16x32_bf16 a[48:51], v[180:183], v[128:131], a[48:51]
v_mfma_f32_16x16x32_bf16 a[84:87], v[180:183], v[244:247], a[84:87]
ds_read_b64_tr_b16 v[176:177], v9 offset:4096
ds_read_b64_tr_b16 v[178:179], v9 offset:4608
s_waitcnt lgkmcnt(12)
v_mfma_f32_16x16x32_bf16 a[16:19], v[184:187], v[56:59], a[16:19]
s_add_u32 s57, s84, 1105920
s_add_u32 m0, s56, 32768
s_nop 0
buffer_load_dwordx4 v16, s[12:15], s57 offen lds
v_mfma_f32_16x16x32_bf16 a[52:55], v[184:187], v[128:131], a[52:55]
v_mfma_f32_16x16x32_bf16 a[88:91], v[184:187], v[244:247], a[88:91]
ds_read_b64_tr_b16 v[180:181], v10 offset:4096
ds_read_b64_tr_b16 v[182:183], v10 offset:4608
s_waitcnt lgkmcnt(12)
v_mfma_f32_16x16x32_bf16 a[20:23], v[188:191], v[56:59], a[20:23]
s_add_u32 s57, s85, 1105920
s_add_u32 m0, s56, 40960
s_nop 0
buffer_load_dwordx4 v16, s[12:15], s57 offen lds
v_mfma_f32_16x16x32_bf16 a[56:59], v[188:191], v[128:131], a[56:59]
s_add_u32 s57, s86, 1105920
s_add_u32 m0, s56, 49152
s_nop 0
buffer_load_dwordx4 v16, s[12:15], s57 offen lds
v_mfma_f32_16x16x32_bf16 a[92:95], v[188:191], v[244:247], a[92:95]
ds_read_b64_tr_b16 v[184:185], v11 offset:4096
ds_read_b64_tr_b16 v[186:187], v11 offset:4608
s_waitcnt lgkmcnt(12)
v_mfma_f32_16x16x32_bf16 a[24:27], v[192:195], v[56:59], a[24:27]
v_mfma_f32_16x16x32_bf16 a[60:63], v[192:195], v[128:131], a[60:63]
s_add_u32 s57, s87, 1105920
s_add_u32 m0, s56, 57344
s_nop 0
buffer_load_dwordx4 v16, s[12:15], s57 offen lds
v_mfma_f32_16x16x32_bf16 a[96:99], v[192:195], v[244:247], a[96:99]
ds_read_b64_tr_b16 v[188:189], v12 offset:4096
ds_read_b64_tr_b16 v[190:191], v12 offset:4608
s_waitcnt lgkmcnt(12)
v_mfma_f32_16x16x32_bf16 a[28:31], v[196:199], v[56:59], a[28:31]
v_mfma_f32_16x16x32_bf16 a[64:67], v[196:199], v[128:131], a[64:67]
s_add_u32 s57, s84, 1133568
s_add_u32 m0, s56, 33792
s_nop 0
buffer_load_dwordx4 v17, s[12:15], s57 offen lds
v_mfma_f32_16x16x32_bf16 a[100:103], v[196:199], v[244:247], a[100:103]
ds_read_b64_tr_b16 v[192:193], v13 offset:4096
ds_read_b64_tr_b16 v[194:195], v13 offset:4608
s_waitcnt lgkmcnt(12)
v_mfma_f32_16x16x32_bf16 a[32:35], v[200:203], v[56:59], a[32:35]
v_mfma_f32_16x16x32_bf16 a[68:71], v[200:203], v[128:131], a[68:71]
s_add_u32 s57, s85, 1133568
s_add_u32 m0, s56, 41984
s_nop 0
buffer_load_dwordx4 v17, s[12:15], s57 offen lds
v_mfma_f32_16x16x32_bf16 a[104:107], v[200:203], v[244:247], a[104:107]
ds_read_b64_tr_b16 v[196:197], v14 offset:4096
ds_read_b64_tr_b16 v[198:199], v14 offset:4608
s_waitcnt lgkmcnt(12)
v_mfma_f32_16x16x32_bf16 a[0:3], v[204:207], v[60:63], a[0:3]
v_mfma_f32_16x16x32_bf16 a[36:39], v[204:207], v[132:135], a[36:39]
s_add_u32 s57, s86, 1133568
s_add_u32 m0, s56, 50176
s_nop 0
buffer_load_dwordx4 v17, s[12:15], s57 offen lds
v_mfma_f32_16x16x32_bf16 a[72:75], v[204:207], v[244:247], a[72:75]
ds_read_b64_tr_b16 v[200:201], v15 offset:4096
ds_read_b64_tr_b16 v[202:203], v15 offset:4608
s_waitcnt lgkmcnt(12)
v_mfma_f32_16x16x32_bf16 a[4:7], v[176:179], v[60:63], a[4:7]
v_mfma_f32_16x16x32_bf16 a[40:43], v[176:179], v[132:135], a[40:43]
s_add_u32 s57, s87, 1133568
s_add_u32 m0, s56, 58368
s_nop 0
buffer_load_dwordx4 v17, s[12:15], s57 offen lds
v_mfma_f32_16x16x32_bf16 a[76:79], v[176:179], v[244:247], a[76:79]
ds_read_b64_tr_b16 v[204:205], v29 offset:4096
ds_read_b64_tr_b16 v[206:207], v29 offset:4608
s_waitcnt lgkmcnt(12)
v_mfma_f32_16x16x32_bf16 a[8:11], v[180:183], v[60:63], a[8:11]
v_mfma_f32_16x16x32_bf16 a[44:47], v[180:183], v[132:135], a[44:47]
v_mfma_f32_16x16x32_bf16 a[80:83], v[180:183], v[244:247], a[80:83]
s_waitcnt vmcnt(12)
s_barrier
v_subrev_u32 v8, 98304, v8
v_subrev_u32 v9, 98304, v9
v_subrev_u32 v10, 98304, v10
v_subrev_u32 v11, 98304, v11
v_subrev_u32 v12, 98304, v12
v_subrev_u32 v13, 98304, v13
v_subrev_u32 v14, 98304, v14
v_subrev_u32 v15, 98304, v15
v_subrev_u32 v29, 98304, v29
ds_read_b64_tr_b16 v[176:177], v8 offset:0
ds_read_b64_tr_b16 v[178:179], v8 offset:512
s_waitcnt lgkmcnt(12)
v_mfma_f32_16x16x32_bf16 a[12:15], v[184:187], v[60:63], a[12:15]
v_mfma_f32_16x16x32_bf16 a[48:51], v[184:187], v[132:135], a[48:51]
v_mfma_f32_16x16x32_bf16 a[84:87], v[184:187], v[244:247], a[84:87]
ds_read_b64_tr_b16 v[180:181], v9 offset:0
ds_read_b64_tr_b16 v[182:183], v9 offset:512
s_waitcnt lgkmcnt(12)
v_mfma_f32_16x16x32_bf16 a[16:19], v[188:191], v[60:63], a[16:19]
v_mfma_f32_16x16x32_bf16 a[52:55], v[188:191], v[132:135], a[52:55]
v_mfma_f32_16x16x32_bf16 a[88:91], v[188:191], v[244:247], a[88:91]
ds_read_b64_tr_b16 v[184:185], v10 offset:0
ds_read_b64_tr_b16 v[186:187], v10 offset:512
s_waitcnt lgkmcnt(12)
v_mfma_f32_16x16x32_bf16 a[20:23], v[192:195], v[60:63], a[20:23]
v_mfma_f32_16x16x32_bf16 a[56:59], v[192:195], v[132:135], a[56:59]
v_mfma_f32_16x16x32_bf16 a[92:95], v[192:195], v[244:247], a[92:95]
ds_read_b64_tr_b16 v[188:189], v11 offset:0
ds_read_b64_tr_b16 v[190:191], v11 offset:512
s_waitcnt lgkmcnt(12)
v_mfma_f32_16x16x32_bf16 a[24:27], v[196:199], v[60:63], a[24:27]
v_mfma_f32_16x16x32_bf16 a[60:63], v[196:199], v[132:135], a[60:63]
v_mfma_f32_16x16x32_bf16 a[96:99], v[196:199], v[244:247], a[96:99]
ds_read_b64_tr_b16 v[192:193], v12 offset:0
ds_read_b64_tr_b16 v[194:195], v12 offset:512
s_waitcnt lgkmcnt(12)
v_mfma_f32_16x16x32_bf16 a[28:31], v[200:203], v[60:63], a[28:31]
v_mfma_f32_16x16x32_bf16 a[64:67], v[200:203], v[132:135], a[64:67]
v_mfma_f32_16x16x32_bf16 a[100:103], v[200:203], v[244:247], a[100:103]
ds_read_b64_tr_b16 v[196:197], v13 offset:0
ds_read_b64_tr_b16 v[198:199], v13 offset:512
s_waitcnt lgkmcnt(12)
v_mfma_f32_16x16x32_bf16 a[32:35], v[204:207], v[60:63], a[32:35]
v_mfma_f32_16x16x32_bf16 a[68:71], v[204:207], v[132:135], a[68:71]
v_mfma_f32_16x16x32_bf16 a[104:107], v[204:207], v[244:247], a[104:107]
s_mov_b64 exec, s[76:77]
v_mov_b32 v240, v68
v_mov_b32 v241, v69
v_mov_b32 v242, v70
v_mov_b32 v243, v71
v_mov_b32_dpp v68, v64 row_ror:8 row_mask:0xf bank_mask:0x3
v_mov_b32_dpp v69, v65 row_ror:8 row_mask:0xf bank_mask:0x3
v_mov_b32_dpp v70, v66 row_ror:8 row_mask:0xf bank_mask:0x3
v_mov_b32_dpp v71, v67 row_ror:8 row_mask:0xf bank_mask:0x3
v_mov_b32_dpp v64, v240 row_ror:8 row_mask:0xf bank_mask:0xc
v_mov_b32_dpp v65, v241 row_ror:8 row_mask:0xf bank_mask:0xc
v_mov_b32_dpp v66, v242 row_ror:8 row_mask:0xf bank_mask:0xc
v_mov_b32_dpp v67, v243 row_ror:8 row_mask:0xf bank_mask:0xc
v_mov_b32 v240, v140
v_mov_b32 v241, v141
v_mov_b32 v242, v142
v_mov_b32 v243, v143
v_mov_b32_dpp v140, v136 row_ror:8 row_mask:0xf bank_mask:0x3
v_mov_b32_dpp v141, v137 row_ror:8 row_mask:0xf bank_mask:0x3
v_mov_b32_dpp v142, v138 row_ror:8 row_mask:0xf bank_mask:0x3
v_mov_b32_dpp v143, v139 row_ror:8 row_mask:0xf bank_mask:0x3
v_mov_b32_dpp v136, v240 row_ror:8 row_mask:0xf bank_mask:0xc
v_mov_b32_dpp v137, v241 row_ror:8 row_mask:0xf bank_mask:0xc
v_mov_b32_dpp v138, v242 row_ror:8 row_mask:0xf bank_mask:0xc
v_mov_b32_dpp v139, v243 row_ror:8 row_mask:0xf bank_mask:0xc
s_mov_b64 exec, -1
ds_read_b64_tr_b16 v[200:201], v14 offset:0
ds_read_b64_tr_b16 v[202:203], v14 offset:512
s_waitcnt lgkmcnt(12)
v_mfma_f32_16x16x32_bf16 a[0:3], v[176:179], v[64:67], a[0:3]
s_mul_i32 s78, s73, 12
s_add_u32 s78, s78, s74
buffer_load_dwordx4 v[80:83], v27, s[8:11], s78 offen
v_mfma_f32_16x16x32_bf16 a[36:39], v[176:179], v[136:139], a[36:39]
v_mfma_f32_16x16x32_bf16 a[72:75], v[176:179], v[244:247], a[72:75]
ds_read_b64_tr_b16 v[204:205], v15 offset:0
ds_read_b64_tr_b16 v[206:207], v15 offset:512
s_waitcnt lgkmcnt(12)
v_mfma_f32_16x16x32_bf16 a[4:7], v[180:183], v[64:67], a[4:7]
s_mul_i32 s78, s73, 12
s_add_u32 s78, s78, s74
s_add_u32 s78, s78, s79
buffer_load_dwordx4 v[84:87], v27, s[8:11], s78 offen
v_mfma_f32_16x16x32_bf16 a[40:43], v[180:183], v[136:139], a[40:43]
v_mfma_f32_16x16x32_bf16 a[76:79], v[180:183], v[244:247], a[76:79]
ds_read_b64_tr_b16 v[176:177], v29 offset:0
ds_read_b64_tr_b16 v[178:179], v29 offset:512
s_waitcnt lgkmcnt(12)
v_mfma_f32_16x16x32_bf16 a[8:11], v[184:187], v[64:67], a[8:11]
s_mul_i32 s78, s73, 12
s_add_u32 s78, s78, s74
s_add_u32 s78, s78, s75
buffer_load_dwordx4 v[152:155], v27, s[8:11], s78 offen
v_mfma_f32_16x16x32_bf16 a[44:47], v[184:187], v[136:139], a[44:47]
v_mfma_f32_16x16x32_bf16 a[80:83], v[184:187], v[244:247], a[80:83]
ds_read_b64_tr_b16 v[180:181], v8 offset:4096
ds_read_b64_tr_b16 v[182:183], v8 offset:4608
s_waitcnt lgkmcnt(12)
v_mfma_f32_16x16x32_bf16 a[12:15], v[188:191], v[64:67], a[12:15]
s_mul_i32 s78, s73, 12
s_add_u32 s78, s78, s74
s_add_u32 s78, s78, s75
s_add_u32 s78, s78, s79
buffer_load_dwordx4 v[156:159], v27, s[8:11], s78 offen
v_mfma_f32_16x16x32_bf16 a[48:51], v[188:191], v[136:139], a[48:51]
v_mfma_f32_16x16x32_bf16 a[84:87], v[188:191], v[244:247], a[84:87]
ds_read_b64_tr_b16 v[184:185], v9 offset:4096
ds_read_b64_tr_b16 v[186:187], v9 offset:4608
s_waitcnt lgkmcnt(12)
v_mfma_f32_16x16x32_bf16 a[16:19], v[192:195], v[64:67], a[16:19]
s_add_u32 s57, s84, 1327104
s_add_u32 m0, s56, 65536
s_nop 0
buffer_load_dwordx4 v16, s[12:15], s57 offen lds
v_mfma_f32_16x16x32_bf16 a[52:55], v[192:195], v[136:139], a[52:55]
v_mfma_f32_16x16x32_bf16 a[88:91], v[192:195], v[244:247], a[88:91]
ds_read_b64_tr_b16 v[188:189], v10 offset:4096
ds_read_b64_tr_b16 v[190:191], v10 offset:4608
s_waitcnt lgkmcnt(12)
v_mfma_f32_16x16x32_bf16 a[20:23], v[196:199], v[64:67], a[20:23]
s_add_u32 s57, s85, 1327104
s_add_u32 m0, s56, 73728
s_nop 0
buffer_load_dwordx4 v16, s[12:15], s57 offen lds
v_mfma_f32_16x16x32_bf16 a[56:59], v[196:199], v[136:139], a[56:59]
s_add_u32 s57, s86, 1327104
s_add_u32 m0, s56, 81920
s_nop 0
buffer_load_dwordx4 v16, s[12:15], s57 offen lds
v_mfma_f32_16x16x32_bf16 a[92:95], v[196:199], v[244:247], a[92:95]
ds_read_b64_tr_b16 v[192:193], v11 offset:4096
ds_read_b64_tr_b16 v[194:195], v11 offset:4608
s_waitcnt lgkmcnt(12)
v_mfma_f32_16x16x32_bf16 a[24:27], v[200:203], v[64:67], a[24:27]
v_mfma_f32_16x16x32_bf16 a[60:63], v[200:203], v[136:139], a[60:63]
s_add_u32 s57, s87, 1327104
s_add_u32 m0, s56, 90112
s_nop 0
buffer_load_dwordx4 v16, s[12:15], s57 offen lds
v_mfma_f32_16x16x32_bf16 a[96:99], v[200:203], v[244:247], a[96:99]
ds_read_b64_tr_b16 v[196:197], v12 offset:4096
ds_read_b64_tr_b16 v[198:199], v12 offset:4608
s_waitcnt lgkmcnt(12)
v_mfma_f32_16x16x32_bf16 a[28:31], v[204:207], v[64:67], a[28:31]
v_mfma_f32_16x16x32_bf16 a[64:67], v[204:207], v[136:139], a[64:67]
s_add_u32 s57, s84, 1354752
s_add_u32 m0, s56, 66560
s_nop 0
buffer_load_dwordx4 v17, s[12:15], s57 offen lds
v_mfma_f32_16x16x32_bf16 a[100:103], v[204:207], v[244:247], a[100:103]
ds_read_b64_tr_b16 v[200:201], v13 offset:4096
ds_read_b64_tr_b16 v[202:203], v13 offset:4608
s_waitcnt lgkmcnt(12)
v_mfma_f32_16x16x32_bf16 a[32:35], v[176:179], v[64:67], a[32:35]
v_mfma_f32_16x16x32_bf16 a[68:71], v[176:179], v[136:139], a[68:71]
s_add_u32 s57, s85, 1354752
s_add_u32 m0, s56, 74752
s_nop 0
buffer_load_dwordx4 v17, s[12:15], s57 offen lds
v_mfma_f32_16x16x32_bf16 a[104:107], v[176:179], v[244:247], a[104:107]
ds_read_b64_tr_b16 v[204:205], v14 offset:4096
ds_read_b64_tr_b16 v[206:207], v14 offset:4608
s_waitcnt lgkmcnt(12)
v_mfma_f32_16x16x32_bf16 a[0:3], v[180:183], v[68:71], a[0:3]
v_mfma_f32_16x16x32_bf16 a[36:39], v[180:183], v[140:143], a[36:39]
s_add_u32 s57, s86, 1354752
s_add_u32 m0, s56, 82944
s_nop 0
buffer_load_dwordx4 v17, s[12:15], s57 offen lds
v_mfma_f32_16x16x32_bf16 a[72:75], v[180:183], v[244:247], a[72:75]
ds_read_b64_tr_b16 v[176:177], v15 offset:4096
ds_read_b64_tr_b16 v[178:179], v15 offset:4608
s_waitcnt lgkmcnt(12)
v_mfma_f32_16x16x32_bf16 a[4:7], v[184:187], v[68:71], a[4:7]
v_mfma_f32_16x16x32_bf16 a[40:43], v[184:187], v[140:143], a[40:43]
s_add_u32 s57, s87, 1354752
s_add_u32 m0, s56, 91136
s_nop 0
buffer_load_dwordx4 v17, s[12:15], s57 offen lds
v_mfma_f32_16x16x32_bf16 a[76:79], v[184:187], v[244:247], a[76:79]
ds_read_b64_tr_b16 v[180:181], v29 offset:4096
ds_read_b64_tr_b16 v[182:183], v29 offset:4608
s_waitcnt lgkmcnt(12)
v_mfma_f32_16x16x32_bf16 a[8:11], v[188:191], v[68:71], a[8:11]
v_mfma_f32_16x16x32_bf16 a[44:47], v[188:191], v[140:143], a[44:47]
v_mfma_f32_16x16x32_bf16 a[80:83], v[188:191], v[244:247], a[80:83]
s_waitcnt vmcnt(12)
s_barrier
v_add_u32 v8, 32768, v8
v_add_u32 v9, 32768, v9
v_add_u32 v10, 32768, v10
v_add_u32 v11, 32768, v11
v_add_u32 v12, 32768, v12
v_add_u32 v13, 32768, v13
v_add_u32 v14, 32768, v14
v_add_u32 v15, 32768, v15
v_add_u32 v29, 32768, v29
ds_read_b64_tr_b16 v[184:185], v8 offset:0
ds_read_b64_tr_b16 v[186:187], v8 offset:512
s_waitcnt lgkmcnt(12)
v_mfma_f32_16x16x32_bf16 a[12:15], v[192:195], v[68:71], a[12:15]
v_mfma_f32_16x16x32_bf16 a[48:51], v[192:195], v[140:143], a[48:51]
v_mfma_f32_16x16x32_bf16 a[84:87], v[192:195], v[244:247], a[84:87]
ds_read_b64_tr_b16 v[188:189], v9 offset:0
ds_read_b64_tr_b16 v[190:191], v9 offset:512
s_waitcnt lgkmcnt(12)
v_mfma_f32_16x16x32_bf16 a[16:19], v[196:199], v[68:71], a[16:19]
v_mfma_f32_16x16x32_bf16 a[52:55], v[196:199], v[140:143], a[52:55]
v_mfma_f32_16x16x32_bf16 a[88:91], v[196:199], v[244:247], a[88:91]
ds_read_b64_tr_b16 v[192:193], v10 offset:0
ds_read_b64_tr_b16 v[194:195], v10 offset:512
s_waitcnt lgkmcnt(12)
v_mfma_f32_16x16x32_bf16 a[20:23], v[200:203], v[68:71], a[20:23]
v_mfma_f32_16x16x32_bf16 a[56:59], v[200:203], v[140:143], a[56:59]
v_mfma_f32_16x16x32_bf16 a[92:95], v[200:203], v[244:247], a[92:95]
ds_read_b64_tr_b16 v[196:197], v11 offset:0
ds_read_b64_tr_b16 v[198:199], v11 offset:512
s_waitcnt lgkmcnt(12)
v_mfma_f32_16x16x32_bf16 a[24:27], v[204:207], v[68:71], a[24:27]
v_mfma_f32_16x16x32_bf16 a[60:63], v[204:207], v[140:143], a[60:63]
v_mfma_f32_16x16x32_bf16 a[96:99], v[204:207], v[244:247], a[96:99]
ds_read_b64_tr_b16 v[200:201], v12 offset:0
ds_read_b64_tr_b16 v[202:203], v12 offset:512
s_waitcnt lgkmcnt(12)
v_mfma_f32_16x16x32_bf16 a[28:31], v[176:179], v[68:71], a[28:31]
v_mfma_f32_16x16x32_bf16 a[64:67], v[176:179], v[140:143], a[64:67]
v_mfma_f32_16x16x32_bf16 a[100:103], v[176:179], v[244:247], a[100:103]
ds_read_b64_tr_b16 v[204:205], v13 offset:0
ds_read_b64_tr_b16 v[206:207], v13 offset:512
s_waitcnt lgkmcnt(12)
v_mfma_f32_16x16x32_bf16 a[32:35], v[180:183], v[68:71], a[32:35]
v_mfma_f32_16x16x32_bf16 a[68:71], v[180:183], v[140:143], a[68:71]
v_mfma_f32_16x16x32_bf16 a[104:107], v[180:183], v[244:247], a[104:107]
s_mov_b64 exec, s[76:77]
v_mov_b32 v240, v76
v_mov_b32 v241, v77
v_mov_b32 v242, v78
v_mov_b32 v243, v79
v_mov_b32_dpp v76, v72 row_ror:8 row_mask:0xf bank_mask:0x3
v_mov_b32_dpp v77, v73 row_ror:8 row_mask:0xf bank_mask:0x3
v_mov_b32_dpp v78, v74 row_ror:8 row_mask:0xf bank_mask:0x3
v_mov_b32_dpp v79, v75 row_ror:8 row_mask:0xf bank_mask:0x3
v_mov_b32_dpp v72, v240 row_ror:8 row_mask:0xf bank_mask:0xc
v_mov_b32_dpp v73, v241 row_ror:8 row_mask:0xf bank_mask:0xc
v_mov_b32_dpp v74, v242 row_ror:8 row_mask:0xf bank_mask:0xc
v_mov_b32_dpp v75, v243 row_ror:8 row_mask:0xf bank_mask:0xc
v_mov_b32 v240, v148
v_mov_b32 v241, v149
v_mov_b32 v242, v150
v_mov_b32 v243, v151
v_mov_b32_dpp v148, v144 row_ror:8 row_mask:0xf bank_mask:0x3
v_mov_b32_dpp v149, v145 row_ror:8 row_mask:0xf bank_mask:0x3
v_mov_b32_dpp v150, v146 row_ror:8 row_mask:0xf bank_mask:0x3
v_mov_b32_dpp v151, v147 row_ror:8 row_mask:0xf bank_mask:0x3
v_mov_b32_dpp v144, v240 row_ror:8 row_mask:0xf bank_mask:0xc
v_mov_b32_dpp v145, v241 row_ror:8 row_mask:0xf bank_mask:0xc
v_mov_b32_dpp v146, v242 row_ror:8 row_mask:0xf bank_mask:0xc
v_mov_b32_dpp v147, v243 row_ror:8 row_mask:0xf bank_mask:0xc
s_mov_b64 exec, -1
ds_read_b64_tr_b16 v[176:177], v14 offset:0
ds_read_b64_tr_b16 v[178:179], v14 offset:512
s_waitcnt lgkmcnt(12)
v_mfma_f32_16x16x32_bf16 a[0:3], v[184:187], v[72:75], a[0:3]
s_mul_i32 s78, s73, 14
s_add_u32 s78, s78, s74
buffer_load_dwordx4 v[88:91], v27, s[8:11], s78 offen
v_mfma_f32_16x16x32_bf16 a[36:39], v[184:187], v[144:147], a[36:39]
v_mfma_f32_16x16x32_bf16 a[72:75], v[184:187], v[244:247], a[72:75]
ds_read_b64_tr_b16 v[180:181], v15 offset:0
ds_read_b64_tr_b16 v[182:183], v15 offset:512
s_waitcnt lgkmcnt(12)
v_mfma_f32_16x16x32_bf16 a[4:7], v[188:191], v[72:75], a[4:7]
s_mul_i32 s78, s73, 14
s_add_u32 s78, s78, s74
s_add_u32 s78, s78, s79
buffer_load_dwordx4 v[92:95], v27, s[8:11], s78 offen
v_mfma_f32_16x16x32_bf16 a[40:43], v[188:191], v[144:147], a[40:43]
v_mfma_f32_16x16x32_bf16 a[76:79], v[188:191], v[244:247], a[76:79]
ds_read_b64_tr_b16 v[184:185], v29 offset:0
ds_read_b64_tr_b16 v[186:187], v29 offset:512
s_waitcnt lgkmcnt(12)
v_mfma_f32_16x16x32_bf16 a[8:11], v[192:195], v[72:75], a[8:11]
s_mul_i32 s78, s73, 14
s_add_u32 s78, s78, s74
s_add_u32 s78, s78, s75
buffer_load_dwordx4 v[160:163], v27, s[8:11], s78 offen
v_mfma_f32_16x16x32_bf16 a[44:47], v[192:195], v[144:147], a[44:47]
v_mfma_f32_16x16x32_bf16 a[80:83], v[192:195], v[244:247], a[80:83]
ds_read_b64_tr_b16 v[188:189], v8 offset:4096
ds_read_b64_tr_b16 v[190:191], v8 offset:4608
s_waitcnt lgkmcnt(12)
v_mfma_f32_16x16x32_bf16 a[12:15], v[196:199], v[72:75], a[12:15]
s_mul_i32 s78, s73, 14
s_add_u32 s78, s78, s74
s_add_u32 s78, s78, s75
s_add_u32 s78, s78, s79
buffer_load_dwordx4 v[164:167], v27, s[8:11], s78 offen
v_mfma_f32_16x16x32_bf16 a[48:51], v[196:199], v[144:147], a[48:51]
v_mfma_f32_16x16x32_bf16 a[84:87], v[196:199], v[244:247], a[84:87]
ds_read_b64_tr_b16 v[192:193], v9 offset:4096
ds_read_b64_tr_b16 v[194:195], v9 offset:4608
s_waitcnt lgkmcnt(12)
v_mfma_f32_16x16x32_bf16 a[16:19], v[200:203], v[72:75], a[16:19]
s_add_u32 s57, s84, 1548288
s_add_u32 m0, s56, 98304
s_nop 0
buffer_load_dwordx4 v16, s[12:15], s57 offen lds
v_mfma_f32_16x16x32_bf16 a[52:55], v[200:203], v[144:147], a[52:55]
v_mfma_f32_16x16x32_bf16 a[88:91], v[200:203], v[244:247], a[88:91]
ds_read_b64_tr_b16 v[196:197], v10 offset:4096
ds_read_b64_tr_b16 v[198:199], v10 offset:4608
s_waitcnt lgkmcnt(12)
v_mfma_f32_16x16x32_bf16 a[20:23], v[204:207], v[72:75], a[20:23]
s_add_u32 s57, s85, 1548288
s_add_u32 m0, s56, 106496
s_nop 0
buffer_load_dwordx4 v16, s[12:15], s57 offen lds
v_mfma_f32_16x16x32_bf16 a[56:59], v[204:207], v[144:147], a[56:59]
s_add_u32 s57, s86, 1548288
s_add_u32 m0, s56, 114688
s_nop 0
buffer_load_dwordx4 v16, s[12:15], s57 offen lds
v_mfma_f32_16x16x32_bf16 a[92:95], v[204:207], v[244:247], a[92:95]
ds_read_b64_tr_b16 v[200:201], v11 offset:4096
ds_read_b64_tr_b16 v[202:203], v11 offset:4608
s_waitcnt lgkmcnt(12)
v_mfma_f32_16x16x32_bf16 a[24:27], v[176:179], v[72:75], a[24:27]
v_mfma_f32_16x16x32_bf16 a[60:63], v[176:179], v[144:147], a[60:63]
s_add_u32 s57, s87, 1548288
s_add_u32 m0, s56, 122880
s_nop 0
buffer_load_dwordx4 v16, s[12:15], s57 offen lds
v_mfma_f32_16x16x32_bf16 a[96:99], v[176:179], v[244:247], a[96:99]
ds_read_b64_tr_b16 v[204:205], v12 offset:4096
ds_read_b64_tr_b16 v[206:207], v12 offset:4608
s_waitcnt lgkmcnt(12)
v_mfma_f32_16x16x32_bf16 a[28:31], v[180:183], v[72:75], a[28:31]
v_mfma_f32_16x16x32_bf16 a[64:67], v[180:183], v[144:147], a[64:67]
s_add_u32 s57, s84, 1575936
s_add_u32 m0, s56, 99328
s_nop 0
buffer_load_dwordx4 v17, s[12:15], s57 offen lds
v_mfma_f32_16x16x32_bf16 a[100:103], v[180:183], v[244:247], a[100:103]
ds_read_b64_tr_b16 v[176:177], v13 offset:4096
ds_read_b64_tr_b16 v[178:179], v13 offset:4608
s_waitcnt lgkmcnt(12)
v_mfma_f32_16x16x32_bf16 a[32:35], v[184:187], v[72:75], a[32:35]
v_mfma_f32_16x16x32_bf16 a[68:71], v[184:187], v[144:147], a[68:71]
s_add_u32 s57, s85, 1575936
s_add_u32 m0, s56, 107520
s_nop 0
buffer_load_dwordx4 v17, s[12:15], s57 offen lds
v_mfma_f32_16x16x32_bf16 a[104:107], v[184:187], v[244:247], a[104:107]
ds_read_b64_tr_b16 v[180:181], v14 offset:4096
ds_read_b64_tr_b16 v[182:183], v14 offset:4608
s_waitcnt lgkmcnt(12)
v_mfma_f32_16x16x32_bf16 a[0:3], v[188:191], v[76:79], a[0:3]
v_mfma_f32_16x16x32_bf16 a[36:39], v[188:191], v[148:151], a[36:39]
s_add_u32 s57, s86, 1575936
s_add_u32 m0, s56, 115712
s_nop 0
buffer_load_dwordx4 v17, s[12:15], s57 offen lds
v_mfma_f32_16x16x32_bf16 a[72:75], v[188:191], v[244:247], a[72:75]
ds_read_b64_tr_b16 v[184:185], v15 offset:4096
ds_read_b64_tr_b16 v[186:187], v15 offset:4608
s_waitcnt lgkmcnt(12)
v_mfma_f32_16x16x32_bf16 a[4:7], v[192:195], v[76:79], a[4:7]
v_mfma_f32_16x16x32_bf16 a[40:43], v[192:195], v[148:151], a[40:43]
s_add_u32 s57, s87, 1575936
s_add_u32 m0, s56, 123904
s_nop 0
buffer_load_dwordx4 v17, s[12:15], s57 offen lds
v_mfma_f32_16x16x32_bf16 a[76:79], v[192:195], v[244:247], a[76:79]
ds_read_b64_tr_b16 v[188:189], v29 offset:4096
ds_read_b64_tr_b16 v[190:191], v29 offset:4608
s_waitcnt lgkmcnt(12)
v_mfma_f32_16x16x32_bf16 a[8:11], v[196:199], v[76:79], a[8:11]
v_mfma_f32_16x16x32_bf16 a[44:47], v[196:199], v[148:151], a[44:47]
v_mfma_f32_16x16x32_bf16 a[80:83], v[196:199], v[244:247], a[80:83]
s_waitcnt vmcnt(12)
s_barrier
v_add_u32 v8, 32768, v8
v_add_u32 v9, 32768, v9
v_add_u32 v10, 32768, v10
v_add_u32 v11, 32768, v11
v_add_u32 v12, 32768, v12
v_add_u32 v13, 32768, v13
v_add_u32 v14, 32768, v14
v_add_u32 v15, 32768, v15
v_add_u32 v29, 32768, v29
ds_read_b64_tr_b16 v[192:193], v8 offset:0
ds_read_b64_tr_b16 v[194:195], v8 offset:512
s_waitcnt lgkmcnt(12)
v_mfma_f32_16x16x32_bf16 a[12:15], v[200:203], v[76:79], a[12:15]
v_mfma_f32_16x16x32_bf16 a[48:51], v[200:203], v[148:151], a[48:51]
v_mfma_f32_16x16x32_bf16 a[84:87], v[200:203], v[244:247], a[84:87]
ds_read_b64_tr_b16 v[196:197], v9 offset:0
ds_read_b64_tr_b16 v[198:199], v9 offset:512
s_waitcnt lgkmcnt(12)
v_mfma_f32_16x16x32_bf16 a[16:19], v[204:207], v[76:79], a[16:19]
v_mfma_f32_16x16x32_bf16 a[52:55], v[204:207], v[148:151], a[52:55]
v_mfma_f32_16x16x32_bf16 a[88:91], v[204:207], v[244:247], a[88:91]
ds_read_b64_tr_b16 v[200:201], v10 offset:0
ds_read_b64_tr_b16 v[202:203], v10 offset:512
s_waitcnt lgkmcnt(12)
v_mfma_f32_16x16x32_bf16 a[20:23], v[176:179], v[76:79], a[20:23]
v_mfma_f32_16x16x32_bf16 a[56:59], v[176:179], v[148:151], a[56:59]
v_mfma_f32_16x16x32_bf16 a[92:95], v[176:179], v[244:247], a[92:95]
ds_read_b64_tr_b16 v[204:205], v11 offset:0
ds_read_b64_tr_b16 v[206:207], v11 offset:512
s_waitcnt lgkmcnt(12)
v_mfma_f32_16x16x32_bf16 a[24:27], v[180:183], v[76:79], a[24:27]
v_mfma_f32_16x16x32_bf16 a[60:63], v[180:183], v[148:151], a[60:63]
v_mfma_f32_16x16x32_bf16 a[96:99], v[180:183], v[244:247], a[96:99]
ds_read_b64_tr_b16 v[176:177], v12 offset:0
ds_read_b64_tr_b16 v[178:179], v12 offset:512
s_waitcnt lgkmcnt(12)
v_mfma_f32_16x16x32_bf16 a[28:31], v[184:187], v[76:79], a[28:31]
v_mfma_f32_16x16x32_bf16 a[64:67], v[184:187], v[148:151], a[64:67]
v_mfma_f32_16x16x32_bf16 a[100:103], v[184:187], v[244:247], a[100:103]
ds_read_b64_tr_b16 v[180:181], v13 offset:0
ds_read_b64_tr_b16 v[182:183], v13 offset:512
s_waitcnt lgkmcnt(12)
v_mfma_f32_16x16x32_bf16 a[32:35], v[188:191], v[76:79], a[32:35]
v_mfma_f32_16x16x32_bf16 a[68:71], v[188:191], v[148:151], a[68:71]
v_mfma_f32_16x16x32_bf16 a[104:107], v[188:191], v[244:247], a[104:107]
s_mov_b64 exec, s[76:77]
v_mov_b32 v240, v84
v_mov_b32 v241, v85
v_mov_b32 v242, v86
v_mov_b32 v243, v87
v_mov_b32_dpp v84, v80 row_ror:8 row_mask:0xf bank_mask:0x3
v_mov_b32_dpp v85, v81 row_ror:8 row_mask:0xf bank_mask:0x3
v_mov_b32_dpp v86, v82 row_ror:8 row_mask:0xf bank_mask:0x3
v_mov_b32_dpp v87, v83 row_ror:8 row_mask:0xf bank_mask:0x3
v_mov_b32_dpp v80, v240 row_ror:8 row_mask:0xf bank_mask:0xc
v_mov_b32_dpp v81, v241 row_ror:8 row_mask:0xf bank_mask:0xc
v_mov_b32_dpp v82, v242 row_ror:8 row_mask:0xf bank_mask:0xc
v_mov_b32_dpp v83, v243 row_ror:8 row_mask:0xf bank_mask:0xc
v_mov_b32 v240, v156
v_mov_b32 v241, v157
v_mov_b32 v242, v158
v_mov_b32 v243, v159
v_mov_b32_dpp v156, v152 row_ror:8 row_mask:0xf bank_mask:0x3
v_mov_b32_dpp v157, v153 row_ror:8 row_mask:0xf bank_mask:0x3
v_mov_b32_dpp v158, v154 row_ror:8 row_mask:0xf bank_mask:0x3
v_mov_b32_dpp v159, v155 row_ror:8 row_mask:0xf bank_mask:0x3
v_mov_b32_dpp v152, v240 row_ror:8 row_mask:0xf bank_mask:0xc
v_mov_b32_dpp v153, v241 row_ror:8 row_mask:0xf bank_mask:0xc
v_mov_b32_dpp v154, v242 row_ror:8 row_mask:0xf bank_mask:0xc
v_mov_b32_dpp v155, v243 row_ror:8 row_mask:0xf bank_mask:0xc
s_mov_b64 exec, -1
ds_read_b64_tr_b16 v[184:185], v14 offset:0
ds_read_b64_tr_b16 v[186:187], v14 offset:512
s_waitcnt lgkmcnt(12)
v_mfma_f32_16x16x32_bf16 a[0:3], v[192:195], v[80:83], a[0:3]
s_mul_i32 s78, s73, 16
s_add_u32 s78, s78, s74
buffer_load_dwordx4 v[96:99], v27, s[8:11], s78 offen
v_mfma_f32_16x16x32_bf16 a[36:39], v[192:195], v[152:155], a[36:39]
v_mfma_f32_16x16x32_bf16 a[72:75], v[192:195], v[244:247], a[72:75]
ds_read_b64_tr_b16 v[188:189], v15 offset:0
ds_read_b64_tr_b16 v[190:191], v15 offset:512
s_waitcnt lgkmcnt(12)
v_mfma_f32_16x16x32_bf16 a[4:7], v[196:199], v[80:83], a[4:7]
s_mul_i32 s78, s73, 16
s_add_u32 s78, s78, s74
s_add_u32 s78, s78, s79
buffer_load_dwordx4 v[100:103], v27, s[8:11], s78 offen
v_mfma_f32_16x16x32_bf16 a[40:43], v[196:199], v[152:155], a[40:43]
v_mfma_f32_16x16x32_bf16 a[76:79], v[196:199], v[244:247], a[76:79]
ds_read_b64_tr_b16 v[192:193], v29 offset:0
ds_read_b64_tr_b16 v[194:195], v29 offset:512
s_waitcnt lgkmcnt(12)
v_mfma_f32_16x16x32_bf16 a[8:11], v[200:203], v[80:83], a[8:11]
s_mul_i32 s78, s73, 16
s_add_u32 s78, s78, s74
s_add_u32 s78, s78, s75
buffer_load_dwordx4 v[168:171], v27, s[8:11], s78 offen
v_mfma_f32_16x16x32_bf16 a[44:47], v[200:203], v[152:155], a[44:47]
v_mfma_f32_16x16x32_bf16 a[80:83], v[200:203], v[244:247], a[80:83]
ds_read_b64_tr_b16 v[196:197], v8 offset:4096
ds_read_b64_tr_b16 v[198:199], v8 offset:4608
s_waitcnt lgkmcnt(12)
v_mfma_f32_16x16x32_bf16 a[12:15], v[204:207], v[80:83], a[12:15]
s_mul_i32 s78, s73, 16
s_add_u32 s78, s78, s74
s_add_u32 s78, s78, s75
s_add_u32 s78, s78, s79
buffer_load_dwordx4 v[172:175], v27, s[8:11], s78 offen
v_mfma_f32_16x16x32_bf16 a[48:51], v[204:207], v[152:155], a[48:51]
v_mfma_f32_16x16x32_bf16 a[84:87], v[204:207], v[244:247], a[84:87]
ds_read_b64_tr_b16 v[200:201], v9 offset:4096
ds_read_b64_tr_b16 v[202:203], v9 offset:4608
s_waitcnt lgkmcnt(12)
v_mfma_f32_16x16x32_bf16 a[16:19], v[176:179], v[80:83], a[16:19]
s_add_u32 s57, s84, 1769472
s_add_u32 m0, s56, 0
s_nop 0
buffer_load_dwordx4 v16, s[12:15], s57 offen lds
v_mfma_f32_16x16x32_bf16 a[52:55], v[176:179], v[152:155], a[52:55]
v_mfma_f32_16x16x32_bf16 a[88:91], v[176:179], v[244:247], a[88:91]
ds_read_b64_tr_b16 v[204:205], v10 offset:4096
ds_read_b64_tr_b16 v[206:207], v10 offset:4608
s_waitcnt lgkmcnt(12)
v_mfma_f32_16x16x32_bf16 a[20:23], v[180:183], v[80:83], a[20:23]
s_add_u32 s57, s85, 1769472
s_add_u32 m0, s56, 8192
s_nop 0
buffer_load_dwordx4 v16, s[12:15], s57 offen lds
v_mfma_f32_16x16x32_bf16 a[56:59], v[180:183], v[152:155], a[56:59]
s_add_u32 s57, s86, 1769472
s_add_u32 m0, s56, 16384
s_nop 0
buffer_load_dwordx4 v16, s[12:15], s57 offen lds
v_mfma_f32_16x16x32_bf16 a[92:95], v[180:183], v[244:247], a[92:95]
ds_read_b64_tr_b16 v[176:177], v11 offset:4096
ds_read_b64_tr_b16 v[178:179], v11 offset:4608
s_waitcnt lgkmcnt(12)
v_mfma_f32_16x16x32_bf16 a[24:27], v[184:187], v[80:83], a[24:27]
v_mfma_f32_16x16x32_bf16 a[60:63], v[184:187], v[152:155], a[60:63]
s_add_u32 s57, s87, 1769472
s_add_u32 m0, s56, 24576
s_nop 0
buffer_load_dwordx4 v16, s[12:15], s57 offen lds
v_mfma_f32_16x16x32_bf16 a[96:99], v[184:187], v[244:247], a[96:99]
ds_read_b64_tr_b16 v[180:181], v12 offset:4096
ds_read_b64_tr_b16 v[182:183], v12 offset:4608
s_waitcnt lgkmcnt(12)
v_mfma_f32_16x16x32_bf16 a[28:31], v[188:191], v[80:83], a[28:31]
v_mfma_f32_16x16x32_bf16 a[64:67], v[188:191], v[152:155], a[64:67]
s_add_u32 s57, s84, 1797120
s_add_u32 m0, s56, 1024
s_nop 0
buffer_load_dwordx4 v17, s[12:15], s57 offen lds
v_mfma_f32_16x16x32_bf16 a[100:103], v[188:191], v[244:247], a[100:103]
ds_read_b64_tr_b16 v[184:185], v13 offset:4096
ds_read_b64_tr_b16 v[186:187], v13 offset:4608
s_waitcnt lgkmcnt(12)
v_mfma_f32_16x16x32_bf16 a[32:35], v[192:195], v[80:83], a[32:35]
v_mfma_f32_16x16x32_bf16 a[68:71], v[192:195], v[152:155], a[68:71]
s_add_u32 s57, s85, 1797120
s_add_u32 m0, s56, 9216
s_nop 0
buffer_load_dwordx4 v17, s[12:15], s57 offen lds
v_mfma_f32_16x16x32_bf16 a[104:107], v[192:195], v[244:247], a[104:107]
ds_read_b64_tr_b16 v[188:189], v14 offset:4096
ds_read_b64_tr_b16 v[190:191], v14 offset:4608
s_waitcnt lgkmcnt(12)
v_mfma_f32_16x16x32_bf16 a[0:3], v[196:199], v[84:87], a[0:3]
v_mfma_f32_16x16x32_bf16 a[36:39], v[196:199], v[156:159], a[36:39]
s_add_u32 s57, s86, 1797120
s_add_u32 m0, s56, 17408
s_nop 0
buffer_load_dwordx4 v17, s[12:15], s57 offen lds
v_mfma_f32_16x16x32_bf16 a[72:75], v[196:199], v[244:247], a[72:75]
ds_read_b64_tr_b16 v[192:193], v15 offset:4096
ds_read_b64_tr_b16 v[194:195], v15 offset:4608
s_waitcnt lgkmcnt(12)
v_mfma_f32_16x16x32_bf16 a[4:7], v[200:203], v[84:87], a[4:7]
v_mfma_f32_16x16x32_bf16 a[40:43], v[200:203], v[156:159], a[40:43]
s_add_u32 s57, s87, 1797120
s_add_u32 m0, s56, 25600
s_nop 0
buffer_load_dwordx4 v17, s[12:15], s57 offen lds
v_mfma_f32_16x16x32_bf16 a[76:79], v[200:203], v[244:247], a[76:79]
ds_read_b64_tr_b16 v[196:197], v29 offset:4096
ds_read_b64_tr_b16 v[198:199], v29 offset:4608
s_waitcnt lgkmcnt(12)
v_mfma_f32_16x16x32_bf16 a[8:11], v[204:207], v[84:87], a[8:11]
v_mfma_f32_16x16x32_bf16 a[44:47], v[204:207], v[156:159], a[44:47]
v_mfma_f32_16x16x32_bf16 a[80:83], v[204:207], v[244:247], a[80:83]
s_waitcnt vmcnt(12)
s_barrier
v_add_u32 v8, 32768, v8
v_add_u32 v9, 32768, v9
v_add_u32 v10, 32768, v10
v_add_u32 v11, 32768, v11
v_add_u32 v12, 32768, v12
v_add_u32 v13, 32768, v13
v_add_u32 v14, 32768, v14
v_add_u32 v15, 32768, v15
v_add_u32 v29, 32768, v29
ds_read_b64_tr_b16 v[200:201], v8 offset:0
ds_read_b64_tr_b16 v[202:203], v8 offset:512
s_waitcnt lgkmcnt(12)
v_mfma_f32_16x16x32_bf16 a[12:15], v[176:179], v[84:87], a[12:15]
v_mfma_f32_16x16x32_bf16 a[48:51], v[176:179], v[156:159], a[48:51]
v_mfma_f32_16x16x32_bf16 a[84:87], v[176:179], v[244:247], a[84:87]
ds_read_b64_tr_b16 v[204:205], v9 offset:0
ds_read_b64_tr_b16 v[206:207], v9 offset:512
s_waitcnt lgkmcnt(12)
v_mfma_f32_16x16x32_bf16 a[16:19], v[180:183], v[84:87], a[16:19]
v_mfma_f32_16x16x32_bf16 a[52:55], v[180:183], v[156:159], a[52:55]
v_mfma_f32_16x16x32_bf16 a[88:91], v[180:183], v[244:247], a[88:91]
ds_read_b64_tr_b16 v[176:177], v10 offset:0
ds_read_b64_tr_b16 v[178:179], v10 offset:512
s_waitcnt lgkmcnt(12)
v_mfma_f32_16x16x32_bf16 a[20:23], v[184:187], v[84:87], a[20:23]
v_mfma_f32_16x16x32_bf16 a[56:59], v[184:187], v[156:159], a[56:59]
v_mfma_f32_16x16x32_bf16 a[92:95], v[184:187], v[244:247], a[92:95]
ds_read_b64_tr_b16 v[180:181], v11 offset:0
ds_read_b64_tr_b16 v[182:183], v11 offset:512
s_waitcnt lgkmcnt(12)
v_mfma_f32_16x16x32_bf16 a[24:27], v[188:191], v[84:87], a[24:27]
v_mfma_f32_16x16x32_bf16 a[60:63], v[188:191], v[156:159], a[60:63]
v_mfma_f32_16x16x32_bf16 a[96:99], v[188:191], v[244:247], a[96:99]
ds_read_b64_tr_b16 v[184:185], v12 offset:0
ds_read_b64_tr_b16 v[186:187], v12 offset:512
s_waitcnt lgkmcnt(12)
v_mfma_f32_16x16x32_bf16 a[28:31], v[192:195], v[84:87], a[28:31]
v_mfma_f32_16x16x32_bf16 a[64:67], v[192:195], v[156:159], a[64:67]
v_mfma_f32_16x16x32_bf16 a[100:103], v[192:195], v[244:247], a[100:103]
ds_read_b64_tr_b16 v[188:189], v13 offset:0
ds_read_b64_tr_b16 v[190:191], v13 offset:512
s_waitcnt lgkmcnt(12)
v_mfma_f32_16x16x32_bf16 a[32:35], v[196:199], v[84:87], a[32:35]
v_mfma_f32_16x16x32_bf16 a[68:71], v[196:199], v[156:159], a[68:71]
v_mfma_f32_16x16x32_bf16 a[104:107], v[196:199], v[244:247], a[104:107]
s_mov_b64 exec, s[76:77]
v_mov_b32 v240, v92
v_mov_b32 v241, v93
v_mov_b32 v242, v94
v_mov_b32 v243, v95
v_mov_b32_dpp v92, v88 row_ror:8 row_mask:0xf bank_mask:0x3
v_mov_b32_dpp v93, v89 row_ror:8 row_mask:0xf bank_mask:0x3
v_mov_b32_dpp v94, v90 row_ror:8 row_mask:0xf bank_mask:0x3
v_mov_b32_dpp v95, v91 row_ror:8 row_mask:0xf bank_mask:0x3
v_mov_b32_dpp v88, v240 row_ror:8 row_mask:0xf bank_mask:0xc
v_mov_b32_dpp v89, v241 row_ror:8 row_mask:0xf bank_mask:0xc
v_mov_b32_dpp v90, v242 row_ror:8 row_mask:0xf bank_mask:0xc
v_mov_b32_dpp v91, v243 row_ror:8 row_mask:0xf bank_mask:0xc
v_mov_b32 v240, v164
v_mov_b32 v241, v165
v_mov_b32 v242, v166
v_mov_b32 v243, v167
v_mov_b32_dpp v164, v160 row_ror:8 row_mask:0xf bank_mask:0x3
v_mov_b32_dpp v165, v161 row_ror:8 row_mask:0xf bank_mask:0x3
v_mov_b32_dpp v166, v162 row_ror:8 row_mask:0xf bank_mask:0x3
v_mov_b32_dpp v167, v163 row_ror:8 row_mask:0xf bank_mask:0x3
v_mov_b32_dpp v160, v240 row_ror:8 row_mask:0xf bank_mask:0xc
v_mov_b32_dpp v161, v241 row_ror:8 row_mask:0xf bank_mask:0xc
v_mov_b32_dpp v162, v242 row_ror:8 row_mask:0xf bank_mask:0xc
v_mov_b32_dpp v163, v243 row_ror:8 row_mask:0xf bank_mask:0xc
s_mov_b64 exec, -1
ds_read_b64_tr_b16 v[192:193], v14 offset:0
ds_read_b64_tr_b16 v[194:195], v14 offset:512
s_waitcnt lgkmcnt(12)
v_mfma_f32_16x16x32_bf16 a[0:3], v[200:203], v[88:91], a[0:3]
v_mfma_f32_16x16x32_bf16 a[36:39], v[200:203], v[160:163], a[36:39]
v_mfma_f32_16x16x32_bf16 a[72:75], v[200:203], v[244:247], a[72:75]
ds_read_b64_tr_b16 v[196:197], v15 offset:0
ds_read_b64_tr_b16 v[198:199], v15 offset:512
s_waitcnt lgkmcnt(12)
v_mfma_f32_16x16x32_bf16 a[4:7], v[204:207], v[88:91], a[4:7]
v_mfma_f32_16x16x32_bf16 a[40:43], v[204:207], v[160:163], a[40:43]
v_mfma_f32_16x16x32_bf16 a[76:79], v[204:207], v[244:247], a[76:79]
ds_read_b64_tr_b16 v[200:201], v29 offset:0
ds_read_b64_tr_b16 v[202:203], v29 offset:512
s_waitcnt lgkmcnt(12)
v_mfma_f32_16x16x32_bf16 a[8:11], v[176:179], v[88:91], a[8:11]
v_mfma_f32_16x16x32_bf16 a[44:47], v[176:179], v[160:163], a[44:47]
v_mfma_f32_16x16x32_bf16 a[80:83], v[176:179], v[244:247], a[80:83]
ds_read_b64_tr_b16 v[204:205], v8 offset:4096
ds_read_b64_tr_b16 v[206:207], v8 offset:4608
s_waitcnt lgkmcnt(12)
v_mfma_f32_16x16x32_bf16 a[12:15], v[180:183], v[88:91], a[12:15]
v_mfma_f32_16x16x32_bf16 a[48:51], v[180:183], v[160:163], a[48:51]
v_mfma_f32_16x16x32_bf16 a[84:87], v[180:183], v[244:247], a[84:87]
ds_read_b64_tr_b16 v[176:177], v9 offset:4096
ds_read_b64_tr_b16 v[178:179], v9 offset:4608
s_waitcnt lgkmcnt(12)
v_mfma_f32_16x16x32_bf16 a[16:19], v[184:187], v[88:91], a[16:19]
v_mfma_f32_16x16x32_bf16 a[52:55], v[184:187], v[160:163], a[52:55]
v_mfma_f32_16x16x32_bf16 a[88:91], v[184:187], v[244:247], a[88:91]
ds_read_b64_tr_b16 v[180:181], v10 offset:4096
ds_read_b64_tr_b16 v[182:183], v10 offset:4608
s_waitcnt lgkmcnt(12)
v_mfma_f32_16x16x32_bf16 a[20:23], v[188:191], v[88:91], a[20:23]
v_mfma_f32_16x16x32_bf16 a[56:59], v[188:191], v[160:163], a[56:59]
v_mfma_f32_16x16x32_bf16 a[92:95], v[188:191], v[244:247], a[92:95]
ds_read_b64_tr_b16 v[184:185], v11 offset:4096
ds_read_b64_tr_b16 v[186:187], v11 offset:4608
s_waitcnt lgkmcnt(12)
v_mfma_f32_16x16x32_bf16 a[24:27], v[192:195], v[88:91], a[24:27]
v_mfma_f32_16x16x32_bf16 a[60:63], v[192:195], v[160:163], a[60:63]
v_mfma_f32_16x16x32_bf16 a[96:99], v[192:195], v[244:247], a[96:99]
ds_read_b64_tr_b16 v[188:189], v12 offset:4096
ds_read_b64_tr_b16 v[190:191], v12 offset:4608
s_waitcnt lgkmcnt(12)
v_mfma_f32_16x16x32_bf16 a[28:31], v[196:199], v[88:91], a[28:31]
v_mfma_f32_16x16x32_bf16 a[64:67], v[196:199], v[160:163], a[64:67]
v_mfma_f32_16x16x32_bf16 a[100:103], v[196:199], v[244:247], a[100:103]
ds_read_b64_tr_b16 v[192:193], v13 offset:4096
ds_read_b64_tr_b16 v[194:195], v13 offset:4608
s_waitcnt lgkmcnt(12)
v_mfma_f32_16x16x32_bf16 a[32:35], v[200:203], v[88:91], a[32:35]
v_mfma_f32_16x16x32_bf16 a[68:71], v[200:203], v[160:163], a[68:71]
v_mfma_f32_16x16x32_bf16 a[104:107], v[200:203], v[244:247], a[104:107]
ds_read_b64_tr_b16 v[196:197], v14 offset:4096
ds_read_b64_tr_b16 v[198:199], v14 offset:4608
s_waitcnt lgkmcnt(12)
v_mfma_f32_16x16x32_bf16 a[0:3], v[204:207], v[92:95], a[0:3]
v_mfma_f32_16x16x32_bf16 a[36:39], v[204:207], v[164:167], a[36:39]
v_mfma_f32_16x16x32_bf16 a[72:75], v[204:207], v[244:247], a[72:75]
ds_read_b64_tr_b16 v[200:201], v15 offset:4096
ds_read_b64_tr_b16 v[202:203], v15 offset:4608
s_waitcnt lgkmcnt(12)
v_mfma_f32_16x16x32_bf16 a[4:7], v[176:179], v[92:95], a[4:7]
v_mfma_f32_16x16x32_bf16 a[40:43], v[176:179], v[164:167], a[40:43]
v_mfma_f32_16x16x32_bf16 a[76:79], v[176:179], v[244:247], a[76:79]
ds_read_b64_tr_b16 v[204:205], v29 offset:4096
ds_read_b64_tr_b16 v[206:207], v29 offset:4608
s_waitcnt lgkmcnt(12)
v_mfma_f32_16x16x32_bf16 a[8:11], v[180:183], v[92:95], a[8:11]
v_mfma_f32_16x16x32_bf16 a[44:47], v[180:183], v[164:167], a[44:47]
v_mfma_f32_16x16x32_bf16 a[80:83], v[180:183], v[244:247], a[80:83]
s_waitcnt vmcnt(0)
s_barrier
v_subrev_u32 v8, 98304, v8
v_subrev_u32 v9, 98304, v9
v_subrev_u32 v10, 98304, v10
v_subrev_u32 v11, 98304, v11
v_subrev_u32 v12, 98304, v12
v_subrev_u32 v13, 98304, v13
v_subrev_u32 v14, 98304, v14
v_subrev_u32 v15, 98304, v15
v_subrev_u32 v29, 98304, v29
ds_read_b64_tr_b16 v[176:177], v8 offset:0
ds_read_b64_tr_b16 v[178:179], v8 offset:512
s_waitcnt lgkmcnt(12)
v_mfma_f32_16x16x32_bf16 a[12:15], v[184:187], v[92:95], a[12:15]
v_mfma_f32_16x16x32_bf16 a[48:51], v[184:187], v[164:167], a[48:51]
v_mfma_f32_16x16x32_bf16 a[84:87], v[184:187], v[244:247], a[84:87]
ds_read_b64_tr_b16 v[180:181], v9 offset:0
ds_read_b64_tr_b16 v[182:183], v9 offset:512
s_waitcnt lgkmcnt(12)
v_mfma_f32_16x16x32_bf16 a[16:19], v[188:191], v[92:95], a[16:19]
v_mfma_f32_16x16x32_bf16 a[52:55], v[188:191], v[164:167], a[52:55]
v_mfma_f32_16x16x32_bf16 a[88:91], v[188:191], v[244:247], a[88:91]
ds_read_b64_tr_b16 v[184:185], v10 offset:0
ds_read_b64_tr_b16 v[186:187], v10 offset:512
s_waitcnt lgkmcnt(12)
v_mfma_f32_16x16x32_bf16 a[20:23], v[192:195], v[92:95], a[20:23]
v_mfma_f32_16x16x32_bf16 a[56:59], v[192:195], v[164:167], a[56:59]
v_mfma_f32_16x16x32_bf16 a[92:95], v[192:195], v[244:247], a[92:95]
ds_read_b64_tr_b16 v[188:189], v11 offset:0
ds_read_b64_tr_b16 v[190:191], v11 offset:512
s_waitcnt lgkmcnt(12)
v_mfma_f32_16x16x32_bf16 a[24:27], v[196:199], v[92:95], a[24:27]
v_mfma_f32_16x16x32_bf16 a[60:63], v[196:199], v[164:167], a[60:63]
v_mfma_f32_16x16x32_bf16 a[96:99], v[196:199], v[244:247], a[96:99]
ds_read_b64_tr_b16 v[192:193], v12 offset:0
ds_read_b64_tr_b16 v[194:195], v12 offset:512
s_waitcnt lgkmcnt(12)
v_mfma_f32_16x16x32_bf16 a[28:31], v[200:203], v[92:95], a[28:31]
v_mfma_f32_16x16x32_bf16 a[64:67], v[200:203], v[164:167], a[64:67]
v_mfma_f32_16x16x32_bf16 a[100:103], v[200:203], v[244:247], a[100:103]
ds_read_b64_tr_b16 v[196:197], v13 offset:0
ds_read_b64_tr_b16 v[198:199], v13 offset:512
s_waitcnt lgkmcnt(12)
v_mfma_f32_16x16x32_bf16 a[32:35], v[204:207], v[92:95], a[32:35]
v_mfma_f32_16x16x32_bf16 a[68:71], v[204:207], v[164:167], a[68:71]
v_mfma_f32_16x16x32_bf16 a[104:107], v[204:207], v[244:247], a[104:107]
s_mov_b64 exec, s[76:77]
v_mov_b32 v240, v100
v_mov_b32 v241, v101
v_mov_b32 v242, v102
v_mov_b32 v243, v103
v_mov_b32_dpp v100, v96 row_ror:8 row_mask:0xf bank_mask:0x3
v_mov_b32_dpp v101, v97 row_ror:8 row_mask:0xf bank_mask:0x3
v_mov_b32_dpp v102, v98 row_ror:8 row_mask:0xf bank_mask:0x3
v_mov_b32_dpp v103, v99 row_ror:8 row_mask:0xf bank_mask:0x3
v_mov_b32_dpp v96, v240 row_ror:8 row_mask:0xf bank_mask:0xc
v_mov_b32_dpp v97, v241 row_ror:8 row_mask:0xf bank_mask:0xc
v_mov_b32_dpp v98, v242 row_ror:8 row_mask:0xf bank_mask:0xc
v_mov_b32_dpp v99, v243 row_ror:8 row_mask:0xf bank_mask:0xc
v_mov_b32 v240, v172
v_mov_b32 v241, v173
v_mov_b32 v242, v174
v_mov_b32 v243, v175
v_mov_b32_dpp v172, v168 row_ror:8 row_mask:0xf bank_mask:0x3
v_mov_b32_dpp v173, v169 row_ror:8 row_mask:0xf bank_mask:0x3
v_mov_b32_dpp v174, v170 row_ror:8 row_mask:0xf bank_mask:0x3
v_mov_b32_dpp v175, v171 row_ror:8 row_mask:0xf bank_mask:0x3
v_mov_b32_dpp v168, v240 row_ror:8 row_mask:0xf bank_mask:0xc
v_mov_b32_dpp v169, v241 row_ror:8 row_mask:0xf bank_mask:0xc
v_mov_b32_dpp v170, v242 row_ror:8 row_mask:0xf bank_mask:0xc
v_mov_b32_dpp v171, v243 row_ror:8 row_mask:0xf bank_mask:0xc
s_mov_b64 exec, -1
ds_read_b64_tr_b16 v[200:201], v14 offset:0
ds_read_b64_tr_b16 v[202:203], v14 offset:512
s_waitcnt lgkmcnt(12)
v_mfma_f32_16x16x32_bf16 a[0:3], v[176:179], v[96:99], a[0:3]
v_mfma_f32_16x16x32_bf16 a[36:39], v[176:179], v[168:171], a[36:39]
v_mfma_f32_16x16x32_bf16 a[72:75], v[176:179], v[244:247], a[72:75]
ds_read_b64_tr_b16 v[204:205], v15 offset:0
ds_read_b64_tr_b16 v[206:207], v15 offset:512
s_waitcnt lgkmcnt(12)
v_mfma_f32_16x16x32_bf16 a[4:7], v[180:183], v[96:99], a[4:7]
v_mfma_f32_16x16x32_bf16 a[40:43], v[180:183], v[168:171], a[40:43]
v_mfma_f32_16x16x32_bf16 a[76:79], v[180:183], v[244:247], a[76:79]
ds_read_b64_tr_b16 v[176:177], v29 offset:0
ds_read_b64_tr_b16 v[178:179], v29 offset:512
s_waitcnt lgkmcnt(12)
v_mfma_f32_16x16x32_bf16 a[8:11], v[184:187], v[96:99], a[8:11]
v_mfma_f32_16x16x32_bf16 a[44:47], v[184:187], v[168:171], a[44:47]
v_mfma_f32_16x16x32_bf16 a[80:83], v[184:187], v[244:247], a[80:83]
ds_read_b64_tr_b16 v[180:181], v8 offset:4096
ds_read_b64_tr_b16 v[182:183], v8 offset:4608
s_waitcnt lgkmcnt(12)
v_mfma_f32_16x16x32_bf16 a[12:15], v[188:191], v[96:99], a[12:15]
v_mfma_f32_16x16x32_bf16 a[48:51], v[188:191], v[168:171], a[48:51]
v_mfma_f32_16x16x32_bf16 a[84:87], v[188:191], v[244:247], a[84:87]
ds_read_b64_tr_b16 v[184:185], v9 offset:4096
ds_read_b64_tr_b16 v[186:187], v9 offset:4608
s_waitcnt lgkmcnt(12)
v_mfma_f32_16x16x32_bf16 a[16:19], v[192:195], v[96:99], a[16:19]
v_mfma_f32_16x16x32_bf16 a[52:55], v[192:195], v[168:171], a[52:55]
v_mfma_f32_16x16x32_bf16 a[88:91], v[192:195], v[244:247], a[88:91]
ds_read_b64_tr_b16 v[188:189], v10 offset:4096
ds_read_b64_tr_b16 v[190:191], v10 offset:4608
s_waitcnt lgkmcnt(12)
v_mfma_f32_16x16x32_bf16 a[20:23], v[196:199], v[96:99], a[20:23]
v_mfma_f32_16x16x32_bf16 a[56:59], v[196:199], v[168:171], a[56:59]
v_mfma_f32_16x16x32_bf16 a[92:95], v[196:199], v[244:247], a[92:95]
ds_read_b64_tr_b16 v[192:193], v11 offset:4096
ds_read_b64_tr_b16 v[194:195], v11 offset:4608
s_waitcnt lgkmcnt(12)
v_mfma_f32_16x16x32_bf16 a[24:27], v[200:203], v[96:99], a[24:27]
v_mfma_f32_16x16x32_bf16 a[60:63], v[200:203], v[168:171], a[60:63]
v_mfma_f32_16x16x32_bf16 a[96:99], v[200:203], v[244:247], a[96:99]
ds_read_b64_tr_b16 v[196:197], v12 offset:4096
ds_read_b64_tr_b16 v[198:199], v12 offset:4608
s_waitcnt lgkmcnt(12)
v_mfma_f32_16x16x32_bf16 a[28:31], v[204:207], v[96:99], a[28:31]
v_mfma_f32_16x16x32_bf16 a[64:67], v[204:207], v[168:171], a[64:67]
v_mfma_f32_16x16x32_bf16 a[100:103], v[204:207], v[244:247], a[100:103]
ds_read_b64_tr_b16 v[200:201], v13 offset:4096
ds_read_b64_tr_b16 v[202:203], v13 offset:4608
s_waitcnt lgkmcnt(12)
v_mfma_f32_16x16x32_bf16 a[32:35], v[176:179], v[96:99], a[32:35]
v_mfma_f32_16x16x32_bf16 a[68:71], v[176:179], v[168:171], a[68:71]
v_mfma_f32_16x16x32_bf16 a[104:107], v[176:179], v[244:247], a[104:107]
ds_read_b64_tr_b16 v[204:205], v14 offset:4096
ds_read_b64_tr_b16 v[206:207], v14 offset:4608
s_waitcnt lgkmcnt(12)
v_mfma_f32_16x16x32_bf16 a[0:3], v[180:183], v[100:103], a[0:3]
v_mfma_f32_16x16x32_bf16 a[36:39], v[180:183], v[172:175], a[36:39]
v_mfma_f32_16x16x32_bf16 a[72:75], v[180:183], v[244:247], a[72:75]
ds_read_b64_tr_b16 v[176:177], v15 offset:4096
ds_read_b64_tr_b16 v[178:179], v15 offset:4608
s_waitcnt lgkmcnt(12)
v_mfma_f32_16x16x32_bf16 a[4:7], v[184:187], v[100:103], a[4:7]
v_mfma_f32_16x16x32_bf16 a[40:43], v[184:187], v[172:175], a[40:43]
v_mfma_f32_16x16x32_bf16 a[76:79], v[184:187], v[244:247], a[76:79]
ds_read_b64_tr_b16 v[180:181], v29 offset:4096
ds_read_b64_tr_b16 v[182:183], v29 offset:4608
s_waitcnt lgkmcnt(12)
v_mfma_f32_16x16x32_bf16 a[8:11], v[188:191], v[100:103], a[8:11]
v_mfma_f32_16x16x32_bf16 a[44:47], v[188:191], v[172:175], a[44:47]
v_mfma_f32_16x16x32_bf16 a[80:83], v[188:191], v[244:247], a[80:83]
s_waitcnt lgkmcnt(10)
v_mfma_f32_16x16x32_bf16 a[12:15], v[192:195], v[100:103], a[12:15]
v_mfma_f32_16x16x32_bf16 a[48:51], v[192:195], v[172:175], a[48:51]
v_mfma_f32_16x16x32_bf16 a[84:87], v[192:195], v[244:247], a[84:87]
s_waitcnt lgkmcnt(8)
v_mfma_f32_16x16x32_bf16 a[16:19], v[196:199], v[100:103], a[16:19]
v_mfma_f32_16x16x32_bf16 a[52:55], v[196:199], v[172:175], a[52:55]
v_mfma_f32_16x16x32_bf16 a[88:91], v[196:199], v[244:247], a[88:91]
s_waitcnt lgkmcnt(6)
v_mfma_f32_16x16x32_bf16 a[20:23], v[200:203], v[100:103], a[20:23]
v_mfma_f32_16x16x32_bf16 a[56:59], v[200:203], v[172:175], a[56:59]
v_mfma_f32_16x16x32_bf16 a[92:95], v[200:203], v[244:247], a[92:95]
s_waitcnt lgkmcnt(4)
v_mfma_f32_16x16x32_bf16 a[24:27], v[204:207], v[100:103], a[24:27]
v_mfma_f32_16x16x32_bf16 a[60:63], v[204:207], v[172:175], a[60:63]
v_mfma_f32_16x16x32_bf16 a[96:99], v[204:207], v[244:247], a[96:99]
s_waitcnt lgkmcnt(2)
v_mfma_f32_16x16x32_bf16 a[28:31], v[176:179], v[100:103], a[28:31]
v_mfma_f32_16x16x32_bf16 a[64:67], v[176:179], v[172:175], a[64:67]
v_mfma_f32_16x16x32_bf16 a[100:103], v[176:179], v[244:247], a[100:103]
s_waitcnt lgkmcnt(0)
v_mfma_f32_16x16x32_bf16 a[32:35], v[180:183], v[100:103], a[32:35]
v_mfma_f32_16x16x32_bf16 a[68:71], v[180:183], v[172:175], a[68:71]
v_mfma_f32_16x16x32_bf16 a[104:107], v[180:183], v[244:247], a[104:107]
s_or_b32 s70, s92, s59
s_cmp_lg_u32 s70, 0
s_cbranch_scc1 k1_nox0
s_add_u32 s70, s72, 61865984
v_lshlrev_b32 v6, 4, v1
s_add_u32 s71, s70, 0
buffer_store_dwordx4 v[32:35], v6, s[16:19], s71 offen offset:0 sc1
s_add_u32 s71, s70, 0
buffer_store_dwordx4 v[36:39], v6, s[16:19], s71 offen offset:1024 sc1
s_add_u32 s71, s70, 0
buffer_store_dwordx4 v[40:43], v6, s[16:19], s71 offen offset:2048 sc1
s_add_u32 s71, s70, 0
buffer_store_dwordx4 v[44:47], v6, s[16:19], s71 offen offset:3072 sc1
s_add_u32 s71, s70, 4096
buffer_store_dwordx4 v[48:51], v6, s[16:19], s71 offen offset:0 sc1
s_add_u32 s71, s70, 4096
buffer_store_dwordx4 v[52:55], v6, s[16:19], s71 offen offset:1024 sc1
s_add_u32 s71, s70, 4096
buffer_store_dwordx4 v[56:59], v6, s[16:19], s71 offen offset:2048 sc1
s_add_u32 s71, s70, 4096
buffer_store_dwordx4 v[60:63], v6, s[16:19], s71 offen offset:3072 sc1
s_add_u32 s71, s70, 8192
buffer_store_dwordx4 v[64:67], v6, s[16:19], s71 offen offset:0 sc1
s_add_u32 s71, s70, 8192
buffer_store_dwordx4 v[68:71], v6, s[16:19], s71 offen offset:1024 sc1
s_add_u32 s71, s70, 8192
buffer_store_dwordx4 v[72:75], v6, s[16:19], s71 offen offset:2048 sc1
s_add_u32 s71, s70, 8192
buffer_store_dwordx4 v[76:79], v6, s[16:19], s71 offen offset:3072 sc1
s_add_u32 s71, s70, 12288
buffer_store_dwordx4 v[80:83], v6, s[16:19], s71 offen offset:0 sc1
s_add_u32 s71, s70, 12288
buffer_store_dwordx4 v[84:87], v6, s[16:19], s71 offen offset:1024 sc1
s_add_u32 s71, s70, 12288
buffer_store_dwordx4 v[88:91], v6, s[16:19], s71 offen offset:2048 sc1
s_add_u32 s71, s70, 12288
buffer_store_dwordx4 v[92:95], v6, s[16:19], s71 offen offset:3072 sc1
s_add_u32 s71, s70, 16384
buffer_store_dwordx4 v[96:99], v6, s[16:19], s71 offen offset:0 sc1
s_add_u32 s71, s70, 16384
buffer_store_dwordx4 v[100:103], v6, s[16:19], s71 offen offset:1024 sc1
s_add_u32 s71, s70, 18432
buffer_store_dwordx4 v[104:107], v6, s[16:19], s71 offen offset:0 sc1
s_add_u32 s71, s70, 18432
buffer_store_dwordx4 v[108:111], v6, s[16:19], s71 offen offset:1024 sc1
s_add_u32 s71, s70, 18432
buffer_store_dwordx4 v[112:115], v6, s[16:19], s71 offen offset:2048 sc1
s_add_u32 s71, s70, 18432
buffer_store_dwordx4 v[116:119], v6, s[16:19], s71 offen offset:3072 sc1
s_add_u32 s71, s70, 22528
buffer_store_dwordx4 v[120:123], v6, s[16:19], s71 offen offset:0 sc1
s_add_u32 s71, s70, 22528
buffer_store_dwordx4 v[124:127], v6, s[16:19], s71 offen offset:1024 sc1
s_add_u32 s71, s70, 22528
buffer_store_dwordx4 v[128:131], v6, s[16:19], s71 offen offset:2048 sc1
s_add_u32 s71, s70, 22528
buffer_store_dwordx4 v[132:135], v6, s[16:19], s71 offen offset:3072 sc1
s_add_u32 s71, s70, 26624
buffer_store_dwordx4 v[136:139], v6, s[16:19], s71 offen offset:0 sc1
s_add_u32 s71, s70, 26624
buffer_store_dwordx4 v[140:143], v6, s[16:19], s71 offen offset:1024 sc1
s_add_u32 s71, s70, 26624
buffer_store_dwordx4 v[144:147], v6, s[16:19], s71 offen offset:2048 sc1
s_add_u32 s71, s70, 26624
buffer_store_dwordx4 v[148:151], v6, s[16:19], s71 offen offset:3072 sc1
s_add_u32 s71, s70, 30720
buffer_store_dwordx4 v[152:155], v6, s[16:19], s71 offen offset:0 sc1
s_add_u32 s71, s70, 30720
buffer_store_dwordx4 v[156:159], v6, s[16:19], s71 offen offset:1024 sc1
s_add_u32 s71, s70, 30720
buffer_store_dwordx4 v[160:163], v6, s[16:19], s71 offen offset:2048 sc1
s_add_u32 s71, s70, 30720
buffer_store_dwordx4 v[164:167], v6, s[16:19], s71 offen offset:3072 sc1
s_add_u32 s71, s70, 34816
buffer_store_dwordx4 v[168:171], v6, s[16:19], s71 offen offset:0 sc1
s_add_u32 s71, s70, 34816
buffer_store_dwordx4 v[172:175], v6, s[16:19], s71 offen offset:1024 sc1
k1_nox0:
s_nop 3
v_dot2_f32_bf16 v248, v32, s82, v248
v_dot2_f32_bf16 v250, v32, v32, v250
v_dot2_f32_bf16 v249, v104, s82, v249
v_dot2_f32_bf16 v251, v104, v104, v251
v_dot2_f32_bf16 v248, v33, s82, v248
v_dot2_f32_bf16 v250, v33, v33, v250
v_dot2_f32_bf16 v249, v105, s82, v249
v_dot2_f32_bf16 v251, v105, v105, v251
v_dot2_f32_bf16 v248, v34, s82, v248
v_dot2_f32_bf16 v250, v34, v34, v250
v_dot2_f32_bf16 v249, v106, s82, v249
v_dot2_f32_bf16 v251, v106, v106, v251
v_dot2_f32_bf16 v248, v35, s82, v248
v_dot2_f32_bf16 v250, v35, v35, v250
v_dot2_f32_bf16 v249, v107, s82, v249
v_dot2_f32_bf16 v251, v107, v107, v251
v_dot2_f32_bf16 v248, v36, s82, v248
v_dot2_f32_bf16 v250, v36, v36, v250
v_dot2_f32_bf16 v249, v108, s82, v249
v_dot2_f32_bf16 v251, v108, v108, v251
v_dot2_f32_bf16 v248, v37, s82, v248
v_dot2_f32_bf16 v250, v37, v37, v250
v_dot2_f32_bf16 v249, v109, s82, v249
v_dot2_f32_bf16 v251, v109, v109, v251
v_dot2_f32_bf16 v248, v38, s82, v248
v_dot2_f32_bf16 v250, v38, v38, v250
v_dot2_f32_bf16 v249, v110, s82, v249
v_dot2_f32_bf16 v251, v110, v110, v251
v_dot2_f32_bf16 v248, v39, s82, v248
v_dot2_f32_bf16 v250, v39, v39, v250
v_dot2_f32_bf16 v249, v111, s82, v249
v_dot2_f32_bf16 v251, v111, v111, v251
v_dot2_f32_bf16 v248, v40, s82, v248
v_dot2_f32_bf16 v250, v40, v40, v250
v_dot2_f32_bf16 v249, v112, s82, v249
v_dot2_f32_bf16 v251, v112, v112, v251
v_dot2_f32_bf16 v248, v41, s82, v248
v_dot2_f32_bf16 v250, v41, v41, v250
v_dot2_f32_bf16 v249, v113, s82, v249
v_dot2_f32_bf16 v251, v113, v113, v251
v_dot2_f32_bf16 v248, v42, s82, v248
v_dot2_f32_bf16 v250, v42, v42, v250
v_dot2_f32_bf16 v249, v114, s82, v249
v_dot2_f32_bf16 v251, v114, v114, v251
v_dot2_f32_bf16 v248, v43, s82, v248
v_dot2_f32_bf16 v250, v43, v43, v250
v_dot2_f32_bf16 v249, v115, s82, v249
v_dot2_f32_bf16 v251, v115, v115, v251
v_dot2_f32_bf16 v248, v44, s82, v248
v_dot2_f32_bf16 v250, v44, v44, v250
v_dot2_f32_bf16 v249, v116, s82, v249
v_dot2_f32_bf16 v251, v116, v116, v251
v_dot2_f32_bf16 v248, v45, s82, v248
v_dot2_f32_bf16 v250, v45, v45, v250
v_dot2_f32_bf16 v249, v117, s82, v249
v_dot2_f32_bf16 v251, v117, v117, v251
v_dot2_f32_bf16 v248, v46, s82, v248
v_dot2_f32_bf16 v250, v46, v46, v250
v_dot2_f32_bf16 v249, v118, s82, v249
v_dot2_f32_bf16 v251, v118, v118, v251
v_dot2_f32_bf16 v248, v47, s82, v248
v_dot2_f32_bf16 v250, v47, v47, v250
v_dot2_f32_bf16 v249, v119, s82, v249
v_dot2_f32_bf16 v251, v119, v119, v251
v_dot2_f32_bf16 v248, v48, s82, v248
v_dot2_f32_bf16 v250, v48, v48, v250
v_dot2_f32_bf16 v249, v120, s82, v249
v_dot2_f32_bf16 v251, v120, v120, v251
v_dot2_f32_bf16 v248, v49, s82, v248
v_dot2_f32_bf16 v250, v49, v49, v250
v_dot2_f32_bf16 v249, v121, s82, v249
v_dot2_f32_bf16 v251, v121, v121, v251
v_dot2_f32_bf16 v248, v50, s82, v248
v_dot2_f32_bf16 v250, v50, v50, v250
v_dot2_f32_bf16 v249, v122, s82, v249
v_dot2_f32_bf16 v251, v122, v122, v251
v_dot2_f32_bf16 v248, v51, s82, v248
v_dot2_f32_bf16 v250, v51, v51, v250
v_dot2_f32_bf16 v249, v123, s82, v249
v_dot2_f32_bf16 v251, v123, v123, v251
v_dot2_f32_bf16 v248, v52, s82, v248
v_dot2_f32_bf16 v250, v52, v52, v250
v_dot2_f32_bf16 v249, v124, s82, v249
v_dot2_f32_bf16 v251, v124, v124, v251
v_dot2_f32_bf16 v248, v53, s82, v248
v_dot2_f32_bf16 v250, v53, v53, v250
v_dot2_f32_bf16 v249, v125, s82, v249
v_dot2_f32_bf16 v251, v125, v125, v251
v_dot2_f32_bf16 v248, v54, s82, v248
v_dot2_f32_bf16 v250, v54, v54, v250
v_dot2_f32_bf16 v249, v126, s82, v249
v_dot2_f32_bf16 v251, v126, v126, v251
v_dot2_f32_bf16 v248, v55, s82, v248
v_dot2_f32_bf16 v250, v55, v55, v250
v_dot2_f32_bf16 v249, v127, s82, v249
v_dot2_f32_bf16 v251, v127, v127, v251
v_dot2_f32_bf16 v248, v56, s82, v248
v_dot2_f32_bf16 v250, v56, v56, v250
v_dot2_f32_bf16 v249, v128, s82, v249
v_dot2_f32_bf16 v251, v128, v128, v251
v_dot2_f32_bf16 v248, v57, s82, v248
v_dot2_f32_bf16 v250, v57, v57, v250
v_dot2_f32_bf16 v249, v129, s82, v249
v_dot2_f32_bf16 v251, v129, v129, v251
v_dot2_f32_bf16 v248, v58, s82, v248
v_dot2_f32_bf16 v250, v58, v58, v250
v_dot2_f32_bf16 v249, v130, s82, v249
v_dot2_f32_bf16 v251, v130, v130, v251
v_dot2_f32_bf16 v248, v59, s82, v248
v_dot2_f32_bf16 v250, v59, v59, v250
v_dot2_f32_bf16 v249, v131, s82, v249
v_dot2_f32_bf16 v251, v131, v131, v251
v_dot2_f32_bf16 v248, v60, s82, v248
v_dot2_f32_bf16 v250, v60, v60, v250
v_dot2_f32_bf16 v249, v132, s82, v249
v_dot2_f32_bf16 v251, v132, v132, v251
v_dot2_f32_bf16 v248, v61, s82, v248
v_dot2_f32_bf16 v250, v61, v61, v250
v_dot2_f32_bf16 v249, v133, s82, v249
v_dot2_f32_bf16 v251, v133, v133, v251
v_dot2_f32_bf16 v248, v62, s82, v248
v_dot2_f32_bf16 v250, v62, v62, v250
v_dot2_f32_bf16 v249, v134, s82, v249
v_dot2_f32_bf16 v251, v134, v134, v251
v_dot2_f32_bf16 v248, v63, s82, v248
v_dot2_f32_bf16 v250, v63, v63, v250
v_dot2_f32_bf16 v249, v135, s82, v249
v_dot2_f32_bf16 v251, v135, v135, v251
v_dot2_f32_bf16 v248, v64, s82, v248
v_dot2_f32_bf16 v250, v64, v64, v250
v_dot2_f32_bf16 v249, v136, s82, v249
v_dot2_f32_bf16 v251, v136, v136, v251
v_dot2_f32_bf16 v248, v65, s82, v248
v_dot2_f32_bf16 v250, v65, v65, v250
v_dot2_f32_bf16 v249, v137, s82, v249
v_dot2_f32_bf16 v251, v137, v137, v251
v_dot2_f32_bf16 v248, v66, s82, v248
v_dot2_f32_bf16 v250, v66, v66, v250
v_dot2_f32_bf16 v249, v138, s82, v249
v_dot2_f32_bf16 v251, v138, v138, v251
v_dot2_f32_bf16 v248, v67, s82, v248
v_dot2_f32_bf16 v250, v67, v67, v250
v_dot2_f32_bf16 v249, v139, s82, v249
v_dot2_f32_bf16 v251, v139, v139, v251
v_dot2_f32_bf16 v248, v68, s82, v248
v_dot2_f32_bf16 v250, v68, v68, v250
v_dot2_f32_bf16 v249, v140, s82, v249
v_dot2_f32_bf16 v251, v140, v140, v251
v_dot2_f32_bf16 v248, v69, s82, v248
v_dot2_f32_bf16 v250, v69, v69, v250
v_dot2_f32_bf16 v249, v141, s82, v249
v_dot2_f32_bf16 v251, v141, v141, v251
v_dot2_f32_bf16 v248, v70, s82, v248
v_dot2_f32_bf16 v250, v70, v70, v250
v_dot2_f32_bf16 v249, v142, s82, v249
v_dot2_f32_bf16 v251, v142, v142, v251
v_dot2_f32_bf16 v248, v71, s82, v248
v_dot2_f32_bf16 v250, v71, v71, v250
v_dot2_f32_bf16 v249, v143, s82, v249
v_dot2_f32_bf16 v251, v143, v143, v251
v_dot2_f32_bf16 v248, v72, s82, v248
v_dot2_f32_bf16 v250, v72, v72, v250
v_dot2_f32_bf16 v249, v144, s82, v249
v_dot2_f32_bf16 v251, v144, v144, v251
v_dot2_f32_bf16 v248, v73, s82, v248
v_dot2_f32_bf16 v250, v73, v73, v250
v_dot2_f32_bf16 v249, v145, s82, v249
v_dot2_f32_bf16 v251, v145, v145, v251
v_dot2_f32_bf16 v248, v74, s82, v248
v_dot2_f32_bf16 v250, v74, v74, v250
v_dot2_f32_bf16 v249, v146, s82, v249
v_dot2_f32_bf16 v251, v146, v146, v251
v_dot2_f32_bf16 v248, v75, s82, v248
v_dot2_f32_bf16 v250, v75, v75, v250
v_dot2_f32_bf16 v249, v147, s82, v249
v_dot2_f32_bf16 v251, v147, v147, v251
v_dot2_f32_bf16 v248, v76, s82, v248
v_dot2_f32_bf16 v250, v76, v76, v250
v_dot2_f32_bf16 v249, v148, s82, v249
v_dot2_f32_bf16 v251, v148, v148, v251
v_dot2_f32_bf16 v248, v77, s82, v248
v_dot2_f32_bf16 v250, v77, v77, v250
v_dot2_f32_bf16 v249, v149, s82, v249
v_dot2_f32_bf16 v251, v149, v149, v251
v_dot2_f32_bf16 v248, v78, s82, v248
v_dot2_f32_bf16 v250, v78, v78, v250
v_dot2_f32_bf16 v249, v150, s82, v249
v_dot2_f32_bf16 v251, v150, v150, v251
v_dot2_f32_bf16 v248, v79, s82, v248
v_dot2_f32_bf16 v250, v79, v79, v250
v_dot2_f32_bf16 v249, v151, s82, v249
v_dot2_f32_bf16 v251, v151, v151, v251
v_dot2_f32_bf16 v248, v80, s82, v248
v_dot2_f32_bf16 v250, v80, v80, v250
v_dot2_f32_bf16 v249, v152, s82, v249
v_dot2_f32_bf16 v251, v152, v152, v251
v_dot2_f32_bf16 v248, v81, s82, v248
v_dot2_f32_bf16 v250, v81, v81, v250
v_dot2_f32_bf16 v249, v153, s82, v249
v_dot2_f32_bf16 v251, v153, v153, v251
v_dot2_f32_bf16 v248, v82, s82, v248
v_dot2_f32_bf16 v250, v82, v82, v250
v_dot2_f32_bf16 v249, v154, s82, v249
v_dot2_f32_bf16 v251, v154, v154, v251
v_dot2_f32_bf16 v248, v83, s82, v248
v_dot2_f32_bf16 v250, v83, v83, v250
v_dot2_f32_bf16 v249, v155, s82, v249
v_dot2_f32_bf16 v251, v155, v155, v251
v_dot2_f32_bf16 v248, v84, s82, v248
v_dot2_f32_bf16 v250, v84, v84, v250
v_dot2_f32_bf16 v249, v156, s82, v249
v_dot2_f32_bf16 v251, v156, v156, v251
v_dot2_f32_bf16 v248, v85, s82, v248
v_dot2_f32_bf16 v250, v85, v85, v250
v_dot2_f32_bf16 v249, v157, s82, v249
v_dot2_f32_bf16 v251, v157, v157, v251
v_dot2_f32_bf16 v248, v86, s82, v248
v_dot2_f32_bf16 v250, v86, v86, v250
v_dot2_f32_bf16 v249, v158, s82, v249
v_dot2_f32_bf16 v251, v158, v158, v251
v_dot2_f32_bf16 v248, v87, s82, v248
v_dot2_f32_bf16 v250, v87, v87, v250
v_dot2_f32_bf16 v249, v159, s82, v249
v_dot2_f32_bf16 v251, v159, v159, v251
v_dot2_f32_bf16 v248, v88, s82, v248
v_dot2_f32_bf16 v250, v88, v88, v250
v_dot2_f32_bf16 v249, v160, s82, v249
v_dot2_f32_bf16 v251, v160, v160, v251
v_dot2_f32_bf16 v248, v89, s82, v248
v_dot2_f32_bf16 v250, v89, v89, v250
v_dot2_f32_bf16 v249, v161, s82, v249
v_dot2_f32_bf16 v251, v161, v161, v251
v_dot2_f32_bf16 v248, v90, s82, v248
v_dot2_f32_bf16 v250, v90, v90, v250
v_dot2_f32_bf16 v249, v162, s82, v249
v_dot2_f32_bf16 v251, v162, v162, v251
v_dot2_f32_bf16 v248, v91, s82, v248
v_dot2_f32_bf16 v250, v91, v91, v250
v_dot2_f32_bf16 v249, v163, s82, v249
v_dot2_f32_bf16 v251, v163, v163, v251
v_dot2_f32_bf16 v248, v92, s82, v248
v_dot2_f32_bf16 v250, v92, v92, v250
v_dot2_f32_bf16 v249, v164, s82, v249
v_dot2_f32_bf16 v251, v164, v164, v251
v_dot2_f32_bf16 v248, v93, s82, v248
v_dot2_f32_bf16 v250, v93, v93, v250
v_dot2_f32_bf16 v249, v165, s82, v249
v_dot2_f32_bf16 v251, v165, v165, v251
v_dot2_f32_bf16 v248, v94, s82, v248
v_dot2_f32_bf16 v250, v94, v94, v250
v_dot2_f32_bf16 v249, v166, s82, v249
v_dot2_f32_bf16 v251, v166, v166, v251
v_dot2_f32_bf16 v248, v95, s82, v248
v_dot2_f32_bf16 v250, v95, v95, v250
v_dot2_f32_bf16 v249, v167, s82, v249
v_dot2_f32_bf16 v251, v167, v167, v251
v_dot2_f32_bf16 v248, v96, s82, v248
v_dot2_f32_bf16 v250, v96, v96, v250
v_dot2_f32_bf16 v249, v168, s82, v249
v_dot2_f32_bf16 v251, v168, v168, v251
v_dot2_f32_bf16 v248, v97, s82, v248
v_dot2_f32_bf16 v250, v97, v97, v250
v_dot2_f32_bf16 v249, v169, s82, v249
v_dot2_f32_bf16 v251, v169, v169, v251
v_dot2_f32_bf16 v248, v98, s82, v248
v_dot2_f32_bf16 v250, v98, v98, v250
v_dot2_f32_bf16 v249, v170, s82, v249
v_dot2_f32_bf16 v251, v170, v170, v251
v_dot2_f32_bf16 v248, v99, s82, v248
v_dot2_f32_bf16 v250, v99, v99, v250
v_dot2_f32_bf16 v249, v171, s82, v249
v_dot2_f32_bf16 v251, v171, v171, v251
v_dot2_f32_bf16 v248, v100, s82, v248
v_dot2_f32_bf16 v250, v100, v100, v250
v_dot2_f32_bf16 v249, v172, s82, v249
v_dot2_f32_bf16 v251, v172, v172, v251
v_dot2_f32_bf16 v248, v101, s82, v248
v_dot2_f32_bf16 v250, v101, v101, v250
v_dot2_f32_bf16 v249, v173, s82, v249
v_dot2_f32_bf16 v251, v173, v173, v251
v_dot2_f32_bf16 v248, v102, s82, v248
v_dot2_f32_bf16 v250, v102, v102, v250
v_dot2_f32_bf16 v249, v174, s82, v249
v_dot2_f32_bf16 v251, v174, v174, v251
v_dot2_f32_bf16 v248, v103, s82, v248
v_dot2_f32_bf16 v250, v103, v103, v250
v_dot2_f32_bf16 v249, v175, s82, v249
v_dot2_f32_bf16 v251, v175, v175, v251
s_nop 3
v_permlane32_swap_b32 v248, v250
v_add_f32 v248, v248, v250
v_mov_b32 v240, v248
s_nop 1
v_permlane16_swap_b32 v248, v240
v_add_f32 v248, v248, v240
v_mov_b32 v250, v248
s_nop 1
v_permlane32_swap_b32 v248, v250
v_mul_f32 v248, 0x3ae38e39, v248
v_mul_f32 v250, 0x3ae38e39, v250
v_fma_f32 v250, -v248, v248, v250
v_max_f32 v250, 0, v250
v_add_f32 v250, 0x3727c5ac, v250
v_rsq_f32 v252, v250
s_nop 0
v_mul_f32 v254, v248, v252
v_sub_f32 v254, 0, v254
v_permlane32_swap_b32 v249, v251
v_add_f32 v249, v249, v251
v_mov_b32 v240, v249
s_nop 1
v_permlane16_swap_b32 v249, v240
v_add_f32 v249, v249, v240
v_mov_b32 v251, v249
s_nop 1
v_permlane32_swap_b32 v249, v251
v_mul_f32 v249, 0x3ae38e39, v249
v_mul_f32 v251, 0x3ae38e39, v251
v_fma_f32 v251, -v249, v249, v251
v_max_f32 v251, 0, v251
v_add_f32 v251, 0x3727c5ac, v251
v_rsq_f32 v253, v251
s_nop 0
v_mul_f32 v255, v249, v253
v_sub_f32 v255, 0, v255
s_nop 7
s_barrier
v_accvgpr_read_b32 v208, a72
v_accvgpr_read_b32 v209, a73
v_accvgpr_read_b32 v210, a74
v_accvgpr_read_b32 v211, a75
v_accvgpr_read_b32 v212, a0
v_accvgpr_read_b32 v213, a1
v_accvgpr_read_b32 v214, a2
v_accvgpr_read_b32 v215, a3
v_pk_mul_f32 v[212:213], v[212:213], v[252:253] op_sel:[0,0] op_sel_hi:[1,0]
v_pk_mul_f32 v[214:215], v[214:215], v[252:253] op_sel:[0,0] op_sel_hi:[1,0]
v_pk_fma_f32 v[212:213], v[208:209], v[254:255], v[212:213] op_sel:[0,0,0] op_sel_hi:[1,0,1]
v_pk_fma_f32 v[214:215], v[210:211], v[254:255], v[214:215] op_sel:[0,0,0] op_sel_hi:[1,0,1]
v_cvt_pk_bf16_f32 v32, v212, v213
v_cvt_pk_bf16_f32 v33, v214, v215
v_accvgpr_read_b32 v216, a36
v_accvgpr_read_b32 v217, a37
v_accvgpr_read_b32 v218, a38
v_accvgpr_read_b32 v219, a39
v_pk_mul_f32 v[216:217], v[216:217], v[252:253] op_sel:[0,1] op_sel_hi:[1,1]
v_pk_mul_f32 v[218:219], v[218:219], v[252:253] op_sel:[0,1] op_sel_hi:[1,1]
v_pk_fma_f32 v[216:217], v[208:209], v[254:255], v[216:217] op_sel:[0,1,0] op_sel_hi:[1,1,1]
v_pk_fma_f32 v[218:219], v[210:211], v[254:255], v[218:219] op_sel:[0,1,0] op_sel_hi:[1,1,1]
v_cvt_pk_bf16_f32 v50, v216, v217
v_cvt_pk_bf16_f32 v51, v218, v219
v_accvgpr_read_b32 v224, a76
v_accvgpr_read_b32 v225, a77
v_accvgpr_read_b32 v226, a78
v_accvgpr_read_b32 v227, a79
v_accvgpr_read_b32 v228, a4
v_accvgpr_read_b32 v229, a5
v_accvgpr_read_b32 v230, a6
v_accvgpr_read_b32 v231, a7
v_pk_mul_f32 v[228:229], v[228:229], v[252:253] op_sel:[0,0] op_sel_hi:[1,0]
v_pk_mul_f32 v[230:231], v[230:231], v[252:253] op_sel:[0,0] op_sel_hi:[1,0]
v_pk_fma_f32 v[228:229], v[224:225], v[254:255], v[228:229] op_sel:[0,0,0] op_sel_hi:[1,0,1]
v_pk_fma_f32 v[230:231], v[226:227], v[254:255], v[230:231] op_sel:[0,0,0] op_sel_hi:[1,0,1]
v_cvt_pk_bf16_f32 v34, v228, v229
v_cvt_pk_bf16_f32 v35, v230, v231
v_accvgpr_read_b32 v232, a40
v_accvgpr_read_b32 v233, a41
v_accvgpr_read_b32 v234, a42
v_accvgpr_read_b32 v235, a43
v_pk_mul_f32 v[232:233], v[232:233], v[252:253] op_sel:[0,1] op_sel_hi:[1,1]
v_pk_mul_f32 v[234:235], v[234:235], v[252:253] op_sel:[0,1] op_sel_hi:[1,1]
v_pk_fma_f32 v[232:233], v[224:225], v[254:255], v[232:233] op_sel:[0,1,0] op_sel_hi:[1,1,1]
v_pk_fma_f32 v[234:235], v[226:227], v[254:255], v[234:235] op_sel:[0,1,0] op_sel_hi:[1,1,1]
v_cvt_pk_bf16_f32 v52, v232, v233
v_cvt_pk_bf16_f32 v53, v234, v235
v_accvgpr_read_b32 v208, a80
v_accvgpr_read_b32 v209, a81
v_accvgpr_read_b32 v210, a82
v_accvgpr_read_b32 v211, a83
v_accvgpr_read_b32 v212, a8
v_accvgpr_read_b32 v213, a9
v_accvgpr_read_b32 v214, a10
v_accvgpr_read_b32 v215, a11
v_pk_mul_f32 v[212:213], v[212:213], v[252:253] op_sel:[0,0] op_sel_hi:[1,0]
v_pk_mul_f32 v[214:215], v[214:215], v[252:253] op_sel:[0,0] op_sel_hi:[1,0]
v_pk_fma_f32 v[212:213], v[208:209], v[254:255], v[212:213] op_sel:[0,0,0] op_sel_hi:[1,0,1]
v_pk_fma_f32 v[214:215], v[210:211], v[254:255], v[214:215] op_sel:[0,0,0] op_sel_hi:[1,0,1]
v_cvt_pk_bf16_f32 v36, v212, v213
v_cvt_pk_bf16_f32 v37, v214, v215
v_accvgpr_read_b32 v216, a44
v_accvgpr_read_b32 v217, a45
v_accvgpr_read_b32 v218, a46
v_accvgpr_read_b32 v219, a47
v_pk_mul_f32 v[216:217], v[216:217], v[252:253] op_sel:[0,1] op_sel_hi:[1,1]
v_pk_mul_f32 v[218:219], v[218:219], v[252:253] op_sel:[0,1] op_sel_hi:[1,1]
v_pk_fma_f32 v[216:217], v[208:209], v[254:255], v[216:217] op_sel:[0,1,0] op_sel_hi:[1,1,1]
v_pk_fma_f32 v[218:219], v[210:211], v[254:255], v[218:219] op_sel:[0,1,0] op_sel_hi:[1,1,1]
v_cvt_pk_bf16_f32 v54, v216, v217
v_cvt_pk_bf16_f32 v55, v218, v219
v_accvgpr_read_b32 v224, a84
v_accvgpr_read_b32 v225, a85
v_accvgpr_read_b32 v226, a86
v_accvgpr_read_b32 v227, a87
v_accvgpr_read_b32 v228, a12
v_accvgpr_read_b32 v229, a13
v_accvgpr_read_b32 v230, a14
v_accvgpr_read_b32 v231, a15
v_pk_mul_f32 v[228:229], v[228:229], v[252:253] op_sel:[0,0] op_sel_hi:[1,0]
v_pk_mul_f32 v[230:231], v[230:231], v[252:253] op_sel:[0,0] op_sel_hi:[1,0]
v_pk_fma_f32 v[228:229], v[224:225], v[254:255], v[228:229] op_sel:[0,0,0] op_sel_hi:[1,0,1]
v_pk_fma_f32 v[230:231], v[226:227], v[254:255], v[230:231] op_sel:[0,0,0] op_sel_hi:[1,0,1]
v_cvt_pk_bf16_f32 v38, v228, v229
v_cvt_pk_bf16_f32 v39, v230, v231
v_accvgpr_read_b32 v232, a48
v_accvgpr_read_b32 v233, a49
v_accvgpr_read_b32 v234, a50
v_accvgpr_read_b32 v235, a51
v_pk_mul_f32 v[232:233], v[232:233], v[252:253] op_sel:[0,1] op_sel_hi:[1,1]
v_pk_mul_f32 v[234:235], v[234:235], v[252:253] op_sel:[0,1] op_sel_hi:[1,1]
v_pk_fma_f32 v[232:233], v[224:225], v[254:255], v[232:233] op_sel:[0,1,0] op_sel_hi:[1,1,1]
v_pk_fma_f32 v[234:235], v[226:227], v[254:255], v[234:235] op_sel:[0,1,0] op_sel_hi:[1,1,1]
v_cvt_pk_bf16_f32 v56, v232, v233
v_cvt_pk_bf16_f32 v57, v234, v235
v_accvgpr_read_b32 v208, a88
v_accvgpr_read_b32 v209, a89
v_accvgpr_read_b32 v210, a90
v_accvgpr_read_b32 v211, a91
v_accvgpr_read_b32 v212, a16
v_accvgpr_read_b32 v213, a17
v_accvgpr_read_b32 v214, a18
v_accvgpr_read_b32 v215, a19
v_pk_mul_f32 v[212:213], v[212:213], v[252:253] op_sel:[0,0] op_sel_hi:[1,0]
v_pk_mul_f32 v[214:215], v[214:215], v[252:253] op_sel:[0,0] op_sel_hi:[1,0]
v_pk_fma_f32 v[212:213], v[208:209], v[254:255], v[212:213] op_sel:[0,0,0] op_sel_hi:[1,0,1]
v_pk_fma_f32 v[214:215], v[210:211], v[254:255], v[214:215] op_sel:[0,0,0] op_sel_hi:[1,0,1]
v_cvt_pk_bf16_f32 v40, v212, v213
v_cvt_pk_bf16_f32 v41, v214, v215
v_accvgpr_read_b32 v216, a52
v_accvgpr_read_b32 v217, a53
v_accvgpr_read_b32 v218, a54
v_accvgpr_read_b32 v219, a55
v_pk_mul_f32 v[216:217], v[216:217], v[252:253] op_sel:[0,1] op_sel_hi:[1,1]
v_pk_mul_f32 v[218:219], v[218:219], v[252:253] op_sel:[0,1] op_sel_hi:[1,1]
v_pk_fma_f32 v[216:217], v[208:209], v[254:255], v[216:217] op_sel:[0,1,0] op_sel_hi:[1,1,1]
v_pk_fma_f32 v[218:219], v[210:211], v[254:255], v[218:219] op_sel:[0,1,0] op_sel_hi:[1,1,1]
v_cvt_pk_bf16_f32 v58, v216, v217
v_cvt_pk_bf16_f32 v59, v218, v219
v_accvgpr_read_b32 v224, a92
v_accvgpr_read_b32 v225, a93
v_accvgpr_read_b32 v226, a94
v_accvgpr_read_b32 v227, a95
v_accvgpr_read_b32 v228, a20
v_accvgpr_read_b32 v229, a21
v_accvgpr_read_b32 v230, a22
v_accvgpr_read_b32 v231, a23
v_pk_mul_f32 v[228:229], v[228:229], v[252:253] op_sel:[0,0] op_sel_hi:[1,0]
v_pk_mul_f32 v[230:231], v[230:231], v[252:253] op_sel:[0,0] op_sel_hi:[1,0]
v_pk_fma_f32 v[228:229], v[224:225], v[254:255], v[228:229] op_sel:[0,0,0] op_sel_hi:[1,0,1]
v_pk_fma_f32 v[230:231], v[226:227], v[254:255], v[230:231] op_sel:[0,0,0] op_sel_hi:[1,0,1]
v_cvt_pk_bf16_f32 v42, v228, v229
v_cvt_pk_bf16_f32 v43, v230, v231
v_accvgpr_read_b32 v232, a56
v_accvgpr_read_b32 v233, a57
v_accvgpr_read_b32 v234, a58
v_accvgpr_read_b32 v235, a59
v_pk_mul_f32 v[232:233], v[232:233], v[252:253] op_sel:[0,1] op_sel_hi:[1,1]
v_pk_mul_f32 v[234:235], v[234:235], v[252:253] op_sel:[0,1] op_sel_hi:[1,1]
v_pk_fma_f32 v[232:233], v[224:225], v[254:255], v[232:233] op_sel:[0,1,0] op_sel_hi:[1,1,1]
v_pk_fma_f32 v[234:235], v[226:227], v[254:255], v[234:235] op_sel:[0,1,0] op_sel_hi:[1,1,1]
v_cvt_pk_bf16_f32 v60, v232, v233
v_cvt_pk_bf16_f32 v61, v234, v235
v_accvgpr_read_b32 v208, a96
v_accvgpr_read_b32 v209, a97
v_accvgpr_read_b32 v210, a98
v_accvgpr_read_b32 v211, a99
v_accvgpr_read_b32 v212, a24
v_accvgpr_read_b32 v213, a25
v_accvgpr_read_b32 v214, a26
v_accvgpr_read_b32 v215, a27
v_pk_mul_f32 v[212:213], v[212:213], v[252:253] op_sel:[0,0] op_sel_hi:[1,0]
v_pk_mul_f32 v[214:215], v[214:215], v[252:253] op_sel:[0,0] op_sel_hi:[1,0]
v_pk_fma_f32 v[212:213], v[208:209], v[254:255], v[212:213] op_sel:[0,0,0] op_sel_hi:[1,0,1]
v_pk_fma_f32 v[214:215], v[210:211], v[254:255], v[214:215] op_sel:[0,0,0] op_sel_hi:[1,0,1]
v_cvt_pk_bf16_f32 v44, v212, v213
v_cvt_pk_bf16_f32 v45, v214, v215
v_accvgpr_read_b32 v216, a60
v_accvgpr_read_b32 v217, a61
v_accvgpr_read_b32 v218, a62
v_accvgpr_read_b32 v219, a63
v_pk_mul_f32 v[216:217], v[216:217], v[252:253] op_sel:[0,1] op_sel_hi:[1,1]
v_pk_mul_f32 v[218:219], v[218:219], v[252:253] op_sel:[0,1] op_sel_hi:[1,1]
v_pk_fma_f32 v[216:217], v[208:209], v[254:255], v[216:217] op_sel:[0,1,0] op_sel_hi:[1,1,1]
v_pk_fma_f32 v[218:219], v[210:211], v[254:255], v[218:219] op_sel:[0,1,0] op_sel_hi:[1,1,1]
v_cvt_pk_bf16_f32 v62, v216, v217
v_cvt_pk_bf16_f32 v63, v218, v219
v_accvgpr_read_b32 v224, a100
v_accvgpr_read_b32 v225, a101
v_accvgpr_read_b32 v226, a102
v_accvgpr_read_b32 v227, a103
v_accvgpr_read_b32 v228, a28
v_accvgpr_read_b32 v229, a29
v_accvgpr_read_b32 v230, a30
v_accvgpr_read_b32 v231, a31
v_pk_mul_f32 v[228:229], v[228:229], v[252:253] op_sel:[0,0] op_sel_hi:[1,0]
v_pk_mul_f32 v[230:231], v[230:231], v[252:253] op_sel:[0,0] op_sel_hi:[1,0]
v_pk_fma_f32 v[228:229], v[224:225], v[254:255], v[228:229] op_sel:[0,0,0] op_sel_hi:[1,0,1]
v_pk_fma_f32 v[230:231], v[226:227], v[254:255], v[230:231] op_sel:[0,0,0] op_sel_hi:[1,0,1]
v_cvt_pk_bf16_f32 v46, v228, v229
v_cvt_pk_bf16_f32 v47, v230, v231
v_accvgpr_read_b32 v232, a64
v_accvgpr_read_b32 v233, a65
v_accvgpr_read_b32 v234, a66
v_accvgpr_read_b32 v235, a67
v_pk_mul_f32 v[232:233], v[232:233], v[252:253] op_sel:[0,1] op_sel_hi:[1,1]
v_pk_mul_f32 v[234:235], v[234:235], v[252:253] op_sel:[0,1] op_sel_hi:[1,1]
v_pk_fma_f32 v[232:233], v[224:225], v[254:255], v[232:233] op_sel:[0,1,0] op_sel_hi:[1,1,1]
v_pk_fma_f32 v[234:235], v[226:227], v[254:255], v[234:235] op_sel:[0,1,0] op_sel_hi:[1,1,1]
v_cvt_pk_bf16_f32 v64, v232, v233
v_cvt_pk_bf16_f32 v65, v234, v235
v_accvgpr_read_b32 v208, a104
v_accvgpr_read_b32 v209, a105
v_accvgpr_read_b32 v210, a106
v_accvgpr_read_b32 v211, a107
v_accvgpr_read_b32 v212, a32
v_accvgpr_read_b32 v213, a33
v_accvgpr_read_b32 v214, a34
v_accvgpr_read_b32 v215, a35
v_pk_mul_f32 v[212:213], v[212:213], v[252:253] op_sel:[0,0] op_sel_hi:[1,0]
v_pk_mul_f32 v[214:215], v[214:215], v[252:253] op_sel:[0,0] op_sel_hi:[1,0]
v_pk_fma_f32 v[212:213], v[208:209], v[254:255], v[212:213] op_sel:[0,0,0] op_sel_hi:[1,0,1]
v_pk_fma_f32 v[214:215], v[210:211], v[254:255], v[214:215] op_sel:[0,0,0] op_sel_hi:[1,0,1]
v_cvt_pk_bf16_f32 v48, v212, v213
v_cvt_pk_bf16_f32 v49, v214, v215
v_accvgpr_read_b32 v216, a68
v_accvgpr_read_b32 v217, a69
v_accvgpr_read_b32 v218, a70
v_accvgpr_read_b32 v219, a71
v_pk_mul_f32 v[216:217], v[216:217], v[252:253] op_sel:[0,1] op_sel_hi:[1,1]
v_pk_mul_f32 v[218:219], v[218:219], v[252:253] op_sel:[0,1] op_sel_hi:[1,1]
v_pk_fma_f32 v[216:217], v[208:209], v[254:255], v[216:217] op_sel:[0,1,0] op_sel_hi:[1,1,1]
v_pk_fma_f32 v[218:219], v[210:211], v[254:255], v[218:219] op_sel:[0,1,0] op_sel_hi:[1,1,1]
v_cvt_pk_bf16_f32 v66, v216, v217
v_cvt_pk_bf16_f32 v67, v218, v219
s_mov_b32 s78, 0xffff
s_mov_b32 s79, 0x0
s_mov_b32 s80, 0x3fb8aa3b
s_mov_b32 s81, 0x3fb8aa3b
v_lshrrev_b32 v5, 2, v3
v_lshl_add_u32 v5, v2, 2, v5
v_lshlrev_b32 v5, 6, v5
v_and_b32 v6, 3, v3
v_lshl_add_u32 v5, v6, 3, v5
v_add_u32 v5, 147456, v5
ds_read_b64_tr_b16 v[112:113], v5 offset:0
ds_read_b64_tr_b16 v[114:115], v5 offset:1024
ds_read_b64_tr_b16 v[116:117], v5 offset:32
ds_read_b64_tr_b16 v[118:119], v5 offset:1056
ds_read_b64_tr_b16 v[120:121], v5 offset:2048
ds_read_b64_tr_b16 v[122:123], v5 offset:3072
ds_read_b64_tr_b16 v[124:125], v5 offset:2080
ds_read_b64_tr_b16 v[126:127], v5 offset:3104
ds_read_b64_tr_b16 v[128:129], v5 offset:4096
ds_read_b64_tr_b16 v[130:131], v5 offset:5120
ds_read_b64_tr_b16 v[132:133], v5 offset:4128
ds_read_b64_tr_b16 v[134:135], v5 offset:5152
ds_read_b64_tr_b16 v[136:137], v5 offset:6144
ds_read_b64_tr_b16 v[138:139], v5 offset:7168
ds_read_b64_tr_b16 v[140:141], v5 offset:6176
ds_read_b64_tr_b16 v[142:143], v5 offset:7200
s_waitcnt lgkmcnt(0)
s_lshl_b32 s77, s3, 5
v_add_u32 v68, s77, v3
v_mul_u32_u24 v69, 288, v68
v_add_u32 v69, 53248, v69
v_mul_u32_u24 v68, 416, v68
v_lshl_add_u32 v68, v2, 3, v68
v_lshl_add_u32 v70, v2, 6, v69
v_mov_b32 v71, 0x3f80
ds_write_b32 v70, v71 offset:36
ds_write_b32 v70, v71 offset:4644
v_lshlrev_b32 v70, 3, v2
s_mov_b32 s82, 0x4007e7e
v_bfe_u32 v71, s82, v70, 8
v_lshl_add_u32 v71, v71, 1, v69
ds_write_b32 v71, v40 offset:0
ds_write_b32 v71, v58 offset:4608
s_mov_b32 s82, 0x6027e7e
v_bfe_u32 v71, s82, v70, 8
v_lshl_add_u32 v71, v71, 1, v69
ds_write_b32 v71, v41 offset:0
ds_write_b32 v71, v59 offset:4608
s_mov_b32 s82, 0x22100c08
v_bfe_u32 v71, s82, v70, 8
v_lshl_add_u32 v71, v71, 1, v69
ds_write_b32 v71, v42 offset:0
ds_write_b32 v71, v60 offset:4608
s_mov_b32 s82, 0x24200e0a
v_bfe_u32 v71, s82, v70, 8
v_lshl_add_u32 v71, v71, 1, v69
ds_write_b32 v71, v43 offset:0
ds_write_b32 v71, v61 offset:4608
s_mov_b32 s82, 0x402e2a26
v_bfe_u32 v71, s82, v70, 8
v_lshl_add_u32 v71, v71, 1, v69
ds_write_b32 v71, v44 offset:0
ds_write_b32 v71, v62 offset:4608
s_mov_b32 s82, 0x42302c28
v_bfe_u32 v71, s82, v70, 8
v_lshl_add_u32 v71, v71, 1, v69
ds_write_b32 v71, v45 offset:0
ds_write_b32 v71, v63 offset:4608
s_mov_b32 s82, 0x504c4844
v_bfe_u32 v71, s82, v70, 8
v_lshl_add_u32 v71, v71, 1, v69
ds_write_b32 v71, v46 offset:0
ds_write_b32 v71, v64 offset:4608
s_mov_b32 s82, 0x604e4a46
v_bfe_u32 v71, s82, v70, 8
v_lshl_add_u32 v71, v71, 1, v69
ds_write_b32 v71, v47 offset:0
ds_write_b32 v71, v65 offset:4608
s_mov_b32 s82, 0x6e6a6662
v_bfe_u32 v71, s82, v70, 8
v_lshl_add_u32 v71, v71, 1, v69
ds_write_b32 v71, v48 offset:0
ds_write_b32 v71, v66 offset:4608
s_mov_b32 s82, 0x706c6864
v_bfe_u32 v71, s82, v70, 8
v_lshl_add_u32 v71, v71, 1, v69
ds_write_b32 v71, v49 offset:0
ds_write_b32 v71, v67 offset:4608
v_mfma_f32_16x16x32_bf16 v[72:75], v[112:115], v[32:35], 0
v_mfma_f32_16x16x32_bf16 v[176:179], v[112:115], v[50:53], 0
v_mfma_f32_16x16x32_bf16 v[76:79], v[116:119], v[32:35], 0
v_mfma_f32_16x16x32_bf16 v[180:183], v[116:119], v[50:53], 0
s_nop 7
v_cndmask_b32 v88, v72, v76, s[78:79]
v_cndmask_b32 v192, v176, v180, s[78:79]
v_cndmask_b32 v89, v72, v77, s[78:79]
v_cndmask_b32 v193, v176, v181, s[78:79]
v_max3_f32 v92, v72, v73, v74
v_max3_f32 v196, v176, v177, v178
v_max3_f32 v94, -v72, -v73, -v74
v_max3_f32 v198, -v176, -v177, -v178
v_max3_f32 v92, v92, v75, v88
v_max3_f32 v196, v196, v179, v192
v_max3_f32 v94, v94, -v75, -v88
v_max3_f32 v198, v198, -v179, -v192
v_max_f32 v92, v92, v89
v_max_f32 v196, v196, v193
v_max3_f32 v94, v94, -v89, -v89
v_max3_f32 v198, v198, -v193, -v193
s_nop 0
v_permlane32_swap_b32 v92, v94
v_permlane32_swap_b32 v196, v198
v_max_f32 v92, v92, v94
v_max_f32 v196, v196, v198
v_mov_b32 v90, v92
v_mov_b32 v194, v196
s_nop 0
v_permlane16_swap_b32 v92, v90
v_permlane16_swap_b32 v196, v194
v_max_f32 v92, v92, v90
v_max_f32 v196, v196, v194
v_mov_b32 v94, v92
v_mov_b32 v198, v196
s_nop 0
v_permlane32_swap_b32 v92, v94
v_permlane32_swap_b32 v196, v198
v_mul_f32 v92, s80, v92
v_mul_f32 v196, s80, v196
v_mul_f32 v94, s80, v94
v_mul_f32 v198, s80, v198
v_pk_fma_f32 v[96:97], v[72:73], s[80:81], v[92:93] op_sel_hi:[1,1,0] neg_lo:[0,0,1] neg_hi:[0,0,1]
v_pk_fma_f32 v[200:201], v[176:177], s[80:81], v[196:197] op_sel_hi:[1,1,0] neg_lo:[0,0,1] neg_hi:[0,0,1]
v_pk_fma_f32 v[102:103], v[72:73], s[80:81], v[94:95] op_sel_hi:[1,1,0] neg_lo:[1,0,1] neg_hi:[1,0,1]
v_pk_fma_f32 v[206:207], v[176:177], s[80:81], v[198:199] op_sel_hi:[1,1,0] neg_lo:[1,0,1] neg_hi:[1,0,1]
v_pk_fma_f32 v[98:99], v[74:75], s[80:81], v[92:93] op_sel_hi:[1,1,0] neg_lo:[0,0,1] neg_hi:[0,0,1]
v_pk_fma_f32 v[202:203], v[178:179], s[80:81], v[196:197] op_sel_hi:[1,1,0] neg_lo:[0,0,1] neg_hi:[0,0,1]
v_pk_fma_f32 v[104:105], v[74:75], s[80:81], v[94:95] op_sel_hi:[1,1,0] neg_lo:[1,0,1] neg_hi:[1,0,1]
v_pk_fma_f32 v[208:209], v[178:179], s[80:81], v[198:199] op_sel_hi:[1,1,0] neg_lo:[1,0,1] neg_hi:[1,0,1]
v_pk_fma_f32 v[100:101], v[76:77], s[80:81], v[92:93] op_sel_hi:[1,1,0] neg_lo:[0,0,1] neg_hi:[0,0,1]
v_pk_fma_f32 v[204:205], v[180:181], s[80:81], v[196:197] op_sel_hi:[1,1,0] neg_lo:[0,0,1] neg_hi:[0,0,1]
v_pk_fma_f32 v[106:107], v[76:77], s[80:81], v[94:95] op_sel_hi:[1,1,0] neg_lo:[1,0,1] neg_hi:[1,0,1]
v_pk_fma_f32 v[210:211], v[180:181], s[80:81], v[198:199] op_sel_hi:[1,1,0] neg_lo:[1,0,1] neg_hi:[1,0,1]
v_exp_f32 v96, v96
v_exp_f32 v200, v200
v_exp_f32 v102, v102
v_exp_f32 v206, v206
v_exp_f32 v97, v97
v_exp_f32 v201, v201
v_exp_f32 v103, v103
v_exp_f32 v207, v207
v_exp_f32 v98, v98
v_exp_f32 v202, v202
v_exp_f32 v104, v104
v_exp_f32 v208, v208
v_exp_f32 v99, v99
v_exp_f32 v203, v203
v_exp_f32 v105, v105
v_exp_f32 v209, v209
v_exp_f32 v100, v100
v_exp_f32 v204, v204
v_exp_f32 v106, v106
v_exp_f32 v210, v210
v_exp_f32 v101, v101
v_exp_f32 v205, v205
v_exp_f32 v107, v107
v_exp_f32 v211, v211
v_cndmask_b32 v100, 0, v100, s[78:79]
v_cndmask_b32 v204, 0, v204, s[78:79]
v_cndmask_b32 v106, 0, v106, s[78:79]
v_cndmask_b32 v210, 0, v210, s[78:79]
v_cndmask_b32 v101, 0, v101, s[78:79]
v_cndmask_b32 v205, 0, v205, s[78:79]
v_cndmask_b32 v107, 0, v107, s[78:79]
v_cndmask_b32 v211, 0, v211, s[78:79]
v_pk_add_f32 v[108:109], v[96:97], v[98:99]
v_pk_add_f32 v[212:213], v[200:201], v[202:203]
v_pk_add_f32 v[108:109], v[108:109], v[100:101]
v_pk_add_f32 v[212:213], v[212:213], v[204:205]
v_add_f32 v108, v108, v109
v_add_f32 v212, v212, v213
v_pk_add_f32 v[110:111], v[102:103], v[104:105]
v_pk_add_f32 v[214:215], v[206:207], v[208:209]
v_pk_add_f32 v[110:111], v[110:111], v[106:107]
v_pk_add_f32 v[214:215], v[214:215], v[210:211]
v_add_f32 v110, v110, v111
v_add_f32 v214, v214, v215
s_nop 0
v_permlane32_swap_b32 v108, v110
v_permlane32_swap_b32 v212, v214
v_add_f32 v108, v108, v110
v_add_f32 v212, v212, v214
v_mov_b32 v90, v108
v_mov_b32 v194, v212
s_nop 0
v_permlane16_swap_b32 v108, v90
v_permlane16_swap_b32 v212, v194
v_add_f32 v108, v108, v90
v_add_f32 v212, v212, v194
v_mov_b32 v110, v108
v_mov_b32 v214, v212
s_nop 0
v_permlane32_swap_b32 v108, v110
v_permlane32_swap_b32 v212, v214
v_rcp_f32 v108, v108
v_rcp_f32 v212, v212
v_rcp_f32 v110, v110
v_rcp_f32 v214, v214
v_pk_mul_f32 v[96:97], v[96:97], v[108:109] op_sel_hi:[1,0]
v_pk_mul_f32 v[200:201], v[200:201], v[212:213] op_sel_hi:[1,0]
v_pk_mul_f32 v[102:103], v[102:103], v[110:111] op_sel_hi:[1,0]
v_pk_mul_f32 v[206:207], v[206:207], v[214:215] op_sel_hi:[1,0]
v_pk_mul_f32 v[98:99], v[98:99], v[108:109] op_sel_hi:[1,0]
v_pk_mul_f32 v[202:203], v[202:203], v[212:213] op_sel_hi:[1,0]
v_pk_mul_f32 v[104:105], v[104:105], v[110:111] op_sel_hi:[1,0]
v_pk_mul_f32 v[208:209], v[208:209], v[214:215] op_sel_hi:[1,0]
v_pk_mul_f32 v[100:101], v[100:101], v[108:109] op_sel_hi:[1,0]
v_pk_mul_f32 v[204:205], v[204:205], v[212:213] op_sel_hi:[1,0]
v_pk_mul_f32 v[106:107], v[106:107], v[110:111] op_sel_hi:[1,0]
v_pk_mul_f32 v[210:211], v[210:211], v[214:215] op_sel_hi:[1,0]
v_cvt_pk_bf16_f32 v80, v96, v97
v_cvt_pk_bf16_f32 v184, v200, v201
v_cvt_pk_bf16_f32 v81, v98, v99
v_cvt_pk_bf16_f32 v185, v202, v203
v_cvt_pk_bf16_f32 v82, v102, v103
v_cvt_pk_bf16_f32 v186, v206, v207
v_cvt_pk_bf16_f32 v83, v104, v105
v_cvt_pk_bf16_f32 v187, v208, v209
v_cvt_pk_bf16_f32 v84, v100, v101
v_cvt_pk_bf16_f32 v188, v204, v205
v_cvt_pk_bf16_f32 v85, v106, v107
v_cvt_pk_bf16_f32 v189, v210, v211
ds_write_b64 v68, v[80:81] offset:0
ds_write_b64 v68, v[184:185] offset:6656
ds_write_b64 v68, v[82:83] offset:32
ds_write_b64 v68, v[186:187] offset:6688
ds_write_b64 v68, v[84:85] offset:64
ds_write_b64 v68, v[188:189] offset:6720
v_mfma_f32_16x16x32_bf16 v[72:75], v[120:123], v[34:37], 0
v_mfma_f32_16x16x32_bf16 v[176:179], v[120:123], v[52:55], 0
v_mfma_f32_16x16x32_bf16 v[76:79], v[124:127], v[34:37], 0
v_mfma_f32_16x16x32_bf16 v[180:183], v[124:127], v[52:55], 0
s_nop 7
v_cndmask_b32 v88, v72, v76, s[78:79]
v_cndmask_b32 v192, v176, v180, s[78:79]
v_cndmask_b32 v89, v72, v77, s[78:79]
v_cndmask_b32 v193, v176, v181, s[78:79]
v_max3_f32 v92, v72, v73, v74
v_max3_f32 v196, v176, v177, v178
v_max3_f32 v94, -v72, -v73, -v74
v_max3_f32 v198, -v176, -v177, -v178
v_max3_f32 v92, v92, v75, v88
v_max3_f32 v196, v196, v179, v192
v_max3_f32 v94, v94, -v75, -v88
v_max3_f32 v198, v198, -v179, -v192
v_max_f32 v92, v92, v89
v_max_f32 v196, v196, v193
v_max3_f32 v94, v94, -v89, -v89
v_max3_f32 v198, v198, -v193, -v193
s_nop 0
v_permlane32_swap_b32 v92, v94
v_permlane32_swap_b32 v196, v198
v_max_f32 v92, v92, v94
v_max_f32 v196, v196, v198
v_mov_b32 v90, v92
v_mov_b32 v194, v196
s_nop 0
v_permlane16_swap_b32 v92, v90
v_permlane16_swap_b32 v196, v194
v_max_f32 v92, v92, v90
v_max_f32 v196, v196, v194
v_mov_b32 v94, v92
v_mov_b32 v198, v196
s_nop 0
v_permlane32_swap_b32 v92, v94
v_permlane32_swap_b32 v196, v198
v_mul_f32 v92, s80, v92
v_mul_f32 v196, s80, v196
v_mul_f32 v94, s80, v94
v_mul_f32 v198, s80, v198
v_pk_fma_f32 v[96:97], v[72:73], s[80:81], v[92:93] op_sel_hi:[1,1,0] neg_lo:[0,0,1] neg_hi:[0,0,1]
v_pk_fma_f32 v[200:201], v[176:177], s[80:81], v[196:197] op_sel_hi:[1,1,0] neg_lo:[0,0,1] neg_hi:[0,0,1]
v_pk_fma_f32 v[102:103], v[72:73], s[80:81], v[94:95] op_sel_hi:[1,1,0] neg_lo:[1,0,1] neg_hi:[1,0,1]
v_pk_fma_f32 v[206:207], v[176:177], s[80:81], v[198:199] op_sel_hi:[1,1,0] neg_lo:[1,0,1] neg_hi:[1,0,1]
v_pk_fma_f32 v[98:99], v[74:75], s[80:81], v[92:93] op_sel_hi:[1,1,0] neg_lo:[0,0,1] neg_hi:[0,0,1]
v_pk_fma_f32 v[202:203], v[178:179], s[80:81], v[196:197] op_sel_hi:[1,1,0] neg_lo:[0,0,1] neg_hi:[0,0,1]
v_pk_fma_f32 v[104:105], v[74:75], s[80:81], v[94:95] op_sel_hi:[1,1,0] neg_lo:[1,0,1] neg_hi:[1,0,1]
v_pk_fma_f32 v[208:209], v[178:179], s[80:81], v[198:199] op_sel_hi:[1,1,0] neg_lo:[1,0,1] neg_hi:[1,0,1]
v_pk_fma_f32 v[100:101], v[76:77], s[80:81], v[92:93] op_sel_hi:[1,1,0] neg_lo:[0,0,1] neg_hi:[0,0,1]
v_pk_fma_f32 v[204:205], v[180:181], s[80:81], v[196:197] op_sel_hi:[1,1,0] neg_lo:[0,0,1] neg_hi:[0,0,1]
v_pk_fma_f32 v[106:107], v[76:77], s[80:81], v[94:95] op_sel_hi:[1,1,0] neg_lo:[1,0,1] neg_hi:[1,0,1]
v_pk_fma_f32 v[210:211], v[180:181], s[80:81], v[198:199] op_sel_hi:[1,1,0] neg_lo:[1,0,1] neg_hi:[1,0,1]
v_exp_f32 v96, v96
v_exp_f32 v200, v200
v_exp_f32 v102, v102
v_exp_f32 v206, v206
v_exp_f32 v97, v97
v_exp_f32 v201, v201
v_exp_f32 v103, v103
v_exp_f32 v207, v207
v_exp_f32 v98, v98
v_exp_f32 v202, v202
v_exp_f32 v104, v104
v_exp_f32 v208, v208
v_exp_f32 v99, v99
v_exp_f32 v203, v203
v_exp_f32 v105, v105
v_exp_f32 v209, v209
v_exp_f32 v100, v100
v_exp_f32 v204, v204
v_exp_f32 v106, v106
v_exp_f32 v210, v210
v_exp_f32 v101, v101
v_exp_f32 v205, v205
v_exp_f32 v107, v107
v_exp_f32 v211, v211
v_cndmask_b32 v100, 0, v100, s[78:79]
v_cndmask_b32 v204, 0, v204, s[78:79]
v_cndmask_b32 v106, 0, v106, s[78:79]
v_cndmask_b32 v210, 0, v210, s[78:79]
v_cndmask_b32 v101, 0, v101, s[78:79]
v_cndmask_b32 v205, 0, v205, s[78:79]
v_cndmask_b32 v107, 0, v107, s[78:79]
v_cndmask_b32 v211, 0, v211, s[78:79]
v_pk_add_f32 v[108:109], v[96:97], v[98:99]
v_pk_add_f32 v[212:213], v[200:201], v[202:203]
v_pk_add_f32 v[108:109], v[108:109], v[100:101]
v_pk_add_f32 v[212:213], v[212:213], v[204:205]
v_add_f32 v108, v108, v109
v_add_f32 v212, v212, v213
v_pk_add_f32 v[110:111], v[102:103], v[104:105]
v_pk_add_f32 v[214:215], v[206:207], v[208:209]
v_pk_add_f32 v[110:111], v[110:111], v[106:107]
v_pk_add_f32 v[214:215], v[214:215], v[210:211]
v_add_f32 v110, v110, v111
v_add_f32 v214, v214, v215
s_nop 0
v_permlane32_swap_b32 v108, v110
v_permlane32_swap_b32 v212, v214
v_add_f32 v108, v108, v110
v_add_f32 v212, v212, v214
v_mov_b32 v90, v108
v_mov_b32 v194, v212
s_nop 0
v_permlane16_swap_b32 v108, v90
v_permlane16_swap_b32 v212, v194
v_add_f32 v108, v108, v90
v_add_f32 v212, v212, v194
v_mov_b32 v110, v108
v_mov_b32 v214, v212
s_nop 0
v_permlane32_swap_b32 v108, v110
v_permlane32_swap_b32 v212, v214
v_rcp_f32 v108, v108
v_rcp_f32 v212, v212
v_rcp_f32 v110, v110
v_rcp_f32 v214, v214
v_pk_mul_f32 v[96:97], v[96:97], v[108:109] op_sel_hi:[1,0]
v_pk_mul_f32 v[200:201], v[200:201], v[212:213] op_sel_hi:[1,0]
v_pk_mul_f32 v[102:103], v[102:103], v[110:111] op_sel_hi:[1,0]
v_pk_mul_f32 v[206:207], v[206:207], v[214:215] op_sel_hi:[1,0]
v_pk_mul_f32 v[98:99], v[98:99], v[108:109] op_sel_hi:[1,0]
v_pk_mul_f32 v[202:203], v[202:203], v[212:213] op_sel_hi:[1,0]
v_pk_mul_f32 v[104:105], v[104:105], v[110:111] op_sel_hi:[1,0]
v_pk_mul_f32 v[208:209], v[208:209], v[214:215] op_sel_hi:[1,0]
v_pk_mul_f32 v[100:101], v[100:101], v[108:109] op_sel_hi:[1,0]
v_pk_mul_f32 v[204:205], v[204:205], v[212:213] op_sel_hi:[1,0]
v_pk_mul_f32 v[106:107], v[106:107], v[110:111] op_sel_hi:[1,0]
v_pk_mul_f32 v[210:211], v[210:211], v[214:215] op_sel_hi:[1,0]
v_cvt_pk_bf16_f32 v80, v96, v97
v_cvt_pk_bf16_f32 v184, v200, v201
v_cvt_pk_bf16_f32 v81, v98, v99
v_cvt_pk_bf16_f32 v185, v202, v203
v_cvt_pk_bf16_f32 v82, v102, v103
v_cvt_pk_bf16_f32 v186, v206, v207
v_cvt_pk_bf16_f32 v83, v104, v105
v_cvt_pk_bf16_f32 v187, v208, v209
v_cvt_pk_bf16_f32 v84, v100, v101
v_cvt_pk_bf16_f32 v188, v204, v205
v_cvt_pk_bf16_f32 v85, v106, v107
v_cvt_pk_bf16_f32 v189, v210, v211
ds_write_b64 v68, v[80:81] offset:96
ds_write_b64 v68, v[184:185] offset:6752
ds_write_b64 v68, v[82:83] offset:128
ds_write_b64 v68, v[186:187] offset:6784
ds_write_b64 v68, v[84:85] offset:160
ds_write_b64 v68, v[188:189] offset:6816
v_mfma_f32_16x16x32_bf16 v[72:75], v[128:131], v[36:39], 0
v_mfma_f32_16x16x32_bf16 v[176:179], v[128:131], v[54:57], 0
v_mfma_f32_16x16x32_bf16 v[76:79], v[132:135], v[36:39], 0
v_mfma_f32_16x16x32_bf16 v[180:183], v[132:135], v[54:57], 0
s_nop 7
v_cndmask_b32 v88, v72, v76, s[78:79]
v_cndmask_b32 v192, v176, v180, s[78:79]
v_cndmask_b32 v89, v72, v77, s[78:79]
v_cndmask_b32 v193, v176, v181, s[78:79]
v_max3_f32 v92, v72, v73, v74
v_max3_f32 v196, v176, v177, v178
v_max3_f32 v94, -v72, -v73, -v74
v_max3_f32 v198, -v176, -v177, -v178
v_max3_f32 v92, v92, v75, v88
v_max3_f32 v196, v196, v179, v192
v_max3_f32 v94, v94, -v75, -v88
v_max3_f32 v198, v198, -v179, -v192
v_max_f32 v92, v92, v89
v_max_f32 v196, v196, v193
v_max3_f32 v94, v94, -v89, -v89
v_max3_f32 v198, v198, -v193, -v193
s_nop 0
v_permlane32_swap_b32 v92, v94
v_permlane32_swap_b32 v196, v198
v_max_f32 v92, v92, v94
v_max_f32 v196, v196, v198
v_mov_b32 v90, v92
v_mov_b32 v194, v196
s_nop 0
v_permlane16_swap_b32 v92, v90
v_permlane16_swap_b32 v196, v194
v_max_f32 v92, v92, v90
v_max_f32 v196, v196, v194
v_mov_b32 v94, v92
v_mov_b32 v198, v196
s_nop 0
v_permlane32_swap_b32 v92, v94
v_permlane32_swap_b32 v196, v198
v_mul_f32 v92, s80, v92
v_mul_f32 v196, s80, v196
v_mul_f32 v94, s80, v94
v_mul_f32 v198, s80, v198
v_pk_fma_f32 v[96:97], v[72:73], s[80:81], v[92:93] op_sel_hi:[1,1,0] neg_lo:[0,0,1] neg_hi:[0,0,1]
v_pk_fma_f32 v[200:201], v[176:177], s[80:81], v[196:197] op_sel_hi:[1,1,0] neg_lo:[0,0,1] neg_hi:[0,0,1]
v_pk_fma_f32 v[102:103], v[72:73], s[80:81], v[94:95] op_sel_hi:[1,1,0] neg_lo:[1,0,1] neg_hi:[1,0,1]
v_pk_fma_f32 v[206:207], v[176:177], s[80:81], v[198:199] op_sel_hi:[1,1,0] neg_lo:[1,0,1] neg_hi:[1,0,1]
v_pk_fma_f32 v[98:99], v[74:75], s[80:81], v[92:93] op_sel_hi:[1,1,0] neg_lo:[0,0,1] neg_hi:[0,0,1]
v_pk_fma_f32 v[202:203], v[178:179], s[80:81], v[196:197] op_sel_hi:[1,1,0] neg_lo:[0,0,1] neg_hi:[0,0,1]
v_pk_fma_f32 v[104:105], v[74:75], s[80:81], v[94:95] op_sel_hi:[1,1,0] neg_lo:[1,0,1] neg_hi:[1,0,1]
v_pk_fma_f32 v[208:209], v[178:179], s[80:81], v[198:199] op_sel_hi:[1,1,0] neg_lo:[1,0,1] neg_hi:[1,0,1]
v_pk_fma_f32 v[100:101], v[76:77], s[80:81], v[92:93] op_sel_hi:[1,1,0] neg_lo:[0,0,1] neg_hi:[0,0,1]
v_pk_fma_f32 v[204:205], v[180:181], s[80:81], v[196:197] op_sel_hi:[1,1,0] neg_lo:[0,0,1] neg_hi:[0,0,1]
v_pk_fma_f32 v[106:107], v[76:77], s[80:81], v[94:95] op_sel_hi:[1,1,0] neg_lo:[1,0,1] neg_hi:[1,0,1]
v_pk_fma_f32 v[210:211], v[180:181], s[80:81], v[198:199] op_sel_hi:[1,1,0] neg_lo:[1,0,1] neg_hi:[1,0,1]
v_exp_f32 v96, v96
v_exp_f32 v200, v200
v_exp_f32 v102, v102
v_exp_f32 v206, v206
v_exp_f32 v97, v97
v_exp_f32 v201, v201
v_exp_f32 v103, v103
v_exp_f32 v207, v207
v_exp_f32 v98, v98
v_exp_f32 v202, v202
v_exp_f32 v104, v104
v_exp_f32 v208, v208
v_exp_f32 v99, v99
v_exp_f32 v203, v203
v_exp_f32 v105, v105
v_exp_f32 v209, v209
v_exp_f32 v100, v100
v_exp_f32 v204, v204
v_exp_f32 v106, v106
v_exp_f32 v210, v210
v_exp_f32 v101, v101
v_exp_f32 v205, v205
v_exp_f32 v107, v107
v_exp_f32 v211, v211
v_cndmask_b32 v100, 0, v100, s[78:79]
v_cndmask_b32 v204, 0, v204, s[78:79]
v_cndmask_b32 v106, 0, v106, s[78:79]
v_cndmask_b32 v210, 0, v210, s[78:79]
v_cndmask_b32 v101, 0, v101, s[78:79]
v_cndmask_b32 v205, 0, v205, s[78:79]
v_cndmask_b32 v107, 0, v107, s[78:79]
v_cndmask_b32 v211, 0, v211, s[78:79]
v_pk_add_f32 v[108:109], v[96:97], v[98:99]
v_pk_add_f32 v[212:213], v[200:201], v[202:203]
v_pk_add_f32 v[108:109], v[108:109], v[100:101]
v_pk_add_f32 v[212:213], v[212:213], v[204:205]
v_add_f32 v108, v108, v109
v_add_f32 v212, v212, v213
v_pk_add_f32 v[110:111], v[102:103], v[104:105]
v_pk_add_f32 v[214:215], v[206:207], v[208:209]
v_pk_add_f32 v[110:111], v[110:111], v[106:107]
v_pk_add_f32 v[214:215], v[214:215], v[210:211]
v_add_f32 v110, v110, v111
v_add_f32 v214, v214, v215
s_nop 0
v_permlane32_swap_b32 v108, v110
v_permlane32_swap_b32 v212, v214
v_add_f32 v108, v108, v110
v_add_f32 v212, v212, v214
v_mov_b32 v90, v108
v_mov_b32 v194, v212
s_nop 0
v_permlane16_swap_b32 v108, v90
v_permlane16_swap_b32 v212, v194
v_add_f32 v108, v108, v90
v_add_f32 v212, v212, v194
v_mov_b32 v110, v108
v_mov_b32 v214, v212
s_nop 0
v_permlane32_swap_b32 v108, v110
v_permlane32_swap_b32 v212, v214
v_rcp_f32 v108, v108
v_rcp_f32 v212, v212
v_rcp_f32 v110, v110
v_rcp_f32 v214, v214
v_pk_mul_f32 v[96:97], v[96:97], v[108:109] op_sel_hi:[1,0]
v_pk_mul_f32 v[200:201], v[200:201], v[212:213] op_sel_hi:[1,0]
v_pk_mul_f32 v[102:103], v[102:103], v[110:111] op_sel_hi:[1,0]
v_pk_mul_f32 v[206:207], v[206:207], v[214:215] op_sel_hi:[1,0]
v_pk_mul_f32 v[98:99], v[98:99], v[108:109] op_sel_hi:[1,0]
v_pk_mul_f32 v[202:203], v[202:203], v[212:213] op_sel_hi:[1,0]
v_pk_mul_f32 v[104:105], v[104:105], v[110:111] op_sel_hi:[1,0]
v_pk_mul_f32 v[208:209], v[208:209], v[214:215] op_sel_hi:[1,0]
v_pk_mul_f32 v[100:101], v[100:101], v[108:109] op_sel_hi:[1,0]
v_pk_mul_f32 v[204:205], v[204:205], v[212:213] op_sel_hi:[1,0]
v_pk_mul_f32 v[106:107], v[106:107], v[110:111] op_sel_hi:[1,0]
v_pk_mul_f32 v[210:211], v[210:211], v[214:215] op_sel_hi:[1,0]
v_cvt_pk_bf16_f32 v80, v96, v97
v_cvt_pk_bf16_f32 v184, v200, v201
v_cvt_pk_bf16_f32 v81, v98, v99
v_cvt_pk_bf16_f32 v185, v202, v203
v_cvt_pk_bf16_f32 v82, v102, v103
v_cvt_pk_bf16_f32 v186, v206, v207
v_cvt_pk_bf16_f32 v83, v104, v105
v_cvt_pk_bf16_f32 v187, v208, v209
v_cvt_pk_bf16_f32 v84, v100, v101
v_cvt_pk_bf16_f32 v188, v204, v205
v_cvt_pk_bf16_f32 v85, v106, v107
v_cvt_pk_bf16_f32 v189, v210, v211
ds_write_b64 v68, v[80:81] offset:192
ds_write_b64 v68, v[184:185] offset:6848
ds_write_b64 v68, v[82:83] offset:224
ds_write_b64 v68, v[186:187] offset:6880
ds_write_b64 v68, v[84:85] offset:256
ds_write_b64 v68, v[188:189] offset:6912
v_mfma_f32_16x16x32_bf16 v[72:75], v[136:139], v[38:41], 0
v_mfma_f32_16x16x32_bf16 v[176:179], v[136:139], v[56:59], 0
v_mfma_f32_16x16x32_bf16 v[76:79], v[140:143], v[38:41], 0
v_mfma_f32_16x16x32_bf16 v[180:183], v[140:143], v[56:59], 0
s_nop 7
v_cndmask_b32 v88, v72, v76, s[78:79]
v_cndmask_b32 v192, v176, v180, s[78:79]
v_cndmask_b32 v89, v72, v77, s[78:79]
v_cndmask_b32 v193, v176, v181, s[78:79]
v_max3_f32 v92, v72, v73, v74
v_max3_f32 v196, v176, v177, v178
v_max3_f32 v94, -v72, -v73, -v74
v_max3_f32 v198, -v176, -v177, -v178
v_max3_f32 v92, v92, v75, v88
v_max3_f32 v196, v196, v179, v192
v_max3_f32 v94, v94, -v75, -v88
v_max3_f32 v198, v198, -v179, -v192
v_max_f32 v92, v92, v89
v_max_f32 v196, v196, v193
v_max3_f32 v94, v94, -v89, -v89
v_max3_f32 v198, v198, -v193, -v193
s_nop 0
v_permlane32_swap_b32 v92, v94
v_permlane32_swap_b32 v196, v198
v_max_f32 v92, v92, v94
v_max_f32 v196, v196, v198
v_mov_b32 v90, v92
v_mov_b32 v194, v196
s_nop 0
v_permlane16_swap_b32 v92, v90
v_permlane16_swap_b32 v196, v194
v_max_f32 v92, v92, v90
v_max_f32 v196, v196, v194
v_mov_b32 v94, v92
v_mov_b32 v198, v196
s_nop 0
v_permlane32_swap_b32 v92, v94
v_permlane32_swap_b32 v196, v198
v_mul_f32 v92, s80, v92
v_mul_f32 v196, s80, v196
v_mul_f32 v94, s80, v94
v_mul_f32 v198, s80, v198
v_pk_fma_f32 v[96:97], v[72:73], s[80:81], v[92:93] op_sel_hi:[1,1,0] neg_lo:[0,0,1] neg_hi:[0,0,1]
v_pk_fma_f32 v[200:201], v[176:177], s[80:81], v[196:197] op_sel_hi:[1,1,0] neg_lo:[0,0,1] neg_hi:[0,0,1]
v_pk_fma_f32 v[102:103], v[72:73], s[80:81], v[94:95] op_sel_hi:[1,1,0] neg_lo:[1,0,1] neg_hi:[1,0,1]
v_pk_fma_f32 v[206:207], v[176:177], s[80:81], v[198:199] op_sel_hi:[1,1,0] neg_lo:[1,0,1] neg_hi:[1,0,1]
v_pk_fma_f32 v[98:99], v[74:75], s[80:81], v[92:93] op_sel_hi:[1,1,0] neg_lo:[0,0,1] neg_hi:[0,0,1]
v_pk_fma_f32 v[202:203], v[178:179], s[80:81], v[196:197] op_sel_hi:[1,1,0] neg_lo:[0,0,1] neg_hi:[0,0,1]
v_pk_fma_f32 v[104:105], v[74:75], s[80:81], v[94:95] op_sel_hi:[1,1,0] neg_lo:[1,0,1] neg_hi:[1,0,1]
v_pk_fma_f32 v[208:209], v[178:179], s[80:81], v[198:199] op_sel_hi:[1,1,0] neg_lo:[1,0,1] neg_hi:[1,0,1]
v_pk_fma_f32 v[100:101], v[76:77], s[80:81], v[92:93] op_sel_hi:[1,1,0] neg_lo:[0,0,1] neg_hi:[0,0,1]
v_pk_fma_f32 v[204:205], v[180:181], s[80:81], v[196:197] op_sel_hi:[1,1,0] neg_lo:[0,0,1] neg_hi:[0,0,1]
v_pk_fma_f32 v[106:107], v[76:77], s[80:81], v[94:95] op_sel_hi:[1,1,0] neg_lo:[1,0,1] neg_hi:[1,0,1]
v_pk_fma_f32 v[210:211], v[180:181], s[80:81], v[198:199] op_sel_hi:[1,1,0] neg_lo:[1,0,1] neg_hi:[1,0,1]
v_exp_f32 v96, v96
v_exp_f32 v200, v200
v_exp_f32 v102, v102
v_exp_f32 v206, v206
v_exp_f32 v97, v97
v_exp_f32 v201, v201
v_exp_f32 v103, v103
v_exp_f32 v207, v207
v_exp_f32 v98, v98
v_exp_f32 v202, v202
v_exp_f32 v104, v104
v_exp_f32 v208, v208
v_exp_f32 v99, v99
v_exp_f32 v203, v203
v_exp_f32 v105, v105
v_exp_f32 v209, v209
v_exp_f32 v100, v100
v_exp_f32 v204, v204
v_exp_f32 v106, v106
v_exp_f32 v210, v210
v_exp_f32 v101, v101
v_exp_f32 v205, v205
v_exp_f32 v107, v107
v_exp_f32 v211, v211
v_cndmask_b32 v100, 0, v100, s[78:79]
v_cndmask_b32 v204, 0, v204, s[78:79]
v_cndmask_b32 v106, 0, v106, s[78:79]
v_cndmask_b32 v210, 0, v210, s[78:79]
v_cndmask_b32 v101, 0, v101, s[78:79]
v_cndmask_b32 v205, 0, v205, s[78:79]
v_cndmask_b32 v107, 0, v107, s[78:79]
v_cndmask_b32 v211, 0, v211, s[78:79]
v_pk_add_f32 v[108:109], v[96:97], v[98:99]
v_pk_add_f32 v[212:213], v[200:201], v[202:203]
v_pk_add_f32 v[108:109], v[108:109], v[100:101]
v_pk_add_f32 v[212:213], v[212:213], v[204:205]
v_add_f32 v108, v108, v109
v_add_f32 v212, v212, v213
v_pk_add_f32 v[110:111], v[102:103], v[104:105]
v_pk_add_f32 v[214:215], v[206:207], v[208:209]
v_pk_add_f32 v[110:111], v[110:111], v[106:107]
v_pk_add_f32 v[214:215], v[214:215], v[210:211]
v_add_f32 v110, v110, v111
v_add_f32 v214, v214, v215
s_nop 0
v_permlane32_swap_b32 v108, v110
v_permlane32_swap_b32 v212, v214
v_add_f32 v108, v108, v110
v_add_f32 v212, v212, v214
v_mov_b32 v90, v108
v_mov_b32 v194, v212
s_nop 0
v_permlane16_swap_b32 v108, v90
v_permlane16_swap_b32 v212, v194
v_add_f32 v108, v108, v90
v_add_f32 v212, v212, v194
v_mov_b32 v110, v108
v_mov_b32 v214, v212
s_nop 0
v_permlane32_swap_b32 v108, v110
v_permlane32_swap_b32 v212, v214
v_rcp_f32 v108, v108
v_rcp_f32 v212, v212
v_rcp_f32 v110, v110
v_rcp_f32 v214, v214
v_pk_mul_f32 v[96:97], v[96:97], v[108:109] op_sel_hi:[1,0]
v_pk_mul_f32 v[200:201], v[200:201], v[212:213] op_sel_hi:[1,0]
v_pk_mul_f32 v[102:103], v[102:103], v[110:111] op_sel_hi:[1,0]
v_pk_mul_f32 v[206:207], v[206:207], v[214:215] op_sel_hi:[1,0]
v_pk_mul_f32 v[98:99], v[98:99], v[108:109] op_sel_hi:[1,0]
v_pk_mul_f32 v[202:203], v[202:203], v[212:213] op_sel_hi:[1,0]
v_pk_mul_f32 v[104:105], v[104:105], v[110:111] op_sel_hi:[1,0]
v_pk_mul_f32 v[208:209], v[208:209], v[214:215] op_sel_hi:[1,0]
v_pk_mul_f32 v[100:101], v[100:101], v[108:109] op_sel_hi:[1,0]
v_pk_mul_f32 v[204:205], v[204:205], v[212:213] op_sel_hi:[1,0]
v_pk_mul_f32 v[106:107], v[106:107], v[110:111] op_sel_hi:[1,0]
v_pk_mul_f32 v[210:211], v[210:211], v[214:215] op_sel_hi:[1,0]
v_cvt_pk_bf16_f32 v80, v96, v97
v_cvt_pk_bf16_f32 v184, v200, v201
v_cvt_pk_bf16_f32 v81, v98, v99
v_cvt_pk_bf16_f32 v185, v202, v203
v_cvt_pk_bf16_f32 v82, v102, v103
v_cvt_pk_bf16_f32 v186, v206, v207
v_cvt_pk_bf16_f32 v83, v104, v105
v_cvt_pk_bf16_f32 v187, v208, v209
v_cvt_pk_bf16_f32 v84, v100, v101
v_cvt_pk_bf16_f32 v188, v204, v205
v_cvt_pk_bf16_f32 v85, v106, v107
v_cvt_pk_bf16_f32 v189, v210, v211
ds_write_b64 v68, v[80:81] offset:288
ds_write_b64 v68, v[184:185] offset:6944
ds_write_b64 v68, v[82:83] offset:320
ds_write_b64 v68, v[186:187] offset:6976
ds_write_b64 v68, v[84:85] offset:352
ds_write_b64 v68, v[188:189] offset:7008
s_waitcnt lgkmcnt(0)
s_barrier
v_lshrrev_b32 v68, 2, v3
v_and_b32 v69, 3, v3
v_lshl_add_u32 v68, v2, 3, v68
v_mul_u32_u24 v70, 416, v68
v_mul_u32_u24 v71, 288, v68
v_lshl_add_u32 v70, v69, 3, v70
v_lshl_add_u32 v71, v69, 3, v71
s_mul_i32 s77, s3, 96
s_lshl_b32 s76, s3, 6
s_add_u32 s76, s76, 53248
v_add_u32 v70, s77, v70
v_add_u32 v71, s76, v71
ds_read_b64_tr_b16 v[160:161], v70 offset:0
ds_read_b64_tr_b16 v[162:163], v70 offset:1664
ds_read_b64_tr_b16 v[164:165], v70 offset:32
ds_read_b64_tr_b16 v[166:167], v70 offset:1696
ds_read_b64_tr_b16 v[168:169], v70 offset:64
ds_read_b64_tr_b16 v[170:171], v70 offset:1728
ds_read_b64_tr_b16 v[208:209], v71 offset:0
ds_read_b64_tr_b16 v[210:211], v71 offset:1152
ds_read_b64_tr_b16 v[212:213], v71 offset:32
ds_read_b64_tr_b16 v[214:215], v71 offset:1184
s_waitcnt lgkmcnt(0)
v_mfma_f32_16x16x32_bf16 v[72:75], v[160:163], v[208:211], 0
v_mfma_f32_16x16x32_bf16 v[76:79], v[160:163], v[212:215], 0
v_mfma_f32_16x16x32_bf16 v[80:83], v[164:167], v[208:211], 0
v_mfma_f32_16x16x32_bf16 v[84:87], v[164:167], v[212:215], 0
v_mfma_f32_16x16x32_bf16 v[88:91], v[168:171], v[208:211], 0
v_mfma_f32_16x16x32_bf16 v[92:95], v[168:171], v[212:215], 0
ds_read_b64_tr_b16 v[172:173], v70 offset:13312
ds_read_b64_tr_b16 v[174:175], v70 offset:14976
ds_read_b64_tr_b16 v[176:177], v70 offset:13344
ds_read_b64_tr_b16 v[178:179], v70 offset:15008
ds_read_b64_tr_b16 v[180:181], v70 offset:13376
ds_read_b64_tr_b16 v[182:183], v70 offset:15040
ds_read_b64_tr_b16 v[216:217], v71 offset:9216
ds_read_b64_tr_b16 v[218:219], v71 offset:10368
ds_read_b64_tr_b16 v[220:221], v71 offset:9248
ds_read_b64_tr_b16 v[222:223], v71 offset:10400
s_waitcnt lgkmcnt(0)
v_mfma_f32_16x16x32_bf16 v[72:75], v[172:175], v[216:219], v[72:75]
v_mfma_f32_16x16x32_bf16 v[76:79], v[172:175], v[220:223], v[76:79]
v_mfma_f32_16x16x32_bf16 v[80:83], v[176:179], v[216:219], v[80:83]
v_mfma_f32_16x16x32_bf16 v[84:87], v[176:179], v[220:223], v[84:87]
v_mfma_f32_16x16x32_bf16 v[88:91], v[180:183], v[216:219], v[88:91]
v_mfma_f32_16x16x32_bf16 v[92:95], v[180:183], v[220:223], v[92:95]
ds_read_b64_tr_b16 v[184:185], v70 offset:26624
ds_read_b64_tr_b16 v[186:187], v70 offset:28288
ds_read_b64_tr_b16 v[188:189], v70 offset:26656
ds_read_b64_tr_b16 v[190:191], v70 offset:28320
ds_read_b64_tr_b16 v[192:193], v70 offset:26688
ds_read_b64_tr_b16 v[194:195], v70 offset:28352
ds_read_b64_tr_b16 v[224:225], v71 offset:18432
ds_read_b64_tr_b16 v[226:227], v71 offset:19584
ds_read_b64_tr_b16 v[228:229], v71 offset:18464
ds_read_b64_tr_b16 v[230:231], v71 offset:19616
s_waitcnt lgkmcnt(0)
v_mfma_f32_16x16x32_bf16 v[72:75], v[184:187], v[224:227], v[72:75]
v_mfma_f32_16x16x32_bf16 v[76:79], v[184:187], v[228:231], v[76:79]
v_mfma_f32_16x16x32_bf16 v[80:83], v[188:191], v[224:227], v[80:83]
v_mfma_f32_16x16x32_bf16 v[84:87], v[188:191], v[228:231], v[84:87]
v_mfma_f32_16x16x32_bf16 v[88:91], v[192:195], v[224:227], v[88:91]
v_mfma_f32_16x16x32_bf16 v[92:95], v[192:195], v[228:231], v[92:95]
ds_read_b64_tr_b16 v[196:197], v70 offset:39936
ds_read_b64_tr_b16 v[198:199], v70 offset:41600
ds_read_b64_tr_b16 v[200:201], v70 offset:39968
ds_read_b64_tr_b16 v[202:203], v70 offset:41632
ds_read_b64_tr_b16 v[204:205], v70 offset:40000
ds_read_b64_tr_b16 v[206:207], v70 offset:41664
ds_read_b64_tr_b16 v[232:233], v71 offset:27648
ds_read_b64_tr_b16 v[234:235], v71 offset:28800
ds_read_b64_tr_b16 v[236:237], v71 offset:27680
ds_read_b64_tr_b16 v[238:239], v71 offset:28832
s_waitcnt lgkmcnt(0)
v_mfma_f32_16x16x32_bf16 v[72:75], v[196:199], v[232:235], v[72:75]
v_mfma_f32_16x16x32_bf16 v[76:79], v[196:199], v[236:239], v[76:79]
v_mfma_f32_16x16x32_bf16 v[80:83], v[200:203], v[232:235], v[80:83]
v_mfma_f32_16x16x32_bf16 v[84:87], v[200:203], v[236:239], v[84:87]
v_mfma_f32_16x16x32_bf16 v[88:91], v[204:207], v[232:235], v[88:91]
v_mfma_f32_16x16x32_bf16 v[92:95], v[204:207], v[236:239], v[92:95]
s_lshl_b32 s77, s58, 5
s_add_u32 s77, s77, s69
s_add_u32 s77, s77, s3
s_mul_i32 s77, s77, 6144
s_add_u32 s77, s77, 5242880
v_lshlrev_b32 v68, 4, v1
buffer_store_dwordx4 v[72:75], v68, s[16:19], s77 offen offset:0 sc1
buffer_store_dwordx4 v[76:79], v68, s[16:19], s77 offen offset:1024 sc1
buffer_store_dwordx4 v[80:83], v68, s[16:19], s77 offen offset:2048 sc1
buffer_store_dwordx4 v[84:87], v68, s[16:19], s77 offen offset:3072 sc1
s_add_u32 s77, s77, 4096
buffer_store_dwordx4 v[88:91], v68, s[16:19], s77 offen offset:0 sc1
buffer_store_dwordx4 v[92:95], v68, s[16:19], s77 offen offset:1024 sc1
s_branch k1_end
k1_pf:
s_cmp_lg_u32 s92, 0
s_cbranch_scc1 k1_end
s_mov_b32 s8, s42
s_and_b32 s9, s43, 0xffff
s_mov_b32 s10, 5308416
s_mov_b32 s11, 0x20000
s_mov_b32 s12, s46
s_and_b32 s13, s47, 0xffff
s_mov_b32 s14, 5308416
s_mov_b32 s15, 0x20000
s_mov_b32 s20, s38
s_and_b32 s21, s39, 0xffff
s_mov_b32 s22, 663552
s_mov_b32 s23, 0x20000
s_sub_u32 s64, s2, 192
s_lshl_b32 s64, s64, 2
s_add_u32 s64, s64, s3
s_mul_i32 s65, s64, 21504
v_lshlrev_b32 v5, 4, v1
s_add_u32 s66, s65, 0
buffer_load_dwordx4 v[32:35], v5, s[8:11], s66 offen
s_add_u32 s66, s65, 1024
buffer_load_dwordx4 v[36:39], v5, s[8:11], s66 offen
s_add_u32 s66, s65, 2048
buffer_load_dwordx4 v[40:43], v5, s[8:11], s66 offen
s_add_u32 s66, s65, 3072
buffer_load_dwordx4 v[44:47], v5, s[8:11], s66 offen
s_add_u32 s66, s65, 4096
buffer_load_dwordx4 v[48:51], v5, s[8:11], s66 offen
s_add_u32 s66, s65, 5120
buffer_load_dwordx4 v[52:55], v5, s[8:11], s66 offen
s_add_u32 s66, s65, 6144
buffer_load_dwordx4 v[56:59], v5, s[8:11], s66 offen
s_add_u32 s66, s65, 7168
buffer_load_dwordx4 v[60:63], v5, s[8:11], s66 offen
s_add_u32 s66, s65, 8192
buffer_load_dwordx4 v[64:67], v5, s[8:11], s66 offen
s_add_u32 s66, s65, 9216
buffer_load_dwordx4 v[68:71], v5, s[8:11], s66 offen
s_add_u32 s66, s65, 10240
buffer_load_dwordx4 v[72:75], v5, s[8:11], s66 offen
s_add_u32 s66, s65, 11264
buffer_load_dwordx4 v[76:79], v5, s[8:11], s66 offen
s_add_u32 s66, s65, 12288
buffer_load_dwordx4 v[80:83], v5, s[8:11], s66 offen
s_add_u32 s66, s65, 13312
buffer_load_dwordx4 v[84:87], v5, s[8:11], s66 offen
s_add_u32 s66, s65, 14336
buffer_load_dwordx4 v[88:91], v5, s[8:11], s66 offen
s_add_u32 s66, s65, 15360
buffer_load_dwordx4 v[92:95], v5, s[8:11], s66 offen
s_add_u32 s66, s65, 16384
buffer_load_dwordx4 v[96:99], v5, s[8:11], s66 offen
s_add_u32 s66, s65, 17408
buffer_load_dwordx4 v[100:103], v5, s[8:11], s66 offen
s_add_u32 s66, s65, 18432
buffer_load_dwordx4 v[104:107], v5, s[8:11], s66 offen
s_add_u32 s66, s65, 19456
buffer_load_dwordx4 v[108:111], v5, s[8:11], s66 offen
s_add_u32 s66, s65, 20480
buffer_load_dwordx4 v[112:115], v5, s[8:11], s66 offen
s_add_u32 s66, s65, 0
buffer_load_dwordx4 v[116:119], v5, s[12:15], s66 offen
s_add_u32 s66, s65, 1024
buffer_load_dwordx4 v[120:123], v5, s[12:15], s66 offen
s_add_u32 s66, s65, 2048
buffer_load_dwordx4 v[124:127], v5, s[12:15], s66 offen
s_add_u32 s66, s65, 3072
buffer_load_dwordx4 v[128:131], v5, s[12:15], s66 offen
s_add_u32 s66, s65, 4096
buffer_load_dwordx4 v[132:135], v5, s[12:15], s66 offen
s_add_u32 s66, s65, 5120
buffer_load_dwordx4 v[136:139], v5, s[12:15], s66 offen
s_add_u32 s66, s65, 6144
buffer_load_dwordx4 v[140:143], v5, s[12:15], s66 offen
s_add_u32 s66, s65, 7168
buffer_load_dwordx4 v[144:147], v5, s[12:15], s66 offen
s_add_u32 s66, s65, 8192
buffer_load_dwordx4 v[148:151], v5, s[12:15], s66 offen
s_add_u32 s66, s65, 9216
buffer_load_dwordx4 v[152:155], v5, s[12:15], s66 offen
s_add_u32 s66, s65, 10240
buffer_load_dwordx4 v[156:159], v5, s[12:15], s66 offen
s_add_u32 s66, s65, 11264
buffer_load_dwordx4 v[160:163], v5, s[12:15], s66 offen
s_add_u32 s66, s65, 12288
buffer_load_dwordx4 v[164:167], v5, s[12:15], s66 offen
s_add_u32 s66, s65, 13312
buffer_load_dwordx4 v[168:171], v5, s[12:15], s66 offen
s_add_u32 s66, s65, 14336
buffer_load_dwordx4 v[172:175], v5, s[12:15], s66 offen
s_add_u32 s66, s65, 15360
buffer_load_dwordx4 v[176:179], v5, s[12:15], s66 offen
s_add_u32 s66, s65, 16384
buffer_load_dwordx4 v[180:183], v5, s[12:15], s66 offen
s_add_u32 s66, s65, 17408
buffer_load_dwordx4 v[184:187], v5, s[12:15], s66 offen
s_add_u32 s66, s65, 18432
buffer_load_dwordx4 v[188:191], v5, s[12:15], s66 offen
s_add_u32 s66, s65, 19456
buffer_load_dwordx4 v[192:195], v5, s[12:15], s66 offen
s_add_u32 s66, s65, 20480
buffer_load_dwordx4 v[196:199], v5, s[12:15], s66 offen
s_mul_i32 s65, s64, 3072
s_add_u32 s66, s65, 0
buffer_load_dwordx4 v[200:203], v5, s[20:23], s66 offen
s_add_u32 s66, s65, 1024
buffer_load_dwordx4 v[204:207], v5, s[20:23], s66 offen
s_add_u32 s66, s65, 2048
buffer_load_dwordx4 v[208:211], v5, s[20:23], s66 offen
s_getpc_b64 s[68:69]
k1_pc:
s_sub_u32 s68, s68, k1_pc-k1_l0_kernel
s_subb_u32 s69, s69, 0
s_lshl_b32 s65, s64, 10
s_cmp_ge_u32 s65, text_end-k1_l0_kernel-1024
s_cbranch_scc1 k1_pf_done
s_add_u32 s68, s68, s65
s_addc_u32 s69, s69, 0
global_load_dwordx4 v[212:215], v5, s[68:69]
k1_pf_done:
s_waitcnt vmcnt(0)
k1_end:
s_endpgm

.globl ko_l0_kernel
.p2align 8
.type ko_l0_kernel,@function
ko_l0_kernel:
s_mov_b32 s92, 0
s_branch ko_body
.globl ko_l1_kernel
.p2align 8
.type ko_l1_kernel,@function
ko_l1_kernel:
s_mov_b32 s92, 1
s_branch ko_body
.p2align 6
ko_body:
s_cmp_ge_u32 s2, 256
s_cbranch_scc1 ko_end
s_load_dwordx16 s[32:47], s[0:1], 0
s_load_dwordx8 s[48:55], s[0:1], 64
v_and_b32 v1, 63, v0
v_lshrrev_b32 v2, 4, v1
v_and_b32 v3, 15, v1
v_lshrrev_b32 v4, 6, v0
s_nop 0
v_readfirstlane_b32 s3, v4
v_lshrrev_b32 v5, 1, v2
v_lshlrev_b32 v5, 8, v5
v_lshl_add_u32 v5, v3, 4, v5
v_and_b32 v6, 1, v2
v_lshl_add_u32 v26, v6, 3, v5
s_waitcnt lgkmcnt(0)
s_mov_b32 s16, s54
s_and_b32 s17, s55, 0xffff
s_mov_b32 s18, 67108864
s_mov_b32 s19, 0x20000
s_and_b32 s69, s2, 31
s_lshr_b32 s68, s2, 5
s_lshl_b32 s68, s68, 4
s_lshl_b32 s64, s3, 2
s_add_u32 s68, s68, s64
v_lshlrev_b32 v52, 4, v1
s_mul_i32 s70, s69, 6144
s_add_u32 s70, s70, 5242880
s_mul_i32 s64, s3, 786432
s_add_u32 s70, s70, s64
s_mov_b32 s74, 0xffff
s_mov_b32 s75, 0x0
s_add_u32 s71, s70, 0
buffer_load_dwordx4 v[64:67], v52, s[16:19], s71 offen
s_add_u32 s71, s70, 196608
buffer_load_dwordx4 v[68:71], v52, s[16:19], s71 offen
s_add_u32 s71, s70, 393216
buffer_load_dwordx4 v[72:75], v52, s[16:19], s71 offen
s_add_u32 s71, s70, 589824
buffer_load_dwordx4 v[76:79], v52, s[16:19], s71 offen
s_add_u32 s71, s70, 1024
buffer_load_dwordx4 v[80:83], v52, s[16:19], s71 offen
s_add_u32 s71, s70, 197632
buffer_load_dwordx4 v[84:87], v52, s[16:19], s71 offen
s_add_u32 s71, s70, 394240
buffer_load_dwordx4 v[88:91], v52, s[16:19], s71 offen
s_add_u32 s71, s70, 590848
buffer_load_dwordx4 v[92:95], v52, s[16:19], s71 offen
s_add_u32 s71, s70, 2048
buffer_load_dwordx4 v[96:99], v52, s[16:19], s71 offen
s_add_u32 s71, s70, 198656
buffer_load_dwordx4 v[100:103], v52, s[16:19], s71 offen
s_add_u32 s71, s70, 395264
buffer_load_dwordx4 v[104:107], v52, s[16:19], s71 offen
s_add_u32 s71, s70, 591872
buffer_load_dwordx4 v[108:111], v52, s[16:19], s71 offen
s_add_u32 s71, s70, 3072
buffer_load_dwordx4 v[112:115], v52, s[16:19], s71 offen
s_add_u32 s71, s70, 199680
buffer_load_dwordx4 v[116:119], v52, s[16:19], s71 offen
s_add_u32 s71, s70, 396288
buffer_load_dwordx4 v[120:123], v52, s[16:19], s71 offen
s_add_u32 s71, s70, 592896
buffer_load_dwordx4 v[124:127], v52, s[16:19], s71 offen
s_add_u32 s71, s70, 4096
buffer_load_dwordx4 v[128:131], v52, s[16:19], s71 offen
s_add_u32 s71, s70, 200704
buffer_load_dwordx4 v[132:135], v52, s[16:19], s71 offen
s_add_u32 s71, s70, 397312
buffer_load_dwordx4 v[136:139], v52, s[16:19], s71 offen
s_add_u32 s71, s70, 593920
buffer_load_dwordx4 v[140:143], v52, s[16:19], s71 offen
s_add_u32 s71, s70, 5120
buffer_load_dwordx4 v[144:147], v52, s[16:19], s71 offen
s_add_u32 s71, s70, 201728
buffer_load_dwordx4 v[148:151], v52, s[16:19], s71 offen
s_add_u32 s71, s70, 398336
buffer_load_dwordx4 v[152:155], v52, s[16:19], s71 offen
s_add_u32 s71, s70, 594944
buffer_load_dwordx4 v[156:159], v52, s[16:19], s71 offen
v_lshlrev_b32 v53, 3, v3
v_mov_b32 v54, 2147418112
v_cndmask_b32 v53, v54, v53, s[74:75]
s_lshl_b32 s72, s68, 5
s_add_u32 s72, s72, s69
s_add_u32 s73, s72, 0
s_lshl_b32 s76, s73, 10
s_lshl_b32 s77, s73, 7
s_add_u32 s77, s77, 4194304
buffer_load_dwordx4 a[192:195], v52, s[16:19], s76 offen
buffer_load_dwordx2 a[196:197], v53, s[16:19], s77 offen
v_accvgpr_write_b32 a198, 0
v_accvgpr_write_b32 a199, 0
s_add_u32 s73, s72, 32
s_lshl_b32 s76, s73, 10
s_lshl_b32 s77, s73, 7
s_add_u32 s77, s77, 4194304
buffer_load_dwordx4 a[200:203], v52, s[16:19], s76 offen
buffer_load_dwordx2 a[204:205], v53, s[16:19], s77 offen
v_accvgpr_write_b32 a206, 0
v_accvgpr_write_b32 a207, 0
s_add_u32 s73, s72, 64
s_lshl_b32 s76, s73, 10
s_lshl_b32 s77, s73, 7
s_add_u32 s77, s77, 4194304
buffer_load_dwordx4 a[208:211], v52, s[16:19], s76 offen
buffer_load_dwordx2 a[212:213], v53, s[16:19], s77 offen
v_accvgpr_write_b32 a214, 0
v_accvgpr_write_b32 a215, 0
s_add_u32 s73, s72, 96
s_lshl_b32 s76, s73, 10
s_lshl_b32 s77, s73, 7
s_add_u32 s77, s77, 4194304
buffer_load_dwordx4 a[216:219], v52, s[16:19], s76 offen
buffer_load_dwordx2 a[220:221], v53, s[16:19], s77 offen
v_accvgpr_write_b32 a222, 0
v_accvgpr_write_b32 a223, 0
s_mul_i32 s78, s69, 18
v_lshl_add_u32 v59, v2, 2, s78
v_lshrrev_b32 v55, 5, v59
v_lshlrev_b32 v55, 10, v55
v_bfe_u32 v58, v59, 3, 2
v_lshl_add_u32 v55, v58, 8, v55
v_and_b32 v58, 7, v59
v_lshl_add_u32 v55, v58, 1, v55
v_lshl_add_u32 v55, v3, 4, v55
v_add_u32 v59, 2, v59
v_lshrrev_b32 v56, 5, v59
v_lshlrev_b32 v56, 10, v56
v_bfe_u32 v58, v59, 3, 2
v_lshl_add_u32 v56, v58, 8, v56
v_and_b32 v58, 7, v59
v_lshl_add_u32 v56, v58, 1, v56
v_lshl_add_u32 v56, v3, 4, v56
v_mov_b32 v59, s78
v_add_u32 v59, 16, v59
v_lshrrev_b32 v57, 5, v59
v_lshlrev_b32 v57, 10, v57
v_bfe_u32 v58, v59, 3, 2
v_lshl_add_u32 v57, v58, 8, v57
v_and_b32 v58, 7, v59
v_lshl_add_u32 v57, v58, 1, v57
v_lshl_add_u32 v57, v3, 4, v57
v_cndmask_b32 v57, v54, v57, s[74:75]
s_mul_i32 s78, s68, 18432
s_add_u32 s78, s78, 8388608
s_mul_i32 s64, s3, 6144
v_add_u32 v60, s64, v52
s_waitcnt vmcnt(28)
v_add_f32 v64, v64, v68
v_add_f32 v72, v72, v76
v_add_f32 v65, v65, v69
v_add_f32 v73, v73, v77
v_add_f32 v66, v66, v70
v_add_f32 v74, v74, v78
v_add_f32 v67, v67, v71
v_add_f32 v75, v75, v79
v_add_f32 v64, v64, v72
v_add_f32 v65, v65, v73
v_add_f32 v66, v66, v74
v_add_f32 v67, v67, v75
ds_write_b128 v60, v[64:67] offset:0
s_waitcnt vmcnt(24)
v_add_f32 v80, v80, v84
v_add_f32 v88, v88, v92
v_add_f32 v81, v81, v85
v_add_f32 v89, v89, v93
v_add_f32 v82, v82, v86
v_add_f32 v90, v90, v94
v_add_f32 v83, v83, v87
v_add_f32 v91, v91, v95
v_add_f32 v80, v80, v88
v_add_f32 v81, v81, v89
v_add_f32 v82, v82, v90
v_add_f32 v83, v83, v91
ds_write_b128 v60, v[80:83] offset:1024
s_waitcnt vmcnt(20)
v_add_f32 v96, v96, v100
v_add_f32 v104, v104, v108
v_add_f32 v97, v97, v101
v_add_f32 v105, v105, v109
v_add_f32 v98, v98, v102
v_add_f32 v106, v106, v110
v_add_f32 v99, v99, v103
v_add_f32 v107, v107, v111
v_add_f32 v96, v96, v104
v_add_f32 v97, v97, v105
v_add_f32 v98, v98, v106
v_add_f32 v99, v99, v107
ds_write_b128 v60, v[96:99] offset:2048
s_waitcnt vmcnt(16)
v_add_f32 v112, v112, v116
v_add_f32 v120, v120, v124
v_add_f32 v113, v113, v117
v_add_f32 v121, v121, v125
v_add_f32 v114, v114, v118
v_add_f32 v122, v122, v126
v_add_f32 v115, v115, v119
v_add_f32 v123, v123, v127
v_add_f32 v112, v112, v120
v_add_f32 v113, v113, v121
v_add_f32 v114, v114, v122
v_add_f32 v115, v115, v123
ds_write_b128 v60, v[112:115] offset:3072
s_waitcnt vmcnt(12)
v_add_f32 v128, v128, v132
v_add_f32 v136, v136, v140
v_add_f32 v129, v129, v133
v_add_f32 v137, v137, v141
v_add_f32 v130, v130, v134
v_add_f32 v138, v138, v142
v_add_f32 v131, v131, v135
v_add_f32 v139, v139, v143
v_add_f32 v128, v128, v136
v_add_f32 v129, v129, v137
v_add_f32 v130, v130, v138
v_add_f32 v131, v131, v139
ds_write_b128 v60, v[128:131] offset:4096
s_waitcnt vmcnt(8)
v_add_f32 v144, v144, v148
v_add_f32 v152, v152, v156
v_add_f32 v145, v145, v149
v_add_f32 v153, v153, v157
v_add_f32 v146, v146, v150
v_add_f32 v154, v154, v158
v_add_f32 v147, v147, v151
v_add_f32 v155, v155, v159
v_add_f32 v144, v144, v152
v_add_f32 v145, v145, v153
v_add_f32 v146, v146, v154
v_add_f32 v147, v147, v155
ds_write_b128 v60, v[144:147] offset:5120
s_waitcnt lgkmcnt(0)
s_barrier
ds_read_b128 v[64:67], v52 offset:0
ds_read_b128 v[68:71], v52 offset:6144
ds_read_b128 v[72:75], v52 offset:12288
ds_read_b128 v[76:79], v52 offset:18432
ds_read_b128 v[80:83], v52 offset:1024
ds_read_b128 v[84:87], v52 offset:7168
ds_read_b128 v[88:91], v52 offset:13312
ds_read_b128 v[92:95], v52 offset:19456
ds_read_b128 v[96:99], v52 offset:2048
ds_read_b128 v[100:103], v52 offset:8192
ds_read_b128 v[104:107], v52 offset:14336
ds_read_b128 v[108:111], v52 offset:20480
ds_read_b128 v[112:115], v52 offset:3072
ds_read_b128 v[116:119], v52 offset:9216
ds_read_b128 v[120:123], v52 offset:15360
ds_read_b128 v[124:127], v52 offset:21504
ds_read_b128 v[128:131], v52 offset:4096
ds_read_b128 v[132:135], v52 offset:10240
ds_read_b128 v[136:139], v52 offset:16384
ds_read_b128 v[140:143], v52 offset:22528
ds_read_b128 v[144:147], v52 offset:5120
ds_read_b128 v[148:151], v52 offset:11264
ds_read_b128 v[152:155], v52 offset:17408
ds_read_b128 v[156:159], v52 offset:23552
s_waitcnt lgkmcnt(0)
v_add_f32 v64, v64, v68
v_add_f32 v72, v72, v76
v_add_f32 v65, v65, v69
v_add_f32 v73, v73, v77
v_add_f32 v66, v66, v70
v_add_f32 v74, v74, v78
v_add_f32 v67, v67, v71
v_add_f32 v75, v75, v79
v_add_f32 v28, v64, v72
v_add_f32 v29, v65, v73
v_add_f32 v30, v66, v74
v_add_f32 v31, v67, v75
v_add_f32 v80, v80, v84
v_add_f32 v88, v88, v92
v_add_f32 v81, v81, v85
v_add_f32 v89, v89, v93
v_add_f32 v82, v82, v86
v_add_f32 v90, v90, v94
v_add_f32 v83, v83, v87
v_add_f32 v91, v91, v95
v_add_f32 v32, v80, v88
v_add_f32 v33, v81, v89
v_add_f32 v34, v82, v90
v_add_f32 v35, v83, v91
v_add_f32 v96, v96, v100
v_add_f32 v104, v104, v108
v_add_f32 v97, v97, v101
v_add_f32 v105, v105, v109
v_add_f32 v98, v98, v102
v_add_f32 v106, v106, v110
v_add_f32 v99, v99, v103
v_add_f32 v107, v107, v111
v_add_f32 v36, v96, v104
v_add_f32 v37, v97, v105
v_add_f32 v38, v98, v106
v_add_f32 v39, v99, v107
v_add_f32 v112, v112, v116
v_add_f32 v120, v120, v124
v_add_f32 v113, v113, v117
v_add_f32 v121, v121, v125
v_add_f32 v114, v114, v118
v_add_f32 v122, v122, v126
v_add_f32 v115, v115, v119
v_add_f32 v123, v123, v127
v_add_f32 v40, v112, v120
v_add_f32 v41, v113, v121
v_add_f32 v42, v114, v122
v_add_f32 v43, v115, v123
v_add_f32 v128, v128, v132
v_add_f32 v136, v136, v140
v_add_f32 v129, v129, v133
v_add_f32 v137, v137, v141
v_add_f32 v130, v130, v134
v_add_f32 v138, v138, v142
v_add_f32 v131, v131, v135
v_add_f32 v139, v139, v143
v_add_f32 v44, v128, v136
v_add_f32 v45, v129, v137
v_add_f32 v46, v130, v138
v_add_f32 v47, v131, v139
v_add_f32 v144, v144, v148
v_add_f32 v152, v152, v156
v_add_f32 v145, v145, v149
v_add_f32 v153, v153, v157
v_add_f32 v146, v146, v150
v_add_f32 v154, v154, v158
v_add_f32 v147, v147, v151
v_add_f32 v155, v155, v159
v_add_f32 v48, v144, v152
v_add_f32 v49, v145, v153
v_add_f32 v50, v146, v154
v_add_f32 v51, v147, v155
v_cvt_pk_bf16_f32 v200, v28, v29
v_cvt_pk_bf16_f32 v201, v30, v31
v_cvt_pk_bf16_f32 v202, v36, v37
v_cvt_pk_bf16_f32 v203, v38, v39
v_cvt_pk_bf16_f32 v208, v44, v45
v_cvt_pk_bf16_f32 v209, v46, v47
v_mov_b32 v210, 0
v_mov_b32 v211, 0
v_cvt_pk_bf16_f32 v204, v32, v33
v_cvt_pk_bf16_f32 v205, v34, v35
v_cvt_pk_bf16_f32 v206, v40, v41
v_cvt_pk_bf16_f32 v207, v42, v43
v_cvt_pk_bf16_f32 v212, v48, v49
v_cvt_pk_bf16_f32 v213, v50, v51
v_mov_b32 v214, 0
v_mov_b32 v215, 0
s_waitcnt vmcnt(0)
v_mfma_f32_16x16x32_bf16 v[64:67], v[200:203], a[192:195], 0
v_mfma_f32_16x16x32_bf16 v[68:71], v[204:207], a[192:195], 0
v_mfma_f32_16x16x32_bf16 v[64:67], v[208:211], a[196:199], v[64:67]
v_mfma_f32_16x16x32_bf16 v[68:71], v[212:215], a[196:199], v[68:71]
v_mfma_f32_16x16x32_bf16 v[80:83], v[200:203], a[200:203], 0
v_mfma_f32_16x16x32_bf16 v[84:87], v[204:207], a[200:203], 0
v_mfma_f32_16x16x32_bf16 v[80:83], v[208:211], a[204:207], v[80:83]
v_mfma_f32_16x16x32_bf16 v[84:87], v[212:215], a[204:207], v[84:87]
v_mfma_f32_16x16x32_bf16 v[96:99], v[200:203], a[208:211], 0
v_mfma_f32_16x16x32_bf16 v[100:103], v[204:207], a[208:211], 0
v_mfma_f32_16x16x32_bf16 v[96:99], v[208:211], a[212:215], v[96:99]
v_mfma_f32_16x16x32_bf16 v[100:103], v[212:215], a[212:215], v[100:103]
v_mfma_f32_16x16x32_bf16 v[112:115], v[200:203], a[216:219], 0
v_mfma_f32_16x16x32_bf16 v[116:119], v[204:207], a[216:219], 0
v_mfma_f32_16x16x32_bf16 v[112:115], v[208:211], a[220:223], v[112:115]
v_mfma_f32_16x16x32_bf16 v[116:119], v[212:215], a[220:223], v[116:119]
v_cndmask_b32 v72, 0, v70, s[74:75]
v_cndmask_b32 v88, 0, v86, s[74:75]
s_nop 2
v_cndmask_b32 v104, 0, v102, s[74:75]
s_nop 2
v_cndmask_b32 v120, 0, v118, s[74:75]
v_mov_b32 v73, 0
v_mov_b32 v89, 0
v_mov_b32 v105, 0
v_mov_b32 v121, 0
v_permlane32_swap_b32 v72, v73
v_permlane32_swap_b32 v88, v89
v_permlane32_swap_b32 v104, v105
v_permlane32_swap_b32 v120, v121
v_add_f32 v72, v72, v73
v_add_f32 v88, v88, v89
v_add_f32 v104, v104, v105
v_add_f32 v120, v120, v121
v_mov_b32 v74, v72
v_mov_b32 v90, v88
v_mov_b32 v106, v104
v_mov_b32 v122, v120
v_permlane16_swap_b32 v72, v74
v_permlane16_swap_b32 v88, v90
v_permlane16_swap_b32 v104, v106
v_permlane16_swap_b32 v120, v122
v_add_f32 v72, v72, v74
v_add_f32 v88, v88, v90
v_add_f32 v104, v104, v106
v_add_f32 v120, v120, v122
v_mov_b32 v73, v72
v_mov_b32 v89, v88
v_mov_b32 v105, v104
v_mov_b32 v121, v120
v_permlane32_swap_b32 v72, v73
v_permlane32_swap_b32 v88, v89
v_permlane32_swap_b32 v104, v105
v_permlane32_swap_b32 v120, v121
v_add_f32 v72, 0x358637bd, v72
v_add_f32 v88, 0x358637bd, v88
v_add_f32 v104, 0x358637bd, v104
v_add_f32 v120, 0x358637bd, v120
v_rcp_f32 v72, v72
v_rcp_f32 v88, v88
v_rcp_f32 v104, v104
v_rcp_f32 v120, v120
v_mul_f32 v64, v64, v72
v_mul_f32 v80, v80, v88
v_mul_f32 v96, v96, v104
v_mul_f32 v112, v112, v120
v_mul_f32 v65, v65, v72
v_mul_f32 v81, v81, v88
v_mul_f32 v97, v97, v104
v_mul_f32 v113, v113, v120
v_mul_f32 v66, v66, v72
v_mul_f32 v82, v82, v88
v_mul_f32 v98, v98, v104
v_mul_f32 v114, v114, v120
v_mul_f32 v67, v67, v72
v_mul_f32 v83, v83, v88
v_mul_f32 v99, v99, v104
v_mul_f32 v115, v115, v120
v_mul_f32 v68, v68, v72
v_mul_f32 v84, v84, v88
v_mul_f32 v100, v100, v104
v_mul_f32 v116, v116, v120
v_mul_f32 v69, v69, v72
v_mul_f32 v85, v85, v88
v_mul_f32 v101, v101, v104
v_mul_f32 v117, v117, v120
v_cvt_pk_bf16_f32 v76, v64, v65
v_cvt_pk_bf16_f32 v92, v80, v81
v_cvt_pk_bf16_f32 v108, v96, v97
v_cvt_pk_bf16_f32 v124, v112, v113
v_cvt_pk_bf16_f32 v77, v66, v67
v_cvt_pk_bf16_f32 v93, v82, v83
v_cvt_pk_bf16_f32 v109, v98, v99
v_cvt_pk_bf16_f32 v125, v114, v115
v_cvt_pk_bf16_f32 v78, v68, v69
v_cvt_pk_bf16_f32 v94, v84, v85
v_cvt_pk_bf16_f32 v110, v100, v101
v_cvt_pk_bf16_f32 v126, v116, v117
s_add_u32 s80, s78, 0
s_add_u32 s81, s78, 18432
s_add_u32 s82, s78, 36864
s_add_u32 s83, s78, 55296
buffer_store_dword v76, v55, s[16:19], s80 offen
buffer_store_dword v92, v55, s[16:19], s81 offen
buffer_store_dword v108, v55, s[16:19], s82 offen
buffer_store_dword v124, v55, s[16:19], s83 offen
buffer_store_dword v77, v56, s[16:19], s80 offen
buffer_store_dword v93, v56, s[16:19], s81 offen
buffer_store_dword v109, v56, s[16:19], s82 offen
buffer_store_dword v125, v56, s[16:19], s83 offen
buffer_store_dword v78, v57, s[16:19], s80 offen
buffer_store_dword v94, v57, s[16:19], s81 offen
buffer_store_dword v110, v57, s[16:19], s82 offen
buffer_store_dword v126, v57, s[16:19], s83 offen
ko_end:
s_endpgm

.globl k2_l0_kernel
.p2align 8
.type k2_l0_kernel,@function
k2_l0_kernel:
s_mov_b32 s92, 0
s_branch k2_body
.globl k2_l1_kernel
.p2align 8
.type k2_l1_kernel,@function
k2_l1_kernel:
s_mov_b32 s92, 1
s_branch k2_body
.p2align 6
k2_body:
s_cmp_ge_u32 s2, 164
s_cbranch_scc1 k2_end
s_load_dwordx16 s[32:47], s[0:1], 0
s_load_dwordx8 s[48:55], s[0:1], 64
v_and_b32 v1, 63, v0
v_lshrrev_b32 v2, 4, v1
v_and_b32 v3, 15, v1
v_lshrrev_b32 v4, 6, v0
s_nop 0
v_readfirstlane_b32 s3, v4
v_lshrrev_b32 v5, 1, v2
v_lshlrev_b32 v5, 8, v5
v_lshl_add_u32 v5, v3, 4, v5
v_and_b32 v6, 1, v2
v_lshl_add_u32 v26, v6, 3, v5
s_waitcnt lgkmcnt(0)
s_mov_b32 s16, s54
s_and_b32 s17, s55, 0xffff
s_mov_b32 s18, 67108864
s_mov_b32 s19, 0x20000
s_cmp_ge_u32 s2, 128
s_cbranch_scc1 k2_cs
s_lshr_b32 s58, s2, 2
s_and_b32 s59, s2, 3
s_mov_b32 s12, s38
s_and_b32 s13, s39, 0xffff
s_mov_b32 s14, 663552
s_mov_b32 s15, 0x20000
s_lshl_b32 s70, s58, 2
s_add_u32 s70, s70, s3
s_mul_i32 s72, s70, 18432
s_add_u32 s73, s72, 8388608
v_lshlrev_b32 v27, 4, v1
s_add_u32 s78, s73, 0
buffer_load_dwordx4 v[32:35], v27, s[16:19], s78 offen offset:0
s_add_u32 s78, s73, 0
buffer_load_dwordx4 v[36:39], v27, s[16:19], s78 offen offset:1024
s_add_u32 s78, s73, 0
buffer_load_dwordx4 v[40:43], v27, s[16:19], s78 offen offset:2048
s_add_u32 s78, s73, 0
buffer_load_dwordx4 v[44:47], v27, s[16:19], s78 offen offset:3072
s_add_u32 s78, s73, 4096
buffer_load_dwordx4 v[48:51], v27, s[16:19], s78 offen offset:0
s_add_u32 s78, s73, 4096
buffer_load_dwordx4 v[52:55], v27, s[16:19], s78 offen offset:1024
s_mul_i32 s65, s59, 288
s_and_b32 s66, s65, 0xffffff80
s_lshl_b32 s67, s59, 1
v_lshrrev_b32 v208, 3, v1
s_mov_b32 s89, 1152
v_mul_lo_u32 v209, v208, s89
v_bfe_u32 v210, v1, 4, 1
v_lshlrev_b32 v210, 1, v210
v_and_b32 v211, 7, v1
v_xor_b32 v211, v211, v210
v_lshl_add_u32 v16, v211, 4, v209
v_xor_b32 v211, 4, v211
v_lshl_add_u32 v17, v211, 4, v209
s_mul_i32 s56, s3, 3072
s_and_b32 s89, s3, 1
s_cmp_eq_u32 s89, 1
s_cselect_b64 s[90:91], -1, 0
v_mov_b32 v208, v16
v_cndmask_b32 v16, v16, v17, s[90:91]
v_cndmask_b32 v17, v17, v208, s[90:91]
s_mul_i32 s61, s3, 27648
s_add_u32 s84, s66, s61
s_add_u32 s85, s66, s61
s_add_u32 s85, s85, 128
s_add_u32 s86, s66, s61
s_add_u32 s86, s86, 256
s_add_u32 s57, s84, 0
s_add_u32 m0, s56, 0
s_nop 0
buffer_load_dwordx4 v16, s[12:15], s57 offen lds
s_add_u32 s57, s85, 0
s_add_u32 m0, s56, 12288
s_nop 0
buffer_load_dwordx4 v16, s[12:15], s57 offen lds
s_add_u32 s57, s86, 0
s_add_u32 m0, s56, 24576
s_nop 0
buffer_load_dwordx4 v16, s[12:15], s57 offen lds
s_add_u32 s57, s84, 9216
s_add_u32 m0, s56, 1024
s_nop 0
buffer_load_dwordx4 v17, s[12:15], s57 offen lds
s_add_u32 s57, s85, 9216
s_add_u32 m0, s56, 13312
s_nop 0
buffer_load_dwordx4 v17, s[12:15], s57 offen lds
s_add_u32 s57, s86, 9216
s_add_u32 m0, s56, 25600
s_nop 0
buffer_load_dwordx4 v17, s[12:15], s57 offen lds
s_add_u32 s57, s84, 18432
s_add_u32 m0, s56, 2048
s_nop 0
buffer_load_dwordx4 v16, s[12:15], s57 offen lds
s_add_u32 s57, s85, 18432
s_add_u32 m0, s56, 14336
s_nop 0
buffer_load_dwordx4 v16, s[12:15], s57 offen lds
s_add_u32 s57, s86, 18432
s_add_u32 m0, s56, 26624
s_nop 0
buffer_load_dwordx4 v16, s[12:15], s57 offen lds
s_add_u32 s57, s84, 110592
s_add_u32 m0, s56, 36864
s_nop 0
buffer_load_dwordx4 v16, s[12:15], s57 offen lds
s_add_u32 s57, s85, 110592
s_add_u32 m0, s56, 49152
s_nop 0
buffer_load_dwordx4 v16, s[12:15], s57 offen lds
s_add_u32 s57, s86, 110592
s_add_u32 m0, s56, 61440
s_nop 0
buffer_load_dwordx4 v16, s[12:15], s57 offen lds
s_add_u32 s57, s84, 119808
s_add_u32 m0, s56, 37888
s_nop 0
buffer_load_dwordx4 v17, s[12:15], s57 offen lds
s_add_u32 s57, s85, 119808
s_add_u32 m0, s56, 50176
s_nop 0
buffer_load_dwordx4 v17, s[12:15], s57 offen lds
s_add_u32 s57, s86, 119808
s_add_u32 m0, s56, 62464
s_nop 0
buffer_load_dwordx4 v17, s[12:15], s57 offen lds
s_add_u32 s57, s84, 129024
s_add_u32 m0, s56, 38912
s_nop 0
buffer_load_dwordx4 v16, s[12:15], s57 offen lds
s_add_u32 s57, s85, 129024
s_add_u32 m0, s56, 51200
s_nop 0
buffer_load_dwordx4 v16, s[12:15], s57 offen lds
s_add_u32 s57, s86, 129024
s_add_u32 m0, s56, 63488
s_nop 0
buffer_load_dwordx4 v16, s[12:15], s57 offen lds
v_lshrrev_b32 v208, 2, v3
v_bfe_u32 v209, v3, 3, 1
v_and_b32 v210, 1, v2
v_lshl_or_b32 v209, v210, 1, v209
v_lshlrev_b32 v209, 1, v209
v_lshl_add_u32 v208, v2, 3, v208
v_bfe_u32 v211, v3, 1, 1
v_add_u32 v211, s67, v211
v_lshrrev_b32 v212, 3, v211
v_and_b32 v211, 7, v211
v_xor_b32 v211, v211, v209
v_lshlrev_b32 v208, 7, v208
v_lshl_add_u32 v208, v211, 4, v208
v_mul_u32_u24 v212, 12288, v212
v_add_u32 v208, v208, v212
v_and_b32 v210, 1, v3
v_lshl_add_u32 v8, v210, 3, v208
v_lshrrev_b32 v208, 2, v3
v_bfe_u32 v209, v3, 3, 1
v_and_b32 v210, 1, v2
v_lshl_or_b32 v209, v210, 1, v209
v_lshlrev_b32 v209, 1, v209
v_lshl_add_u32 v208, v2, 3, v208
v_bfe_u32 v211, v3, 1, 1
v_add_u32 v211, s67, v211
v_add_u32 v211, 2, v211
v_lshrrev_b32 v212, 3, v211
v_and_b32 v211, 7, v211
v_xor_b32 v211, v211, v209
v_lshlrev_b32 v208, 7, v208
v_lshl_add_u32 v208, v211, 4, v208
v_mul_u32_u24 v212, 12288, v212
v_add_u32 v208, v208, v212
v_and_b32 v210, 1, v3
v_lshl_add_u32 v9, v210, 3, v208
v_lshrrev_b32 v208, 2, v3
v_bfe_u32 v209, v3, 3, 1
v_and_b32 v210, 1, v2
v_lshl_or_b32 v209, v210, 1, v209
v_lshlrev_b32 v209, 1, v209
v_lshl_add_u32 v208, v2, 3, v208
v_bfe_u32 v211, v3, 1, 1
v_add_u32 v211, s67, v211
v_add_u32 v211, 4, v211
v_lshrrev_b32 v212, 3, v211
v_and_b32 v211, 7, v211
v_xor_b32 v211, v211, v209
v_lshlrev_b32 v208, 7, v208
v_lshl_add_u32 v208, v211, 4, v208
v_mul_u32_u24 v212, 12288, v212
v_add_u32 v208, v208, v212
v_and_b32 v210, 1, v3
v_lshl_add_u32 v10, v210, 3, v208
v_lshrrev_b32 v208, 2, v3
v_bfe_u32 v209, v3, 3, 1
v_and_b32 v210, 1, v2
v_lshl_or_b32 v209, v210, 1, v209
v_lshlrev_b32 v209, 1, v209
v_lshl_add_u32 v208, v2, 3, v208
v_bfe_u32 v211, v3, 1, 1
v_add_u32 v211, s67, v211
v_add_u32 v211, 6, v211
v_lshrrev_b32 v212, 3, v211
v_and_b32 v211, 7, v211
v_xor_b32 v211, v211, v209
v_lshlrev_b32 v208, 7, v208
v_lshl_add_u32 v208, v211, 4, v208
v_mul_u32_u24 v212, 12288, v212
v_add_u32 v208, v208, v212
v_and_b32 v210, 1, v3
v_lshl_add_u32 v11, v210, 3, v208
s_cmp_eq_u32 s92, 0
s_mov_b32 s74, 14680064
s_cselect_b32 s74, 61865984, s74
s_mov_b32 s75, 17825792
s_cselect_b32 s75, 11534336, s75
s_mul_i32 s76, s59, 4608
s_add_u32 s76, s76, s72
s_add_u32 s74, s74, s76
s_add_u32 s75, s75, s76
s_waitcnt vmcnt(9)
s_barrier
ds_read_b64_tr_b16 v[176:177], v8 offset:0
ds_read_b64_tr_b16 v[178:179], v8 offset:512
ds_read_b64_tr_b16 v[180:181], v9 offset:0
ds_read_b64_tr_b16 v[182:183], v9 offset:512
ds_read_b64_tr_b16 v[184:185], v10 offset:0
ds_read_b64_tr_b16 v[186:187], v10 offset:512
ds_read_b64_tr_b16 v[188:189], v11 offset:0
ds_read_b64_tr_b16 v[190:191], v11 offset:512
ds_read_b64_tr_b16 v[192:193], v8 offset:12288
ds_read_b64_tr_b16 v[194:195], v8 offset:12800
ds_read_b64_tr_b16 v[196:197], v9 offset:12288
ds_read_b64_tr_b16 v[198:199], v9 offset:12800
ds_read_b64_tr_b16 v[200:201], v10 offset:12288
ds_read_b64_tr_b16 v[202:203], v10 offset:12800
s_waitcnt lgkmcnt(12)
v_mfma_f32_16x16x32_bf16 a[0:3], v[176:179], v[32:35], 0
s_add_u32 s78, s73, 4096
buffer_load_dwordx4 v[56:59], v27, s[16:19], s78 offen offset:2048
ds_read_b64_tr_b16 v[204:205], v11 offset:12288
ds_read_b64_tr_b16 v[206:207], v11 offset:12800
s_waitcnt lgkmcnt(12)
v_mfma_f32_16x16x32_bf16 a[4:7], v[180:183], v[32:35], 0
ds_read_b64_tr_b16 v[176:177], v8 offset:24576
ds_read_b64_tr_b16 v[178:179], v8 offset:25088
s_waitcnt lgkmcnt(12)
v_mfma_f32_16x16x32_bf16 a[8:11], v[184:187], v[32:35], 0
s_add_u32 s78, s73, 4096
buffer_load_dwordx4 v[60:63], v27, s[16:19], s78 offen offset:3072
ds_read_b64_tr_b16 v[180:181], v8 offset:4096
ds_read_b64_tr_b16 v[182:183], v8 offset:4608
s_waitcnt lgkmcnt(12)
v_mfma_f32_16x16x32_bf16 a[12:15], v[188:191], v[32:35], 0
ds_read_b64_tr_b16 v[184:185], v9 offset:4096
ds_read_b64_tr_b16 v[186:187], v9 offset:4608
s_waitcnt lgkmcnt(12)
v_mfma_f32_16x16x32_bf16 a[16:19], v[192:195], v[32:35], 0
s_add_u32 s78, s73, 8192
buffer_load_dwordx4 v[64:67], v27, s[16:19], s78 offen offset:0
ds_read_b64_tr_b16 v[188:189], v10 offset:4096
ds_read_b64_tr_b16 v[190:191], v10 offset:4608
s_waitcnt lgkmcnt(12)
v_mfma_f32_16x16x32_bf16 a[20:23], v[196:199], v[32:35], 0
s_add_u32 s57, s84, 221184
s_add_u32 m0, s56, 73728
s_nop 0
buffer_load_dwordx4 v16, s[12:15], s57 offen lds
ds_read_b64_tr_b16 v[192:193], v11 offset:4096
ds_read_b64_tr_b16 v[194:195], v11 offset:4608
s_waitcnt lgkmcnt(12)
v_mfma_f32_16x16x32_bf16 a[24:27], v[200:203], v[32:35], 0
ds_read_b64_tr_b16 v[196:197], v8 offset:16384
ds_read_b64_tr_b16 v[198:199], v8 offset:16896
s_waitcnt lgkmcnt(12)
v_mfma_f32_16x16x32_bf16 a[28:31], v[204:207], v[32:35], 0
s_add_u32 s57, s85, 221184
s_add_u32 m0, s56, 86016
s_nop 0
buffer_load_dwordx4 v16, s[12:15], s57 offen lds
ds_read_b64_tr_b16 v[200:201], v9 offset:16384
ds_read_b64_tr_b16 v[202:203], v9 offset:16896
s_waitcnt lgkmcnt(12)
v_mfma_f32_16x16x32_bf16 a[32:35], v[176:179], v[32:35], 0
ds_read_b64_tr_b16 v[204:205], v10 offset:16384
ds_read_b64_tr_b16 v[206:207], v10 offset:16896
s_waitcnt lgkmcnt(12)
v_mfma_f32_16x16x32_bf16 a[0:3], v[180:183], v[36:39], a[0:3]
s_add_u32 s57, s86, 221184
s_add_u32 m0, s56, 98304
s_nop 0
buffer_load_dwordx4 v16, s[12:15], s57 offen lds
ds_read_b64_tr_b16 v[176:177], v11 offset:16384
ds_read_b64_tr_b16 v[178:179], v11 offset:16896
s_waitcnt lgkmcnt(12)
v_mfma_f32_16x16x32_bf16 a[4:7], v[184:187], v[36:39], a[4:7]
s_add_u32 s57, s84, 230400
s_add_u32 m0, s56, 74752
s_nop 0
buffer_load_dwordx4 v17, s[12:15], s57 offen lds
ds_read_b64_tr_b16 v[180:181], v8 offset:28672
ds_read_b64_tr_b16 v[182:183], v8 offset:29184
s_waitcnt lgkmcnt(12)
v_mfma_f32_16x16x32_bf16 a[8:11], v[188:191], v[36:39], a[8:11]
ds_read_b64_tr_b16 v[184:185], v8 offset:8192
ds_read_b64_tr_b16 v[186:187], v8 offset:8704
s_waitcnt lgkmcnt(12)
v_mfma_f32_16x16x32_bf16 a[12:15], v[192:195], v[36:39], a[12:15]
s_add_u32 s57, s85, 230400
s_add_u32 m0, s56, 87040
s_nop 0
buffer_load_dwordx4 v17, s[12:15], s57 offen lds
ds_read_b64_tr_b16 v[188:189], v9 offset:8192
ds_read_b64_tr_b16 v[190:191], v9 offset:8704
s_waitcnt lgkmcnt(12)
v_mfma_f32_16x16x32_bf16 a[16:19], v[196:199], v[36:39], a[16:19]
ds_read_b64_tr_b16 v[192:193], v10 offset:8192
ds_read_b64_tr_b16 v[194:195], v10 offset:8704
s_waitcnt lgkmcnt(12)
v_mfma_f32_16x16x32_bf16 a[20:23], v[200:203], v[36:39], a[20:23]
s_add_u32 s57, s86, 230400
s_add_u32 m0, s56, 99328
s_nop 0
buffer_load_dwordx4 v17, s[12:15], s57 offen lds
ds_read_b64_tr_b16 v[196:197], v11 offset:8192
ds_read_b64_tr_b16 v[198:199], v11 offset:8704
s_waitcnt lgkmcnt(12)
v_mfma_f32_16x16x32_bf16 a[24:27], v[204:207], v[36:39], a[24:27]
s_add_u32 s57, s84, 239616
s_add_u32 m0, s56, 75776
s_nop 0
buffer_load_dwordx4 v16, s[12:15], s57 offen lds
ds_read_b64_tr_b16 v[200:201], v8 offset:20480
ds_read_b64_tr_b16 v[202:203], v8 offset:20992
s_waitcnt lgkmcnt(12)
v_mfma_f32_16x16x32_bf16 a[28:31], v[176:179], v[36:39], a[28:31]
ds_read_b64_tr_b16 v[204:205], v9 offset:20480
ds_read_b64_tr_b16 v[206:207], v9 offset:20992
s_waitcnt lgkmcnt(12)
v_mfma_f32_16x16x32_bf16 a[32:35], v[180:183], v[36:39], a[32:35]
s_add_u32 s57, s85, 239616
s_add_u32 m0, s56, 88064
s_nop 0
buffer_load_dwordx4 v16, s[12:15], s57 offen lds
ds_read_b64_tr_b16 v[176:177], v10 offset:20480
ds_read_b64_tr_b16 v[178:179], v10 offset:20992
s_waitcnt lgkmcnt(12)
v_mfma_f32_16x16x32_bf16 a[0:3], v[184:187], v[40:43], a[0:3]
ds_read_b64_tr_b16 v[180:181], v11 offset:20480
ds_read_b64_tr_b16 v[182:183], v11 offset:20992
s_waitcnt lgkmcnt(12)
v_mfma_f32_16x16x32_bf16 a[4:7], v[188:191], v[40:43], a[4:7]
s_add_u32 s57, s86, 239616
s_add_u32 m0, s56, 100352
s_nop 0
buffer_load_dwordx4 v16, s[12:15], s57 offen lds
ds_read_b64_tr_b16 v[184:185], v8 offset:32768
ds_read_b64_tr_b16 v[186:187], v8 offset:33280
s_waitcnt lgkmcnt(12)
v_mfma_f32_16x16x32_bf16 a[8:11], v[192:195], v[40:43], a[8:11]
s_waitcnt vmcnt(12)
s_barrier
v_add_u32 v8, 36864, v8
v_add_u32 v9, 36864, v9
v_add_u32 v10, 36864, v10
v_add_u32 v11, 36864, v11
ds_read_b64_tr_b16 v[188:189], v8 offset:0
ds_read_b64_tr_b16 v[190:191], v8 offset:512
s_waitcnt lgkmcnt(12)
v_mfma_f32_16x16x32_bf16 a[12:15], v[196:199], v[40:43], a[12:15]
ds_read_b64_tr_b16 v[192:193], v9 offset:0
ds_read_b64_tr_b16 v[194:195], v9 offset:512
s_waitcnt lgkmcnt(12)
v_mfma_f32_16x16x32_bf16 a[16:19], v[200:203], v[40:43], a[16:19]
ds_read_b64_tr_b16 v[196:197], v10 offset:0
ds_read_b64_tr_b16 v[198:199], v10 offset:512
s_waitcnt lgkmcnt(12)
v_mfma_f32_16x16x32_bf16 a[20:23], v[204:207], v[40:43], a[20:23]
ds_read_b64_tr_b16 v[200:201], v11 offset:0
ds_read_b64_tr_b16 v[202:203], v11 offset:512
s_waitcnt lgkmcnt(12)
v_mfma_f32_16x16x32_bf16 a[24:27], v[176:179], v[40:43], a[24:27]
ds_read_b64_tr_b16 v[204:205], v8 offset:12288
ds_read_b64_tr_b16 v[206:207], v8 offset:12800
s_waitcnt lgkmcnt(12)
v_mfma_f32_16x16x32_bf16 a[28:31], v[180:183], v[40:43], a[28:31]
ds_read_b64_tr_b16 v[176:177], v9 offset:12288
ds_read_b64_tr_b16 v[178:179], v9 offset:12800
s_waitcnt lgkmcnt(12)
v_mfma_f32_16x16x32_bf16 a[32:35], v[184:187], v[40:43], a[32:35]
ds_read_b64_tr_b16 v[180:181], v10 offset:12288
ds_read_b64_tr_b16 v[182:183], v10 offset:12800
s_waitcnt lgkmcnt(12)
v_mfma_f32_16x16x32_bf16 a[0:3], v[188:191], v[44:47], a[0:3]
s_add_u32 s78, s73, 8192
buffer_load_dwordx4 v[68:71], v27, s[16:19], s78 offen offset:1024
ds_read_b64_tr_b16 v[184:185], v11 offset:12288
ds_read_b64_tr_b16 v[186:187], v11 offset:12800
s_waitcnt lgkmcnt(12)
v_mfma_f32_16x16x32_bf16 a[4:7], v[192:195], v[44:47], a[4:7]
ds_read_b64_tr_b16 v[188:189], v8 offset:24576
ds_read_b64_tr_b16 v[190:191], v8 offset:25088
s_waitcnt lgkmcnt(12)
v_mfma_f32_16x16x32_bf16 a[8:11], v[196:199], v[44:47], a[8:11]
s_add_u32 s78, s73, 8192
buffer_load_dwordx4 v[72:75], v27, s[16:19], s78 offen offset:2048
ds_read_b64_tr_b16 v[192:193], v8 offset:4096
ds_read_b64_tr_b16 v[194:195], v8 offset:4608
s_waitcnt lgkmcnt(12)
v_mfma_f32_16x16x32_bf16 a[12:15], v[200:203], v[44:47], a[12:15]
s_add_u32 s77, s74, 0
buffer_load_dwordx2 v[212:213], v26, s[16:19], s77 offen offset:0
ds_read_b64_tr_b16 v[196:197], v9 offset:4096
ds_read_b64_tr_b16 v[198:199], v9 offset:4608
s_waitcnt lgkmcnt(12)
v_mfma_f32_16x16x32_bf16 a[16:19], v[204:207], v[44:47], a[16:19]
s_add_u32 s78, s73, 8192
buffer_load_dwordx4 v[76:79], v27, s[16:19], s78 offen offset:3072
ds_read_b64_tr_b16 v[200:201], v10 offset:4096
ds_read_b64_tr_b16 v[202:203], v10 offset:4608
s_waitcnt lgkmcnt(12)
v_mfma_f32_16x16x32_bf16 a[20:23], v[176:179], v[44:47], a[20:23]
s_add_u32 s57, s84, 331776
s_add_u32 m0, s56, 110592
s_nop 0
buffer_load_dwordx4 v16, s[12:15], s57 offen lds
ds_read_b64_tr_b16 v[204:205], v11 offset:4096
ds_read_b64_tr_b16 v[206:207], v11 offset:4608
s_waitcnt lgkmcnt(12)
v_mfma_f32_16x16x32_bf16 a[24:27], v[180:183], v[44:47], a[24:27]
ds_read_b64_tr_b16 v[176:177], v8 offset:16384
ds_read_b64_tr_b16 v[178:179], v8 offset:16896
s_waitcnt lgkmcnt(12)
v_mfma_f32_16x16x32_bf16 a[28:31], v[184:187], v[44:47], a[28:31]
s_add_u32 s57, s85, 331776
s_add_u32 m0, s56, 122880
s_nop 0
buffer_load_dwordx4 v16, s[12:15], s57 offen lds
s_add_u32 s77, s74, 0
buffer_load_dwordx2 v[214:215], v26, s[16:19], s77 offen offset:512
ds_read_b64_tr_b16 v[180:181], v9 offset:16384
ds_read_b64_tr_b16 v[182:183], v9 offset:16896
s_waitcnt lgkmcnt(12)
v_mfma_f32_16x16x32_bf16 a[32:35], v[188:191], v[44:47], a[32:35]
ds_read_b64_tr_b16 v[184:185], v10 offset:16384
ds_read_b64_tr_b16 v[186:187], v10 offset:16896
s_waitcnt lgkmcnt(12)
v_mfma_f32_16x16x32_bf16 a[0:3], v[192:195], v[48:51], a[0:3]
s_add_u32 s57, s86, 331776
s_add_u32 m0, s56, 135168
s_nop 0
buffer_load_dwordx4 v16, s[12:15], s57 offen lds
ds_read_b64_tr_b16 v[188:189], v11 offset:16384
ds_read_b64_tr_b16 v[190:191], v11 offset:16896
s_waitcnt lgkmcnt(12)
v_mfma_f32_16x16x32_bf16 a[4:7], v[196:199], v[48:51], a[4:7]
s_add_u32 s57, s84, 340992
s_add_u32 m0, s56, 111616
s_nop 0
buffer_load_dwordx4 v17, s[12:15], s57 offen lds
ds_read_b64_tr_b16 v[192:193], v8 offset:28672
ds_read_b64_tr_b16 v[194:195], v8 offset:29184
s_waitcnt lgkmcnt(12)
v_mfma_f32_16x16x32_bf16 a[8:11], v[200:203], v[48:51], a[8:11]
s_add_u32 s77, s74, 0
buffer_load_dwordx2 v[216:217], v26, s[16:19], s77 offen offset:1024
ds_read_b64_tr_b16 v[196:197], v8 offset:8192
ds_read_b64_tr_b16 v[198:199], v8 offset:8704
s_waitcnt lgkmcnt(12)
v_mfma_f32_16x16x32_bf16 a[12:15], v[204:207], v[48:51], a[12:15]
s_add_u32 s57, s85, 340992
s_add_u32 m0, s56, 123904
s_nop 0
buffer_load_dwordx4 v17, s[12:15], s57 offen lds
ds_read_b64_tr_b16 v[200:201], v9 offset:8192
ds_read_b64_tr_b16 v[202:203], v9 offset:8704
s_waitcnt lgkmcnt(12)
v_mfma_f32_16x16x32_bf16 a[16:19], v[176:179], v[48:51], a[16:19]
ds_read_b64_tr_b16 v[204:205], v10 offset:8192
ds_read_b64_tr_b16 v[206:207], v10 offset:8704
s_waitcnt lgkmcnt(12)
v_mfma_f32_16x16x32_bf16 a[20:23], v[180:183], v[48:51], a[20:23]
s_add_u32 s57, s86, 340992
s_add_u32 m0, s56, 136192
s_nop 0
buffer_load_dwordx4 v17, s[12:15], s57 offen lds
ds_read_b64_tr_b16 v[176:177], v11 offset:8192
ds_read_b64_tr_b16 v[178:179], v11 offset:8704
s_waitcnt lgkmcnt(12)
v_mfma_f32_16x16x32_bf16 a[24:27], v[184:187], v[48:51], a[24:27]
s_add_u32 s57, s84, 350208
s_add_u32 m0, s56, 112640
s_nop 0
buffer_load_dwordx4 v16, s[12:15], s57 offen lds
s_add_u32 s77, s74, 0
buffer_load_dwordx2 v[218:219], v26, s[16:19], s77 offen offset:1536
ds_read_b64_tr_b16 v[180:181], v8 offset:20480
ds_read_b64_tr_b16 v[182:183], v8 offset:20992
s_waitcnt lgkmcnt(12)
v_mfma_f32_16x16x32_bf16 a[28:31], v[188:191], v[48:51], a[28:31]
ds_read_b64_tr_b16 v[184:185], v9 offset:20480
ds_read_b64_tr_b16 v[186:187], v9 offset:20992
s_waitcnt lgkmcnt(12)
v_mfma_f32_16x16x32_bf16 a[32:35], v[192:195], v[48:51], a[32:35]
s_add_u32 s57, s85, 350208
s_add_u32 m0, s56, 124928
s_nop 0
buffer_load_dwordx4 v16, s[12:15], s57 offen lds
ds_read_b64_tr_b16 v[188:189], v10 offset:20480
ds_read_b64_tr_b16 v[190:191], v10 offset:20992
s_waitcnt lgkmcnt(12)
v_mfma_f32_16x16x32_bf16 a[0:3], v[196:199], v[52:55], a[0:3]
ds_read_b64_tr_b16 v[192:193], v11 offset:20480
ds_read_b64_tr_b16 v[194:195], v11 offset:20992
s_waitcnt lgkmcnt(12)
v_mfma_f32_16x16x32_bf16 a[4:7], v[200:203], v[52:55], a[4:7]
s_add_u32 s57, s86, 350208
s_add_u32 m0, s56, 137216
s_nop 0
buffer_load_dwordx4 v16, s[12:15], s57 offen lds
s_add_u32 s77, s74, 0
buffer_load_dwordx2 v[220:221], v26, s[16:19], s77 offen offset:2048
ds_read_b64_tr_b16 v[196:197], v8 offset:32768
ds_read_b64_tr_b16 v[198:199], v8 offset:33280
s_waitcnt lgkmcnt(12)
v_mfma_f32_16x16x32_bf16 a[8:11], v[204:207], v[52:55], a[8:11]
s_waitcnt vmcnt(17)
s_barrier
v_add_u32 v8, 36864, v8
v_add_u32 v9, 36864, v9
v_add_u32 v10, 36864, v10
v_add_u32 v11, 36864, v11
ds_read_b64_tr_b16 v[200:201], v8 offset:0
ds_read_b64_tr_b16 v[202:203], v8 offset:512
s_waitcnt lgkmcnt(12)
v_mfma_f32_16x16x32_bf16 a[12:15], v[176:179], v[52:55], a[12:15]
ds_read_b64_tr_b16 v[204:205], v9 offset:0
ds_read_b64_tr_b16 v[206:207], v9 offset:512
s_waitcnt lgkmcnt(12)
v_mfma_f32_16x16x32_bf16 a[16:19], v[180:183], v[52:55], a[16:19]
ds_read_b64_tr_b16 v[176:177], v10 offset:0
ds_read_b64_tr_b16 v[178:179], v10 offset:512
s_waitcnt lgkmcnt(12)
v_mfma_f32_16x16x32_bf16 a[20:23], v[184:187], v[52:55], a[20:23]
s_add_u32 s77, s74, 0
buffer_load_dwordx2 v[222:223], v26, s[16:19], s77 offen offset:2560
ds_read_b64_tr_b16 v[180:181], v11 offset:0
ds_read_b64_tr_b16 v[182:183], v11 offset:512
s_waitcnt lgkmcnt(12)
v_mfma_f32_16x16x32_bf16 a[24:27], v[188:191], v[52:55], a[24:27]
ds_read_b64_tr_b16 v[184:185], v8 offset:12288
ds_read_b64_tr_b16 v[186:187], v8 offset:12800
s_waitcnt lgkmcnt(12)
v_mfma_f32_16x16x32_bf16 a[28:31], v[192:195], v[52:55], a[28:31]
ds_read_b64_tr_b16 v[188:189], v9 offset:12288
ds_read_b64_tr_b16 v[190:191], v9 offset:12800
s_waitcnt lgkmcnt(12)
v_mfma_f32_16x16x32_bf16 a[32:35], v[196:199], v[52:55], a[32:35]
ds_read_b64_tr_b16 v[192:193], v10 offset:12288
ds_read_b64_tr_b16 v[194:195], v10 offset:12800
s_waitcnt lgkmcnt(12)
v_mfma_f32_16x16x32_bf16 a[0:3], v[200:203], v[56:59], a[0:3]
s_add_u32 s78, s73, 12288
buffer_load_dwordx4 v[80:83], v27, s[16:19], s78 offen offset:0
s_add_u32 s77, s74, 0
buffer_load_dwordx2 v[224:225], v26, s[16:19], s77 offen offset:3072
ds_read_b64_tr_b16 v[196:197], v11 offset:12288
ds_read_b64_tr_b16 v[198:199], v11 offset:12800
s_waitcnt lgkmcnt(12)
v_mfma_f32_16x16x32_bf16 a[4:7], v[204:207], v[56:59], a[4:7]
ds_read_b64_tr_b16 v[200:201], v8 offset:24576
ds_read_b64_tr_b16 v[202:203], v8 offset:25088
s_waitcnt lgkmcnt(12)
v_mfma_f32_16x16x32_bf16 a[8:11], v[176:179], v[56:59], a[8:11]
s_add_u32 s78, s73, 12288
buffer_load_dwordx4 v[84:87], v27, s[16:19], s78 offen offset:1024
ds_read_b64_tr_b16 v[204:205], v8 offset:4096
ds_read_b64_tr_b16 v[206:207], v8 offset:4608
s_waitcnt lgkmcnt(12)
v_mfma_f32_16x16x32_bf16 a[12:15], v[180:183], v[56:59], a[12:15]
ds_read_b64_tr_b16 v[176:177], v9 offset:4096
ds_read_b64_tr_b16 v[178:179], v9 offset:4608
s_waitcnt lgkmcnt(12)
v_mfma_f32_16x16x32_bf16 a[16:19], v[184:187], v[56:59], a[16:19]
s_add_u32 s78, s73, 12288
buffer_load_dwordx4 v[88:91], v27, s[16:19], s78 offen offset:2048
s_add_u32 s77, s74, 0
buffer_load_dwordx2 v[226:227], v26, s[16:19], s77 offen offset:3584
ds_read_b64_tr_b16 v[180:181], v10 offset:4096
ds_read_b64_tr_b16 v[182:183], v10 offset:4608
s_waitcnt lgkmcnt(12)
v_mfma_f32_16x16x32_bf16 a[20:23], v[188:191], v[56:59], a[20:23]
s_add_u32 s57, s84, 442368
s_add_u32 m0, s56, 0
s_nop 0
buffer_load_dwordx4 v16, s[12:15], s57 offen lds
ds_read_b64_tr_b16 v[184:185], v11 offset:4096
ds_read_b64_tr_b16 v[186:187], v11 offset:4608
s_waitcnt lgkmcnt(12)
v_mfma_f32_16x16x32_bf16 a[24:27], v[192:195], v[56:59], a[24:27]
ds_read_b64_tr_b16 v[188:189], v8 offset:16384
ds_read_b64_tr_b16 v[190:191], v8 offset:16896
s_waitcnt lgkmcnt(12)
v_mfma_f32_16x16x32_bf16 a[28:31], v[196:199], v[56:59], a[28:31]
s_add_u32 s57, s85, 442368
s_add_u32 m0, s56, 12288
s_nop 0
buffer_load_dwordx4 v16, s[12:15], s57 offen lds
ds_read_b64_tr_b16 v[192:193], v9 offset:16384
ds_read_b64_tr_b16 v[194:195], v9 offset:16896
s_waitcnt lgkmcnt(12)
v_mfma_f32_16x16x32_bf16 a[32:35], v[200:203], v[56:59], a[32:35]
s_add_u32 s77, s74, 4096
buffer_load_dwordx2 v[228:229], v26, s[16:19], s77 offen offset:0
ds_read_b64_tr_b16 v[196:197], v10 offset:16384
ds_read_b64_tr_b16 v[198:199], v10 offset:16896
s_waitcnt lgkmcnt(12)
v_mfma_f32_16x16x32_bf16 a[0:3], v[204:207], v[60:63], a[0:3]
s_add_u32 s57, s86, 442368
s_add_u32 m0, s56, 24576
s_nop 0
buffer_load_dwordx4 v16, s[12:15], s57 offen lds
ds_read_b64_tr_b16 v[200:201], v11 offset:16384
ds_read_b64_tr_b16 v[202:203], v11 offset:16896
s_waitcnt lgkmcnt(12)
v_mfma_f32_16x16x32_bf16 a[4:7], v[176:179], v[60:63], a[4:7]
s_add_u32 s57, s84, 451584
s_add_u32 m0, s56, 1024
s_nop 0
buffer_load_dwordx4 v17, s[12:15], s57 offen lds
ds_read_b64_tr_b16 v[204:205], v8 offset:28672
ds_read_b64_tr_b16 v[206:207], v8 offset:29184
s_waitcnt lgkmcnt(12)
v_mfma_f32_16x16x32_bf16 a[8:11], v[180:183], v[60:63], a[8:11]
ds_read_b64_tr_b16 v[176:177], v8 offset:8192
ds_read_b64_tr_b16 v[178:179], v8 offset:8704
s_waitcnt lgkmcnt(12)
v_mfma_f32_16x16x32_bf16 a[12:15], v[184:187], v[60:63], a[12:15]
s_add_u32 s57, s85, 451584
s_add_u32 m0, s56, 13312
s_nop 0
buffer_load_dwordx4 v17, s[12:15], s57 offen lds
ds_read_b64_tr_b16 v[180:181], v9 offset:8192
ds_read_b64_tr_b16 v[182:183], v9 offset:8704
s_waitcnt lgkmcnt(12)
v_mfma_f32_16x16x32_bf16 a[16:19], v[188:191], v[60:63], a[16:19]
ds_read_b64_tr_b16 v[184:185], v10 offset:8192
ds_read_b64_tr_b16 v[186:187], v10 offset:8704
s_waitcnt lgkmcnt(12)
v_mfma_f32_16x16x32_bf16 a[20:23], v[192:195], v[60:63], a[20:23]
s_add_u32 s57, s86, 451584
s_add_u32 m0, s56, 25600
s_nop 0
buffer_load_dwordx4 v17, s[12:15], s57 offen lds
ds_read_b64_tr_b16 v[188:189], v11 offset:8192
ds_read_b64_tr_b16 v[190:191], v11 offset:8704
s_waitcnt lgkmcnt(12)
v_mfma_f32_16x16x32_bf16 a[24:27], v[196:199], v[60:63], a[24:27]
s_add_u32 s57, s84, 460800
s_add_u32 m0, s56, 2048
s_nop 0
buffer_load_dwordx4 v16, s[12:15], s57 offen lds
ds_read_b64_tr_b16 v[192:193], v8 offset:20480
ds_read_b64_tr_b16 v[194:195], v8 offset:20992
s_waitcnt lgkmcnt(12)
v_mfma_f32_16x16x32_bf16 a[28:31], v[200:203], v[60:63], a[28:31]
ds_read_b64_tr_b16 v[196:197], v9 offset:20480
ds_read_b64_tr_b16 v[198:199], v9 offset:20992
s_waitcnt lgkmcnt(12)
v_mfma_f32_16x16x32_bf16 a[32:35], v[204:207], v[60:63], a[32:35]
s_add_u32 s57, s85, 460800
s_add_u32 m0, s56, 14336
s_nop 0
buffer_load_dwordx4 v16, s[12:15], s57 offen lds
ds_read_b64_tr_b16 v[200:201], v10 offset:20480
ds_read_b64_tr_b16 v[202:203], v10 offset:20992
s_waitcnt lgkmcnt(12)
v_mfma_f32_16x16x32_bf16 a[0:3], v[176:179], v[64:67], a[0:3]
ds_read_b64_tr_b16 v[204:205], v11 offset:20480
ds_read_b64_tr_b16 v[206:207], v11 offset:20992
s_waitcnt lgkmcnt(12)
v_mfma_f32_16x16x32_bf16 a[4:7], v[180:183], v[64:67], a[4:7]
s_add_u32 s57, s86, 460800
s_add_u32 m0, s56, 26624
s_nop 0
buffer_load_dwordx4 v16, s[12:15], s57 offen lds
ds_read_b64_tr_b16 v[176:177], v8 offset:32768
ds_read_b64_tr_b16 v[178:179], v8 offset:33280
s_waitcnt lgkmcnt(12)
v_mfma_f32_16x16x32_bf16 a[8:11], v[184:187], v[64:67], a[8:11]
s_waitcnt vmcnt(17)
s_barrier
v_add_u32 v8, 36864, v8
v_add_u32 v9, 36864, v9
v_add_u32 v10, 36864, v10
v_add_u32 v11, 36864, v11
ds_read_b64_tr_b16 v[180:181], v8 offset:0
ds_read_b64_tr_b16 v[182:183], v8 offset:512
s_waitcnt lgkmcnt(12)
v_mfma_f32_16x16x32_bf16 a[12:15], v[188:191], v[64:67], a[12:15]
ds_read_b64_tr_b16 v[184:185], v9 offset:0
ds_read_b64_tr_b16 v[186:187], v9 offset:512
s_waitcnt lgkmcnt(12)
v_mfma_f32_16x16x32_bf16 a[16:19], v[192:195], v[64:67], a[16:19]
ds_read_b64_tr_b16 v[188:189], v10 offset:0
ds_read_b64_tr_b16 v[190:191], v10 offset:512
s_waitcnt lgkmcnt(12)
v_mfma_f32_16x16x32_bf16 a[20:23], v[196:199], v[64:67], a[20:23]
ds_read_b64_tr_b16 v[192:193], v11 offset:0
ds_read_b64_tr_b16 v[194:195], v11 offset:512
s_waitcnt lgkmcnt(12)
v_mfma_f32_16x16x32_bf16 a[24:27], v[200:203], v[64:67], a[24:27]
ds_read_b64_tr_b16 v[196:197], v8 offset:12288
ds_read_b64_tr_b16 v[198:199], v8 offset:12800
s_waitcnt lgkmcnt(12)
v_mfma_f32_16x16x32_bf16 a[28:31], v[204:207], v[64:67], a[28:31]
ds_read_b64_tr_b16 v[200:201], v9 offset:12288
ds_read_b64_tr_b16 v[202:203], v9 offset:12800
s_waitcnt lgkmcnt(12)
v_mfma_f32_16x16x32_bf16 a[32:35], v[176:179], v[64:67], a[32:35]
ds_read_b64_tr_b16 v[204:205], v10 offset:12288
ds_read_b64_tr_b16 v[206:207], v10 offset:12800
s_waitcnt lgkmcnt(12)
v_mfma_f32_16x16x32_bf16 a[0:3], v[180:183], v[68:71], a[0:3]
s_add_u32 s78, s73, 12288
buffer_load_dwordx4 v[92:95], v27, s[16:19], s78 offen offset:3072
ds_read_b64_tr_b16 v[176:177], v11 offset:12288
ds_read_b64_tr_b16 v[178:179], v11 offset:12800
s_waitcnt lgkmcnt(12)
v_mfma_f32_16x16x32_bf16 a[4:7], v[184:187], v[68:71], a[4:7]
ds_read_b64_tr_b16 v[180:181], v8 offset:24576
ds_read_b64_tr_b16 v[182:183], v8 offset:25088
s_waitcnt lgkmcnt(12)
v_mfma_f32_16x16x32_bf16 a[8:11], v[188:191], v[68:71], a[8:11]
s_add_u32 s78, s73, 16384
buffer_load_dwordx4 v[96:99], v27, s[16:19], s78 offen offset:0
ds_read_b64_tr_b16 v[184:185], v8 offset:4096
ds_read_b64_tr_b16 v[186:187], v8 offset:4608
s_waitcnt lgkmcnt(12)
v_mfma_f32_16x16x32_bf16 a[12:15], v[192:195], v[68:71], a[12:15]
ds_read_b64_tr_b16 v[188:189], v9 offset:4096
ds_read_b64_tr_b16 v[190:191], v9 offset:4608
s_waitcnt lgkmcnt(12)
v_mfma_f32_16x16x32_bf16 a[16:19], v[196:199], v[68:71], a[16:19]
s_add_u32 s78, s73, 16384
buffer_load_dwordx4 v[100:103], v27, s[16:19], s78 offen offset:1024
ds_read_b64_tr_b16 v[192:193], v10 offset:4096
ds_read_b64_tr_b16 v[194:195], v10 offset:4608
s_waitcnt lgkmcnt(12)
v_mfma_f32_16x16x32_bf16 a[20:23], v[200:203], v[68:71], a[20:23]
s_add_u32 s57, s84, 552960
s_add_u32 m0, s56, 36864
s_nop 0
buffer_load_dwordx4 v16, s[12:15], s57 offen lds
ds_read_b64_tr_b16 v[196:197], v11 offset:4096
ds_read_b64_tr_b16 v[198:199], v11 offset:4608
s_waitcnt lgkmcnt(12)
v_mfma_f32_16x16x32_bf16 a[24:27], v[204:207], v[68:71], a[24:27]
ds_read_b64_tr_b16 v[200:201], v8 offset:16384
ds_read_b64_tr_b16 v[202:203], v8 offset:16896
s_waitcnt lgkmcnt(12)
v_mfma_f32_16x16x32_bf16 a[28:31], v[176:179], v[68:71], a[28:31]
s_add_u32 s57, s85, 552960
s_add_u32 m0, s56, 49152
s_nop 0
buffer_load_dwordx4 v16, s[12:15], s57 offen lds
ds_read_b64_tr_b16 v[204:205], v9 offset:16384
ds_read_b64_tr_b16 v[206:207], v9 offset:16896
s_waitcnt lgkmcnt(12)
v_mfma_f32_16x16x32_bf16 a[32:35], v[180:183], v[68:71], a[32:35]
ds_read_b64_tr_b16 v[176:177], v10 offset:16384
ds_read_b64_tr_b16 v[178:179], v10 offset:16896
s_waitcnt lgkmcnt(12)
v_mfma_f32_16x16x32_bf16 a[0:3], v[184:187], v[72:75], a[0:3]
s_add_u32 s57, s86, 552960
s_add_u32 m0, s56, 61440
s_nop 0
buffer_load_dwordx4 v16, s[12:15], s57 offen lds
ds_read_b64_tr_b16 v[180:181], v11 offset:16384
ds_read_b64_tr_b16 v[182:183], v11 offset:16896
s_waitcnt lgkmcnt(12)
v_mfma_f32_16x16x32_bf16 a[4:7], v[188:191], v[72:75], a[4:7]
s_add_u32 s57, s84, 562176
s_add_u32 m0, s56, 37888
s_nop 0
buffer_load_dwordx4 v17, s[12:15], s57 offen lds
ds_read_b64_tr_b16 v[184:185], v8 offset:28672
ds_read_b64_tr_b16 v[186:187], v8 offset:29184
s_waitcnt lgkmcnt(12)
v_mfma_f32_16x16x32_bf16 a[8:11], v[192:195], v[72:75], a[8:11]
ds_read_b64_tr_b16 v[188:189], v8 offset:8192
ds_read_b64_tr_b16 v[190:191], v8 offset:8704
s_waitcnt lgkmcnt(12)
v_mfma_f32_16x16x32_bf16 a[12:15], v[196:199], v[72:75], a[12:15]
s_add_u32 s57, s85, 562176
s_add_u32 m0, s56, 50176
s_nop 0
buffer_load_dwordx4 v17, s[12:15], s57 offen lds
ds_read_b64_tr_b16 v[192:193], v9 offset:8192
ds_read_b64_tr_b16 v[194:195], v9 offset:8704
s_waitcnt lgkmcnt(12)
v_mfma_f32_16x16x32_bf16 a[16:19], v[200:203], v[72:75], a[16:19]
ds_read_b64_tr_b16 v[196:197], v10 offset:8192
ds_read_b64_tr_b16 v[198:199], v10 offset:8704
s_waitcnt lgkmcnt(12)
v_mfma_f32_16x16x32_bf16 a[20:23], v[204:207], v[72:75], a[20:23]
s_add_u32 s57, s86, 562176
s_add_u32 m0, s56, 62464
s_nop 0
buffer_load_dwordx4 v17, s[12:15], s57 offen lds
ds_read_b64_tr_b16 v[200:201], v11 offset:8192
ds_read_b64_tr_b16 v[202:203], v11 offset:8704
s_waitcnt lgkmcnt(12)
v_mfma_f32_16x16x32_bf16 a[24:27], v[176:179], v[72:75], a[24:27]
s_add_u32 s57, s84, 571392
s_add_u32 m0, s56, 38912
s_nop 0
buffer_load_dwordx4 v16, s[12:15], s57 offen lds
ds_read_b64_tr_b16 v[204:205], v8 offset:20480
ds_read_b64_tr_b16 v[206:207], v8 offset:20992
s_waitcnt lgkmcnt(12)
v_mfma_f32_16x16x32_bf16 a[28:31], v[180:183], v[72:75], a[28:31]
ds_read_b64_tr_b16 v[176:177], v9 offset:20480
ds_read_b64_tr_b16 v[178:179], v9 offset:20992
s_waitcnt lgkmcnt(12)
v_mfma_f32_16x16x32_bf16 a[32:35], v[184:187], v[72:75], a[32:35]
s_add_u32 s57, s85, 571392
s_add_u32 m0, s56, 51200
s_nop 0
buffer_load_dwordx4 v16, s[12:15], s57 offen lds
ds_read_b64_tr_b16 v[180:181], v10 offset:20480
ds_read_b64_tr_b16 v[182:183], v10 offset:20992
s_waitcnt lgkmcnt(12)
v_mfma_f32_16x16x32_bf16 a[0:3], v[188:191], v[76:79], a[0:3]
ds_read_b64_tr_b16 v[184:185], v11 offset:20480
ds_read_b64_tr_b16 v[186:187], v11 offset:20992
s_waitcnt lgkmcnt(12)
v_mfma_f32_16x16x32_bf16 a[4:7], v[192:195], v[76:79], a[4:7]
s_add_u32 s57, s86, 571392
s_add_u32 m0, s56, 63488
s_nop 0
buffer_load_dwordx4 v16, s[12:15], s57 offen lds
ds_read_b64_tr_b16 v[188:189], v8 offset:32768
ds_read_b64_tr_b16 v[190:191], v8 offset:33280
s_waitcnt lgkmcnt(12)
v_mfma_f32_16x16x32_bf16 a[8:11], v[196:199], v[76:79], a[8:11]
s_waitcnt vmcnt(12)
s_barrier
v_subrev_u32 v8, 110592, v8
v_subrev_u32 v9, 110592, v9
v_subrev_u32 v10, 110592, v10
v_subrev_u32 v11, 110592, v11
ds_read_b64_tr_b16 v[192:193], v8 offset:0
ds_read_b64_tr_b16 v[194:195], v8 offset:512
s_waitcnt lgkmcnt(12)
v_mfma_f32_16x16x32_bf16 a[12:15], v[200:203], v[76:79], a[12:15]
ds_read_b64_tr_b16 v[196:197], v9 offset:0
ds_read_b64_tr_b16 v[198:199], v9 offset:512
s_waitcnt lgkmcnt(12)
v_mfma_f32_16x16x32_bf16 a[16:19], v[204:207], v[76:79], a[16:19]
ds_read_b64_tr_b16 v[200:201], v10 offset:0
ds_read_b64_tr_b16 v[202:203], v10 offset:512
s_waitcnt lgkmcnt(12)
v_mfma_f32_16x16x32_bf16 a[20:23], v[176:179], v[76:79], a[20:23]
ds_read_b64_tr_b16 v[204:205], v11 offset:0
ds_read_b64_tr_b16 v[206:207], v11 offset:512
s_waitcnt lgkmcnt(12)
v_mfma_f32_16x16x32_bf16 a[24:27], v[180:183], v[76:79], a[24:27]
ds_read_b64_tr_b16 v[176:177], v8 offset:12288
ds_read_b64_tr_b16 v[178:179], v8 offset:12800
s_waitcnt lgkmcnt(12)
v_mfma_f32_16x16x32_bf16 a[28:31], v[184:187], v[76:79], a[28:31]
ds_read_b64_tr_b16 v[180:181], v9 offset:12288
ds_read_b64_tr_b16 v[182:183], v9 offset:12800
s_waitcnt lgkmcnt(12)
v_mfma_f32_16x16x32_bf16 a[32:35], v[188:191], v[76:79], a[32:35]
ds_read_b64_tr_b16 v[184:185], v10 offset:12288
ds_read_b64_tr_b16 v[186:187], v10 offset:12800
s_waitcnt lgkmcnt(12)
v_mfma_f32_16x16x32_bf16 a[0:3], v[192:195], v[80:83], a[0:3]
ds_read_b64_tr_b16 v[188:189], v11 offset:12288
ds_read_b64_tr_b16 v[190:191], v11 offset:12800
s_waitcnt lgkmcnt(12)
v_mfma_f32_16x16x32_bf16 a[4:7], v[196:199], v[80:83], a[4:7]
ds_read_b64_tr_b16 v[192:193], v8 offset:24576
ds_read_b64_tr_b16 v[194:195], v8 offset:25088
s_waitcnt lgkmcnt(12)
v_mfma_f32_16x16x32_bf16 a[8:11], v[200:203], v[80:83], a[8:11]
ds_read_b64_tr_b16 v[196:197], v8 offset:4096
ds_read_b64_tr_b16 v[198:199], v8 offset:4608
s_waitcnt lgkmcnt(12)
v_mfma_f32_16x16x32_bf16 a[12:15], v[204:207], v[80:83], a[12:15]
ds_read_b64_tr_b16 v[200:201], v9 offset:4096
ds_read_b64_tr_b16 v[202:203], v9 offset:4608
s_waitcnt lgkmcnt(12)
v_mfma_f32_16x16x32_bf16 a[16:19], v[176:179], v[80:83], a[16:19]
ds_read_b64_tr_b16 v[204:205], v10 offset:4096
ds_read_b64_tr_b16 v[206:207], v10 offset:4608
s_waitcnt lgkmcnt(12)
v_mfma_f32_16x16x32_bf16 a[20:23], v[180:183], v[80:83], a[20:23]
ds_read_b64_tr_b16 v[176:177], v11 offset:4096
ds_read_b64_tr_b16 v[178:179], v11 offset:4608
s_waitcnt lgkmcnt(12)
v_mfma_f32_16x16x32_bf16 a[24:27], v[184:187], v[80:83], a[24:27]
ds_read_b64_tr_b16 v[180:181], v8 offset:16384
ds_read_b64_tr_b16 v[182:183], v8 offset:16896
s_waitcnt lgkmcnt(12)
v_mfma_f32_16x16x32_bf16 a[28:31], v[188:191], v[80:83], a[28:31]
ds_read_b64_tr_b16 v[184:185], v9 offset:16384
ds_read_b64_tr_b16 v[186:187], v9 offset:16896
s_waitcnt lgkmcnt(12)
v_mfma_f32_16x16x32_bf16 a[32:35], v[192:195], v[80:83], a[32:35]
ds_read_b64_tr_b16 v[188:189], v10 offset:16384
ds_read_b64_tr_b16 v[190:191], v10 offset:16896
s_waitcnt lgkmcnt(12)
v_mfma_f32_16x16x32_bf16 a[0:3], v[196:199], v[84:87], a[0:3]
ds_read_b64_tr_b16 v[192:193], v11 offset:16384
ds_read_b64_tr_b16 v[194:195], v11 offset:16896
s_waitcnt lgkmcnt(12)
v_mfma_f32_16x16x32_bf16 a[4:7], v[200:203], v[84:87], a[4:7]
ds_read_b64_tr_b16 v[196:197], v8 offset:28672
ds_read_b64_tr_b16 v[198:199], v8 offset:29184
s_waitcnt lgkmcnt(12)
v_mfma_f32_16x16x32_bf16 a[8:11], v[204:207], v[84:87], a[8:11]
ds_read_b64_tr_b16 v[200:201], v8 offset:8192
ds_read_b64_tr_b16 v[202:203], v8 offset:8704
s_waitcnt lgkmcnt(12)
v_mfma_f32_16x16x32_bf16 a[12:15], v[176:179], v[84:87], a[12:15]
ds_read_b64_tr_b16 v[204:205], v9 offset:8192
ds_read_b64_tr_b16 v[206:207], v9 offset:8704
s_waitcnt lgkmcnt(12)
v_mfma_f32_16x16x32_bf16 a[16:19], v[180:183], v[84:87], a[16:19]
ds_read_b64_tr_b16 v[176:177], v10 offset:8192
ds_read_b64_tr_b16 v[178:179], v10 offset:8704
s_waitcnt lgkmcnt(12)
v_mfma_f32_16x16x32_bf16 a[20:23], v[184:187], v[84:87], a[20:23]
ds_read_b64_tr_b16 v[180:181], v11 offset:8192
ds_read_b64_tr_b16 v[182:183], v11 offset:8704
s_waitcnt lgkmcnt(12)
v_mfma_f32_16x16x32_bf16 a[24:27], v[188:191], v[84:87], a[24:27]
ds_read_b64_tr_b16 v[184:185], v8 offset:20480
ds_read_b64_tr_b16 v[186:187], v8 offset:20992
s_waitcnt lgkmcnt(12)
v_mfma_f32_16x16x32_bf16 a[28:31], v[192:195], v[84:87], a[28:31]
ds_read_b64_tr_b16 v[188:189], v9 offset:20480
ds_read_b64_tr_b16 v[190:191], v9 offset:20992
s_waitcnt lgkmcnt(12)
v_mfma_f32_16x16x32_bf16 a[32:35], v[196:199], v[84:87], a[32:35]
ds_read_b64_tr_b16 v[192:193], v10 offset:20480
ds_read_b64_tr_b16 v[194:195], v10 offset:20992
s_waitcnt lgkmcnt(12)
v_mfma_f32_16x16x32_bf16 a[0:3], v[200:203], v[88:91], a[0:3]
ds_read_b64_tr_b16 v[196:197], v11 offset:20480
ds_read_b64_tr_b16 v[198:199], v11 offset:20992
s_waitcnt lgkmcnt(12)
v_mfma_f32_16x16x32_bf16 a[4:7], v[204:207], v[88:91], a[4:7]
ds_read_b64_tr_b16 v[200:201], v8 offset:32768
ds_read_b64_tr_b16 v[202:203], v8 offset:33280
s_waitcnt lgkmcnt(12)
v_mfma_f32_16x16x32_bf16 a[8:11], v[176:179], v[88:91], a[8:11]
s_waitcnt vmcnt(0)
s_barrier
v_add_u32 v8, 36864, v8
v_add_u32 v9, 36864, v9
v_add_u32 v10, 36864, v10
v_add_u32 v11, 36864, v11
ds_read_b64_tr_b16 v[204:205], v8 offset:0
ds_read_b64_tr_b16 v[206:207], v8 offset:512
s_waitcnt lgkmcnt(12)
v_mfma_f32_16x16x32_bf16 a[12:15], v[180:183], v[88:91], a[12:15]
ds_read_b64_tr_b16 v[176:177], v9 offset:0
ds_read_b64_tr_b16 v[178:179], v9 offset:512
s_waitcnt lgkmcnt(12)
v_mfma_f32_16x16x32_bf16 a[16:19], v[184:187], v[88:91], a[16:19]
ds_read_b64_tr_b16 v[180:181], v10 offset:0
ds_read_b64_tr_b16 v[182:183], v10 offset:512
s_waitcnt lgkmcnt(12)
v_mfma_f32_16x16x32_bf16 a[20:23], v[188:191], v[88:91], a[20:23]
ds_read_b64_tr_b16 v[184:185], v11 offset:0
ds_read_b64_tr_b16 v[186:187], v11 offset:512
s_waitcnt lgkmcnt(12)
v_mfma_f32_16x16x32_bf16 a[24:27], v[192:195], v[88:91], a[24:27]
ds_read_b64_tr_b16 v[188:189], v8 offset:12288
ds_read_b64_tr_b16 v[190:191], v8 offset:12800
s_waitcnt lgkmcnt(12)
v_mfma_f32_16x16x32_bf16 a[28:31], v[196:199], v[88:91], a[28:31]
ds_read_b64_tr_b16 v[192:193], v9 offset:12288
ds_read_b64_tr_b16 v[194:195], v9 offset:12800
s_waitcnt lgkmcnt(12)
v_mfma_f32_16x16x32_bf16 a[32:35], v[200:203], v[88:91], a[32:35]
ds_read_b64_tr_b16 v[196:197], v10 offset:12288
ds_read_b64_tr_b16 v[198:199], v10 offset:12800
s_waitcnt lgkmcnt(12)
v_mfma_f32_16x16x32_bf16 a[0:3], v[204:207], v[92:95], a[0:3]
ds_read_b64_tr_b16 v[200:201], v11 offset:12288
ds_read_b64_tr_b16 v[202:203], v11 offset:12800
s_waitcnt lgkmcnt(12)
v_mfma_f32_16x16x32_bf16 a[4:7], v[176:179], v[92:95], a[4:7]
ds_read_b64_tr_b16 v[204:205], v8 offset:24576
ds_read_b64_tr_b16 v[206:207], v8 offset:25088
s_waitcnt lgkmcnt(12)
v_mfma_f32_16x16x32_bf16 a[8:11], v[180:183], v[92:95], a[8:11]
ds_read_b64_tr_b16 v[176:177], v8 offset:4096
ds_read_b64_tr_b16 v[178:179], v8 offset:4608
s_waitcnt lgkmcnt(12)
v_mfma_f32_16x16x32_bf16 a[12:15], v[184:187], v[92:95], a[12:15]
ds_read_b64_tr_b16 v[180:181], v9 offset:4096
ds_read_b64_tr_b16 v[182:183], v9 offset:4608
s_waitcnt lgkmcnt(12)
v_mfma_f32_16x16x32_bf16 a[16:19], v[188:191], v[92:95], a[16:19]
ds_read_b64_tr_b16 v[184:185], v10 offset:4096
ds_read_b64_tr_b16 v[186:187], v10 offset:4608
s_waitcnt lgkmcnt(12)
v_mfma_f32_16x16x32_bf16 a[20:23], v[192:195], v[92:95], a[20:23]
ds_read_b64_tr_b16 v[188:189], v11 offset:4096
ds_read_b64_tr_b16 v[190:191], v11 offset:4608
s_waitcnt lgkmcnt(12)
v_mfma_f32_16x16x32_bf16 a[24:27], v[196:199], v[92:95], a[24:27]
ds_read_b64_tr_b16 v[192:193], v8 offset:16384
ds_read_b64_tr_b16 v[194:195], v8 offset:16896
s_waitcnt lgkmcnt(12)
v_mfma_f32_16x16x32_bf16 a[28:31], v[200:203], v[92:95], a[28:31]
ds_read_b64_tr_b16 v[196:197], v9 offset:16384
ds_read_b64_tr_b16 v[198:199], v9 offset:16896
s_waitcnt lgkmcnt(12)
v_mfma_f32_16x16x32_bf16 a[32:35], v[204:207], v[92:95], a[32:35]
ds_read_b64_tr_b16 v[200:201], v10 offset:16384
ds_read_b64_tr_b16 v[202:203], v10 offset:16896
s_waitcnt lgkmcnt(12)
v_mfma_f32_16x16x32_bf16 a[0:3], v[176:179], v[96:99], a[0:3]
ds_read_b64_tr_b16 v[204:205], v11 offset:16384
ds_read_b64_tr_b16 v[206:207], v11 offset:16896
s_waitcnt lgkmcnt(12)
v_mfma_f32_16x16x32_bf16 a[4:7], v[180:183], v[96:99], a[4:7]
ds_read_b64_tr_b16 v[176:177], v8 offset:28672
ds_read_b64_tr_b16 v[178:179], v8 offset:29184
s_waitcnt lgkmcnt(12)
v_mfma_f32_16x16x32_bf16 a[8:11], v[184:187], v[96:99], a[8:11]
ds_read_b64_tr_b16 v[180:181], v8 offset:8192
ds_read_b64_tr_b16 v[182:183], v8 offset:8704
s_waitcnt lgkmcnt(12)
v_mfma_f32_16x16x32_bf16 a[12:15], v[188:191], v[96:99], a[12:15]
ds_read_b64_tr_b16 v[184:185], v9 offset:8192
ds_read_b64_tr_b16 v[186:187], v9 offset:8704
s_waitcnt lgkmcnt(12)
v_mfma_f32_16x16x32_bf16 a[16:19], v[192:195], v[96:99], a[16:19]
ds_read_b64_tr_b16 v[188:189], v10 offset:8192
ds_read_b64_tr_b16 v[190:191], v10 offset:8704
s_waitcnt lgkmcnt(12)
v_mfma_f32_16x16x32_bf16 a[20:23], v[196:199], v[96:99], a[20:23]
ds_read_b64_tr_b16 v[192:193], v11 offset:8192
ds_read_b64_tr_b16 v[194:195], v11 offset:8704
s_waitcnt lgkmcnt(12)
v_mfma_f32_16x16x32_bf16 a[24:27], v[200:203], v[96:99], a[24:27]
ds_read_b64_tr_b16 v[196:197], v8 offset:20480
ds_read_b64_tr_b16 v[198:199], v8 offset:20992
s_waitcnt lgkmcnt(12)
v_mfma_f32_16x16x32_bf16 a[28:31], v[204:207], v[96:99], a[28:31]
ds_read_b64_tr_b16 v[200:201], v9 offset:20480
ds_read_b64_tr_b16 v[202:203], v9 offset:20992
s_waitcnt lgkmcnt(12)
v_mfma_f32_16x16x32_bf16 a[32:35], v[176:179], v[96:99], a[32:35]
ds_read_b64_tr_b16 v[204:205], v10 offset:20480
ds_read_b64_tr_b16 v[206:207], v10 offset:20992
s_waitcnt lgkmcnt(12)
v_mfma_f32_16x16x32_bf16 a[0:3], v[180:183], v[100:103], a[0:3]
ds_read_b64_tr_b16 v[176:177], v11 offset:20480
ds_read_b64_tr_b16 v[178:179], v11 offset:20992
s_waitcnt lgkmcnt(12)
v_mfma_f32_16x16x32_bf16 a[4:7], v[184:187], v[100:103], a[4:7]
ds_read_b64_tr_b16 v[180:181], v8 offset:32768
ds_read_b64_tr_b16 v[182:183], v8 offset:33280
s_waitcnt lgkmcnt(12)
v_mfma_f32_16x16x32_bf16 a[8:11], v[188:191], v[100:103], a[8:11]
s_waitcnt lgkmcnt(10)
v_mfma_f32_16x16x32_bf16 a[12:15], v[192:195], v[100:103], a[12:15]
s_waitcnt lgkmcnt(8)
v_mfma_f32_16x16x32_bf16 a[16:19], v[196:199], v[100:103], a[16:19]
s_waitcnt lgkmcnt(6)
v_mfma_f32_16x16x32_bf16 a[20:23], v[200:203], v[100:103], a[20:23]
s_waitcnt lgkmcnt(4)
v_mfma_f32_16x16x32_bf16 a[24:27], v[204:207], v[100:103], a[24:27]
s_waitcnt lgkmcnt(2)
v_mfma_f32_16x16x32_bf16 a[28:31], v[176:179], v[100:103], a[28:31]
s_waitcnt lgkmcnt(0)
v_mfma_f32_16x16x32_bf16 a[32:35], v[180:183], v[100:103], a[32:35]
s_nop 7
v_accvgpr_read_b32 v36, a0
v_accvgpr_read_b32 v37, a1
v_accvgpr_read_b32 v38, a2
v_accvgpr_read_b32 v39, a3
v_lshlrev_b32 v32, 16, v212
v_and_b32 v33, 0xffff0000, v212
v_lshlrev_b32 v34, 16, v213
v_and_b32 v35, 0xffff0000, v213
v_add_f32 v32, v32, v36
v_add_f32 v33, v33, v37
v_add_f32 v34, v34, v38
v_add_f32 v35, v35, v39
v_cvt_pk_bf16_f32 v212, v32, v33
v_cvt_pk_bf16_f32 v213, v34, v35
s_add_u32 s77, s75, 0
buffer_store_dwordx2 v[212:213], v26, s[16:19], s77 offen offset:0
v_accvgpr_read_b32 v44, a4
v_accvgpr_read_b32 v45, a5
v_accvgpr_read_b32 v46, a6
v_accvgpr_read_b32 v47, a7
v_lshlrev_b32 v40, 16, v214
v_and_b32 v41, 0xffff0000, v214
v_lshlrev_b32 v42, 16, v215
v_and_b32 v43, 0xffff0000, v215
v_add_f32 v40, v40, v44
v_add_f32 v41, v41, v45
v_add_f32 v42, v42, v46
v_add_f32 v43, v43, v47
v_cvt_pk_bf16_f32 v214, v40, v41
v_cvt_pk_bf16_f32 v215, v42, v43
s_add_u32 s77, s75, 0
buffer_store_dwordx2 v[214:215], v26, s[16:19], s77 offen offset:512
v_accvgpr_read_b32 v36, a8
v_accvgpr_read_b32 v37, a9
v_accvgpr_read_b32 v38, a10
v_accvgpr_read_b32 v39, a11
v_lshlrev_b32 v32, 16, v216
v_and_b32 v33, 0xffff0000, v216
v_lshlrev_b32 v34, 16, v217
v_and_b32 v35, 0xffff0000, v217
v_add_f32 v32, v32, v36
v_add_f32 v33, v33, v37
v_add_f32 v34, v34, v38
v_add_f32 v35, v35, v39
v_cvt_pk_bf16_f32 v216, v32, v33
v_cvt_pk_bf16_f32 v217, v34, v35
s_add_u32 s77, s75, 0
buffer_store_dwordx2 v[216:217], v26, s[16:19], s77 offen offset:1024
v_accvgpr_read_b32 v44, a12
v_accvgpr_read_b32 v45, a13
v_accvgpr_read_b32 v46, a14
v_accvgpr_read_b32 v47, a15
v_lshlrev_b32 v40, 16, v218
v_and_b32 v41, 0xffff0000, v218
v_lshlrev_b32 v42, 16, v219
v_and_b32 v43, 0xffff0000, v219
v_add_f32 v40, v40, v44
v_add_f32 v41, v41, v45
v_add_f32 v42, v42, v46
v_add_f32 v43, v43, v47
v_cvt_pk_bf16_f32 v218, v40, v41
v_cvt_pk_bf16_f32 v219, v42, v43
s_add_u32 s77, s75, 0
buffer_store_dwordx2 v[218:219], v26, s[16:19], s77 offen offset:1536
v_accvgpr_read_b32 v36, a16
v_accvgpr_read_b32 v37, a17
v_accvgpr_read_b32 v38, a18
v_accvgpr_read_b32 v39, a19
v_lshlrev_b32 v32, 16, v220
v_and_b32 v33, 0xffff0000, v220
v_lshlrev_b32 v34, 16, v221
v_and_b32 v35, 0xffff0000, v221
v_add_f32 v32, v32, v36
v_add_f32 v33, v33, v37
v_add_f32 v34, v34, v38
v_add_f32 v35, v35, v39
v_cvt_pk_bf16_f32 v220, v32, v33
v_cvt_pk_bf16_f32 v221, v34, v35
s_add_u32 s77, s75, 0
buffer_store_dwordx2 v[220:221], v26, s[16:19], s77 offen offset:2048
v_accvgpr_read_b32 v44, a20
v_accvgpr_read_b32 v45, a21
v_accvgpr_read_b32 v46, a22
v_accvgpr_read_b32 v47, a23
v_lshlrev_b32 v40, 16, v222
v_and_b32 v41, 0xffff0000, v222
v_lshlrev_b32 v42, 16, v223
v_and_b32 v43, 0xffff0000, v223
v_add_f32 v40, v40, v44
v_add_f32 v41, v41, v45
v_add_f32 v42, v42, v46
v_add_f32 v43, v43, v47
v_cvt_pk_bf16_f32 v222, v40, v41
v_cvt_pk_bf16_f32 v223, v42, v43
s_add_u32 s77, s75, 0
buffer_store_dwordx2 v[222:223], v26, s[16:19], s77 offen offset:2560
v_accvgpr_read_b32 v36, a24
v_accvgpr_read_b32 v37, a25
v_accvgpr_read_b32 v38, a26
v_accvgpr_read_b32 v39, a27
v_lshlrev_b32 v32, 16, v224
v_and_b32 v33, 0xffff0000, v224
v_lshlrev_b32 v34, 16, v225
v_and_b32 v35, 0xffff0000, v225
v_add_f32 v32, v32, v36
v_add_f32 v33, v33, v37
v_add_f32 v34, v34, v38
v_add_f32 v35, v35, v39
v_cvt_pk_bf16_f32 v224, v32, v33
v_cvt_pk_bf16_f32 v225, v34, v35
s_add_u32 s77, s75, 0
buffer_store_dwordx2 v[224:225], v26, s[16:19], s77 offen offset:3072
v_accvgpr_read_b32 v44, a28
v_accvgpr_read_b32 v45, a29
v_accvgpr_read_b32 v46, a30
v_accvgpr_read_b32 v47, a31
v_lshlrev_b32 v40, 16, v226
v_and_b32 v41, 0xffff0000, v226
v_lshlrev_b32 v42, 16, v227
v_and_b32 v43, 0xffff0000, v227
v_add_f32 v40, v40, v44
v_add_f32 v41, v41, v45
v_add_f32 v42, v42, v46
v_add_f32 v43, v43, v47
v_cvt_pk_bf16_f32 v226, v40, v41
v_cvt_pk_bf16_f32 v227, v42, v43
s_add_u32 s77, s75, 0
buffer_store_dwordx2 v[226:227], v26, s[16:19], s77 offen offset:3584
v_accvgpr_read_b32 v36, a32
v_accvgpr_read_b32 v37, a33
v_accvgpr_read_b32 v38, a34
v_accvgpr_read_b32 v39, a35
v_lshlrev_b32 v32, 16, v228
v_and_b32 v33, 0xffff0000, v228
v_lshlrev_b32 v34, 16, v229
v_and_b32 v35, 0xffff0000, v229
v_add_f32 v32, v32, v36
v_add_f32 v33, v33, v37
v_add_f32 v34, v34, v38
v_add_f32 v35, v35, v39
v_cvt_pk_bf16_f32 v228, v32, v33
v_cvt_pk_bf16_f32 v229, v34, v35
s_add_u32 s77, s75, 4096
buffer_store_dwordx2 v[228:229], v26, s[16:19], s77 offen offset:0
s_branch k2_end
k2_cs:
s_cmp_lg_u32 s92, 0
s_cbranch_scc1 k2_end
s_mov_b32 s12, s42
s_and_b32 s13, s43, 0xffff
s_mov_b32 s14, 5308416
s_mov_b32 s15, 0x20000
s_sub_u32 s64, s2, 128
s_lshl_b32 s65, s64, 8
s_mul_i32 s66, s3, 1327104
s_add_u32 s65, s65, s66
v_lshlrev_b32 v5, 2, v1
v_mov_b32 v6, 0
v_mov_b32 v7, 0
s_add_u32 s67, s65, 0
buffer_load_dword v32, v5, s[12:15], s67 offen
s_add_u32 s67, s65, 9216
buffer_load_dword v33, v5, s[12:15], s67 offen
s_add_u32 s67, s65, 18432
buffer_load_dword v34, v5, s[12:15], s67 offen
s_add_u32 s67, s65, 27648
buffer_load_dword v35, v5, s[12:15], s67 offen
s_add_u32 s67, s65, 36864
buffer_load_dword v36, v5, s[12:15], s67 offen
s_add_u32 s67, s65, 46080
buffer_load_dword v37, v5, s[12:15], s67 offen
s_add_u32 s67, s65, 55296
buffer_load_dword v38, v5, s[12:15], s67 offen
s_add_u32 s67, s65, 64512
buffer_load_dword v39, v5, s[12:15], s67 offen
s_add_u32 s67, s65, 73728
buffer_load_dword v40, v5, s[12:15], s67 offen
s_add_u32 s67, s65, 82944
buffer_load_dword v41, v5, s[12:15], s67 offen
s_add_u32 s67, s65, 92160
buffer_load_dword v42, v5, s[12:15], s67 offen
s_add_u32 s67, s65, 101376
buffer_load_dword v43, v5, s[12:15], s67 offen
s_add_u32 s67, s65, 110592
buffer_load_dword v44, v5, s[12:15], s67 offen
s_add_u32 s67, s65, 119808
buffer_load_dword v45, v5, s[12:15], s67 offen
s_add_u32 s67, s65, 129024
buffer_load_dword v46, v5, s[12:15], s67 offen
s_add_u32 s67, s65, 138240
buffer_load_dword v47, v5, s[12:15], s67 offen
s_add_u32 s67, s65, 147456
buffer_load_dword v48, v5, s[12:15], s67 offen
s_add_u32 s67, s65, 156672
buffer_load_dword v49, v5, s[12:15], s67 offen
s_add_u32 s67, s65, 165888
buffer_load_dword v50, v5, s[12:15], s67 offen
s_add_u32 s67, s65, 175104
buffer_load_dword v51, v5, s[12:15], s67 offen
s_add_u32 s67, s65, 184320
buffer_load_dword v52, v5, s[12:15], s67 offen
s_add_u32 s67, s65, 193536
buffer_load_dword v53, v5, s[12:15], s67 offen
s_add_u32 s67, s65, 202752
buffer_load_dword v54, v5, s[12:15], s67 offen
s_add_u32 s67, s65, 211968
buffer_load_dword v55, v5, s[12:15], s67 offen
s_add_u32 s67, s65, 221184
buffer_load_dword v56, v5, s[12:15], s67 offen
s_add_u32 s67, s65, 230400
buffer_load_dword v57, v5, s[12:15], s67 offen
s_add_u32 s67, s65, 239616
buffer_load_dword v58, v5, s[12:15], s67 offen
s_add_u32 s67, s65, 248832
buffer_load_dword v59, v5, s[12:15], s67 offen
s_add_u32 s67, s65, 258048
buffer_load_dword v60, v5, s[12:15], s67 offen
s_add_u32 s67, s65, 267264
buffer_load_dword v61, v5, s[12:15], s67 offen
s_add_u32 s67, s65, 276480
buffer_load_dword v62, v5, s[12:15], s67 offen
s_add_u32 s67, s65, 285696
buffer_load_dword v63, v5, s[12:15], s67 offen
s_add_u32 s67, s65, 294912
buffer_load_dword v64, v5, s[12:15], s67 offen
s_add_u32 s67, s65, 304128
buffer_load_dword v65, v5, s[12:15], s67 offen
s_add_u32 s67, s65, 313344
buffer_load_dword v66, v5, s[12:15], s67 offen
s_add_u32 s67, s65, 322560
buffer_load_dword v67, v5, s[12:15], s67 offen
s_add_u32 s67, s65, 331776
buffer_load_dword v68, v5, s[12:15], s67 offen
s_add_u32 s67, s65, 340992
buffer_load_dword v69, v5, s[12:15], s67 offen
s_add_u32 s67, s65, 350208
buffer_load_dword v70, v5, s[12:15], s67 offen
s_add_u32 s67, s65, 359424
buffer_load_dword v71, v5, s[12:15], s67 offen
s_add_u32 s67, s65, 368640
buffer_load_dword v72, v5, s[12:15], s67 offen
s_add_u32 s67, s65, 377856
buffer_load_dword v73, v5, s[12:15], s67 offen
s_add_u32 s67, s65, 387072
buffer_load_dword v74, v5, s[12:15], s67 offen
s_add_u32 s67, s65, 396288
buffer_load_dword v75, v5, s[12:15], s67 offen
s_add_u32 s67, s65, 405504
buffer_load_dword v76, v5, s[12:15], s67 offen
s_add_u32 s67, s65, 414720
buffer_load_dword v77, v5, s[12:15], s67 offen
s_add_u32 s67, s65, 423936
buffer_load_dword v78, v5, s[12:15], s67 offen
s_add_u32 s67, s65, 433152
buffer_load_dword v79, v5, s[12:15], s67 offen
s_waitcnt vmcnt(0)
v_lshlrev_b32 v8, 16, v32
v_and_b32 v9, 0xffff0000, v32
v_add_f32 v6, v6, v8
v_add_f32 v7, v7, v9
v_lshlrev_b32 v8, 16, v33
v_and_b32 v9, 0xffff0000, v33
v_add_f32 v6, v6, v8
v_add_f32 v7, v7, v9
v_lshlrev_b32 v8, 16, v34
v_and_b32 v9, 0xffff0000, v34
v_add_f32 v6, v6, v8
v_add_f32 v7, v7, v9
v_lshlrev_b32 v8, 16, v35
v_and_b32 v9, 0xffff0000, v35
v_add_f32 v6, v6, v8
v_add_f32 v7, v7, v9
v_lshlrev_b32 v8, 16, v36
v_and_b32 v9, 0xffff0000, v36
v_add_f32 v6, v6, v8
v_add_f32 v7, v7, v9
v_lshlrev_b32 v8, 16, v37
v_and_b32 v9, 0xffff0000, v37
v_add_f32 v6, v6, v8
v_add_f32 v7, v7, v9
v_lshlrev_b32 v8, 16, v38
v_and_b32 v9, 0xffff0000, v38
v_add_f32 v6, v6, v8
v_add_f32 v7, v7, v9
v_lshlrev_b32 v8, 16, v39
v_and_b32 v9, 0xffff0000, v39
v_add_f32 v6, v6, v8
v_add_f32 v7, v7, v9
v_lshlrev_b32 v8, 16, v40
v_and_b32 v9, 0xffff0000, v40
v_add_f32 v6, v6, v8
v_add_f32 v7, v7, v9
v_lshlrev_b32 v8, 16, v41
v_and_b32 v9, 0xffff0000, v41
v_add_f32 v6, v6, v8
v_add_f32 v7, v7, v9
v_lshlrev_b32 v8, 16, v42
v_and_b32 v9, 0xffff0000, v42
v_add_f32 v6, v6, v8
v_add_f32 v7, v7, v9
v_lshlrev_b32 v8, 16, v43
v_and_b32 v9, 0xffff0000, v43
v_add_f32 v6, v6, v8
v_add_f32 v7, v7, v9
v_lshlrev_b32 v8, 16, v44
v_and_b32 v9, 0xffff0000, v44
v_add_f32 v6, v6, v8
v_add_f32 v7, v7, v9
v_lshlrev_b32 v8, 16, v45
v_and_b32 v9, 0xffff0000, v45
v_add_f32 v6, v6, v8
v_add_f32 v7, v7, v9
v_lshlrev_b32 v8, 16, v46
v_and_b32 v9, 0xffff0000, v46
v_add_f32 v6, v6, v8
v_add_f32 v7, v7, v9
v_lshlrev_b32 v8, 16, v47
v_and_b32 v9, 0xffff0000, v47
v_add_f32 v6, v6, v8
v_add_f32 v7, v7, v9
v_lshlrev_b32 v8, 16, v48
v_and_b32 v9, 0xffff0000, v48
v_add_f32 v6, v6, v8
v_add_f32 v7, v7, v9
v_lshlrev_b32 v8, 16, v49
v_and_b32 v9, 0xffff0000, v49
v_add_f32 v6, v6, v8
v_add_f32 v7, v7, v9
v_lshlrev_b32 v8, 16, v50
v_and_b32 v9, 0xffff0000, v50
v_add_f32 v6, v6, v8
v_add_f32 v7, v7, v9
v_lshlrev_b32 v8, 16, v51
v_and_b32 v9, 0xffff0000, v51
v_add_f32 v6, v6, v8
v_add_f32 v7, v7, v9
v_lshlrev_b32 v8, 16, v52
v_and_b32 v9, 0xffff0000, v52
v_add_f32 v6, v6, v8
v_add_f32 v7, v7, v9
v_lshlrev_b32 v8, 16, v53
v_and_b32 v9, 0xffff0000, v53
v_add_f32 v6, v6, v8
v_add_f32 v7, v7, v9
v_lshlrev_b32 v8, 16, v54
v_and_b32 v9, 0xffff0000, v54
v_add_f32 v6, v6, v8
v_add_f32 v7, v7, v9
v_lshlrev_b32 v8, 16, v55
v_and_b32 v9, 0xffff0000, v55
v_add_f32 v6, v6, v8
v_add_f32 v7, v7, v9
v_lshlrev_b32 v8, 16, v56
v_and_b32 v9, 0xffff0000, v56
v_add_f32 v6, v6, v8
v_add_f32 v7, v7, v9
v_lshlrev_b32 v8, 16, v57
v_and_b32 v9, 0xffff0000, v57
v_add_f32 v6, v6, v8
v_add_f32 v7, v7, v9
v_lshlrev_b32 v8, 16, v58
v_and_b32 v9, 0xffff0000, v58
v_add_f32 v6, v6, v8
v_add_f32 v7, v7, v9
v_lshlrev_b32 v8, 16, v59
v_and_b32 v9, 0xffff0000, v59
v_add_f32 v6, v6, v8
v_add_f32 v7, v7, v9
v_lshlrev_b32 v8, 16, v60
v_and_b32 v9, 0xffff0000, v60
v_add_f32 v6, v6, v8
v_add_f32 v7, v7, v9
v_lshlrev_b32 v8, 16, v61
v_and_b32 v9, 0xffff0000, v61
v_add_f32 v6, v6, v8
v_add_f32 v7, v7, v9
v_lshlrev_b32 v8, 16, v62
v_and_b32 v9, 0xffff0000, v62
v_add_f32 v6, v6, v8
v_add_f32 v7, v7, v9
v_lshlrev_b32 v8, 16, v63
v_and_b32 v9, 0xffff0000, v63
v_add_f32 v6, v6, v8
v_add_f32 v7, v7, v9
v_lshlrev_b32 v8, 16, v64
v_and_b32 v9, 0xffff0000, v64
v_add_f32 v6, v6, v8
v_add_f32 v7, v7, v9
v_lshlrev_b32 v8, 16, v65
v_and_b32 v9, 0xffff0000, v65
v_add_f32 v6, v6, v8
v_add_f32 v7, v7, v9
v_lshlrev_b32 v8, 16, v66
v_and_b32 v9, 0xffff0000, v66
v_add_f32 v6, v6, v8
v_add_f32 v7, v7, v9
v_lshlrev_b32 v8, 16, v67
v_and_b32 v9, 0xffff0000, v67
v_add_f32 v6, v6, v8
v_add_f32 v7, v7, v9
v_lshlrev_b32 v8, 16, v68
v_and_b32 v9, 0xffff0000, v68
v_add_f32 v6, v6, v8
v_add_f32 v7, v7, v9
v_lshlrev_b32 v8, 16, v69
v_and_b32 v9, 0xffff0000, v69
v_add_f32 v6, v6, v8
v_add_f32 v7, v7, v9
v_lshlrev_b32 v8, 16, v70
v_and_b32 v9, 0xffff0000, v70
v_add_f32 v6, v6, v8
v_add_f32 v7, v7, v9
v_lshlrev_b32 v8, 16, v71
v_and_b32 v9, 0xffff0000, v71
v_add_f32 v6, v6, v8
v_add_f32 v7, v7, v9
v_lshlrev_b32 v8, 16, v72
v_and_b32 v9, 0xffff0000, v72
v_add_f32 v6, v6, v8
v_add_f32 v7, v7, v9
v_lshlrev_b32 v8, 16, v73
v_and_b32 v9, 0xffff0000, v73
v_add_f32 v6, v6, v8
v_add_f32 v7, v7, v9
v_lshlrev_b32 v8, 16, v74
v_and_b32 v9, 0xffff0000, v74
v_add_f32 v6, v6, v8
v_add_f32 v7, v7, v9
v_lshlrev_b32 v8, 16, v75
v_and_b32 v9, 0xffff0000, v75
v_add_f32 v6, v6, v8
v_add_f32 v7, v7, v9
v_lshlrev_b32 v8, 16, v76
v_and_b32 v9, 0xffff0000, v76
v_add_f32 v6, v6, v8
v_add_f32 v7, v7, v9
v_lshlrev_b32 v8, 16, v77
v_and_b32 v9, 0xffff0000, v77
v_add_f32 v6, v6, v8
v_add_f32 v7, v7, v9
v_lshlrev_b32 v8, 16, v78
v_and_b32 v9, 0xffff0000, v78
v_add_f32 v6, v6, v8
v_add_f32 v7, v7, v9
v_lshlrev_b32 v8, 16, v79
v_and_b32 v9, 0xffff0000, v79
v_add_f32 v6, v6, v8
v_add_f32 v7, v7, v9
s_add_u32 s67, s65, 442368
buffer_load_dword v32, v5, s[12:15], s67 offen
s_add_u32 s67, s65, 451584
buffer_load_dword v33, v5, s[12:15], s67 offen
s_add_u32 s67, s65, 460800
buffer_load_dword v34, v5, s[12:15], s67 offen
s_add_u32 s67, s65, 470016
buffer_load_dword v35, v5, s[12:15], s67 offen
s_add_u32 s67, s65, 479232
buffer_load_dword v36, v5, s[12:15], s67 offen
s_add_u32 s67, s65, 488448
buffer_load_dword v37, v5, s[12:15], s67 offen
s_add_u32 s67, s65, 497664
buffer_load_dword v38, v5, s[12:15], s67 offen
s_add_u32 s67, s65, 506880
buffer_load_dword v39, v5, s[12:15], s67 offen
s_add_u32 s67, s65, 516096
buffer_load_dword v40, v5, s[12:15], s67 offen
s_add_u32 s67, s65, 525312
buffer_load_dword v41, v5, s[12:15], s67 offen
s_add_u32 s67, s65, 534528
buffer_load_dword v42, v5, s[12:15], s67 offen
s_add_u32 s67, s65, 543744
buffer_load_dword v43, v5, s[12:15], s67 offen
s_add_u32 s67, s65, 552960
buffer_load_dword v44, v5, s[12:15], s67 offen
s_add_u32 s67, s65, 562176
buffer_load_dword v45, v5, s[12:15], s67 offen
s_add_u32 s67, s65, 571392
buffer_load_dword v46, v5, s[12:15], s67 offen
s_add_u32 s67, s65, 580608
buffer_load_dword v47, v5, s[12:15], s67 offen
s_add_u32 s67, s65, 589824
buffer_load_dword v48, v5, s[12:15], s67 offen
s_add_u32 s67, s65, 599040
buffer_load_dword v49, v5, s[12:15], s67 offen
s_add_u32 s67, s65, 608256
buffer_load_dword v50, v5, s[12:15], s67 offen
s_add_u32 s67, s65, 617472
buffer_load_dword v51, v5, s[12:15], s67 offen
s_add_u32 s67, s65, 626688
buffer_load_dword v52, v5, s[12:15], s67 offen
s_add_u32 s67, s65, 635904
buffer_load_dword v53, v5, s[12:15], s67 offen
s_add_u32 s67, s65, 645120
buffer_load_dword v54, v5, s[12:15], s67 offen
s_add_u32 s67, s65, 654336
buffer_load_dword v55, v5, s[12:15], s67 offen
s_add_u32 s67, s65, 663552
buffer_load_dword v56, v5, s[12:15], s67 offen
s_add_u32 s67, s65, 672768
buffer_load_dword v57, v5, s[12:15], s67 offen
s_add_u32 s67, s65, 681984
buffer_load_dword v58, v5, s[12:15], s67 offen
s_add_u32 s67, s65, 691200
buffer_load_dword v59, v5, s[12:15], s67 offen
s_add_u32 s67, s65, 700416
buffer_load_dword v60, v5, s[12:15], s67 offen
s_add_u32 s67, s65, 709632
buffer_load_dword v61, v5, s[12:15], s67 offen
s_add_u32 s67, s65, 718848
buffer_load_dword v62, v5, s[12:15], s67 offen
s_add_u32 s67, s65, 728064
buffer_load_dword v63, v5, s[12:15], s67 offen
s_add_u32 s67, s65, 737280
buffer_load_dword v64, v5, s[12:15], s67 offen
s_add_u32 s67, s65, 746496
buffer_load_dword v65, v5, s[12:15], s67 offen
s_add_u32 s67, s65, 755712
buffer_load_dword v66, v5, s[12:15], s67 offen
s_add_u32 s67, s65, 764928
buffer_load_dword v67, v5, s[12:15], s67 offen
s_add_u32 s67, s65, 774144
buffer_load_dword v68, v5, s[12:15], s67 offen
s_add_u32 s67, s65, 783360
buffer_load_dword v69, v5, s[12:15], s67 offen
s_add_u32 s67, s65, 792576
buffer_load_dword v70, v5, s[12:15], s67 offen
s_add_u32 s67, s65, 801792
buffer_load_dword v71, v5, s[12:15], s67 offen
s_add_u32 s67, s65, 811008
buffer_load_dword v72, v5, s[12:15], s67 offen
s_add_u32 s67, s65, 820224
buffer_load_dword v73, v5, s[12:15], s67 offen
s_add_u32 s67, s65, 829440
buffer_load_dword v74, v5, s[12:15], s67 offen
s_add_u32 s67, s65, 838656
buffer_load_dword v75, v5, s[12:15], s67 offen
s_add_u32 s67, s65, 847872
buffer_load_dword v76, v5, s[12:15], s67 offen
s_add_u32 s67, s65, 857088
buffer_load_dword v77, v5, s[12:15], s67 offen
s_add_u32 s67, s65, 866304
buffer_load_dword v78, v5, s[12:15], s67 offen
s_add_u32 s67, s65, 875520
buffer_load_dword v79, v5, s[12:15], s67 offen
s_waitcnt vmcnt(0)
v_lshlrev_b32 v8, 16, v32
v_and_b32 v9, 0xffff0000, v32
v_add_f32 v6, v6, v8
v_add_f32 v7, v7, v9
v_lshlrev_b32 v8, 16, v33
v_and_b32 v9, 0xffff0000, v33
v_add_f32 v6, v6, v8
v_add_f32 v7, v7, v9
v_lshlrev_b32 v8, 16, v34
v_and_b32 v9, 0xffff0000, v34
v_add_f32 v6, v6, v8
v_add_f32 v7, v7, v9
v_lshlrev_b32 v8, 16, v35
v_and_b32 v9, 0xffff0000, v35
v_add_f32 v6, v6, v8
v_add_f32 v7, v7, v9
v_lshlrev_b32 v8, 16, v36
v_and_b32 v9, 0xffff0000, v36
v_add_f32 v6, v6, v8
v_add_f32 v7, v7, v9
v_lshlrev_b32 v8, 16, v37
v_and_b32 v9, 0xffff0000, v37
v_add_f32 v6, v6, v8
v_add_f32 v7, v7, v9
v_lshlrev_b32 v8, 16, v38
v_and_b32 v9, 0xffff0000, v38
v_add_f32 v6, v6, v8
v_add_f32 v7, v7, v9
v_lshlrev_b32 v8, 16, v39
v_and_b32 v9, 0xffff0000, v39
v_add_f32 v6, v6, v8
v_add_f32 v7, v7, v9
v_lshlrev_b32 v8, 16, v40
v_and_b32 v9, 0xffff0000, v40
v_add_f32 v6, v6, v8
v_add_f32 v7, v7, v9
v_lshlrev_b32 v8, 16, v41
v_and_b32 v9, 0xffff0000, v41
v_add_f32 v6, v6, v8
v_add_f32 v7, v7, v9
v_lshlrev_b32 v8, 16, v42
v_and_b32 v9, 0xffff0000, v42
v_add_f32 v6, v6, v8
v_add_f32 v7, v7, v9
v_lshlrev_b32 v8, 16, v43
v_and_b32 v9, 0xffff0000, v43
v_add_f32 v6, v6, v8
v_add_f32 v7, v7, v9
v_lshlrev_b32 v8, 16, v44
v_and_b32 v9, 0xffff0000, v44
v_add_f32 v6, v6, v8
v_add_f32 v7, v7, v9
v_lshlrev_b32 v8, 16, v45
v_and_b32 v9, 0xffff0000, v45
v_add_f32 v6, v6, v8
v_add_f32 v7, v7, v9
v_lshlrev_b32 v8, 16, v46
v_and_b32 v9, 0xffff0000, v46
v_add_f32 v6, v6, v8
v_add_f32 v7, v7, v9
v_lshlrev_b32 v8, 16, v47
v_and_b32 v9, 0xffff0000, v47
v_add_f32 v6, v6, v8
v_add_f32 v7, v7, v9
v_lshlrev_b32 v8, 16, v48
v_and_b32 v9, 0xffff0000, v48
v_add_f32 v6, v6, v8
v_add_f32 v7, v7, v9
v_lshlrev_b32 v8, 16, v49
v_and_b32 v9, 0xffff0000, v49
v_add_f32 v6, v6, v8
v_add_f32 v7, v7, v9
v_lshlrev_b32 v8, 16, v50
v_and_b32 v9, 0xffff0000, v50
v_add_f32 v6, v6, v8
v_add_f32 v7, v7, v9
v_lshlrev_b32 v8, 16, v51
v_and_b32 v9, 0xffff0000, v51
v_add_f32 v6, v6, v8
v_add_f32 v7, v7, v9
v_lshlrev_b32 v8, 16, v52
v_and_b32 v9, 0xffff0000, v52
v_add_f32 v6, v6, v8
v_add_f32 v7, v7, v9
v_lshlrev_b32 v8, 16, v53
v_and_b32 v9, 0xffff0000, v53
v_add_f32 v6, v6, v8
v_add_f32 v7, v7, v9
v_lshlrev_b32 v8, 16, v54
v_and_b32 v9, 0xffff0000, v54
v_add_f32 v6, v6, v8
v_add_f32 v7, v7, v9
v_lshlrev_b32 v8, 16, v55
v_and_b32 v9, 0xffff0000, v55
v_add_f32 v6, v6, v8
v_add_f32 v7, v7, v9
v_lshlrev_b32 v8, 16, v56
v_and_b32 v9, 0xffff0000, v56
v_add_f32 v6, v6, v8
v_add_f32 v7, v7, v9
v_lshlrev_b32 v8, 16, v57
v_and_b32 v9, 0xffff0000, v57
v_add_f32 v6, v6, v8
v_add_f32 v7, v7, v9
v_lshlrev_b32 v8, 16, v58
v_and_b32 v9, 0xffff0000, v58
v_add_f32 v6, v6, v8
v_add_f32 v7, v7, v9
v_lshlrev_b32 v8, 16, v59
v_and_b32 v9, 0xffff0000, v59
v_add_f32 v6, v6, v8
v_add_f32 v7, v7, v9
v_lshlrev_b32 v8, 16, v60
v_and_b32 v9, 0xffff0000, v60
v_add_f32 v6, v6, v8
v_add_f32 v7, v7, v9
v_lshlrev_b32 v8, 16, v61
v_and_b32 v9, 0xffff0000, v61
v_add_f32 v6, v6, v8
v_add_f32 v7, v7, v9
v_lshlrev_b32 v8, 16, v62
v_and_b32 v9, 0xffff0000, v62
v_add_f32 v6, v6, v8
v_add_f32 v7, v7, v9
v_lshlrev_b32 v8, 16, v63
v_and_b32 v9, 0xffff0000, v63
v_add_f32 v6, v6, v8
v_add_f32 v7, v7, v9
v_lshlrev_b32 v8, 16, v64
v_and_b32 v9, 0xffff0000, v64
v_add_f32 v6, v6, v8
v_add_f32 v7, v7, v9
v_lshlrev_b32 v8, 16, v65
v_and_b32 v9, 0xffff0000, v65
v_add_f32 v6, v6, v8
v_add_f32 v7, v7, v9
v_lshlrev_b32 v8, 16, v66
v_and_b32 v9, 0xffff0000, v66
v_add_f32 v6, v6, v8
v_add_f32 v7, v7, v9
v_lshlrev_b32 v8, 16, v67
v_and_b32 v9, 0xffff0000, v67
v_add_f32 v6, v6, v8
v_add_f32 v7, v7, v9
v_lshlrev_b32 v8, 16, v68
v_and_b32 v9, 0xffff0000, v68
v_add_f32 v6, v6, v8
v_add_f32 v7, v7, v9
v_lshlrev_b32 v8, 16, v69
v_and_b32 v9, 0xffff0000, v69
v_add_f32 v6, v6, v8
v_add_f32 v7, v7, v9
v_lshlrev_b32 v8, 16, v70
v_and_b32 v9, 0xffff0000, v70
v_add_f32 v6, v6, v8
v_add_f32 v7, v7, v9
v_lshlrev_b32 v8, 16, v71
v_and_b32 v9, 0xffff0000, v71
v_add_f32 v6, v6, v8
v_add_f32 v7, v7, v9
v_lshlrev_b32 v8, 16, v72
v_and_b32 v9, 0xffff0000, v72
v_add_f32 v6, v6, v8
v_add_f32 v7, v7, v9
v_lshlrev_b32 v8, 16, v73
v_and_b32 v9, 0xffff0000, v73
v_add_f32 v6, v6, v8
v_add_f32 v7, v7, v9
v_lshlrev_b32 v8, 16, v74
v_and_b32 v9, 0xffff0000, v74
v_add_f32 v6, v6, v8
v_add_f32 v7, v7, v9
v_lshlrev_b32 v8, 16, v75
v_and_b32 v9, 0xffff0000, v75
v_add_f32 v6, v6, v8
v_add_f32 v7, v7, v9
v_lshlrev_b32 v8, 16, v76
v_and_b32 v9, 0xffff0000, v76
v_add_f32 v6, v6, v8
v_add_f32 v7, v7, v9
v_lshlrev_b32 v8, 16, v77
v_and_b32 v9, 0xffff0000, v77
v_add_f32 v6, v6, v8
v_add_f32 v7, v7, v9
v_lshlrev_b32 v8, 16, v78
v_and_b32 v9, 0xffff0000, v78
v_add_f32 v6, v6, v8
v_add_f32 v7, v7, v9
v_lshlrev_b32 v8, 16, v79
v_and_b32 v9, 0xffff0000, v79
v_add_f32 v6, v6, v8
v_add_f32 v7, v7, v9
s_add_u32 s67, s65, 884736
buffer_load_dword v32, v5, s[12:15], s67 offen
s_add_u32 s67, s65, 893952
buffer_load_dword v33, v5, s[12:15], s67 offen
s_add_u32 s67, s65, 903168
buffer_load_dword v34, v5, s[12:15], s67 offen
s_add_u32 s67, s65, 912384
buffer_load_dword v35, v5, s[12:15], s67 offen
s_add_u32 s67, s65, 921600
buffer_load_dword v36, v5, s[12:15], s67 offen
s_add_u32 s67, s65, 930816
buffer_load_dword v37, v5, s[12:15], s67 offen
s_add_u32 s67, s65, 940032
buffer_load_dword v38, v5, s[12:15], s67 offen
s_add_u32 s67, s65, 949248
buffer_load_dword v39, v5, s[12:15], s67 offen
s_add_u32 s67, s65, 958464
buffer_load_dword v40, v5, s[12:15], s67 offen
s_add_u32 s67, s65, 967680
buffer_load_dword v41, v5, s[12:15], s67 offen
s_add_u32 s67, s65, 976896
buffer_load_dword v42, v5, s[12:15], s67 offen
s_add_u32 s67, s65, 986112
buffer_load_dword v43, v5, s[12:15], s67 offen
s_add_u32 s67, s65, 995328
buffer_load_dword v44, v5, s[12:15], s67 offen
s_add_u32 s67, s65, 1004544
buffer_load_dword v45, v5, s[12:15], s67 offen
s_add_u32 s67, s65, 1013760
buffer_load_dword v46, v5, s[12:15], s67 offen
s_add_u32 s67, s65, 1022976
buffer_load_dword v47, v5, s[12:15], s67 offen
s_add_u32 s67, s65, 1032192
buffer_load_dword v48, v5, s[12:15], s67 offen
s_add_u32 s67, s65, 1041408
buffer_load_dword v49, v5, s[12:15], s67 offen
s_add_u32 s67, s65, 1050624
buffer_load_dword v50, v5, s[12:15], s67 offen
s_add_u32 s67, s65, 1059840
buffer_load_dword v51, v5, s[12:15], s67 offen
s_add_u32 s67, s65, 1069056
buffer_load_dword v52, v5, s[12:15], s67 offen
s_add_u32 s67, s65, 1078272
buffer_load_dword v53, v5, s[12:15], s67 offen
s_add_u32 s67, s65, 1087488
buffer_load_dword v54, v5, s[12:15], s67 offen
s_add_u32 s67, s65, 1096704
buffer_load_dword v55, v5, s[12:15], s67 offen
s_add_u32 s67, s65, 1105920
buffer_load_dword v56, v5, s[12:15], s67 offen
s_add_u32 s67, s65, 1115136
buffer_load_dword v57, v5, s[12:15], s67 offen
s_add_u32 s67, s65, 1124352
buffer_load_dword v58, v5, s[12:15], s67 offen
s_add_u32 s67, s65, 1133568
buffer_load_dword v59, v5, s[12:15], s67 offen
s_add_u32 s67, s65, 1142784
buffer_load_dword v60, v5, s[12:15], s67 offen
s_add_u32 s67, s65, 1152000
buffer_load_dword v61, v5, s[12:15], s67 offen
s_add_u32 s67, s65, 1161216
buffer_load_dword v62, v5, s[12:15], s67 offen
s_add_u32 s67, s65, 1170432
buffer_load_dword v63, v5, s[12:15], s67 offen
s_add_u32 s67, s65, 1179648
buffer_load_dword v64, v5, s[12:15], s67 offen
s_add_u32 s67, s65, 1188864
buffer_load_dword v65, v5, s[12:15], s67 offen
s_add_u32 s67, s65, 1198080
buffer_load_dword v66, v5, s[12:15], s67 offen
s_add_u32 s67, s65, 1207296
buffer_load_dword v67, v5, s[12:15], s67 offen
s_add_u32 s67, s65, 1216512
buffer_load_dword v68, v5, s[12:15], s67 offen
s_add_u32 s67, s65, 1225728
buffer_load_dword v69, v5, s[12:15], s67 offen
s_add_u32 s67, s65, 1234944
buffer_load_dword v70, v5, s[12:15], s67 offen
s_add_u32 s67, s65, 1244160
buffer_load_dword v71, v5, s[12:15], s67 offen
s_add_u32 s67, s65, 1253376
buffer_load_dword v72, v5, s[12:15], s67 offen
s_add_u32 s67, s65, 1262592
buffer_load_dword v73, v5, s[12:15], s67 offen
s_add_u32 s67, s65, 1271808
buffer_load_dword v74, v5, s[12:15], s67 offen
s_add_u32 s67, s65, 1281024
buffer_load_dword v75, v5, s[12:15], s67 offen
s_add_u32 s67, s65, 1290240
buffer_load_dword v76, v5, s[12:15], s67 offen
s_add_u32 s67, s65, 1299456
buffer_load_dword v77, v5, s[12:15], s67 offen
s_add_u32 s67, s65, 1308672
buffer_load_dword v78, v5, s[12:15], s67 offen
s_add_u32 s67, s65, 1317888
buffer_load_dword v79, v5, s[12:15], s67 offen
s_waitcnt vmcnt(0)
v_lshlrev_b32 v8, 16, v32
v_and_b32 v9, 0xffff0000, v32
v_add_f32 v6, v6, v8
v_add_f32 v7, v7, v9
v_lshlrev_b32 v8, 16, v33
v_and_b32 v9, 0xffff0000, v33
v_add_f32 v6, v6, v8
v_add_f32 v7, v7, v9
v_lshlrev_b32 v8, 16, v34
v_and_b32 v9, 0xffff0000, v34
v_add_f32 v6, v6, v8
v_add_f32 v7, v7, v9
v_lshlrev_b32 v8, 16, v35
v_and_b32 v9, 0xffff0000, v35
v_add_f32 v6, v6, v8
v_add_f32 v7, v7, v9
v_lshlrev_b32 v8, 16, v36
v_and_b32 v9, 0xffff0000, v36
v_add_f32 v6, v6, v8
v_add_f32 v7, v7, v9
v_lshlrev_b32 v8, 16, v37
v_and_b32 v9, 0xffff0000, v37
v_add_f32 v6, v6, v8
v_add_f32 v7, v7, v9
v_lshlrev_b32 v8, 16, v38
v_and_b32 v9, 0xffff0000, v38
v_add_f32 v6, v6, v8
v_add_f32 v7, v7, v9
v_lshlrev_b32 v8, 16, v39
v_and_b32 v9, 0xffff0000, v39
v_add_f32 v6, v6, v8
v_add_f32 v7, v7, v9
v_lshlrev_b32 v8, 16, v40
v_and_b32 v9, 0xffff0000, v40
v_add_f32 v6, v6, v8
v_add_f32 v7, v7, v9
v_lshlrev_b32 v8, 16, v41
v_and_b32 v9, 0xffff0000, v41
v_add_f32 v6, v6, v8
v_add_f32 v7, v7, v9
v_lshlrev_b32 v8, 16, v42
v_and_b32 v9, 0xffff0000, v42
v_add_f32 v6, v6, v8
v_add_f32 v7, v7, v9
v_lshlrev_b32 v8, 16, v43
v_and_b32 v9, 0xffff0000, v43
v_add_f32 v6, v6, v8
v_add_f32 v7, v7, v9
v_lshlrev_b32 v8, 16, v44
v_and_b32 v9, 0xffff0000, v44
v_add_f32 v6, v6, v8
v_add_f32 v7, v7, v9
v_lshlrev_b32 v8, 16, v45
v_and_b32 v9, 0xffff0000, v45
v_add_f32 v6, v6, v8
v_add_f32 v7, v7, v9
v_lshlrev_b32 v8, 16, v46
v_and_b32 v9, 0xffff0000, v46
v_add_f32 v6, v6, v8
v_add_f32 v7, v7, v9
v_lshlrev_b32 v8, 16, v47
v_and_b32 v9, 0xffff0000, v47
v_add_f32 v6, v6, v8
v_add_f32 v7, v7, v9
v_lshlrev_b32 v8, 16, v48
v_and_b32 v9, 0xffff0000, v48
v_add_f32 v6, v6, v8
v_add_f32 v7, v7, v9
v_lshlrev_b32 v8, 16, v49
v_and_b32 v9, 0xffff0000, v49
v_add_f32 v6, v6, v8
v_add_f32 v7, v7, v9
v_lshlrev_b32 v8, 16, v50
v_and_b32 v9, 0xffff0000, v50
v_add_f32 v6, v6, v8
v_add_f32 v7, v7, v9
v_lshlrev_b32 v8, 16, v51
v_and_b32 v9, 0xffff0000, v51
v_add_f32 v6, v6, v8
v_add_f32 v7, v7, v9
v_lshlrev_b32 v8, 16, v52
v_and_b32 v9, 0xffff0000, v52
v_add_f32 v6, v6, v8
v_add_f32 v7, v7, v9
v_lshlrev_b32 v8, 16, v53
v_and_b32 v9, 0xffff0000, v53
v_add_f32 v6, v6, v8
v_add_f32 v7, v7, v9
v_lshlrev_b32 v8, 16, v54
v_and_b32 v9, 0xffff0000, v54
v_add_f32 v6, v6, v8
v_add_f32 v7, v7, v9
v_lshlrev_b32 v8, 16, v55
v_and_b32 v9, 0xffff0000, v55
v_add_f32 v6, v6, v8
v_add_f32 v7, v7, v9
v_lshlrev_b32 v8, 16, v56
v_and_b32 v9, 0xffff0000, v56
v_add_f32 v6, v6, v8
v_add_f32 v7, v7, v9
v_lshlrev_b32 v8, 16, v57
v_and_b32 v9, 0xffff0000, v57
v_add_f32 v6, v6, v8
v_add_f32 v7, v7, v9
v_lshlrev_b32 v8, 16, v58
v_and_b32 v9, 0xffff0000, v58
v_add_f32 v6, v6, v8
v_add_f32 v7, v7, v9
v_lshlrev_b32 v8, 16, v59
v_and_b32 v9, 0xffff0000, v59
v_add_f32 v6, v6, v8
v_add_f32 v7, v7, v9
v_lshlrev_b32 v8, 16, v60
v_and_b32 v9, 0xffff0000, v60
v_add_f32 v6, v6, v8
v_add_f32 v7, v7, v9
v_lshlrev_b32 v8, 16, v61
v_and_b32 v9, 0xffff0000, v61
v_add_f32 v6, v6, v8
v_add_f32 v7, v7, v9
v_lshlrev_b32 v8, 16, v62
v_and_b32 v9, 0xffff0000, v62
v_add_f32 v6, v6, v8
v_add_f32 v7, v7, v9
v_lshlrev_b32 v8, 16, v63
v_and_b32 v9, 0xffff0000, v63
v_add_f32 v6, v6, v8
v_add_f32 v7, v7, v9
v_lshlrev_b32 v8, 16, v64
v_and_b32 v9, 0xffff0000, v64
v_add_f32 v6, v6, v8
v_add_f32 v7, v7, v9
v_lshlrev_b32 v8, 16, v65
v_and_b32 v9, 0xffff0000, v65
v_add_f32 v6, v6, v8
v_add_f32 v7, v7, v9
v_lshlrev_b32 v8, 16, v66
v_and_b32 v9, 0xffff0000, v66
v_add_f32 v6, v6, v8
v_add_f32 v7, v7, v9
v_lshlrev_b32 v8, 16, v67
v_and_b32 v9, 0xffff0000, v67
v_add_f32 v6, v6, v8
v_add_f32 v7, v7, v9
v_lshlrev_b32 v8, 16, v68
v_and_b32 v9, 0xffff0000, v68
v_add_f32 v6, v6, v8
v_add_f32 v7, v7, v9
v_lshlrev_b32 v8, 16, v69
v_and_b32 v9, 0xffff0000, v69
v_add_f32 v6, v6, v8
v_add_f32 v7, v7, v9
v_lshlrev_b32 v8, 16, v70
v_and_b32 v9, 0xffff0000, v70
v_add_f32 v6, v6, v8
v_add_f32 v7, v7, v9
v_lshlrev_b32 v8, 16, v71
v_and_b32 v9, 0xffff0000, v71
v_add_f32 v6, v6, v8
v_add_f32 v7, v7, v9
v_lshlrev_b32 v8, 16, v72
v_and_b32 v9, 0xffff0000, v72
v_add_f32 v6, v6, v8
v_add_f32 v7, v7, v9
v_lshlrev_b32 v8, 16, v73
v_and_b32 v9, 0xffff0000, v73
v_add_f32 v6, v6, v8
v_add_f32 v7, v7, v9
v_lshlrev_b32 v8, 16, v74
v_and_b32 v9, 0xffff0000, v74
v_add_f32 v6, v6, v8
v_add_f32 v7, v7, v9
v_lshlrev_b32 v8, 16, v75
v_and_b32 v9, 0xffff0000, v75
v_add_f32 v6, v6, v8
v_add_f32 v7, v7, v9
v_lshlrev_b32 v8, 16, v76
v_and_b32 v9, 0xffff0000, v76
v_add_f32 v6, v6, v8
v_add_f32 v7, v7, v9
v_lshlrev_b32 v8, 16, v77
v_and_b32 v9, 0xffff0000, v77
v_add_f32 v6, v6, v8
v_add_f32 v7, v7, v9
v_lshlrev_b32 v8, 16, v78
v_and_b32 v9, 0xffff0000, v78
v_add_f32 v6, v6, v8
v_add_f32 v7, v7, v9
v_lshlrev_b32 v8, 16, v79
v_and_b32 v9, 0xffff0000, v79
v_add_f32 v6, v6, v8
v_add_f32 v7, v7, v9
v_lshlrev_b32 v10, 3, v0
ds_write_b64 v10, v[6:7]
s_waitcnt lgkmcnt(0)
s_barrier
v_lshlrev_b32 v10, 3, v1
ds_read_b64 v[12:13], v10 offset:0
ds_read_b64 v[14:15], v10 offset:512
ds_read_b64 v[16:17], v10 offset:1024
ds_read_b64 v[18:19], v10 offset:1536
s_waitcnt lgkmcnt(0)
v_add_f32 v12, v12, v14
v_add_f32 v16, v16, v18
v_add_f32 v12, v12, v16
v_add_f32 v13, v13, v15
v_add_f32 v17, v17, v19
v_add_f32 v13, v13, v17
s_lshl_b32 s65, s64, 9
s_add_u32 s65, s65, 64487424
buffer_store_dwordx2 v[12:13], v10, s[16:19], s65 offen
k2_end:
s_endpgm

.globl k3_l0_kernel
.p2align 8
.type k3_l0_kernel,@function
k3_l0_kernel:
s_mov_b32 s92, 0
s_branch k3_body
.globl k3_l1_kernel
.p2align 8
.type k3_l1_kernel,@function
k3_l1_kernel:
s_mov_b32 s92, 1
s_branch k3_body
.p2align 6
k3_body:
s_cmp_ge_u32 s2, 256
s_cbranch_scc1 k3_end
s_load_dwordx16 s[32:47], s[0:1], 0
s_load_dwordx8 s[48:55], s[0:1], 64
v_and_b32 v1, 63, v0
v_lshrrev_b32 v2, 4, v1
v_and_b32 v3, 15, v1
v_lshrrev_b32 v4, 6, v0
s_nop 0
v_readfirstlane_b32 s3, v4
v_lshrrev_b32 v5, 1, v2
v_lshlrev_b32 v5, 8, v5
v_lshl_add_u32 v5, v3, 4, v5
v_and_b32 v6, 1, v2
v_lshl_add_u32 v26, v6, 3, v5
s_waitcnt lgkmcnt(0)
s_mov_b32 s16, s54
s_and_b32 s17, s55, 0xffff
s_mov_b32 s18, 67108864
s_mov_b32 s19, 0x20000
s_lshr_b32 s58, s2, 4
s_and_b32 s64, s2, 7
s_lshl_b32 s64, s64, 1
s_lshr_b32 s65, s2, 3
s_and_b32 s65, s65, 1
s_add_u32 s59, s64, s65
s_mov_b32 s12, s42
s_and_b32 s13, s43, 0xffff
s_mov_b32 s14, 5308416
s_mov_b32 s15, 0x20000
s_mov_b32 s20, s44
s_and_b32 s21, s45, 0xffff
s_mov_b32 s22, 9216
s_mov_b32 s23, 0x20000
s_lshl_b32 s70, s58, 3
s_lshl_b32 s71, s3, 1
s_add_u32 s70, s70, s71
s_mul_i32 s72, s70, 18432
s_cmp_eq_u32 s92, 0
s_mov_b32 s73, 17825792
s_cselect_b32 s73, 11534336, s73
s_add_u32 s73, s73, s72
v_lshlrev_b32 v27, 4, v1
s_add_u32 s78, s73, 0
buffer_load_dwordx4 v[32:35], v27, s[16:19], s78 offen offset:0
s_add_u32 s78, s73, 18432
buffer_load_dwordx4 v[104:107], v27, s[16:19], s78 offen offset:0
s_add_u32 s78, s73, 0
buffer_load_dwordx4 v[36:39], v27, s[16:19], s78 offen offset:1024
s_add_u32 s78, s73, 18432
buffer_load_dwordx4 v[108:111], v27, s[16:19], s78 offen offset:1024
s_add_u32 s78, s73, 0
buffer_load_dwordx4 v[40:43], v27, s[16:19], s78 offen offset:2048
s_add_u32 s78, s73, 18432
buffer_load_dwordx4 v[112:115], v27, s[16:19], s78 offen offset:2048
s_add_u32 s78, s73, 0
buffer_load_dwordx4 v[44:47], v27, s[16:19], s78 offen offset:3072
s_add_u32 s78, s73, 18432
buffer_load_dwordx4 v[116:119], v27, s[16:19], s78 offen offset:3072
s_mov_b32 s82, 0x3f803f80
v_mov_b32 v248, 0
v_mov_b32 v249, 0
v_mov_b32 v250, 0
v_mov_b32 v251, 0
s_mul_i32 s65, s59, 576
s_and_b32 s66, s65, 0xffffff80
s_sub_u32 s67, s65, s66
s_lshr_b32 s67, s67, 4
v_lshrrev_b32 v208, 3, v1
s_mov_b32 s89, 9216
v_mul_lo_u32 v209, v208, s89
v_bfe_u32 v210, v1, 4, 1
v_lshlrev_b32 v210, 1, v210
v_and_b32 v211, 7, v1
v_xor_b32 v211, v211, v210
v_lshl_add_u32 v16, v211, 4, v209
v_xor_b32 v211, 4, v211
v_lshl_add_u32 v17, v211, 4, v209
s_mul_i32 s56, s3, 2048
s_mul_i32 s61, s3, 147456
s_add_u32 s84, s66, s61
s_add_u32 s85, s66, s61
s_add_u32 s85, s85, 128
s_add_u32 s86, s66, s61
s_add_u32 s86, s86, 256
s_add_u32 s87, s66, s61
s_add_u32 s87, s87, 384
s_add_u32 s88, s66, s61
s_add_u32 s88, s88, 512
s_add_u32 s57, s84, 0
s_add_u32 m0, s56, 0
s_nop 0
buffer_load_dwordx4 v16, s[12:15], s57 offen lds
s_add_u32 s57, s85, 0
s_add_u32 m0, s56, 8192
s_nop 0
buffer_load_dwordx4 v16, s[12:15], s57 offen lds
s_add_u32 s57, s86, 0
s_add_u32 m0, s56, 16384
s_nop 0
buffer_load_dwordx4 v16, s[12:15], s57 offen lds
s_add_u32 s57, s87, 0
s_add_u32 m0, s56, 24576
s_nop 0
buffer_load_dwordx4 v16, s[12:15], s57 offen lds
s_add_u32 s57, s88, 0
s_add_u32 m0, s56, 32768
s_nop 0
buffer_load_dwordx4 v16, s[12:15], s57 offen lds
s_add_u32 s57, s84, 73728
s_add_u32 m0, s56, 1024
s_nop 0
buffer_load_dwordx4 v17, s[12:15], s57 offen lds
s_add_u32 s57, s85, 73728
s_add_u32 m0, s56, 9216
s_nop 0
buffer_load_dwordx4 v17, s[12:15], s57 offen lds
s_add_u32 s57, s86, 73728
s_add_u32 m0, s56, 17408
s_nop 0
buffer_load_dwordx4 v17, s[12:15], s57 offen lds
s_add_u32 s57, s87, 73728
s_add_u32 m0, s56, 25600
s_nop 0
buffer_load_dwordx4 v17, s[12:15], s57 offen lds
s_add_u32 s57, s88, 73728
s_add_u32 m0, s56, 33792
s_nop 0
buffer_load_dwordx4 v17, s[12:15], s57 offen lds
s_add_u32 s57, s84, 589824
s_add_u32 m0, s56, 40960
s_nop 0
buffer_load_dwordx4 v16, s[12:15], s57 offen lds
s_add_u32 s57, s85, 589824
s_add_u32 m0, s56, 49152
s_nop 0
buffer_load_dwordx4 v16, s[12:15], s57 offen lds
s_add_u32 s57, s86, 589824
s_add_u32 m0, s56, 57344
s_nop 0
buffer_load_dwordx4 v16, s[12:15], s57 offen lds
s_add_u32 s57, s87, 589824
s_add_u32 m0, s56, 65536
s_nop 0
buffer_load_dwordx4 v16, s[12:15], s57 offen lds
s_add_u32 s57, s88, 589824
s_add_u32 m0, s56, 73728
s_nop 0
buffer_load_dwordx4 v16, s[12:15], s57 offen lds
s_add_u32 s57, s84, 663552
s_add_u32 m0, s56, 41984
s_nop 0
buffer_load_dwordx4 v17, s[12:15], s57 offen lds
s_add_u32 s57, s85, 663552
s_add_u32 m0, s56, 50176
s_nop 0
buffer_load_dwordx4 v17, s[12:15], s57 offen lds
s_add_u32 s57, s86, 663552
s_add_u32 m0, s56, 58368
s_nop 0
buffer_load_dwordx4 v17, s[12:15], s57 offen lds
s_add_u32 s57, s87, 663552
s_add_u32 m0, s56, 66560
s_nop 0
buffer_load_dwordx4 v17, s[12:15], s57 offen lds
s_add_u32 s57, s88, 663552
s_add_u32 m0, s56, 74752
s_nop 0
buffer_load_dwordx4 v17, s[12:15], s57 offen lds
v_lshrrev_b32 v208, 2, v3
v_bfe_u32 v209, v3, 3, 1
v_and_b32 v210, 1, v2
v_lshl_or_b32 v209, v210, 1, v209
v_lshlrev_b32 v209, 1, v209
v_lshl_add_u32 v208, v2, 3, v208
v_bfe_u32 v211, v3, 1, 1
v_add_u32 v211, s67, v211
v_lshrrev_b32 v212, 3, v211
v_and_b32 v211, 7, v211
v_xor_b32 v211, v211, v209
v_lshlrev_b32 v208, 7, v208
v_lshl_add_u32 v208, v211, 4, v208
v_mul_u32_u24 v212, 8192, v212
v_add_u32 v208, v208, v212
v_and_b32 v210, 1, v3
v_lshl_add_u32 v8, v210, 3, v208
v_lshrrev_b32 v208, 2, v3
v_bfe_u32 v209, v3, 3, 1
v_and_b32 v210, 1, v2
v_lshl_or_b32 v209, v210, 1, v209
v_lshlrev_b32 v209, 1, v209
v_lshl_add_u32 v208, v2, 3, v208
v_bfe_u32 v211, v3, 1, 1
v_add_u32 v211, s67, v211
v_add_u32 v211, 2, v211
v_lshrrev_b32 v212, 3, v211
v_and_b32 v211, 7, v211
v_xor_b32 v211, v211, v209
v_lshlrev_b32 v208, 7, v208
v_lshl_add_u32 v208, v211, 4, v208
v_mul_u32_u24 v212, 8192, v212
v_add_u32 v208, v208, v212
v_and_b32 v210, 1, v3
v_lshl_add_u32 v9, v210, 3, v208
v_lshrrev_b32 v208, 2, v3
v_bfe_u32 v209, v3, 3, 1
v_and_b32 v210, 1, v2
v_lshl_or_b32 v209, v210, 1, v209
v_lshlrev_b32 v209, 1, v209
v_lshl_add_u32 v208, v2, 3, v208
v_bfe_u32 v211, v3, 1, 1
v_add_u32 v211, s67, v211
v_add_u32 v211, 4, v211
v_lshrrev_b32 v212, 3, v211
v_and_b32 v211, 7, v211
v_xor_b32 v211, v211, v209
v_lshlrev_b32 v208, 7, v208
v_lshl_add_u32 v208, v211, 4, v208
v_mul_u32_u24 v212, 8192, v212
v_add_u32 v208, v208, v212
v_and_b32 v210, 1, v3
v_lshl_add_u32 v10, v210, 3, v208
v_lshrrev_b32 v208, 2, v3
v_bfe_u32 v209, v3, 3, 1
v_and_b32 v210, 1, v2
v_lshl_or_b32 v209, v210, 1, v209
v_lshlrev_b32 v209, 1, v209
v_lshl_add_u32 v208, v2, 3, v208
v_bfe_u32 v211, v3, 1, 1
v_add_u32 v211, s67, v211
v_add_u32 v211, 6, v211
v_lshrrev_b32 v212, 3, v211
v_and_b32 v211, 7, v211
v_xor_b32 v211, v211, v209
v_lshlrev_b32 v208, 7, v208
v_lshl_add_u32 v208, v211, 4, v208
v_mul_u32_u24 v212, 8192, v212
v_add_u32 v208, v208, v212
v_and_b32 v210, 1, v3
v_lshl_add_u32 v11, v210, 3, v208
v_lshlrev_b32 v28, 3, v2
s_mul_i32 s75, s59, 576
v_add_u32 v28, s75, v28
v_lshlrev_b32 v29, 4, v2
s_mul_i32 s75, s59, 1152
s_add_u32 s75, s75, 64487424
s_waitcnt vmcnt(10)
s_barrier
ds_read_b64_tr_b16 v[176:177], v8 offset:0
ds_read_b64_tr_b16 v[178:179], v8 offset:512
ds_read_b64_tr_b16 v[180:181], v9 offset:0
ds_read_b64_tr_b16 v[182:183], v9 offset:512
ds_read_b64_tr_b16 v[184:185], v10 offset:0
ds_read_b64_tr_b16 v[186:187], v10 offset:512
ds_read_b64_tr_b16 v[188:189], v11 offset:0
ds_read_b64_tr_b16 v[190:191], v11 offset:512
ds_read_b64_tr_b16 v[192:193], v8 offset:8192
ds_read_b64_tr_b16 v[194:195], v8 offset:8704
ds_read_b64_tr_b16 v[196:197], v9 offset:8192
ds_read_b64_tr_b16 v[198:199], v9 offset:8704
ds_read_b64_tr_b16 v[200:201], v10 offset:8192
ds_read_b64_tr_b16 v[202:203], v10 offset:8704
s_waitcnt lgkmcnt(12)
v_mfma_f32_16x16x32_bf16 a[0:3], v[176:179], v[32:35], 0
s_add_u32 s78, s73, 4096
buffer_load_dwordx4 v[48:51], v27, s[16:19], s78 offen offset:0
v_mfma_f32_16x16x32_bf16 a[72:75], v[176:179], v[104:107], 0
ds_read_b64_tr_b16 v[204:205], v11 offset:8192
ds_read_b64_tr_b16 v[206:207], v11 offset:8704
s_waitcnt lgkmcnt(12)
v_mfma_f32_16x16x32_bf16 a[4:7], v[180:183], v[32:35], 0
v_mfma_f32_16x16x32_bf16 a[76:79], v[180:183], v[104:107], 0
ds_read_b64_tr_b16 v[176:177], v8 offset:16384
ds_read_b64_tr_b16 v[178:179], v8 offset:16896
s_waitcnt lgkmcnt(12)
v_mfma_f32_16x16x32_bf16 a[8:11], v[184:187], v[32:35], 0
v_mfma_f32_16x16x32_bf16 a[80:83], v[184:187], v[104:107], 0
s_add_u32 s78, s73, 22528
buffer_load_dwordx4 v[120:123], v27, s[16:19], s78 offen offset:0
ds_read_b64_tr_b16 v[180:181], v9 offset:16384
ds_read_b64_tr_b16 v[182:183], v9 offset:16896
s_waitcnt lgkmcnt(12)
v_mfma_f32_16x16x32_bf16 a[12:15], v[188:191], v[32:35], 0
v_mfma_f32_16x16x32_bf16 a[84:87], v[188:191], v[104:107], 0
ds_read_b64_tr_b16 v[184:185], v10 offset:16384
ds_read_b64_tr_b16 v[186:187], v10 offset:16896
s_waitcnt lgkmcnt(12)
v_mfma_f32_16x16x32_bf16 a[16:19], v[192:195], v[32:35], 0
v_mfma_f32_16x16x32_bf16 a[88:91], v[192:195], v[104:107], 0
s_add_u32 s78, s73, 4096
buffer_load_dwordx4 v[52:55], v27, s[16:19], s78 offen offset:1024
ds_read_b64_tr_b16 v[188:189], v11 offset:16384
ds_read_b64_tr_b16 v[190:191], v11 offset:16896
s_waitcnt lgkmcnt(12)
v_mfma_f32_16x16x32_bf16 a[20:23], v[196:199], v[32:35], 0
v_mfma_f32_16x16x32_bf16 a[92:95], v[196:199], v[104:107], 0
ds_read_b64_tr_b16 v[192:193], v8 offset:24576
ds_read_b64_tr_b16 v[194:195], v8 offset:25088
s_waitcnt lgkmcnt(12)
v_mfma_f32_16x16x32_bf16 a[24:27], v[200:203], v[32:35], 0
v_mfma_f32_16x16x32_bf16 a[96:99], v[200:203], v[104:107], 0
s_add_u32 s78, s73, 22528
buffer_load_dwordx4 v[124:127], v27, s[16:19], s78 offen offset:1024
ds_read_b64_tr_b16 v[196:197], v9 offset:24576
ds_read_b64_tr_b16 v[198:199], v9 offset:25088
s_waitcnt lgkmcnt(12)
v_mfma_f32_16x16x32_bf16 a[28:31], v[204:207], v[32:35], 0
v_mfma_f32_16x16x32_bf16 a[100:103], v[204:207], v[104:107], 0
ds_read_b64_tr_b16 v[200:201], v10 offset:24576
ds_read_b64_tr_b16 v[202:203], v10 offset:25088
s_waitcnt lgkmcnt(12)
v_mfma_f32_16x16x32_bf16 a[32:35], v[176:179], v[32:35], 0
v_mfma_f32_16x16x32_bf16 a[104:107], v[176:179], v[104:107], 0
s_add_u32 s57, s84, 1179648
s_add_u32 m0, s56, 81920
s_nop 0
buffer_load_dwordx4 v16, s[12:15], s57 offen lds
ds_read_b64_tr_b16 v[204:205], v11 offset:24576
ds_read_b64_tr_b16 v[206:207], v11 offset:25088
s_waitcnt lgkmcnt(12)
v_mfma_f32_16x16x32_bf16 a[36:39], v[180:183], v[32:35], 0
v_mfma_f32_16x16x32_bf16 a[108:111], v[180:183], v[104:107], 0
ds_read_b64_tr_b16 v[176:177], v8 offset:32768
ds_read_b64_tr_b16 v[178:179], v8 offset:33280
s_waitcnt lgkmcnt(12)
v_mfma_f32_16x16x32_bf16 a[40:43], v[184:187], v[32:35], 0
v_mfma_f32_16x16x32_bf16 a[112:115], v[184:187], v[104:107], 0
s_add_u32 s57, s85, 1179648
s_add_u32 m0, s56, 90112
s_nop 0
buffer_load_dwordx4 v16, s[12:15], s57 offen lds
ds_read_b64_tr_b16 v[180:181], v9 offset:32768
ds_read_b64_tr_b16 v[182:183], v9 offset:33280
s_waitcnt lgkmcnt(12)
v_mfma_f32_16x16x32_bf16 a[44:47], v[188:191], v[32:35], 0
v_mfma_f32_16x16x32_bf16 a[116:119], v[188:191], v[104:107], 0
ds_read_b64_tr_b16 v[184:185], v8 offset:4096
ds_read_b64_tr_b16 v[186:187], v8 offset:4608
s_waitcnt lgkmcnt(12)
v_mfma_f32_16x16x32_bf16 a[48:51], v[192:195], v[32:35], 0
v_mfma_f32_16x16x32_bf16 a[120:123], v[192:195], v[104:107], 0
s_add_u32 s57, s86, 1179648
s_add_u32 m0, s56, 98304
s_nop 0
buffer_load_dwordx4 v16, s[12:15], s57 offen lds
ds_read_b64_tr_b16 v[188:189], v9 offset:4096
ds_read_b64_tr_b16 v[190:191], v9 offset:4608
s_waitcnt lgkmcnt(12)
v_mfma_f32_16x16x32_bf16 a[52:55], v[196:199], v[32:35], 0
v_mfma_f32_16x16x32_bf16 a[124:127], v[196:199], v[104:107], 0
ds_read_b64_tr_b16 v[192:193], v10 offset:4096
ds_read_b64_tr_b16 v[194:195], v10 offset:4608
s_waitcnt lgkmcnt(12)
v_mfma_f32_16x16x32_bf16 a[56:59], v[200:203], v[32:35], 0
v_mfma_f32_16x16x32_bf16 a[128:131], v[200:203], v[104:107], 0
s_add_u32 s57, s87, 1179648
s_add_u32 m0, s56, 106496
s_nop 0
buffer_load_dwordx4 v16, s[12:15], s57 offen lds
ds_read_b64_tr_b16 v[196:197], v11 offset:4096
ds_read_b64_tr_b16 v[198:199], v11 offset:4608
s_waitcnt lgkmcnt(12)
v_mfma_f32_16x16x32_bf16 a[60:63], v[204:207], v[32:35], 0
v_mfma_f32_16x16x32_bf16 a[132:135], v[204:207], v[104:107], 0
ds_read_b64_tr_b16 v[200:201], v8 offset:12288
ds_read_b64_tr_b16 v[202:203], v8 offset:12800
s_waitcnt lgkmcnt(12)
v_mfma_f32_16x16x32_bf16 a[64:67], v[176:179], v[32:35], 0
v_mfma_f32_16x16x32_bf16 a[136:139], v[176:179], v[104:107], 0
ds_read_b64_tr_b16 v[204:205], v9 offset:12288
ds_read_b64_tr_b16 v[206:207], v9 offset:12800
s_waitcnt lgkmcnt(12)
v_mfma_f32_16x16x32_bf16 a[68:71], v[180:183], v[32:35], 0
s_add_u32 s57, s88, 1179648
s_add_u32 m0, s56, 114688
s_nop 0
buffer_load_dwordx4 v16, s[12:15], s57 offen lds
v_mfma_f32_16x16x32_bf16 a[140:143], v[180:183], v[104:107], 0
ds_read_b64_tr_b16 v[176:177], v10 offset:12288
ds_read_b64_tr_b16 v[178:179], v10 offset:12800
s_waitcnt lgkmcnt(12)
v_mfma_f32_16x16x32_bf16 a[0:3], v[184:187], v[36:39], a[0:3]
v_mfma_f32_16x16x32_bf16 a[72:75], v[184:187], v[108:111], a[72:75]
ds_read_b64_tr_b16 v[180:181], v11 offset:12288
ds_read_b64_tr_b16 v[182:183], v11 offset:12800
s_waitcnt lgkmcnt(12)
v_mfma_f32_16x16x32_bf16 a[4:7], v[188:191], v[36:39], a[4:7]
s_add_u32 s57, s84, 1253376
s_add_u32 m0, s56, 82944
s_nop 0
buffer_load_dwordx4 v17, s[12:15], s57 offen lds
v_mfma_f32_16x16x32_bf16 a[76:79], v[188:191], v[108:111], a[76:79]
ds_read_b64_tr_b16 v[184:185], v8 offset:20480
ds_read_b64_tr_b16 v[186:187], v8 offset:20992
s_waitcnt lgkmcnt(12)
v_mfma_f32_16x16x32_bf16 a[8:11], v[192:195], v[36:39], a[8:11]
v_mfma_f32_16x16x32_bf16 a[80:83], v[192:195], v[108:111], a[80:83]
ds_read_b64_tr_b16 v[188:189], v9 offset:20480
ds_read_b64_tr_b16 v[190:191], v9 offset:20992
s_waitcnt lgkmcnt(12)
v_mfma_f32_16x16x32_bf16 a[12:15], v[196:199], v[36:39], a[12:15]
s_add_u32 s57, s85, 1253376
s_add_u32 m0, s56, 91136
s_nop 0
buffer_load_dwordx4 v17, s[12:15], s57 offen lds
v_mfma_f32_16x16x32_bf16 a[84:87], v[196:199], v[108:111], a[84:87]
ds_read_b64_tr_b16 v[192:193], v10 offset:20480
ds_read_b64_tr_b16 v[194:195], v10 offset:20992
s_waitcnt lgkmcnt(12)
v_mfma_f32_16x16x32_bf16 a[16:19], v[200:203], v[36:39], a[16:19]
v_mfma_f32_16x16x32_bf16 a[88:91], v[200:203], v[108:111], a[88:91]
ds_read_b64_tr_b16 v[196:197], v11 offset:20480
ds_read_b64_tr_b16 v[198:199], v11 offset:20992
s_waitcnt lgkmcnt(12)
v_mfma_f32_16x16x32_bf16 a[20:23], v[204:207], v[36:39], a[20:23]
s_add_u32 s57, s86, 1253376
s_add_u32 m0, s56, 99328
s_nop 0
buffer_load_dwordx4 v17, s[12:15], s57 offen lds
v_mfma_f32_16x16x32_bf16 a[92:95], v[204:207], v[108:111], a[92:95]
ds_read_b64_tr_b16 v[200:201], v8 offset:28672
ds_read_b64_tr_b16 v[202:203], v8 offset:29184
s_waitcnt lgkmcnt(12)
v_mfma_f32_16x16x32_bf16 a[24:27], v[176:179], v[36:39], a[24:27]
v_mfma_f32_16x16x32_bf16 a[96:99], v[176:179], v[108:111], a[96:99]
ds_read_b64_tr_b16 v[204:205], v9 offset:28672
ds_read_b64_tr_b16 v[206:207], v9 offset:29184
s_waitcnt lgkmcnt(12)
v_mfma_f32_16x16x32_bf16 a[28:31], v[180:183], v[36:39], a[28:31]
s_add_u32 s57, s87, 1253376
s_add_u32 m0, s56, 107520
s_nop 0
buffer_load_dwordx4 v17, s[12:15], s57 offen lds
v_mfma_f32_16x16x32_bf16 a[100:103], v[180:183], v[108:111], a[100:103]
ds_read_b64_tr_b16 v[176:177], v10 offset:28672
ds_read_b64_tr_b16 v[178:179], v10 offset:29184
s_waitcnt lgkmcnt(12)
v_mfma_f32_16x16x32_bf16 a[32:35], v[184:187], v[36:39], a[32:35]
v_mfma_f32_16x16x32_bf16 a[104:107], v[184:187], v[108:111], a[104:107]
ds_read_b64_tr_b16 v[180:181], v11 offset:28672
ds_read_b64_tr_b16 v[182:183], v11 offset:29184
s_waitcnt lgkmcnt(12)
v_mfma_f32_16x16x32_bf16 a[36:39], v[188:191], v[36:39], a[36:39]
s_add_u32 s57, s88, 1253376
s_add_u32 m0, s56, 115712
s_nop 0
buffer_load_dwordx4 v17, s[12:15], s57 offen lds
v_mfma_f32_16x16x32_bf16 a[108:111], v[188:191], v[108:111], a[108:111]
ds_read_b64_tr_b16 v[184:185], v8 offset:36864
ds_read_b64_tr_b16 v[186:187], v8 offset:37376
s_waitcnt lgkmcnt(12)
v_mfma_f32_16x16x32_bf16 a[40:43], v[192:195], v[36:39], a[40:43]
v_mfma_f32_16x16x32_bf16 a[112:115], v[192:195], v[108:111], a[112:115]
ds_read_b64_tr_b16 v[188:189], v9 offset:36864
ds_read_b64_tr_b16 v[190:191], v9 offset:37376
s_waitcnt lgkmcnt(12)
v_mfma_f32_16x16x32_bf16 a[44:47], v[196:199], v[36:39], a[44:47]
v_mfma_f32_16x16x32_bf16 a[116:119], v[196:199], v[108:111], a[116:119]
s_waitcnt vmcnt(14)
s_barrier
v_add_u32 v8, 40960, v8
v_add_u32 v9, 40960, v9
v_add_u32 v10, 40960, v10
v_add_u32 v11, 40960, v11
ds_read_b64_tr_b16 v[192:193], v8 offset:0
ds_read_b64_tr_b16 v[194:195], v8 offset:512
s_waitcnt lgkmcnt(12)
v_mfma_f32_16x16x32_bf16 a[48:51], v[200:203], v[36:39], a[48:51]
v_mfma_f32_16x16x32_bf16 a[120:123], v[200:203], v[108:111], a[120:123]
ds_read_b64_tr_b16 v[196:197], v9 offset:0
ds_read_b64_tr_b16 v[198:199], v9 offset:512
s_waitcnt lgkmcnt(12)
v_mfma_f32_16x16x32_bf16 a[52:55], v[204:207], v[36:39], a[52:55]
v_mfma_f32_16x16x32_bf16 a[124:127], v[204:207], v[108:111], a[124:127]
ds_read_b64_tr_b16 v[200:201], v10 offset:0
ds_read_b64_tr_b16 v[202:203], v10 offset:512
s_waitcnt lgkmcnt(12)
v_mfma_f32_16x16x32_bf16 a[56:59], v[176:179], v[36:39], a[56:59]
v_mfma_f32_16x16x32_bf16 a[128:131], v[176:179], v[108:111], a[128:131]
ds_read_b64_tr_b16 v[204:205], v11 offset:0
ds_read_b64_tr_b16 v[206:207], v11 offset:512
s_waitcnt lgkmcnt(12)
v_mfma_f32_16x16x32_bf16 a[60:63], v[180:183], v[36:39], a[60:63]
v_mfma_f32_16x16x32_bf16 a[132:135], v[180:183], v[108:111], a[132:135]
ds_read_b64_tr_b16 v[176:177], v8 offset:8192
ds_read_b64_tr_b16 v[178:179], v8 offset:8704
s_waitcnt lgkmcnt(12)
v_mfma_f32_16x16x32_bf16 a[64:67], v[184:187], v[36:39], a[64:67]
v_mfma_f32_16x16x32_bf16 a[136:139], v[184:187], v[108:111], a[136:139]
ds_read_b64_tr_b16 v[180:181], v9 offset:8192
ds_read_b64_tr_b16 v[182:183], v9 offset:8704
s_waitcnt lgkmcnt(12)
v_mfma_f32_16x16x32_bf16 a[68:71], v[188:191], v[36:39], a[68:71]
v_mfma_f32_16x16x32_bf16 a[140:143], v[188:191], v[108:111], a[140:143]
ds_read_b64_tr_b16 v[184:185], v10 offset:8192
ds_read_b64_tr_b16 v[186:187], v10 offset:8704
s_waitcnt lgkmcnt(12)
v_mfma_f32_16x16x32_bf16 a[0:3], v[192:195], v[40:43], a[0:3]
s_add_u32 s78, s73, 4096
buffer_load_dwordx4 v[56:59], v27, s[16:19], s78 offen offset:2048
v_mfma_f32_16x16x32_bf16 a[72:75], v[192:195], v[112:115], a[72:75]
ds_read_b64_tr_b16 v[188:189], v11 offset:8192
ds_read_b64_tr_b16 v[190:191], v11 offset:8704
s_waitcnt lgkmcnt(12)
v_mfma_f32_16x16x32_bf16 a[4:7], v[196:199], v[40:43], a[4:7]
v_mfma_f32_16x16x32_bf16 a[76:79], v[196:199], v[112:115], a[76:79]
ds_read_b64_tr_b16 v[192:193], v8 offset:16384
ds_read_b64_tr_b16 v[194:195], v8 offset:16896
s_waitcnt lgkmcnt(12)
v_mfma_f32_16x16x32_bf16 a[8:11], v[200:203], v[40:43], a[8:11]
v_mfma_f32_16x16x32_bf16 a[80:83], v[200:203], v[112:115], a[80:83]
s_add_u32 s78, s73, 22528
buffer_load_dwordx4 v[128:131], v27, s[16:19], s78 offen offset:2048
ds_read_b64_tr_b16 v[196:197], v9 offset:16384
ds_read_b64_tr_b16 v[198:199], v9 offset:16896
s_waitcnt lgkmcnt(12)
v_mfma_f32_16x16x32_bf16 a[12:15], v[204:207], v[40:43], a[12:15]
v_mfma_f32_16x16x32_bf16 a[84:87], v[204:207], v[112:115], a[84:87]
ds_read_b64_tr_b16 v[200:201], v10 offset:16384
ds_read_b64_tr_b16 v[202:203], v10 offset:16896
s_waitcnt lgkmcnt(12)
v_mfma_f32_16x16x32_bf16 a[16:19], v[176:179], v[40:43], a[16:19]
v_mfma_f32_16x16x32_bf16 a[88:91], v[176:179], v[112:115], a[88:91]
s_add_u32 s78, s73, 4096
buffer_load_dwordx4 v[60:63], v27, s[16:19], s78 offen offset:3072
buffer_load_dwordx2 a[144:145], v28, s[20:23], 0 offen offset:0
ds_read_b64_tr_b16 v[204:205], v11 offset:16384
ds_read_b64_tr_b16 v[206:207], v11 offset:16896
s_waitcnt lgkmcnt(12)
v_mfma_f32_16x16x32_bf16 a[20:23], v[180:183], v[40:43], a[20:23]
v_mfma_f32_16x16x32_bf16 a[92:95], v[180:183], v[112:115], a[92:95]
ds_read_b64_tr_b16 v[176:177], v8 offset:24576
ds_read_b64_tr_b16 v[178:179], v8 offset:25088
s_waitcnt lgkmcnt(12)
v_mfma_f32_16x16x32_bf16 a[24:27], v[184:187], v[40:43], a[24:27]
v_mfma_f32_16x16x32_bf16 a[96:99], v[184:187], v[112:115], a[96:99]
s_add_u32 s78, s73, 22528
buffer_load_dwordx4 v[132:135], v27, s[16:19], s78 offen offset:3072
ds_read_b64_tr_b16 v[180:181], v9 offset:24576
ds_read_b64_tr_b16 v[182:183], v9 offset:25088
s_waitcnt lgkmcnt(12)
v_mfma_f32_16x16x32_bf16 a[28:31], v[188:191], v[40:43], a[28:31]
v_mfma_f32_16x16x32_bf16 a[100:103], v[188:191], v[112:115], a[100:103]
ds_read_b64_tr_b16 v[184:185], v10 offset:24576
ds_read_b64_tr_b16 v[186:187], v10 offset:25088
s_waitcnt lgkmcnt(12)
v_mfma_f32_16x16x32_bf16 a[32:35], v[192:195], v[40:43], a[32:35]
v_mfma_f32_16x16x32_bf16 a[104:107], v[192:195], v[112:115], a[104:107]
s_add_u32 s57, s84, 1769472
s_add_u32 m0, s56, 122880
s_nop 0
buffer_load_dwordx4 v16, s[12:15], s57 offen lds
buffer_load_dwordx4 a[180:183], v29, s[16:19], s75 offen offset:0
ds_read_b64_tr_b16 v[188:189], v11 offset:24576
ds_read_b64_tr_b16 v[190:191], v11 offset:25088
s_waitcnt lgkmcnt(12)
v_mfma_f32_16x16x32_bf16 a[36:39], v[196:199], v[40:43], a[36:39]
v_mfma_f32_16x16x32_bf16 a[108:111], v[196:199], v[112:115], a[108:111]
ds_read_b64_tr_b16 v[192:193], v8 offset:32768
ds_read_b64_tr_b16 v[194:195], v8 offset:33280
s_waitcnt lgkmcnt(12)
v_mfma_f32_16x16x32_bf16 a[40:43], v[200:203], v[40:43], a[40:43]
v_mfma_f32_16x16x32_bf16 a[112:115], v[200:203], v[112:115], a[112:115]
s_add_u32 s57, s85, 1769472
s_add_u32 m0, s56, 131072
s_nop 0
buffer_load_dwordx4 v16, s[12:15], s57 offen lds
ds_read_b64_tr_b16 v[196:197], v9 offset:32768
ds_read_b64_tr_b16 v[198:199], v9 offset:33280
s_waitcnt lgkmcnt(12)
v_mfma_f32_16x16x32_bf16 a[44:47], v[204:207], v[40:43], a[44:47]
v_mfma_f32_16x16x32_bf16 a[116:119], v[204:207], v[112:115], a[116:119]
ds_read_b64_tr_b16 v[200:201], v8 offset:4096
ds_read_b64_tr_b16 v[202:203], v8 offset:4608
s_waitcnt lgkmcnt(12)
v_mfma_f32_16x16x32_bf16 a[48:51], v[176:179], v[40:43], a[48:51]
v_mfma_f32_16x16x32_bf16 a[120:123], v[176:179], v[112:115], a[120:123]
s_add_u32 s57, s86, 1769472
s_add_u32 m0, s56, 139264
s_nop 0
buffer_load_dwordx4 v16, s[12:15], s57 offen lds
buffer_load_dwordx2 a[146:147], v28, s[20:23], 0 offen offset:32
ds_read_b64_tr_b16 v[204:205], v9 offset:4096
ds_read_b64_tr_b16 v[206:207], v9 offset:4608
s_waitcnt lgkmcnt(12)
v_mfma_f32_16x16x32_bf16 a[52:55], v[180:183], v[40:43], a[52:55]
v_mfma_f32_16x16x32_bf16 a[124:127], v[180:183], v[112:115], a[124:127]
ds_read_b64_tr_b16 v[176:177], v10 offset:4096
ds_read_b64_tr_b16 v[178:179], v10 offset:4608
s_waitcnt lgkmcnt(12)
v_mfma_f32_16x16x32_bf16 a[56:59], v[184:187], v[40:43], a[56:59]
v_mfma_f32_16x16x32_bf16 a[128:131], v[184:187], v[112:115], a[128:131]
s_add_u32 s57, s87, 1769472
s_add_u32 m0, s56, 147456
s_nop 0
buffer_load_dwordx4 v16, s[12:15], s57 offen lds
ds_read_b64_tr_b16 v[180:181], v11 offset:4096
ds_read_b64_tr_b16 v[182:183], v11 offset:4608
s_waitcnt lgkmcnt(12)
v_mfma_f32_16x16x32_bf16 a[60:63], v[188:191], v[40:43], a[60:63]
v_mfma_f32_16x16x32_bf16 a[132:135], v[188:191], v[112:115], a[132:135]
ds_read_b64_tr_b16 v[184:185], v8 offset:12288
ds_read_b64_tr_b16 v[186:187], v8 offset:12800
s_waitcnt lgkmcnt(12)
v_mfma_f32_16x16x32_bf16 a[64:67], v[192:195], v[40:43], a[64:67]
v_mfma_f32_16x16x32_bf16 a[136:139], v[192:195], v[112:115], a[136:139]
buffer_load_dwordx4 a[184:187], v29, s[16:19], s75 offen offset:64
ds_read_b64_tr_b16 v[188:189], v9 offset:12288
ds_read_b64_tr_b16 v[190:191], v9 offset:12800
s_waitcnt lgkmcnt(12)
v_mfma_f32_16x16x32_bf16 a[68:71], v[196:199], v[40:43], a[68:71]
s_add_u32 s57, s88, 1769472
s_add_u32 m0, s56, 155648
s_nop 0
buffer_load_dwordx4 v16, s[12:15], s57 offen lds
v_mfma_f32_16x16x32_bf16 a[140:143], v[196:199], v[112:115], a[140:143]
ds_read_b64_tr_b16 v[192:193], v10 offset:12288
ds_read_b64_tr_b16 v[194:195], v10 offset:12800
s_waitcnt lgkmcnt(12)
v_mfma_f32_16x16x32_bf16 a[0:3], v[200:203], v[44:47], a[0:3]
v_mfma_f32_16x16x32_bf16 a[72:75], v[200:203], v[116:119], a[72:75]
ds_read_b64_tr_b16 v[196:197], v11 offset:12288
ds_read_b64_tr_b16 v[198:199], v11 offset:12800
s_waitcnt lgkmcnt(12)
v_mfma_f32_16x16x32_bf16 a[4:7], v[204:207], v[44:47], a[4:7]
s_add_u32 s57, s84, 1843200
s_add_u32 m0, s56, 123904
s_nop 0
buffer_load_dwordx4 v17, s[12:15], s57 offen lds
v_mfma_f32_16x16x32_bf16 a[76:79], v[204:207], v[116:119], a[76:79]
ds_read_b64_tr_b16 v[200:201], v8 offset:20480
ds_read_b64_tr_b16 v[202:203], v8 offset:20992
s_waitcnt lgkmcnt(12)
v_mfma_f32_16x16x32_bf16 a[8:11], v[176:179], v[44:47], a[8:11]
v_mfma_f32_16x16x32_bf16 a[80:83], v[176:179], v[116:119], a[80:83]
buffer_load_dwordx2 a[148:149], v28, s[20:23], 0 offen offset:64
ds_read_b64_tr_b16 v[204:205], v9 offset:20480
ds_read_b64_tr_b16 v[206:207], v9 offset:20992
s_waitcnt lgkmcnt(12)
v_mfma_f32_16x16x32_bf16 a[12:15], v[180:183], v[44:47], a[12:15]
s_add_u32 s57, s85, 1843200
s_add_u32 m0, s56, 132096
s_nop 0
buffer_load_dwordx4 v17, s[12:15], s57 offen lds
v_mfma_f32_16x16x32_bf16 a[84:87], v[180:183], v[116:119], a[84:87]
ds_read_b64_tr_b16 v[176:177], v10 offset:20480
ds_read_b64_tr_b16 v[178:179], v10 offset:20992
s_waitcnt lgkmcnt(12)
v_mfma_f32_16x16x32_bf16 a[16:19], v[184:187], v[44:47], a[16:19]
v_mfma_f32_16x16x32_bf16 a[88:91], v[184:187], v[116:119], a[88:91]
ds_read_b64_tr_b16 v[180:181], v11 offset:20480
ds_read_b64_tr_b16 v[182:183], v11 offset:20992
s_waitcnt lgkmcnt(12)
v_mfma_f32_16x16x32_bf16 a[20:23], v[188:191], v[44:47], a[20:23]
s_add_u32 s57, s86, 1843200
s_add_u32 m0, s56, 140288
s_nop 0
buffer_load_dwordx4 v17, s[12:15], s57 offen lds
v_mfma_f32_16x16x32_bf16 a[92:95], v[188:191], v[116:119], a[92:95]
ds_read_b64_tr_b16 v[184:185], v8 offset:28672
ds_read_b64_tr_b16 v[186:187], v8 offset:29184
s_waitcnt lgkmcnt(12)
v_mfma_f32_16x16x32_bf16 a[24:27], v[192:195], v[44:47], a[24:27]
v_mfma_f32_16x16x32_bf16 a[96:99], v[192:195], v[116:119], a[96:99]
buffer_load_dwordx4 a[188:191], v29, s[16:19], s75 offen offset:128
ds_read_b64_tr_b16 v[188:189], v9 offset:28672
ds_read_b64_tr_b16 v[190:191], v9 offset:29184
s_waitcnt lgkmcnt(12)
v_mfma_f32_16x16x32_bf16 a[28:31], v[196:199], v[44:47], a[28:31]
s_add_u32 s57, s87, 1843200
s_add_u32 m0, s56, 148480
s_nop 0
buffer_load_dwordx4 v17, s[12:15], s57 offen lds
v_mfma_f32_16x16x32_bf16 a[100:103], v[196:199], v[116:119], a[100:103]
ds_read_b64_tr_b16 v[192:193], v10 offset:28672
ds_read_b64_tr_b16 v[194:195], v10 offset:29184
s_waitcnt lgkmcnt(12)
v_mfma_f32_16x16x32_bf16 a[32:35], v[200:203], v[44:47], a[32:35]
v_mfma_f32_16x16x32_bf16 a[104:107], v[200:203], v[116:119], a[104:107]
ds_read_b64_tr_b16 v[196:197], v11 offset:28672
ds_read_b64_tr_b16 v[198:199], v11 offset:29184
s_waitcnt lgkmcnt(12)
v_mfma_f32_16x16x32_bf16 a[36:39], v[204:207], v[44:47], a[36:39]
s_add_u32 s57, s88, 1843200
s_add_u32 m0, s56, 156672
s_nop 0
buffer_load_dwordx4 v17, s[12:15], s57 offen lds
v_mfma_f32_16x16x32_bf16 a[108:111], v[204:207], v[116:119], a[108:111]
ds_read_b64_tr_b16 v[200:201], v8 offset:36864
ds_read_b64_tr_b16 v[202:203], v8 offset:37376
s_waitcnt lgkmcnt(12)
v_mfma_f32_16x16x32_bf16 a[40:43], v[176:179], v[44:47], a[40:43]
v_mfma_f32_16x16x32_bf16 a[112:115], v[176:179], v[116:119], a[112:115]
buffer_load_dwordx2 a[150:151], v28, s[20:23], 0 offen offset:96
ds_read_b64_tr_b16 v[204:205], v9 offset:36864
ds_read_b64_tr_b16 v[206:207], v9 offset:37376
s_waitcnt lgkmcnt(12)
v_mfma_f32_16x16x32_bf16 a[44:47], v[180:183], v[44:47], a[44:47]
v_mfma_f32_16x16x32_bf16 a[116:119], v[180:183], v[116:119], a[116:119]
s_waitcnt vmcnt(21)
s_barrier
v_add_u32 v8, 40960, v8
v_add_u32 v9, 40960, v9
v_add_u32 v10, 40960, v10
v_add_u32 v11, 40960, v11
ds_read_b64_tr_b16 v[176:177], v8 offset:0
ds_read_b64_tr_b16 v[178:179], v8 offset:512
s_waitcnt lgkmcnt(12)
v_mfma_f32_16x16x32_bf16 a[48:51], v[184:187], v[44:47], a[48:51]
v_mfma_f32_16x16x32_bf16 a[120:123], v[184:187], v[116:119], a[120:123]
ds_read_b64_tr_b16 v[180:181], v9 offset:0
ds_read_b64_tr_b16 v[182:183], v9 offset:512
s_waitcnt lgkmcnt(12)
v_mfma_f32_16x16x32_bf16 a[52:55], v[188:191], v[44:47], a[52:55]
v_mfma_f32_16x16x32_bf16 a[124:127], v[188:191], v[116:119], a[124:127]
ds_read_b64_tr_b16 v[184:185], v10 offset:0
ds_read_b64_tr_b16 v[186:187], v10 offset:512
s_waitcnt lgkmcnt(12)
v_mfma_f32_16x16x32_bf16 a[56:59], v[192:195], v[44:47], a[56:59]
v_mfma_f32_16x16x32_bf16 a[128:131], v[192:195], v[116:119], a[128:131]
buffer_load_dwordx4 a[192:195], v29, s[16:19], s75 offen offset:192
ds_read_b64_tr_b16 v[188:189], v11 offset:0
ds_read_b64_tr_b16 v[190:191], v11 offset:512
s_waitcnt lgkmcnt(12)
v_mfma_f32_16x16x32_bf16 a[60:63], v[196:199], v[44:47], a[60:63]
v_mfma_f32_16x16x32_bf16 a[132:135], v[196:199], v[116:119], a[132:135]
ds_read_b64_tr_b16 v[192:193], v8 offset:8192
ds_read_b64_tr_b16 v[194:195], v8 offset:8704
s_waitcnt lgkmcnt(12)
v_mfma_f32_16x16x32_bf16 a[64:67], v[200:203], v[44:47], a[64:67]
v_mfma_f32_16x16x32_bf16 a[136:139], v[200:203], v[116:119], a[136:139]
ds_read_b64_tr_b16 v[196:197], v9 offset:8192
ds_read_b64_tr_b16 v[198:199], v9 offset:8704
s_waitcnt lgkmcnt(12)
v_mfma_f32_16x16x32_bf16 a[68:71], v[204:207], v[44:47], a[68:71]
v_mfma_f32_16x16x32_bf16 a[140:143], v[204:207], v[116:119], a[140:143]
ds_read_b64_tr_b16 v[200:201], v10 offset:8192
ds_read_b64_tr_b16 v[202:203], v10 offset:8704
s_waitcnt lgkmcnt(12)
v_mfma_f32_16x16x32_bf16 a[0:3], v[176:179], v[48:51], a[0:3]
s_add_u32 s78, s73, 8192
buffer_load_dwordx4 v[64:67], v27, s[16:19], s78 offen offset:0
v_mfma_f32_16x16x32_bf16 a[72:75], v[176:179], v[120:123], a[72:75]
buffer_load_dwordx2 a[152:153], v28, s[20:23], 0 offen offset:128
ds_read_b64_tr_b16 v[204:205], v11 offset:8192
ds_read_b64_tr_b16 v[206:207], v11 offset:8704
s_waitcnt lgkmcnt(12)
v_mfma_f32_16x16x32_bf16 a[4:7], v[180:183], v[48:51], a[4:7]
v_mfma_f32_16x16x32_bf16 a[76:79], v[180:183], v[120:123], a[76:79]
ds_read_b64_tr_b16 v[176:177], v8 offset:16384
ds_read_b64_tr_b16 v[178:179], v8 offset:16896
s_waitcnt lgkmcnt(12)
v_mfma_f32_16x16x32_bf16 a[8:11], v[184:187], v[48:51], a[8:11]
v_mfma_f32_16x16x32_bf16 a[80:83], v[184:187], v[120:123], a[80:83]
s_add_u32 s78, s73, 26624
buffer_load_dwordx4 v[136:139], v27, s[16:19], s78 offen offset:0
ds_read_b64_tr_b16 v[180:181], v9 offset:16384
ds_read_b64_tr_b16 v[182:183], v9 offset:16896
s_waitcnt lgkmcnt(12)
v_mfma_f32_16x16x32_bf16 a[12:15], v[188:191], v[48:51], a[12:15]
v_mfma_f32_16x16x32_bf16 a[84:87], v[188:191], v[120:123], a[84:87]
ds_read_b64_tr_b16 v[184:185], v10 offset:16384
ds_read_b64_tr_b16 v[186:187], v10 offset:16896
s_waitcnt lgkmcnt(12)
v_mfma_f32_16x16x32_bf16 a[16:19], v[192:195], v[48:51], a[16:19]
v_mfma_f32_16x16x32_bf16 a[88:91], v[192:195], v[120:123], a[88:91]
s_add_u32 s78, s73, 8192
buffer_load_dwordx4 v[68:71], v27, s[16:19], s78 offen offset:1024
buffer_load_dwordx4 a[196:199], v29, s[16:19], s75 offen offset:256
ds_read_b64_tr_b16 v[188:189], v11 offset:16384
ds_read_b64_tr_b16 v[190:191], v11 offset:16896
s_waitcnt lgkmcnt(12)
v_mfma_f32_16x16x32_bf16 a[20:23], v[196:199], v[48:51], a[20:23]
v_mfma_f32_16x16x32_bf16 a[92:95], v[196:199], v[120:123], a[92:95]
ds_read_b64_tr_b16 v[192:193], v8 offset:24576
ds_read_b64_tr_b16 v[194:195], v8 offset:25088
s_waitcnt lgkmcnt(12)
v_mfma_f32_16x16x32_bf16 a[24:27], v[200:203], v[48:51], a[24:27]
v_mfma_f32_16x16x32_bf16 a[96:99], v[200:203], v[120:123], a[96:99]
s_add_u32 s78, s73, 26624
buffer_load_dwordx4 v[140:143], v27, s[16:19], s78 offen offset:1024
ds_read_b64_tr_b16 v[196:197], v9 offset:24576
ds_read_b64_tr_b16 v[198:199], v9 offset:25088
s_waitcnt lgkmcnt(12)
v_mfma_f32_16x16x32_bf16 a[28:31], v[204:207], v[48:51], a[28:31]
v_mfma_f32_16x16x32_bf16 a[100:103], v[204:207], v[120:123], a[100:103]
ds_read_b64_tr_b16 v[200:201], v10 offset:24576
ds_read_b64_tr_b16 v[202:203], v10 offset:25088
s_waitcnt lgkmcnt(12)
v_mfma_f32_16x16x32_bf16 a[32:35], v[176:179], v[48:51], a[32:35]
v_mfma_f32_16x16x32_bf16 a[104:107], v[176:179], v[120:123], a[104:107]
s_add_u32 s57, s84, 2359296
s_add_u32 m0, s56, 0
s_nop 0
buffer_load_dwordx4 v16, s[12:15], s57 offen lds
buffer_load_dwordx2 a[154:155], v28, s[20:23], 0 offen offset:160
ds_read_b64_tr_b16 v[204:205], v11 offset:24576
ds_read_b64_tr_b16 v[206:207], v11 offset:25088
s_waitcnt lgkmcnt(12)
v_mfma_f32_16x16x32_bf16 a[36:39], v[180:183], v[48:51], a[36:39]
v_mfma_f32_16x16x32_bf16 a[108:111], v[180:183], v[120:123], a[108:111]
ds_read_b64_tr_b16 v[176:177], v8 offset:32768
ds_read_b64_tr_b16 v[178:179], v8 offset:33280
s_waitcnt lgkmcnt(12)
v_mfma_f32_16x16x32_bf16 a[40:43], v[184:187], v[48:51], a[40:43]
v_mfma_f32_16x16x32_bf16 a[112:115], v[184:187], v[120:123], a[112:115]
s_add_u32 s57, s85, 2359296
s_add_u32 m0, s56, 8192
s_nop 0
buffer_load_dwordx4 v16, s[12:15], s57 offen lds
ds_read_b64_tr_b16 v[180:181], v9 offset:32768
ds_read_b64_tr_b16 v[182:183], v9 offset:33280
s_waitcnt lgkmcnt(12)
v_mfma_f32_16x16x32_bf16 a[44:47], v[188:191], v[48:51], a[44:47]
v_mfma_f32_16x16x32_bf16 a[116:119], v[188:191], v[120:123], a[116:119]
ds_read_b64_tr_b16 v[184:185], v8 offset:4096
ds_read_b64_tr_b16 v[186:187], v8 offset:4608
s_waitcnt lgkmcnt(12)
v_mfma_f32_16x16x32_bf16 a[48:51], v[192:195], v[48:51], a[48:51]
v_mfma_f32_16x16x32_bf16 a[120:123], v[192:195], v[120:123], a[120:123]
s_add_u32 s57, s86, 2359296
s_add_u32 m0, s56, 16384
s_nop 0
buffer_load_dwordx4 v16, s[12:15], s57 offen lds
buffer_load_dwordx4 a[200:203], v29, s[16:19], s75 offen offset:320
ds_read_b64_tr_b16 v[188:189], v9 offset:4096
ds_read_b64_tr_b16 v[190:191], v9 offset:4608
s_waitcnt lgkmcnt(12)
v_mfma_f32_16x16x32_bf16 a[52:55], v[196:199], v[48:51], a[52:55]
v_mfma_f32_16x16x32_bf16 a[124:127], v[196:199], v[120:123], a[124:127]
ds_read_b64_tr_b16 v[192:193], v10 offset:4096
ds_read_b64_tr_b16 v[194:195], v10 offset:4608
s_waitcnt lgkmcnt(12)
v_mfma_f32_16x16x32_bf16 a[56:59], v[200:203], v[48:51], a[56:59]
v_mfma_f32_16x16x32_bf16 a[128:131], v[200:203], v[120:123], a[128:131]
s_add_u32 s57, s87, 2359296
s_add_u32 m0, s56, 24576
s_nop 0
buffer_load_dwordx4 v16, s[12:15], s57 offen lds
ds_read_b64_tr_b16 v[196:197], v11 offset:4096
ds_read_b64_tr_b16 v[198:199], v11 offset:4608
s_waitcnt lgkmcnt(12)
v_mfma_f32_16x16x32_bf16 a[60:63], v[204:207], v[48:51], a[60:63]
v_mfma_f32_16x16x32_bf16 a[132:135], v[204:207], v[120:123], a[132:135]
ds_read_b64_tr_b16 v[200:201], v8 offset:12288
ds_read_b64_tr_b16 v[202:203], v8 offset:12800
s_waitcnt lgkmcnt(12)
v_mfma_f32_16x16x32_bf16 a[64:67], v[176:179], v[48:51], a[64:67]
v_mfma_f32_16x16x32_bf16 a[136:139], v[176:179], v[120:123], a[136:139]
buffer_load_dwordx2 a[156:157], v28, s[20:23], 0 offen offset:192
ds_read_b64_tr_b16 v[204:205], v9 offset:12288
ds_read_b64_tr_b16 v[206:207], v9 offset:12800
s_waitcnt lgkmcnt(12)
v_mfma_f32_16x16x32_bf16 a[68:71], v[180:183], v[48:51], a[68:71]
s_add_u32 s57, s88, 2359296
s_add_u32 m0, s56, 32768
s_nop 0
buffer_load_dwordx4 v16, s[12:15], s57 offen lds
v_mfma_f32_16x16x32_bf16 a[140:143], v[180:183], v[120:123], a[140:143]
ds_read_b64_tr_b16 v[176:177], v10 offset:12288
ds_read_b64_tr_b16 v[178:179], v10 offset:12800
s_waitcnt lgkmcnt(12)
v_mfma_f32_16x16x32_bf16 a[0:3], v[184:187], v[52:55], a[0:3]
v_mfma_f32_16x16x32_bf16 a[72:75], v[184:187], v[124:127], a[72:75]
ds_read_b64_tr_b16 v[180:181], v11 offset:12288
ds_read_b64_tr_b16 v[182:183], v11 offset:12800
s_waitcnt lgkmcnt(12)
v_mfma_f32_16x16x32_bf16 a[4:7], v[188:191], v[52:55], a[4:7]
s_add_u32 s57, s84, 2433024
s_add_u32 m0, s56, 1024
s_nop 0
buffer_load_dwordx4 v17, s[12:15], s57 offen lds
v_mfma_f32_16x16x32_bf16 a[76:79], v[188:191], v[124:127], a[76:79]
ds_read_b64_tr_b16 v[184:185], v8 offset:20480
ds_read_b64_tr_b16 v[186:187], v8 offset:20992
s_waitcnt lgkmcnt(12)
v_mfma_f32_16x16x32_bf16 a[8:11], v[192:195], v[52:55], a[8:11]
v_mfma_f32_16x16x32_bf16 a[80:83], v[192:195], v[124:127], a[80:83]
buffer_load_dwordx4 a[204:207], v29, s[16:19], s75 offen offset:384
ds_read_b64_tr_b16 v[188:189], v9 offset:20480
ds_read_b64_tr_b16 v[190:191], v9 offset:20992
s_waitcnt lgkmcnt(12)
v_mfma_f32_16x16x32_bf16 a[12:15], v[196:199], v[52:55], a[12:15]
s_add_u32 s57, s85, 2433024
s_add_u32 m0, s56, 9216
s_nop 0
buffer_load_dwordx4 v17, s[12:15], s57 offen lds
v_mfma_f32_16x16x32_bf16 a[84:87], v[196:199], v[124:127], a[84:87]
ds_read_b64_tr_b16 v[192:193], v10 offset:20480
ds_read_b64_tr_b16 v[194:195], v10 offset:20992
s_waitcnt lgkmcnt(12)
v_mfma_f32_16x16x32_bf16 a[16:19], v[200:203], v[52:55], a[16:19]
v_mfma_f32_16x16x32_bf16 a[88:91], v[200:203], v[124:127], a[88:91]
ds_read_b64_tr_b16 v[196:197], v11 offset:20480
ds_read_b64_tr_b16 v[198:199], v11 offset:20992
s_waitcnt lgkmcnt(12)
v_mfma_f32_16x16x32_bf16 a[20:23], v[204:207], v[52:55], a[20:23]
s_add_u32 s57, s86, 2433024
s_add_u32 m0, s56, 17408
s_nop 0
buffer_load_dwordx4 v17, s[12:15], s57 offen lds
v_mfma_f32_16x16x32_bf16 a[92:95], v[204:207], v[124:127], a[92:95]
ds_read_b64_tr_b16 v[200:201], v8 offset:28672
ds_read_b64_tr_b16 v[202:203], v8 offset:29184
s_waitcnt lgkmcnt(12)
v_mfma_f32_16x16x32_bf16 a[24:27], v[176:179], v[52:55], a[24:27]
v_mfma_f32_16x16x32_bf16 a[96:99], v[176:179], v[124:127], a[96:99]
buffer_load_dwordx2 a[158:159], v28, s[20:23], 0 offen offset:224
ds_read_b64_tr_b16 v[204:205], v9 offset:28672
ds_read_b64_tr_b16 v[206:207], v9 offset:29184
s_waitcnt lgkmcnt(12)
v_mfma_f32_16x16x32_bf16 a[28:31], v[180:183], v[52:55], a[28:31]
s_add_u32 s57, s87, 2433024
s_add_u32 m0, s56, 25600
s_nop 0
buffer_load_dwordx4 v17, s[12:15], s57 offen lds
v_mfma_f32_16x16x32_bf16 a[100:103], v[180:183], v[124:127], a[100:103]
ds_read_b64_tr_b16 v[176:177], v10 offset:28672
ds_read_b64_tr_b16 v[178:179], v10 offset:29184
s_waitcnt lgkmcnt(12)
v_mfma_f32_16x16x32_bf16 a[32:35], v[184:187], v[52:55], a[32:35]
v_mfma_f32_16x16x32_bf16 a[104:107], v[184:187], v[124:127], a[104:107]
ds_read_b64_tr_b16 v[180:181], v11 offset:28672
ds_read_b64_tr_b16 v[182:183], v11 offset:29184
s_waitcnt lgkmcnt(12)
v_mfma_f32_16x16x32_bf16 a[36:39], v[188:191], v[52:55], a[36:39]
s_add_u32 s57, s88, 2433024
s_add_u32 m0, s56, 33792
s_nop 0
buffer_load_dwordx4 v17, s[12:15], s57 offen lds
v_mfma_f32_16x16x32_bf16 a[108:111], v[188:191], v[124:127], a[108:111]
ds_read_b64_tr_b16 v[184:185], v8 offset:36864
ds_read_b64_tr_b16 v[186:187], v8 offset:37376
s_waitcnt lgkmcnt(12)
v_mfma_f32_16x16x32_bf16 a[40:43], v[192:195], v[52:55], a[40:43]
v_mfma_f32_16x16x32_bf16 a[112:115], v[192:195], v[124:127], a[112:115]
buffer_load_dwordx4 a[208:211], v29, s[16:19], s75 offen offset:448
ds_read_b64_tr_b16 v[188:189], v9 offset:36864
ds_read_b64_tr_b16 v[190:191], v9 offset:37376
s_waitcnt lgkmcnt(12)
v_mfma_f32_16x16x32_bf16 a[44:47], v[196:199], v[52:55], a[44:47]
v_mfma_f32_16x16x32_bf16 a[116:119], v[196:199], v[124:127], a[116:119]
s_waitcnt vmcnt(24)
s_barrier
v_add_u32 v8, 40960, v8
v_add_u32 v9, 40960, v9
v_add_u32 v10, 40960, v10
v_add_u32 v11, 40960, v11
ds_read_b64_tr_b16 v[192:193], v8 offset:0
ds_read_b64_tr_b16 v[194:195], v8 offset:512
s_waitcnt lgkmcnt(12)
v_mfma_f32_16x16x32_bf16 a[48:51], v[200:203], v[52:55], a[48:51]
v_mfma_f32_16x16x32_bf16 a[120:123], v[200:203], v[124:127], a[120:123]
ds_read_b64_tr_b16 v[196:197], v9 offset:0
ds_read_b64_tr_b16 v[198:199], v9 offset:512
s_waitcnt lgkmcnt(12)
v_mfma_f32_16x16x32_bf16 a[52:55], v[204:207], v[52:55], a[52:55]
v_mfma_f32_16x16x32_bf16 a[124:127], v[204:207], v[124:127], a[124:127]
ds_read_b64_tr_b16 v[200:201], v10 offset:0
ds_read_b64_tr_b16 v[202:203], v10 offset:512
s_waitcnt lgkmcnt(12)
v_mfma_f32_16x16x32_bf16 a[56:59], v[176:179], v[52:55], a[56:59]
v_mfma_f32_16x16x32_bf16 a[128:131], v[176:179], v[124:127], a[128:131]
buffer_load_dwordx2 a[160:161], v28, s[20:23], 0 offen offset:256
ds_read_b64_tr_b16 v[204:205], v11 offset:0
ds_read_b64_tr_b16 v[206:207], v11 offset:512
s_waitcnt lgkmcnt(12)
v_mfma_f32_16x16x32_bf16 a[60:63], v[180:183], v[52:55], a[60:63]
v_mfma_f32_16x16x32_bf16 a[132:135], v[180:183], v[124:127], a[132:135]
ds_read_b64_tr_b16 v[176:177], v8 offset:8192
ds_read_b64_tr_b16 v[178:179], v8 offset:8704
s_waitcnt lgkmcnt(12)
v_mfma_f32_16x16x32_bf16 a[64:67], v[184:187], v[52:55], a[64:67]
v_mfma_f32_16x16x32_bf16 a[136:139], v[184:187], v[124:127], a[136:139]
ds_read_b64_tr_b16 v[180:181], v9 offset:8192
ds_read_b64_tr_b16 v[182:183], v9 offset:8704
s_waitcnt lgkmcnt(12)
v_mfma_f32_16x16x32_bf16 a[68:71], v[188:191], v[52:55], a[68:71]
v_mfma_f32_16x16x32_bf16 a[140:143], v[188:191], v[124:127], a[140:143]
ds_read_b64_tr_b16 v[184:185], v10 offset:8192
ds_read_b64_tr_b16 v[186:187], v10 offset:8704
s_waitcnt lgkmcnt(12)
v_mfma_f32_16x16x32_bf16 a[0:3], v[192:195], v[56:59], a[0:3]
s_add_u32 s78, s73, 8192
buffer_load_dwordx4 v[72:75], v27, s[16:19], s78 offen offset:2048
v_mfma_f32_16x16x32_bf16 a[72:75], v[192:195], v[128:131], a[72:75]
buffer_load_dwordx4 a[212:215], v29, s[16:19], s75 offen offset:512
ds_read_b64_tr_b16 v[188:189], v11 offset:8192
ds_read_b64_tr_b16 v[190:191], v11 offset:8704
s_waitcnt lgkmcnt(12)
v_mfma_f32_16x16x32_bf16 a[4:7], v[196:199], v[56:59], a[4:7]
v_mfma_f32_16x16x32_bf16 a[76:79], v[196:199], v[128:131], a[76:79]
ds_read_b64_tr_b16 v[192:193], v8 offset:16384
ds_read_b64_tr_b16 v[194:195], v8 offset:16896
s_waitcnt lgkmcnt(12)
v_mfma_f32_16x16x32_bf16 a[8:11], v[200:203], v[56:59], a[8:11]
v_mfma_f32_16x16x32_bf16 a[80:83], v[200:203], v[128:131], a[80:83]
s_add_u32 s78, s73, 26624
buffer_load_dwordx4 v[144:147], v27, s[16:19], s78 offen offset:2048
ds_read_b64_tr_b16 v[196:197], v9 offset:16384
ds_read_b64_tr_b16 v[198:199], v9 offset:16896
s_waitcnt lgkmcnt(12)
v_mfma_f32_16x16x32_bf16 a[12:15], v[204:207], v[56:59], a[12:15]
v_mfma_f32_16x16x32_bf16 a[84:87], v[204:207], v[128:131], a[84:87]
ds_read_b64_tr_b16 v[200:201], v10 offset:16384
ds_read_b64_tr_b16 v[202:203], v10 offset:16896
s_waitcnt lgkmcnt(12)
v_mfma_f32_16x16x32_bf16 a[16:19], v[176:179], v[56:59], a[16:19]
v_mfma_f32_16x16x32_bf16 a[88:91], v[176:179], v[128:131], a[88:91]
s_add_u32 s78, s73, 8192
buffer_load_dwordx4 v[76:79], v27, s[16:19], s78 offen offset:3072
buffer_load_dwordx2 a[162:163], v28, s[20:23], 0 offen offset:288
ds_read_b64_tr_b16 v[204:205], v11 offset:16384
ds_read_b64_tr_b16 v[206:207], v11 offset:16896
s_waitcnt lgkmcnt(12)
v_mfma_f32_16x16x32_bf16 a[20:23], v[180:183], v[56:59], a[20:23]
v_mfma_f32_16x16x32_bf16 a[92:95], v[180:183], v[128:131], a[92:95]
ds_read_b64_tr_b16 v[176:177], v8 offset:24576
ds_read_b64_tr_b16 v[178:179], v8 offset:25088
s_waitcnt lgkmcnt(12)
v_mfma_f32_16x16x32_bf16 a[24:27], v[184:187], v[56:59], a[24:27]
v_mfma_f32_16x16x32_bf16 a[96:99], v[184:187], v[128:131], a[96:99]
s_add_u32 s78, s73, 26624
buffer_load_dwordx4 v[148:151], v27, s[16:19], s78 offen offset:3072
ds_read_b64_tr_b16 v[180:181], v9 offset:24576
ds_read_b64_tr_b16 v[182:183], v9 offset:25088
s_waitcnt lgkmcnt(12)
v_mfma_f32_16x16x32_bf16 a[28:31], v[188:191], v[56:59], a[28:31]
v_mfma_f32_16x16x32_bf16 a[100:103], v[188:191], v[128:131], a[100:103]
ds_read_b64_tr_b16 v[184:185], v10 offset:24576
ds_read_b64_tr_b16 v[186:187], v10 offset:25088
s_waitcnt lgkmcnt(12)
v_mfma_f32_16x16x32_bf16 a[32:35], v[192:195], v[56:59], a[32:35]
v_mfma_f32_16x16x32_bf16 a[104:107], v[192:195], v[128:131], a[104:107]
s_add_u32 s57, s84, 2949120
s_add_u32 m0, s56, 40960
s_nop 0
buffer_load_dwordx4 v16, s[12:15], s57 offen lds
buffer_load_dwordx4 a[216:219], v29, s[16:19], s75 offen offset:576
ds_read_b64_tr_b16 v[188:189], v11 offset:24576
ds_read_b64_tr_b16 v[190:191], v11 offset:25088
s_waitcnt lgkmcnt(12)
v_mfma_f32_16x16x32_bf16 a[36:39], v[196:199], v[56:59], a[36:39]
v_mfma_f32_16x16x32_bf16 a[108:111], v[196:199], v[128:131], a[108:111]
ds_read_b64_tr_b16 v[192:193], v8 offset:32768
ds_read_b64_tr_b16 v[194:195], v8 offset:33280
s_waitcnt lgkmcnt(12)
v_mfma_f32_16x16x32_bf16 a[40:43], v[200:203], v[56:59], a[40:43]
v_mfma_f32_16x16x32_bf16 a[112:115], v[200:203], v[128:131], a[112:115]
s_add_u32 s57, s85, 2949120
s_add_u32 m0, s56, 49152
s_nop 0
buffer_load_dwordx4 v16, s[12:15], s57 offen lds
ds_read_b64_tr_b16 v[196:197], v9 offset:32768
ds_read_b64_tr_b16 v[198:199], v9 offset:33280
s_waitcnt lgkmcnt(12)
v_mfma_f32_16x16x32_bf16 a[44:47], v[204:207], v[56:59], a[44:47]
v_mfma_f32_16x16x32_bf16 a[116:119], v[204:207], v[128:131], a[116:119]
ds_read_b64_tr_b16 v[200:201], v8 offset:4096
ds_read_b64_tr_b16 v[202:203], v8 offset:4608
s_waitcnt lgkmcnt(12)
v_mfma_f32_16x16x32_bf16 a[48:51], v[176:179], v[56:59], a[48:51]
v_mfma_f32_16x16x32_bf16 a[120:123], v[176:179], v[128:131], a[120:123]
s_add_u32 s57, s86, 2949120
s_add_u32 m0, s56, 57344
s_nop 0
buffer_load_dwordx4 v16, s[12:15], s57 offen lds
buffer_load_dwordx2 a[164:165], v28, s[20:23], 0 offen offset:320
ds_read_b64_tr_b16 v[204:205], v9 offset:4096
ds_read_b64_tr_b16 v[206:207], v9 offset:4608
s_waitcnt lgkmcnt(12)
v_mfma_f32_16x16x32_bf16 a[52:55], v[180:183], v[56:59], a[52:55]
v_mfma_f32_16x16x32_bf16 a[124:127], v[180:183], v[128:131], a[124:127]
ds_read_b64_tr_b16 v[176:177], v10 offset:4096
ds_read_b64_tr_b16 v[178:179], v10 offset:4608
s_waitcnt lgkmcnt(12)
v_mfma_f32_16x16x32_bf16 a[56:59], v[184:187], v[56:59], a[56:59]
v_mfma_f32_16x16x32_bf16 a[128:131], v[184:187], v[128:131], a[128:131]
s_add_u32 s57, s87, 2949120
s_add_u32 m0, s56, 65536
s_nop 0
buffer_load_dwordx4 v16, s[12:15], s57 offen lds
ds_read_b64_tr_b16 v[180:181], v11 offset:4096
ds_read_b64_tr_b16 v[182:183], v11 offset:4608
s_waitcnt lgkmcnt(12)
v_mfma_f32_16x16x32_bf16 a[60:63], v[188:191], v[56:59], a[60:63]
v_mfma_f32_16x16x32_bf16 a[132:135], v[188:191], v[128:131], a[132:135]
ds_read_b64_tr_b16 v[184:185], v8 offset:12288
ds_read_b64_tr_b16 v[186:187], v8 offset:12800
s_waitcnt lgkmcnt(12)
v_mfma_f32_16x16x32_bf16 a[64:67], v[192:195], v[56:59], a[64:67]
v_mfma_f32_16x16x32_bf16 a[136:139], v[192:195], v[128:131], a[136:139]
buffer_load_dwordx4 a[220:223], v29, s[16:19], s75 offen offset:640
ds_read_b64_tr_b16 v[188:189], v9 offset:12288
ds_read_b64_tr_b16 v[190:191], v9 offset:12800
s_waitcnt lgkmcnt(12)
v_mfma_f32_16x16x32_bf16 a[68:71], v[196:199], v[56:59], a[68:71]
s_add_u32 s57, s88, 2949120
s_add_u32 m0, s56, 73728
s_nop 0
buffer_load_dwordx4 v16, s[12:15], s57 offen lds
v_mfma_f32_16x16x32_bf16 a[140:143], v[196:199], v[128:131], a[140:143]
ds_read_b64_tr_b16 v[192:193], v10 offset:12288
ds_read_b64_tr_b16 v[194:195], v10 offset:12800
s_waitcnt lgkmcnt(12)
v_mfma_f32_16x16x32_bf16 a[0:3], v[200:203], v[60:63], a[0:3]
v_mfma_f32_16x16x32_bf16 a[72:75], v[200:203], v[132:135], a[72:75]
ds_read_b64_tr_b16 v[196:197], v11 offset:12288
ds_read_b64_tr_b16 v[198:199], v11 offset:12800
s_waitcnt lgkmcnt(12)
v_mfma_f32_16x16x32_bf16 a[4:7], v[204:207], v[60:63], a[4:7]
s_add_u32 s57, s84, 3022848
s_add_u32 m0, s56, 41984
s_nop 0
buffer_load_dwordx4 v17, s[12:15], s57 offen lds
v_mfma_f32_16x16x32_bf16 a[76:79], v[204:207], v[132:135], a[76:79]
ds_read_b64_tr_b16 v[200:201], v8 offset:20480
ds_read_b64_tr_b16 v[202:203], v8 offset:20992
s_waitcnt lgkmcnt(12)
v_mfma_f32_16x16x32_bf16 a[8:11], v[176:179], v[60:63], a[8:11]
v_mfma_f32_16x16x32_bf16 a[80:83], v[176:179], v[132:135], a[80:83]
buffer_load_dwordx2 a[166:167], v28, s[20:23], 0 offen offset:352
ds_read_b64_tr_b16 v[204:205], v9 offset:20480
ds_read_b64_tr_b16 v[206:207], v9 offset:20992
s_waitcnt lgkmcnt(12)
v_mfma_f32_16x16x32_bf16 a[12:15], v[180:183], v[60:63], a[12:15]
s_add_u32 s57, s85, 3022848
s_add_u32 m0, s56, 50176
s_nop 0
buffer_load_dwordx4 v17, s[12:15], s57 offen lds
v_mfma_f32_16x16x32_bf16 a[84:87], v[180:183], v[132:135], a[84:87]
ds_read_b64_tr_b16 v[176:177], v10 offset:20480
ds_read_b64_tr_b16 v[178:179], v10 offset:20992
s_waitcnt lgkmcnt(12)
v_mfma_f32_16x16x32_bf16 a[16:19], v[184:187], v[60:63], a[16:19]
v_mfma_f32_16x16x32_bf16 a[88:91], v[184:187], v[132:135], a[88:91]
ds_read_b64_tr_b16 v[180:181], v11 offset:20480
ds_read_b64_tr_b16 v[182:183], v11 offset:20992
s_waitcnt lgkmcnt(12)
v_mfma_f32_16x16x32_bf16 a[20:23], v[188:191], v[60:63], a[20:23]
s_add_u32 s57, s86, 3022848
s_add_u32 m0, s56, 58368
s_nop 0
buffer_load_dwordx4 v17, s[12:15], s57 offen lds
v_mfma_f32_16x16x32_bf16 a[92:95], v[188:191], v[132:135], a[92:95]
ds_read_b64_tr_b16 v[184:185], v8 offset:28672
ds_read_b64_tr_b16 v[186:187], v8 offset:29184
s_waitcnt lgkmcnt(12)
v_mfma_f32_16x16x32_bf16 a[24:27], v[192:195], v[60:63], a[24:27]
v_mfma_f32_16x16x32_bf16 a[96:99], v[192:195], v[132:135], a[96:99]
buffer_load_dwordx4 a[224:227], v29, s[16:19], s75 offen offset:704
ds_read_b64_tr_b16 v[188:189], v9 offset:28672
ds_read_b64_tr_b16 v[190:191], v9 offset:29184
s_waitcnt lgkmcnt(12)
v_mfma_f32_16x16x32_bf16 a[28:31], v[196:199], v[60:63], a[28:31]
s_add_u32 s57, s87, 3022848
s_add_u32 m0, s56, 66560
s_nop 0
buffer_load_dwordx4 v17, s[12:15], s57 offen lds
v_mfma_f32_16x16x32_bf16 a[100:103], v[196:199], v[132:135], a[100:103]
ds_read_b64_tr_b16 v[192:193], v10 offset:28672
ds_read_b64_tr_b16 v[194:195], v10 offset:29184
s_waitcnt lgkmcnt(12)
v_mfma_f32_16x16x32_bf16 a[32:35], v[200:203], v[60:63], a[32:35]
v_mfma_f32_16x16x32_bf16 a[104:107], v[200:203], v[132:135], a[104:107]
ds_read_b64_tr_b16 v[196:197], v11 offset:28672
ds_read_b64_tr_b16 v[198:199], v11 offset:29184
s_waitcnt lgkmcnt(12)
v_mfma_f32_16x16x32_bf16 a[36:39], v[204:207], v[60:63], a[36:39]
s_add_u32 s57, s88, 3022848
s_add_u32 m0, s56, 74752
s_nop 0
buffer_load_dwordx4 v17, s[12:15], s57 offen lds
v_mfma_f32_16x16x32_bf16 a[108:111], v[204:207], v[132:135], a[108:111]
ds_read_b64_tr_b16 v[200:201], v8 offset:36864
ds_read_b64_tr_b16 v[202:203], v8 offset:37376
s_waitcnt lgkmcnt(12)
v_mfma_f32_16x16x32_bf16 a[40:43], v[176:179], v[60:63], a[40:43]
v_mfma_f32_16x16x32_bf16 a[112:115], v[176:179], v[132:135], a[112:115]
buffer_load_dwordx2 a[168:169], v28, s[20:23], 0 offen offset:384
ds_read_b64_tr_b16 v[204:205], v9 offset:36864
ds_read_b64_tr_b16 v[206:207], v9 offset:37376
s_waitcnt lgkmcnt(12)
v_mfma_f32_16x16x32_bf16 a[44:47], v[180:183], v[60:63], a[44:47]
v_mfma_f32_16x16x32_bf16 a[116:119], v[180:183], v[132:135], a[116:119]
s_waitcnt vmcnt(24)
s_barrier
v_subrev_u32 v8, 122880, v8
v_subrev_u32 v9, 122880, v9
v_subrev_u32 v10, 122880, v10
v_subrev_u32 v11, 122880, v11
ds_read_b64_tr_b16 v[176:177], v8 offset:0
ds_read_b64_tr_b16 v[178:179], v8 offset:512
s_waitcnt lgkmcnt(12)
v_mfma_f32_16x16x32_bf16 a[48:51], v[184:187], v[60:63], a[48:51]
v_mfma_f32_16x16x32_bf16 a[120:123], v[184:187], v[132:135], a[120:123]
ds_read_b64_tr_b16 v[180:181], v9 offset:0
ds_read_b64_tr_b16 v[182:183], v9 offset:512
s_waitcnt lgkmcnt(12)
v_mfma_f32_16x16x32_bf16 a[52:55], v[188:191], v[60:63], a[52:55]
v_mfma_f32_16x16x32_bf16 a[124:127], v[188:191], v[132:135], a[124:127]
ds_read_b64_tr_b16 v[184:185], v10 offset:0
ds_read_b64_tr_b16 v[186:187], v10 offset:512
s_waitcnt lgkmcnt(12)
v_mfma_f32_16x16x32_bf16 a[56:59], v[192:195], v[60:63], a[56:59]
v_mfma_f32_16x16x32_bf16 a[128:131], v[192:195], v[132:135], a[128:131]
buffer_load_dwordx4 a[228:231], v29, s[16:19], s75 offen offset:768
ds_read_b64_tr_b16 v[188:189], v11 offset:0
ds_read_b64_tr_b16 v[190:191], v11 offset:512
s_waitcnt lgkmcnt(12)
v_mfma_f32_16x16x32_bf16 a[60:63], v[196:199], v[60:63], a[60:63]
v_mfma_f32_16x16x32_bf16 a[132:135], v[196:199], v[132:135], a[132:135]
ds_read_b64_tr_b16 v[192:193], v8 offset:8192
ds_read_b64_tr_b16 v[194:195], v8 offset:8704
s_waitcnt lgkmcnt(12)
v_mfma_f32_16x16x32_bf16 a[64:67], v[200:203], v[60:63], a[64:67]
v_mfma_f32_16x16x32_bf16 a[136:139], v[200:203], v[132:135], a[136:139]
ds_read_b64_tr_b16 v[196:197], v9 offset:8192
ds_read_b64_tr_b16 v[198:199], v9 offset:8704
s_waitcnt lgkmcnt(12)
v_mfma_f32_16x16x32_bf16 a[68:71], v[204:207], v[60:63], a[68:71]
v_mfma_f32_16x16x32_bf16 a[140:143], v[204:207], v[132:135], a[140:143]
ds_read_b64_tr_b16 v[200:201], v10 offset:8192
ds_read_b64_tr_b16 v[202:203], v10 offset:8704
s_waitcnt lgkmcnt(12)
v_mfma_f32_16x16x32_bf16 a[0:3], v[176:179], v[64:67], a[0:3]
s_add_u32 s78, s73, 12288
buffer_load_dwordx4 v[80:83], v27, s[16:19], s78 offen offset:0
v_mfma_f32_16x16x32_bf16 a[72:75], v[176:179], v[136:139], a[72:75]
buffer_load_dwordx2 a[170:171], v28, s[20:23], 0 offen offset:416
ds_read_b64_tr_b16 v[204:205], v11 offset:8192
ds_read_b64_tr_b16 v[206:207], v11 offset:8704
s_waitcnt lgkmcnt(12)
v_mfma_f32_16x16x32_bf16 a[4:7], v[180:183], v[64:67], a[4:7]
v_mfma_f32_16x16x32_bf16 a[76:79], v[180:183], v[136:139], a[76:79]
ds_read_b64_tr_b16 v[176:177], v8 offset:16384
ds_read_b64_tr_b16 v[178:179], v8 offset:16896
s_waitcnt lgkmcnt(12)
v_mfma_f32_16x16x32_bf16 a[8:11], v[184:187], v[64:67], a[8:11]
v_mfma_f32_16x16x32_bf16 a[80:83], v[184:187], v[136:139], a[80:83]
s_add_u32 s78, s73, 30720
buffer_load_dwordx4 v[152:155], v27, s[16:19], s78 offen offset:0
ds_read_b64_tr_b16 v[180:181], v9 offset:16384
ds_read_b64_tr_b16 v[182:183], v9 offset:16896
s_waitcnt lgkmcnt(12)
v_mfma_f32_16x16x32_bf16 a[12:15], v[188:191], v[64:67], a[12:15]
v_mfma_f32_16x16x32_bf16 a[84:87], v[188:191], v[136:139], a[84:87]
ds_read_b64_tr_b16 v[184:185], v10 offset:16384
ds_read_b64_tr_b16 v[186:187], v10 offset:16896
s_waitcnt lgkmcnt(12)
v_mfma_f32_16x16x32_bf16 a[16:19], v[192:195], v[64:67], a[16:19]
v_mfma_f32_16x16x32_bf16 a[88:91], v[192:195], v[136:139], a[88:91]
s_add_u32 s78, s73, 12288
buffer_load_dwordx4 v[84:87], v27, s[16:19], s78 offen offset:1024
buffer_load_dwordx4 a[232:235], v29, s[16:19], s75 offen offset:832
ds_read_b64_tr_b16 v[188:189], v11 offset:16384
ds_read_b64_tr_b16 v[190:191], v11 offset:16896
s_waitcnt lgkmcnt(12)
v_mfma_f32_16x16x32_bf16 a[20:23], v[196:199], v[64:67], a[20:23]
v_mfma_f32_16x16x32_bf16 a[92:95], v[196:199], v[136:139], a[92:95]
ds_read_b64_tr_b16 v[192:193], v8 offset:24576
ds_read_b64_tr_b16 v[194:195], v8 offset:25088
s_waitcnt lgkmcnt(12)
v_mfma_f32_16x16x32_bf16 a[24:27], v[200:203], v[64:67], a[24:27]
v_mfma_f32_16x16x32_bf16 a[96:99], v[200:203], v[136:139], a[96:99]
s_add_u32 s78, s73, 30720
buffer_load_dwordx4 v[156:159], v27, s[16:19], s78 offen offset:1024
ds_read_b64_tr_b16 v[196:197], v9 offset:24576
ds_read_b64_tr_b16 v[198:199], v9 offset:25088
s_waitcnt lgkmcnt(12)
v_mfma_f32_16x16x32_bf16 a[28:31], v[204:207], v[64:67], a[28:31]
v_mfma_f32_16x16x32_bf16 a[100:103], v[204:207], v[136:139], a[100:103]
ds_read_b64_tr_b16 v[200:201], v10 offset:24576
ds_read_b64_tr_b16 v[202:203], v10 offset:25088
s_waitcnt lgkmcnt(12)
v_mfma_f32_16x16x32_bf16 a[32:35], v[176:179], v[64:67], a[32:35]
v_mfma_f32_16x16x32_bf16 a[104:107], v[176:179], v[136:139], a[104:107]
s_add_u32 s57, s84, 3538944
s_add_u32 m0, s56, 81920
s_nop 0
buffer_load_dwordx4 v16, s[12:15], s57 offen lds
buffer_load_dwordx2 a[172:173], v28, s[20:23], 0 offen offset:448
ds_read_b64_tr_b16 v[204:205], v11 offset:24576
ds_read_b64_tr_b16 v[206:207], v11 offset:25088
s_waitcnt lgkmcnt(12)
v_mfma_f32_16x16x32_bf16 a[36:39], v[180:183], v[64:67], a[36:39]
v_mfma_f32_16x16x32_bf16 a[108:111], v[180:183], v[136:139], a[108:111]
ds_read_b64_tr_b16 v[176:177], v8 offset:32768
ds_read_b64_tr_b16 v[178:179], v8 offset:33280
s_waitcnt lgkmcnt(12)
v_mfma_f32_16x16x32_bf16 a[40:43], v[184:187], v[64:67], a[40:43]
v_mfma_f32_16x16x32_bf16 a[112:115], v[184:187], v[136:139], a[112:115]
s_add_u32 s57, s85, 3538944
s_add_u32 m0, s56, 90112
s_nop 0
buffer_load_dwordx4 v16, s[12:15], s57 offen lds
ds_read_b64_tr_b16 v[180:181], v9 offset:32768
ds_read_b64_tr_b16 v[182:183], v9 offset:33280
s_waitcnt lgkmcnt(12)
v_mfma_f32_16x16x32_bf16 a[44:47], v[188:191], v[64:67], a[44:47]
v_mfma_f32_16x16x32_bf16 a[116:119], v[188:191], v[136:139], a[116:119]
ds_read_b64_tr_b16 v[184:185], v8 offset:4096
ds_read_b64_tr_b16 v[186:187], v8 offset:4608
s_waitcnt lgkmcnt(12)
v_mfma_f32_16x16x32_bf16 a[48:51], v[192:195], v[64:67], a[48:51]
v_mfma_f32_16x16x32_bf16 a[120:123], v[192:195], v[136:139], a[120:123]
s_add_u32 s57, s86, 3538944
s_add_u32 m0, s56, 98304
s_nop 0
buffer_load_dwordx4 v16, s[12:15], s57 offen lds
buffer_load_dwordx4 a[236:239], v29, s[16:19], s75 offen offset:896
ds_read_b64_tr_b16 v[188:189], v9 offset:4096
ds_read_b64_tr_b16 v[190:191], v9 offset:4608
s_waitcnt lgkmcnt(12)
v_mfma_f32_16x16x32_bf16 a[52:55], v[196:199], v[64:67], a[52:55]
v_mfma_f32_16x16x32_bf16 a[124:127], v[196:199], v[136:139], a[124:127]
ds_read_b64_tr_b16 v[192:193], v10 offset:4096
ds_read_b64_tr_b16 v[194:195], v10 offset:4608
s_waitcnt lgkmcnt(12)
v_mfma_f32_16x16x32_bf16 a[56:59], v[200:203], v[64:67], a[56:59]
v_mfma_f32_16x16x32_bf16 a[128:131], v[200:203], v[136:139], a[128:131]
s_add_u32 s57, s87, 3538944
s_add_u32 m0, s56, 106496
s_nop 0
buffer_load_dwordx4 v16, s[12:15], s57 offen lds
ds_read_b64_tr_b16 v[196:197], v11 offset:4096
ds_read_b64_tr_b16 v[198:199], v11 offset:4608
s_waitcnt lgkmcnt(12)
v_mfma_f32_16x16x32_bf16 a[60:63], v[204:207], v[64:67], a[60:63]
v_mfma_f32_16x16x32_bf16 a[132:135], v[204:207], v[136:139], a[132:135]
ds_read_b64_tr_b16 v[200:201], v8 offset:12288
ds_read_b64_tr_b16 v[202:203], v8 offset:12800
s_waitcnt lgkmcnt(12)
v_mfma_f32_16x16x32_bf16 a[64:67], v[176:179], v[64:67], a[64:67]
v_mfma_f32_16x16x32_bf16 a[136:139], v[176:179], v[136:139], a[136:139]
buffer_load_dwordx2 a[174:175], v28, s[20:23], 0 offen offset:480
ds_read_b64_tr_b16 v[204:205], v9 offset:12288
ds_read_b64_tr_b16 v[206:207], v9 offset:12800
s_waitcnt lgkmcnt(12)
v_mfma_f32_16x16x32_bf16 a[68:71], v[180:183], v[64:67], a[68:71]
s_add_u32 s57, s88, 3538944
s_add_u32 m0, s56, 114688
s_nop 0
buffer_load_dwordx4 v16, s[12:15], s57 offen lds
v_mfma_f32_16x16x32_bf16 a[140:143], v[180:183], v[136:139], a[140:143]
ds_read_b64_tr_b16 v[176:177], v10 offset:12288
ds_read_b64_tr_b16 v[178:179], v10 offset:12800
s_waitcnt lgkmcnt(12)
v_mfma_f32_16x16x32_bf16 a[0:3], v[184:187], v[68:71], a[0:3]
v_mfma_f32_16x16x32_bf16 a[72:75], v[184:187], v[140:143], a[72:75]
ds_read_b64_tr_b16 v[180:181], v11 offset:12288
ds_read_b64_tr_b16 v[182:183], v11 offset:12800
s_waitcnt lgkmcnt(12)
v_mfma_f32_16x16x32_bf16 a[4:7], v[188:191], v[68:71], a[4:7]
s_add_u32 s57, s84, 3612672
s_add_u32 m0, s56, 82944
s_nop 0
buffer_load_dwordx4 v17, s[12:15], s57 offen lds
v_mfma_f32_16x16x32_bf16 a[76:79], v[188:191], v[140:143], a[76:79]
ds_read_b64_tr_b16 v[184:185], v8 offset:20480
ds_read_b64_tr_b16 v[186:187], v8 offset:20992
s_waitcnt lgkmcnt(12)
v_mfma_f32_16x16x32_bf16 a[8:11], v[192:195], v[68:71], a[8:11]
v_mfma_f32_16x16x32_bf16 a[80:83], v[192:195], v[140:143], a[80:83]
buffer_load_dwordx4 a[240:243], v29, s[16:19], s75 offen offset:960
ds_read_b64_tr_b16 v[188:189], v9 offset:20480
ds_read_b64_tr_b16 v[190:191], v9 offset:20992
s_waitcnt lgkmcnt(12)
v_mfma_f32_16x16x32_bf16 a[12:15], v[196:199], v[68:71], a[12:15]
s_add_u32 s57, s85, 3612672
s_add_u32 m0, s56, 91136
s_nop 0
buffer_load_dwordx4 v17, s[12:15], s57 offen lds
v_mfma_f32_16x16x32_bf16 a[84:87], v[196:199], v[140:143], a[84:87]
ds_read_b64_tr_b16 v[192:193], v10 offset:20480
ds_read_b64_tr_b16 v[194:195], v10 offset:20992
s_waitcnt lgkmcnt(12)
v_mfma_f32_16x16x32_bf16 a[16:19], v[200:203], v[68:71], a[16:19]
v_mfma_f32_16x16x32_bf16 a[88:91], v[200:203], v[140:143], a[88:91]
ds_read_b64_tr_b16 v[196:197], v11 offset:20480
ds_read_b64_tr_b16 v[198:199], v11 offset:20992
s_waitcnt lgkmcnt(12)
v_mfma_f32_16x16x32_bf16 a[20:23], v[204:207], v[68:71], a[20:23]
s_add_u32 s57, s86, 3612672
s_add_u32 m0, s56, 99328
s_nop 0
buffer_load_dwordx4 v17, s[12:15], s57 offen lds
v_mfma_f32_16x16x32_bf16 a[92:95], v[204:207], v[140:143], a[92:95]
ds_read_b64_tr_b16 v[200:201], v8 offset:28672
ds_read_b64_tr_b16 v[202:203], v8 offset:29184
s_waitcnt lgkmcnt(12)
v_mfma_f32_16x16x32_bf16 a[24:27], v[176:179], v[68:71], a[24:27]
v_mfma_f32_16x16x32_bf16 a[96:99], v[176:179], v[140:143], a[96:99]
buffer_load_dwordx2 a[176:177], v28, s[20:23], 0 offen offset:512
ds_read_b64_tr_b16 v[204:205], v9 offset:28672
ds_read_b64_tr_b16 v[206:207], v9 offset:29184
s_waitcnt lgkmcnt(12)
v_mfma_f32_16x16x32_bf16 a[28:31], v[180:183], v[68:71], a[28:31]
s_add_u32 s57, s87, 3612672
s_add_u32 m0, s56, 107520
s_nop 0
buffer_load_dwordx4 v17, s[12:15], s57 offen lds
v_mfma_f32_16x16x32_bf16 a[100:103], v[180:183], v[140:143], a[100:103]
ds_read_b64_tr_b16 v[176:177], v10 offset:28672
ds_read_b64_tr_b16 v[178:179], v10 offset:29184
s_waitcnt lgkmcnt(12)
v_mfma_f32_16x16x32_bf16 a[32:35], v[184:187], v[68:71], a[32:35]
v_mfma_f32_16x16x32_bf16 a[104:107], v[184:187], v[140:143], a[104:107]
ds_read_b64_tr_b16 v[180:181], v11 offset:28672
ds_read_b64_tr_b16 v[182:183], v11 offset:29184
s_waitcnt lgkmcnt(12)
v_mfma_f32_16x16x32_bf16 a[36:39], v[188:191], v[68:71], a[36:39]
s_add_u32 s57, s88, 3612672
s_add_u32 m0, s56, 115712
s_nop 0
buffer_load_dwordx4 v17, s[12:15], s57 offen lds
v_mfma_f32_16x16x32_bf16 a[108:111], v[188:191], v[140:143], a[108:111]
ds_read_b64_tr_b16 v[184:185], v8 offset:36864
ds_read_b64_tr_b16 v[186:187], v8 offset:37376
s_waitcnt lgkmcnt(12)
v_mfma_f32_16x16x32_bf16 a[40:43], v[192:195], v[68:71], a[40:43]
v_mfma_f32_16x16x32_bf16 a[112:115], v[192:195], v[140:143], a[112:115]
buffer_load_dwordx4 a[244:247], v29, s[16:19], s75 offen offset:1024
ds_read_b64_tr_b16 v[188:189], v9 offset:36864
ds_read_b64_tr_b16 v[190:191], v9 offset:37376
s_waitcnt lgkmcnt(12)
v_mfma_f32_16x16x32_bf16 a[44:47], v[196:199], v[68:71], a[44:47]
v_mfma_f32_16x16x32_bf16 a[116:119], v[196:199], v[140:143], a[116:119]
s_waitcnt vmcnt(24)
s_barrier
v_add_u32 v8, 40960, v8
v_add_u32 v9, 40960, v9
v_add_u32 v10, 40960, v10
v_add_u32 v11, 40960, v11
ds_read_b64_tr_b16 v[192:193], v8 offset:0
ds_read_b64_tr_b16 v[194:195], v8 offset:512
s_waitcnt lgkmcnt(12)
v_mfma_f32_16x16x32_bf16 a[48:51], v[200:203], v[68:71], a[48:51]
v_mfma_f32_16x16x32_bf16 a[120:123], v[200:203], v[140:143], a[120:123]
ds_read_b64_tr_b16 v[196:197], v9 offset:0
ds_read_b64_tr_b16 v[198:199], v9 offset:512
s_waitcnt lgkmcnt(12)
v_mfma_f32_16x16x32_bf16 a[52:55], v[204:207], v[68:71], a[52:55]
v_mfma_f32_16x16x32_bf16 a[124:127], v[204:207], v[140:143], a[124:127]
ds_read_b64_tr_b16 v[200:201], v10 offset:0
ds_read_b64_tr_b16 v[202:203], v10 offset:512
s_waitcnt lgkmcnt(12)
v_mfma_f32_16x16x32_bf16 a[56:59], v[176:179], v[68:71], a[56:59]
v_mfma_f32_16x16x32_bf16 a[128:131], v[176:179], v[140:143], a[128:131]
buffer_load_dwordx2 a[178:179], v28, s[20:23], 0 offen offset:544
ds_read_b64_tr_b16 v[204:205], v11 offset:0
ds_read_b64_tr_b16 v[206:207], v11 offset:512
s_waitcnt lgkmcnt(12)
v_mfma_f32_16x16x32_bf16 a[60:63], v[180:183], v[68:71], a[60:63]
v_mfma_f32_16x16x32_bf16 a[132:135], v[180:183], v[140:143], a[132:135]
ds_read_b64_tr_b16 v[176:177], v8 offset:8192
ds_read_b64_tr_b16 v[178:179], v8 offset:8704
s_waitcnt lgkmcnt(12)
v_mfma_f32_16x16x32_bf16 a[64:67], v[184:187], v[68:71], a[64:67]
v_mfma_f32_16x16x32_bf16 a[136:139], v[184:187], v[140:143], a[136:139]
ds_read_b64_tr_b16 v[180:181], v9 offset:8192
ds_read_b64_tr_b16 v[182:183], v9 offset:8704
s_waitcnt lgkmcnt(12)
v_mfma_f32_16x16x32_bf16 a[68:71], v[188:191], v[68:71], a[68:71]
v_mfma_f32_16x16x32_bf16 a[140:143], v[188:191], v[140:143], a[140:143]
ds_read_b64_tr_b16 v[184:185], v10 offset:8192
ds_read_b64_tr_b16 v[186:187], v10 offset:8704
s_waitcnt lgkmcnt(12)
v_mfma_f32_16x16x32_bf16 a[0:3], v[192:195], v[72:75], a[0:3]
s_add_u32 s78, s73, 12288
buffer_load_dwordx4 v[88:91], v27, s[16:19], s78 offen offset:2048
v_mfma_f32_16x16x32_bf16 a[72:75], v[192:195], v[144:147], a[72:75]
buffer_load_dwordx4 a[248:251], v29, s[16:19], s75 offen offset:1088
ds_read_b64_tr_b16 v[188:189], v11 offset:8192
ds_read_b64_tr_b16 v[190:191], v11 offset:8704
s_waitcnt lgkmcnt(12)
v_mfma_f32_16x16x32_bf16 a[4:7], v[196:199], v[72:75], a[4:7]
v_mfma_f32_16x16x32_bf16 a[76:79], v[196:199], v[144:147], a[76:79]
ds_read_b64_tr_b16 v[192:193], v8 offset:16384
ds_read_b64_tr_b16 v[194:195], v8 offset:16896
s_waitcnt lgkmcnt(12)
v_mfma_f32_16x16x32_bf16 a[8:11], v[200:203], v[72:75], a[8:11]
v_mfma_f32_16x16x32_bf16 a[80:83], v[200:203], v[144:147], a[80:83]
s_add_u32 s78, s73, 30720
buffer_load_dwordx4 v[160:163], v27, s[16:19], s78 offen offset:2048
ds_read_b64_tr_b16 v[196:197], v9 offset:16384
ds_read_b64_tr_b16 v[198:199], v9 offset:16896
s_waitcnt lgkmcnt(12)
v_mfma_f32_16x16x32_bf16 a[12:15], v[204:207], v[72:75], a[12:15]
v_mfma_f32_16x16x32_bf16 a[84:87], v[204:207], v[144:147], a[84:87]
ds_read_b64_tr_b16 v[200:201], v10 offset:16384
ds_read_b64_tr_b16 v[202:203], v10 offset:16896
s_waitcnt lgkmcnt(12)
v_mfma_f32_16x16x32_bf16 a[16:19], v[176:179], v[72:75], a[16:19]
v_mfma_f32_16x16x32_bf16 a[88:91], v[176:179], v[144:147], a[88:91]
s_add_u32 s78, s73, 12288
buffer_load_dwordx4 v[92:95], v27, s[16:19], s78 offen offset:3072
ds_read_b64_tr_b16 v[204:205], v11 offset:16384
ds_read_b64_tr_b16 v[206:207], v11 offset:16896
s_waitcnt lgkmcnt(12)
v_mfma_f32_16x16x32_bf16 a[20:23], v[180:183], v[72:75], a[20:23]
v_mfma_f32_16x16x32_bf16 a[92:95], v[180:183], v[144:147], a[92:95]
ds_read_b64_tr_b16 v[176:177], v8 offset:24576
ds_read_b64_tr_b16 v[178:179], v8 offset:25088
s_waitcnt lgkmcnt(12)
v_mfma_f32_16x16x32_bf16 a[24:27], v[184:187], v[72:75], a[24:27]
v_mfma_f32_16x16x32_bf16 a[96:99], v[184:187], v[144:147], a[96:99]
s_add_u32 s78, s73, 30720
buffer_load_dwordx4 v[164:167], v27, s[16:19], s78 offen offset:3072
ds_read_b64_tr_b16 v[180:181], v9 offset:24576
ds_read_b64_tr_b16 v[182:183], v9 offset:25088
s_waitcnt lgkmcnt(12)
v_mfma_f32_16x16x32_bf16 a[28:31], v[188:191], v[72:75], a[28:31]
v_mfma_f32_16x16x32_bf16 a[100:103], v[188:191], v[144:147], a[100:103]
ds_read_b64_tr_b16 v[184:185], v10 offset:24576
ds_read_b64_tr_b16 v[186:187], v10 offset:25088
s_waitcnt lgkmcnt(12)
v_mfma_f32_16x16x32_bf16 a[32:35], v[192:195], v[72:75], a[32:35]
v_mfma_f32_16x16x32_bf16 a[104:107], v[192:195], v[144:147], a[104:107]
s_add_u32 s57, s84, 4128768
s_add_u32 m0, s56, 122880
s_nop 0
buffer_load_dwordx4 v16, s[12:15], s57 offen lds
ds_read_b64_tr_b16 v[188:189], v11 offset:24576
ds_read_b64_tr_b16 v[190:191], v11 offset:25088
s_waitcnt lgkmcnt(12)
v_mfma_f32_16x16x32_bf16 a[36:39], v[196:199], v[72:75], a[36:39]
v_mfma_f32_16x16x32_bf16 a[108:111], v[196:199], v[144:147], a[108:111]
ds_read_b64_tr_b16 v[192:193], v8 offset:32768
ds_read_b64_tr_b16 v[194:195], v8 offset:33280
s_waitcnt lgkmcnt(12)
v_mfma_f32_16x16x32_bf16 a[40:43], v[200:203], v[72:75], a[40:43]
v_mfma_f32_16x16x32_bf16 a[112:115], v[200:203], v[144:147], a[112:115]
s_add_u32 s57, s85, 4128768
s_add_u32 m0, s56, 131072
s_nop 0
buffer_load_dwordx4 v16, s[12:15], s57 offen lds
ds_read_b64_tr_b16 v[196:197], v9 offset:32768
ds_read_b64_tr_b16 v[198:199], v9 offset:33280
s_waitcnt lgkmcnt(12)
v_mfma_f32_16x16x32_bf16 a[44:47], v[204:207], v[72:75], a[44:47]
v_mfma_f32_16x16x32_bf16 a[116:119], v[204:207], v[144:147], a[116:119]
ds_read_b64_tr_b16 v[200:201], v8 offset:4096
ds_read_b64_tr_b16 v[202:203], v8 offset:4608
s_waitcnt lgkmcnt(12)
v_mfma_f32_16x16x32_bf16 a[48:51], v[176:179], v[72:75], a[48:51]
v_mfma_f32_16x16x32_bf16 a[120:123], v[176:179], v[144:147], a[120:123]
s_add_u32 s57, s86, 4128768
s_add_u32 m0, s56, 139264
s_nop 0
buffer_load_dwordx4 v16, s[12:15], s57 offen lds
ds_read_b64_tr_b16 v[204:205], v9 offset:4096
ds_read_b64_tr_b16 v[206:207], v9 offset:4608
s_waitcnt lgkmcnt(12)
v_mfma_f32_16x16x32_bf16 a[52:55], v[180:183], v[72:75], a[52:55]
v_mfma_f32_16x16x32_bf16 a[124:127], v[180:183], v[144:147], a[124:127]
ds_read_b64_tr_b16 v[176:177], v10 offset:4096
ds_read_b64_tr_b16 v[178:179], v10 offset:4608
s_waitcnt lgkmcnt(12)
v_mfma_f32_16x16x32_bf16 a[56:59], v[184:187], v[72:75], a[56:59]
v_mfma_f32_16x16x32_bf16 a[128:131], v[184:187], v[144:147], a[128:131]
s_add_u32 s57, s87, 4128768
s_add_u32 m0, s56, 147456
s_nop 0
buffer_load_dwordx4 v16, s[12:15], s57 offen lds
ds_read_b64_tr_b16 v[180:181], v11 offset:4096
ds_read_b64_tr_b16 v[182:183], v11 offset:4608
s_waitcnt lgkmcnt(12)
v_mfma_f32_16x16x32_bf16 a[60:63], v[188:191], v[72:75], a[60:63]
v_mfma_f32_16x16x32_bf16 a[132:135], v[188:191], v[144:147], a[132:135]
ds_read_b64_tr_b16 v[184:185], v8 offset:12288
ds_read_b64_tr_b16 v[186:187], v8 offset:12800
s_waitcnt lgkmcnt(12)
v_mfma_f32_16x16x32_bf16 a[64:67], v[192:195], v[72:75], a[64:67]
v_mfma_f32_16x16x32_bf16 a[136:139], v[192:195], v[144:147], a[136:139]
ds_read_b64_tr_b16 v[188:189], v9 offset:12288
ds_read_b64_tr_b16 v[190:191], v9 offset:12800
s_waitcnt lgkmcnt(12)
v_mfma_f32_16x16x32_bf16 a[68:71], v[196:199], v[72:75], a[68:71]
s_add_u32 s57, s88, 4128768
s_add_u32 m0, s56, 155648
s_nop 0
buffer_load_dwordx4 v16, s[12:15], s57 offen lds
v_mfma_f32_16x16x32_bf16 a[140:143], v[196:199], v[144:147], a[140:143]
ds_read_b64_tr_b16 v[192:193], v10 offset:12288
ds_read_b64_tr_b16 v[194:195], v10 offset:12800
s_waitcnt lgkmcnt(12)
v_mfma_f32_16x16x32_bf16 a[0:3], v[200:203], v[76:79], a[0:3]
v_mfma_f32_16x16x32_bf16 a[72:75], v[200:203], v[148:151], a[72:75]
ds_read_b64_tr_b16 v[196:197], v11 offset:12288
ds_read_b64_tr_b16 v[198:199], v11 offset:12800
s_waitcnt lgkmcnt(12)
v_mfma_f32_16x16x32_bf16 a[4:7], v[204:207], v[76:79], a[4:7]
s_add_u32 s57, s84, 4202496
s_add_u32 m0, s56, 123904
s_nop 0
buffer_load_dwordx4 v17, s[12:15], s57 offen lds
v_mfma_f32_16x16x32_bf16 a[76:79], v[204:207], v[148:151], a[76:79]
ds_read_b64_tr_b16 v[200:201], v8 offset:20480
ds_read_b64_tr_b16 v[202:203], v8 offset:20992
s_waitcnt lgkmcnt(12)
v_mfma_f32_16x16x32_bf16 a[8:11], v[176:179], v[76:79], a[8:11]
v_mfma_f32_16x16x32_bf16 a[80:83], v[176:179], v[148:151], a[80:83]
ds_read_b64_tr_b16 v[204:205], v9 offset:20480
ds_read_b64_tr_b16 v[206:207], v9 offset:20992
s_waitcnt lgkmcnt(12)
v_mfma_f32_16x16x32_bf16 a[12:15], v[180:183], v[76:79], a[12:15]
s_add_u32 s57, s85, 4202496
s_add_u32 m0, s56, 132096
s_nop 0
buffer_load_dwordx4 v17, s[12:15], s57 offen lds
v_mfma_f32_16x16x32_bf16 a[84:87], v[180:183], v[148:151], a[84:87]
ds_read_b64_tr_b16 v[176:177], v10 offset:20480
ds_read_b64_tr_b16 v[178:179], v10 offset:20992
s_waitcnt lgkmcnt(12)
v_mfma_f32_16x16x32_bf16 a[16:19], v[184:187], v[76:79], a[16:19]
v_mfma_f32_16x16x32_bf16 a[88:91], v[184:187], v[148:151], a[88:91]
ds_read_b64_tr_b16 v[180:181], v11 offset:20480
ds_read_b64_tr_b16 v[182:183], v11 offset:20992
s_waitcnt lgkmcnt(12)
v_mfma_f32_16x16x32_bf16 a[20:23], v[188:191], v[76:79], a[20:23]
s_add_u32 s57, s86, 4202496
s_add_u32 m0, s56, 140288
s_nop 0
buffer_load_dwordx4 v17, s[12:15], s57 offen lds
v_mfma_f32_16x16x32_bf16 a[92:95], v[188:191], v[148:151], a[92:95]
ds_read_b64_tr_b16 v[184:185], v8 offset:28672
ds_read_b64_tr_b16 v[186:187], v8 offset:29184
s_waitcnt lgkmcnt(12)
v_mfma_f32_16x16x32_bf16 a[24:27], v[192:195], v[76:79], a[24:27]
v_mfma_f32_16x16x32_bf16 a[96:99], v[192:195], v[148:151], a[96:99]
ds_read_b64_tr_b16 v[188:189], v9 offset:28672
ds_read_b64_tr_b16 v[190:191], v9 offset:29184
s_waitcnt lgkmcnt(12)
v_mfma_f32_16x16x32_bf16 a[28:31], v[196:199], v[76:79], a[28:31]
s_add_u32 s57, s87, 4202496
s_add_u32 m0, s56, 148480
s_nop 0
buffer_load_dwordx4 v17, s[12:15], s57 offen lds
v_mfma_f32_16x16x32_bf16 a[100:103], v[196:199], v[148:151], a[100:103]
ds_read_b64_tr_b16 v[192:193], v10 offset:28672
ds_read_b64_tr_b16 v[194:195], v10 offset:29184
s_waitcnt lgkmcnt(12)
v_mfma_f32_16x16x32_bf16 a[32:35], v[200:203], v[76:79], a[32:35]
v_mfma_f32_16x16x32_bf16 a[104:107], v[200:203], v[148:151], a[104:107]
ds_read_b64_tr_b16 v[196:197], v11 offset:28672
ds_read_b64_tr_b16 v[198:199], v11 offset:29184
s_waitcnt lgkmcnt(12)
v_mfma_f32_16x16x32_bf16 a[36:39], v[204:207], v[76:79], a[36:39]
s_add_u32 s57, s88, 4202496
s_add_u32 m0, s56, 156672
s_nop 0
buffer_load_dwordx4 v17, s[12:15], s57 offen lds
v_mfma_f32_16x16x32_bf16 a[108:111], v[204:207], v[148:151], a[108:111]
ds_read_b64_tr_b16 v[200:201], v8 offset:36864
ds_read_b64_tr_b16 v[202:203], v8 offset:37376
s_waitcnt lgkmcnt(12)
v_mfma_f32_16x16x32_bf16 a[40:43], v[176:179], v[76:79], a[40:43]
v_mfma_f32_16x16x32_bf16 a[112:115], v[176:179], v[148:151], a[112:115]
ds_read_b64_tr_b16 v[204:205], v9 offset:36864
ds_read_b64_tr_b16 v[206:207], v9 offset:37376
s_waitcnt lgkmcnt(12)
v_mfma_f32_16x16x32_bf16 a[44:47], v[180:183], v[76:79], a[44:47]
v_mfma_f32_16x16x32_bf16 a[116:119], v[180:183], v[148:151], a[116:119]
s_waitcnt vmcnt(17)
s_barrier
v_add_u32 v8, 40960, v8
v_add_u32 v9, 40960, v9
v_add_u32 v10, 40960, v10
v_add_u32 v11, 40960, v11
ds_read_b64_tr_b16 v[176:177], v8 offset:0
ds_read_b64_tr_b16 v[178:179], v8 offset:512
s_waitcnt lgkmcnt(12)
v_mfma_f32_16x16x32_bf16 a[48:51], v[184:187], v[76:79], a[48:51]
v_mfma_f32_16x16x32_bf16 a[120:123], v[184:187], v[148:151], a[120:123]
ds_read_b64_tr_b16 v[180:181], v9 offset:0
ds_read_b64_tr_b16 v[182:183], v9 offset:512
s_waitcnt lgkmcnt(12)
v_mfma_f32_16x16x32_bf16 a[52:55], v[188:191], v[76:79], a[52:55]
v_mfma_f32_16x16x32_bf16 a[124:127], v[188:191], v[148:151], a[124:127]
ds_read_b64_tr_b16 v[184:185], v10 offset:0
ds_read_b64_tr_b16 v[186:187], v10 offset:512
s_waitcnt lgkmcnt(12)
v_mfma_f32_16x16x32_bf16 a[56:59], v[192:195], v[76:79], a[56:59]
v_mfma_f32_16x16x32_bf16 a[128:131], v[192:195], v[148:151], a[128:131]
ds_read_b64_tr_b16 v[188:189], v11 offset:0
ds_read_b64_tr_b16 v[190:191], v11 offset:512
s_waitcnt lgkmcnt(12)
v_mfma_f32_16x16x32_bf16 a[60:63], v[196:199], v[76:79], a[60:63]
v_mfma_f32_16x16x32_bf16 a[132:135], v[196:199], v[148:151], a[132:135]
ds_read_b64_tr_b16 v[192:193], v8 offset:8192
ds_read_b64_tr_b16 v[194:195], v8 offset:8704
s_waitcnt lgkmcnt(12)
v_mfma_f32_16x16x32_bf16 a[64:67], v[200:203], v[76:79], a[64:67]
v_mfma_f32_16x16x32_bf16 a[136:139], v[200:203], v[148:151], a[136:139]
ds_read_b64_tr_b16 v[196:197], v9 offset:8192
ds_read_b64_tr_b16 v[198:199], v9 offset:8704
s_waitcnt lgkmcnt(12)
v_mfma_f32_16x16x32_bf16 a[68:71], v[204:207], v[76:79], a[68:71]
v_mfma_f32_16x16x32_bf16 a[140:143], v[204:207], v[148:151], a[140:143]
ds_read_b64_tr_b16 v[200:201], v10 offset:8192
ds_read_b64_tr_b16 v[202:203], v10 offset:8704
s_waitcnt lgkmcnt(12)
v_mfma_f32_16x16x32_bf16 a[0:3], v[176:179], v[80:83], a[0:3]
s_add_u32 s78, s73, 16384
buffer_load_dwordx4 v[96:99], v27, s[16:19], s78 offen offset:0
v_mfma_f32_16x16x32_bf16 a[72:75], v[176:179], v[152:155], a[72:75]
ds_read_b64_tr_b16 v[204:205], v11 offset:8192
ds_read_b64_tr_b16 v[206:207], v11 offset:8704
s_waitcnt lgkmcnt(12)
v_mfma_f32_16x16x32_bf16 a[4:7], v[180:183], v[80:83], a[4:7]
v_mfma_f32_16x16x32_bf16 a[76:79], v[180:183], v[152:155], a[76:79]
ds_read_b64_tr_b16 v[176:177], v8 offset:16384
ds_read_b64_tr_b16 v[178:179], v8 offset:16896
s_waitcnt lgkmcnt(12)
v_mfma_f32_16x16x32_bf16 a[8:11], v[184:187], v[80:83], a[8:11]
v_mfma_f32_16x16x32_bf16 a[80:83], v[184:187], v[152:155], a[80:83]
s_add_u32 s78, s73, 34816
buffer_load_dwordx4 v[168:171], v27, s[16:19], s78 offen offset:0
ds_read_b64_tr_b16 v[180:181], v9 offset:16384
ds_read_b64_tr_b16 v[182:183], v9 offset:16896
s_waitcnt lgkmcnt(12)
v_mfma_f32_16x16x32_bf16 a[12:15], v[188:191], v[80:83], a[12:15]
v_mfma_f32_16x16x32_bf16 a[84:87], v[188:191], v[152:155], a[84:87]
ds_read_b64_tr_b16 v[184:185], v10 offset:16384
ds_read_b64_tr_b16 v[186:187], v10 offset:16896
s_waitcnt lgkmcnt(12)
v_mfma_f32_16x16x32_bf16 a[16:19], v[192:195], v[80:83], a[16:19]
v_mfma_f32_16x16x32_bf16 a[88:91], v[192:195], v[152:155], a[88:91]
s_add_u32 s78, s73, 16384
buffer_load_dwordx4 v[100:103], v27, s[16:19], s78 offen offset:1024
ds_read_b64_tr_b16 v[188:189], v11 offset:16384
ds_read_b64_tr_b16 v[190:191], v11 offset:16896
s_waitcnt lgkmcnt(12)
v_mfma_f32_16x16x32_bf16 a[20:23], v[196:199], v[80:83], a[20:23]
v_mfma_f32_16x16x32_bf16 a[92:95], v[196:199], v[152:155], a[92:95]
ds_read_b64_tr_b16 v[192:193], v8 offset:24576
ds_read_b64_tr_b16 v[194:195], v8 offset:25088
s_waitcnt lgkmcnt(12)
v_mfma_f32_16x16x32_bf16 a[24:27], v[200:203], v[80:83], a[24:27]
v_mfma_f32_16x16x32_bf16 a[96:99], v[200:203], v[152:155], a[96:99]
s_add_u32 s78, s73, 34816
buffer_load_dwordx4 v[172:175], v27, s[16:19], s78 offen offset:1024
ds_read_b64_tr_b16 v[196:197], v9 offset:24576
ds_read_b64_tr_b16 v[198:199], v9 offset:25088
s_waitcnt lgkmcnt(12)
v_mfma_f32_16x16x32_bf16 a[28:31], v[204:207], v[80:83], a[28:31]
v_mfma_f32_16x16x32_bf16 a[100:103], v[204:207], v[152:155], a[100:103]
ds_read_b64_tr_b16 v[200:201], v10 offset:24576
ds_read_b64_tr_b16 v[202:203], v10 offset:25088
s_waitcnt lgkmcnt(12)
v_mfma_f32_16x16x32_bf16 a[32:35], v[176:179], v[80:83], a[32:35]
v_mfma_f32_16x16x32_bf16 a[104:107], v[176:179], v[152:155], a[104:107]
s_add_u32 s57, s84, 4718592
s_add_u32 m0, s56, 0
s_nop 0
buffer_load_dwordx4 v16, s[12:15], s57 offen lds
ds_read_b64_tr_b16 v[204:205], v11 offset:24576
ds_read_b64_tr_b16 v[206:207], v11 offset:25088
s_waitcnt lgkmcnt(12)
v_mfma_f32_16x16x32_bf16 a[36:39], v[180:183], v[80:83], a[36:39]
v_mfma_f32_16x16x32_bf16 a[108:111], v[180:183], v[152:155], a[108:111]
ds_read_b64_tr_b16 v[176:177], v8 offset:32768
ds_read_b64_tr_b16 v[178:179], v8 offset:33280
s_waitcnt lgkmcnt(12)
v_mfma_f32_16x16x32_bf16 a[40:43], v[184:187], v[80:83], a[40:43]
v_mfma_f32_16x16x32_bf16 a[112:115], v[184:187], v[152:155], a[112:115]
s_add_u32 s57, s85, 4718592
s_add_u32 m0, s56, 8192
s_nop 0
buffer_load_dwordx4 v16, s[12:15], s57 offen lds
ds_read_b64_tr_b16 v[180:181], v9 offset:32768
ds_read_b64_tr_b16 v[182:183], v9 offset:33280
s_waitcnt lgkmcnt(12)
v_mfma_f32_16x16x32_bf16 a[44:47], v[188:191], v[80:83], a[44:47]
v_mfma_f32_16x16x32_bf16 a[116:119], v[188:191], v[152:155], a[116:119]
ds_read_b64_tr_b16 v[184:185], v8 offset:4096
ds_read_b64_tr_b16 v[186:187], v8 offset:4608
s_waitcnt lgkmcnt(12)
v_mfma_f32_16x16x32_bf16 a[48:51], v[192:195], v[80:83], a[48:51]
v_mfma_f32_16x16x32_bf16 a[120:123], v[192:195], v[152:155], a[120:123]
s_add_u32 s57, s86, 4718592
s_add_u32 m0, s56, 16384
s_nop 0
buffer_load_dwordx4 v16, s[12:15], s57 offen lds
ds_read_b64_tr_b16 v[188:189], v9 offset:4096
ds_read_b64_tr_b16 v[190:191], v9 offset:4608
s_waitcnt lgkmcnt(12)
v_mfma_f32_16x16x32_bf16 a[52:55], v[196:199], v[80:83], a[52:55]
v_mfma_f32_16x16x32_bf16 a[124:127], v[196:199], v[152:155], a[124:127]
ds_read_b64_tr_b16 v[192:193], v10 offset:4096
ds_read_b64_tr_b16 v[194:195], v10 offset:4608
s_waitcnt lgkmcnt(12)
v_mfma_f32_16x16x32_bf16 a[56:59], v[200:203], v[80:83], a[56:59]
v_mfma_f32_16x16x32_bf16 a[128:131], v[200:203], v[152:155], a[128:131]
s_add_u32 s57, s87, 4718592
s_add_u32 m0, s56, 24576
s_nop 0
buffer_load_dwordx4 v16, s[12:15], s57 offen lds
ds_read_b64_tr_b16 v[196:197], v11 offset:4096
ds_read_b64_tr_b16 v[198:199], v11 offset:4608
s_waitcnt lgkmcnt(12)
v_mfma_f32_16x16x32_bf16 a[60:63], v[204:207], v[80:83], a[60:63]
v_mfma_f32_16x16x32_bf16 a[132:135], v[204:207], v[152:155], a[132:135]
ds_read_b64_tr_b16 v[200:201], v8 offset:12288
ds_read_b64_tr_b16 v[202:203], v8 offset:12800
s_waitcnt lgkmcnt(12)
v_mfma_f32_16x16x32_bf16 a[64:67], v[176:179], v[80:83], a[64:67]
v_mfma_f32_16x16x32_bf16 a[136:139], v[176:179], v[152:155], a[136:139]
ds_read_b64_tr_b16 v[204:205], v9 offset:12288
ds_read_b64_tr_b16 v[206:207], v9 offset:12800
s_waitcnt lgkmcnt(12)
v_mfma_f32_16x16x32_bf16 a[68:71], v[180:183], v[80:83], a[68:71]
s_add_u32 s57, s88, 4718592
s_add_u32 m0, s56, 32768
s_nop 0
buffer_load_dwordx4 v16, s[12:15], s57 offen lds
v_mfma_f32_16x16x32_bf16 a[140:143], v[180:183], v[152:155], a[140:143]
ds_read_b64_tr_b16 v[176:177], v10 offset:12288
ds_read_b64_tr_b16 v[178:179], v10 offset:12800
s_waitcnt lgkmcnt(12)
v_mfma_f32_16x16x32_bf16 a[0:3], v[184:187], v[84:87], a[0:3]
v_mfma_f32_16x16x32_bf16 a[72:75], v[184:187], v[156:159], a[72:75]
ds_read_b64_tr_b16 v[180:181], v11 offset:12288
ds_read_b64_tr_b16 v[182:183], v11 offset:12800
s_waitcnt lgkmcnt(12)
v_mfma_f32_16x16x32_bf16 a[4:7], v[188:191], v[84:87], a[4:7]
s_add_u32 s57, s84, 4792320
s_add_u32 m0, s56, 1024
s_nop 0
buffer_load_dwordx4 v17, s[12:15], s57 offen lds
v_mfma_f32_16x16x32_bf16 a[76:79], v[188:191], v[156:159], a[76:79]
ds_read_b64_tr_b16 v[184:185], v8 offset:20480
ds_read_b64_tr_b16 v[186:187], v8 offset:20992
s_waitcnt lgkmcnt(12)
v_mfma_f32_16x16x32_bf16 a[8:11], v[192:195], v[84:87], a[8:11]
v_mfma_f32_16x16x32_bf16 a[80:83], v[192:195], v[156:159], a[80:83]
ds_read_b64_tr_b16 v[188:189], v9 offset:20480
ds_read_b64_tr_b16 v[190:191], v9 offset:20992
s_waitcnt lgkmcnt(12)
v_mfma_f32_16x16x32_bf16 a[12:15], v[196:199], v[84:87], a[12:15]
s_add_u32 s57, s85, 4792320
s_add_u32 m0, s56, 9216
s_nop 0
buffer_load_dwordx4 v17, s[12:15], s57 offen lds
v_mfma_f32_16x16x32_bf16 a[84:87], v[196:199], v[156:159], a[84:87]
ds_read_b64_tr_b16 v[192:193], v10 offset:20480
ds_read_b64_tr_b16 v[194:195], v10 offset:20992
s_waitcnt lgkmcnt(12)
v_mfma_f32_16x16x32_bf16 a[16:19], v[200:203], v[84:87], a[16:19]
v_mfma_f32_16x16x32_bf16 a[88:91], v[200:203], v[156:159], a[88:91]
ds_read_b64_tr_b16 v[196:197], v11 offset:20480
ds_read_b64_tr_b16 v[198:199], v11 offset:20992
s_waitcnt lgkmcnt(12)
v_mfma_f32_16x16x32_bf16 a[20:23], v[204:207], v[84:87], a[20:23]
s_add_u32 s57, s86, 4792320
s_add_u32 m0, s56, 17408
s_nop 0
buffer_load_dwordx4 v17, s[12:15], s57 offen lds
v_mfma_f32_16x16x32_bf16 a[92:95], v[204:207], v[156:159], a[92:95]
ds_read_b64_tr_b16 v[200:201], v8 offset:28672
ds_read_b64_tr_b16 v[202:203], v8 offset:29184
s_waitcnt lgkmcnt(12)
v_mfma_f32_16x16x32_bf16 a[24:27], v[176:179], v[84:87], a[24:27]
v_mfma_f32_16x16x32_bf16 a[96:99], v[176:179], v[156:159], a[96:99]
ds_read_b64_tr_b16 v[204:205], v9 offset:28672
ds_read_b64_tr_b16 v[206:207], v9 offset:29184
s_waitcnt lgkmcnt(12)
v_mfma_f32_16x16x32_bf16 a[28:31], v[180:183], v[84:87], a[28:31]
s_add_u32 s57, s87, 4792320
s_add_u32 m0, s56, 25600
s_nop 0
buffer_load_dwordx4 v17, s[12:15], s57 offen lds
v_mfma_f32_16x16x32_bf16 a[100:103], v[180:183], v[156:159], a[100:103]
ds_read_b64_tr_b16 v[176:177], v10 offset:28672
ds_read_b64_tr_b16 v[178:179], v10 offset:29184
s_waitcnt lgkmcnt(12)
v_mfma_f32_16x16x32_bf16 a[32:35], v[184:187], v[84:87], a[32:35]
v_mfma_f32_16x16x32_bf16 a[104:107], v[184:187], v[156:159], a[104:107]
ds_read_b64_tr_b16 v[180:181], v11 offset:28672
ds_read_b64_tr_b16 v[182:183], v11 offset:29184
s_waitcnt lgkmcnt(12)
v_mfma_f32_16x16x32_bf16 a[36:39], v[188:191], v[84:87], a[36:39]
s_add_u32 s57, s88, 4792320
s_add_u32 m0, s56, 33792
s_nop 0
buffer_load_dwordx4 v17, s[12:15], s57 offen lds
v_mfma_f32_16x16x32_bf16 a[108:111], v[188:191], v[156:159], a[108:111]
ds_read_b64_tr_b16 v[184:185], v8 offset:36864
ds_read_b64_tr_b16 v[186:187], v8 offset:37376
s_waitcnt lgkmcnt(12)
v_mfma_f32_16x16x32_bf16 a[40:43], v[192:195], v[84:87], a[40:43]
v_mfma_f32_16x16x32_bf16 a[112:115], v[192:195], v[156:159], a[112:115]
ds_read_b64_tr_b16 v[188:189], v9 offset:36864
ds_read_b64_tr_b16 v[190:191], v9 offset:37376
s_waitcnt lgkmcnt(12)
v_mfma_f32_16x16x32_bf16 a[44:47], v[196:199], v[84:87], a[44:47]
v_mfma_f32_16x16x32_bf16 a[116:119], v[196:199], v[156:159], a[116:119]
s_waitcnt vmcnt(14)
s_barrier
v_add_u32 v8, 40960, v8
v_add_u32 v9, 40960, v9
v_add_u32 v10, 40960, v10
v_add_u32 v11, 40960, v11
ds_read_b64_tr_b16 v[192:193], v8 offset:0
ds_read_b64_tr_b16 v[194:195], v8 offset:512
s_waitcnt lgkmcnt(12)
v_mfma_f32_16x16x32_bf16 a[48:51], v[200:203], v[84:87], a[48:51]
v_mfma_f32_16x16x32_bf16 a[120:123], v[200:203], v[156:159], a[120:123]
ds_read_b64_tr_b16 v[196:197], v9 offset:0
ds_read_b64_tr_b16 v[198:199], v9 offset:512
s_waitcnt lgkmcnt(12)
v_mfma_f32_16x16x32_bf16 a[52:55], v[204:207], v[84:87], a[52:55]
v_mfma_f32_16x16x32_bf16 a[124:127], v[204:207], v[156:159], a[124:127]
ds_read_b64_tr_b16 v[200:201], v10 offset:0
ds_read_b64_tr_b16 v[202:203], v10 offset:512
s_waitcnt lgkmcnt(12)
v_mfma_f32_16x16x32_bf16 a[56:59], v[176:179], v[84:87], a[56:59]
v_mfma_f32_16x16x32_bf16 a[128:131], v[176:179], v[156:159], a[128:131]
ds_read_b64_tr_b16 v[204:205], v11 offset:0
ds_read_b64_tr_b16 v[206:207], v11 offset:512
s_waitcnt lgkmcnt(12)
v_mfma_f32_16x16x32_bf16 a[60:63], v[180:183], v[84:87], a[60:63]
v_mfma_f32_16x16x32_bf16 a[132:135], v[180:183], v[156:159], a[132:135]
ds_read_b64_tr_b16 v[176:177], v8 offset:8192
ds_read_b64_tr_b16 v[178:179], v8 offset:8704
s_waitcnt lgkmcnt(12)
v_mfma_f32_16x16x32_bf16 a[64:67], v[184:187], v[84:87], a[64:67]
v_mfma_f32_16x16x32_bf16 a[136:139], v[184:187], v[156:159], a[136:139]
ds_read_b64_tr_b16 v[180:181], v9 offset:8192
ds_read_b64_tr_b16 v[182:183], v9 offset:8704
s_waitcnt lgkmcnt(12)
v_mfma_f32_16x16x32_bf16 a[68:71], v[188:191], v[84:87], a[68:71]
v_mfma_f32_16x16x32_bf16 a[140:143], v[188:191], v[156:159], a[140:143]
ds_read_b64_tr_b16 v[184:185], v10 offset:8192
ds_read_b64_tr_b16 v[186:187], v10 offset:8704
s_waitcnt lgkmcnt(12)
v_mfma_f32_16x16x32_bf16 a[0:3], v[192:195], v[88:91], a[0:3]
v_mfma_f32_16x16x32_bf16 a[72:75], v[192:195], v[160:163], a[72:75]
ds_read_b64_tr_b16 v[188:189], v11 offset:8192
ds_read_b64_tr_b16 v[190:191], v11 offset:8704
s_waitcnt lgkmcnt(12)
v_mfma_f32_16x16x32_bf16 a[4:7], v[196:199], v[88:91], a[4:7]
v_mfma_f32_16x16x32_bf16 a[76:79], v[196:199], v[160:163], a[76:79]
ds_read_b64_tr_b16 v[192:193], v8 offset:16384
ds_read_b64_tr_b16 v[194:195], v8 offset:16896
s_waitcnt lgkmcnt(12)
v_mfma_f32_16x16x32_bf16 a[8:11], v[200:203], v[88:91], a[8:11]
v_mfma_f32_16x16x32_bf16 a[80:83], v[200:203], v[160:163], a[80:83]
ds_read_b64_tr_b16 v[196:197], v9 offset:16384
ds_read_b64_tr_b16 v[198:199], v9 offset:16896
s_waitcnt lgkmcnt(12)
v_mfma_f32_16x16x32_bf16 a[12:15], v[204:207], v[88:91], a[12:15]
v_mfma_f32_16x16x32_bf16 a[84:87], v[204:207], v[160:163], a[84:87]
ds_read_b64_tr_b16 v[200:201], v10 offset:16384
ds_read_b64_tr_b16 v[202:203], v10 offset:16896
s_waitcnt lgkmcnt(12)
v_mfma_f32_16x16x32_bf16 a[16:19], v[176:179], v[88:91], a[16:19]
v_mfma_f32_16x16x32_bf16 a[88:91], v[176:179], v[160:163], a[88:91]
ds_read_b64_tr_b16 v[204:205], v11 offset:16384
ds_read_b64_tr_b16 v[206:207], v11 offset:16896
s_waitcnt lgkmcnt(12)
v_mfma_f32_16x16x32_bf16 a[20:23], v[180:183], v[88:91], a[20:23]
v_mfma_f32_16x16x32_bf16 a[92:95], v[180:183], v[160:163], a[92:95]
ds_read_b64_tr_b16 v[176:177], v8 offset:24576
ds_read_b64_tr_b16 v[178:179], v8 offset:25088
s_waitcnt lgkmcnt(12)
v_mfma_f32_16x16x32_bf16 a[24:27], v[184:187], v[88:91], a[24:27]
v_mfma_f32_16x16x32_bf16 a[96:99], v[184:187], v[160:163], a[96:99]
ds_read_b64_tr_b16 v[180:181], v9 offset:24576
ds_read_b64_tr_b16 v[182:183], v9 offset:25088
s_waitcnt lgkmcnt(12)
v_mfma_f32_16x16x32_bf16 a[28:31], v[188:191], v[88:91], a[28:31]
v_mfma_f32_16x16x32_bf16 a[100:103], v[188:191], v[160:163], a[100:103]
ds_read_b64_tr_b16 v[184:185], v10 offset:24576
ds_read_b64_tr_b16 v[186:187], v10 offset:25088
s_waitcnt lgkmcnt(12)
v_mfma_f32_16x16x32_bf16 a[32:35], v[192:195], v[88:91], a[32:35]
v_mfma_f32_16x16x32_bf16 a[104:107], v[192:195], v[160:163], a[104:107]
ds_read_b64_tr_b16 v[188:189], v11 offset:24576
ds_read_b64_tr_b16 v[190:191], v11 offset:25088
s_waitcnt lgkmcnt(12)
v_mfma_f32_16x16x32_bf16 a[36:39], v[196:199], v[88:91], a[36:39]
v_mfma_f32_16x16x32_bf16 a[108:111], v[196:199], v[160:163], a[108:111]
ds_read_b64_tr_b16 v[192:193], v8 offset:32768
ds_read_b64_tr_b16 v[194:195], v8 offset:33280
s_waitcnt lgkmcnt(12)
v_mfma_f32_16x16x32_bf16 a[40:43], v[200:203], v[88:91], a[40:43]
v_mfma_f32_16x16x32_bf16 a[112:115], v[200:203], v[160:163], a[112:115]
ds_read_b64_tr_b16 v[196:197], v9 offset:32768
ds_read_b64_tr_b16 v[198:199], v9 offset:33280
s_waitcnt lgkmcnt(12)
v_mfma_f32_16x16x32_bf16 a[44:47], v[204:207], v[88:91], a[44:47]
v_mfma_f32_16x16x32_bf16 a[116:119], v[204:207], v[160:163], a[116:119]
ds_read_b64_tr_b16 v[200:201], v8 offset:4096
ds_read_b64_tr_b16 v[202:203], v8 offset:4608
s_waitcnt lgkmcnt(12)
v_mfma_f32_16x16x32_bf16 a[48:51], v[176:179], v[88:91], a[48:51]
v_mfma_f32_16x16x32_bf16 a[120:123], v[176:179], v[160:163], a[120:123]
ds_read_b64_tr_b16 v[204:205], v9 offset:4096
ds_read_b64_tr_b16 v[206:207], v9 offset:4608
s_waitcnt lgkmcnt(12)
v_mfma_f32_16x16x32_bf16 a[52:55], v[180:183], v[88:91], a[52:55]
v_mfma_f32_16x16x32_bf16 a[124:127], v[180:183], v[160:163], a[124:127]
ds_read_b64_tr_b16 v[176:177], v10 offset:4096
ds_read_b64_tr_b16 v[178:179], v10 offset:4608
s_waitcnt lgkmcnt(12)
v_mfma_f32_16x16x32_bf16 a[56:59], v[184:187], v[88:91], a[56:59]
v_mfma_f32_16x16x32_bf16 a[128:131], v[184:187], v[160:163], a[128:131]
ds_read_b64_tr_b16 v[180:181], v11 offset:4096
ds_read_b64_tr_b16 v[182:183], v11 offset:4608
s_waitcnt lgkmcnt(12)
v_mfma_f32_16x16x32_bf16 a[60:63], v[188:191], v[88:91], a[60:63]
v_mfma_f32_16x16x32_bf16 a[132:135], v[188:191], v[160:163], a[132:135]
ds_read_b64_tr_b16 v[184:185], v8 offset:12288
ds_read_b64_tr_b16 v[186:187], v8 offset:12800
s_waitcnt lgkmcnt(12)
v_mfma_f32_16x16x32_bf16 a[64:67], v[192:195], v[88:91], a[64:67]
v_mfma_f32_16x16x32_bf16 a[136:139], v[192:195], v[160:163], a[136:139]
ds_read_b64_tr_b16 v[188:189], v9 offset:12288
ds_read_b64_tr_b16 v[190:191], v9 offset:12800
s_waitcnt lgkmcnt(12)
v_mfma_f32_16x16x32_bf16 a[68:71], v[196:199], v[88:91], a[68:71]
v_mfma_f32_16x16x32_bf16 a[140:143], v[196:199], v[160:163], a[140:143]
ds_read_b64_tr_b16 v[192:193], v10 offset:12288
ds_read_b64_tr_b16 v[194:195], v10 offset:12800
s_waitcnt lgkmcnt(12)
v_mfma_f32_16x16x32_bf16 a[0:3], v[200:203], v[92:95], a[0:3]
v_mfma_f32_16x16x32_bf16 a[72:75], v[200:203], v[164:167], a[72:75]
ds_read_b64_tr_b16 v[196:197], v11 offset:12288
ds_read_b64_tr_b16 v[198:199], v11 offset:12800
s_waitcnt lgkmcnt(12)
v_mfma_f32_16x16x32_bf16 a[4:7], v[204:207], v[92:95], a[4:7]
v_mfma_f32_16x16x32_bf16 a[76:79], v[204:207], v[164:167], a[76:79]
ds_read_b64_tr_b16 v[200:201], v8 offset:20480
ds_read_b64_tr_b16 v[202:203], v8 offset:20992
s_waitcnt lgkmcnt(12)
v_mfma_f32_16x16x32_bf16 a[8:11], v[176:179], v[92:95], a[8:11]
v_mfma_f32_16x16x32_bf16 a[80:83], v[176:179], v[164:167], a[80:83]
ds_read_b64_tr_b16 v[204:205], v9 offset:20480
ds_read_b64_tr_b16 v[206:207], v9 offset:20992
s_waitcnt lgkmcnt(12)
v_mfma_f32_16x16x32_bf16 a[12:15], v[180:183], v[92:95], a[12:15]
v_mfma_f32_16x16x32_bf16 a[84:87], v[180:183], v[164:167], a[84:87]
ds_read_b64_tr_b16 v[176:177], v10 offset:20480
ds_read_b64_tr_b16 v[178:179], v10 offset:20992
s_waitcnt lgkmcnt(12)
v_mfma_f32_16x16x32_bf16 a[16:19], v[184:187], v[92:95], a[16:19]
v_mfma_f32_16x16x32_bf16 a[88:91], v[184:187], v[164:167], a[88:91]
ds_read_b64_tr_b16 v[180:181], v11 offset:20480
ds_read_b64_tr_b16 v[182:183], v11 offset:20992
s_waitcnt lgkmcnt(12)
v_mfma_f32_16x16x32_bf16 a[20:23], v[188:191], v[92:95], a[20:23]
v_mfma_f32_16x16x32_bf16 a[92:95], v[188:191], v[164:167], a[92:95]
ds_read_b64_tr_b16 v[184:185], v8 offset:28672
ds_read_b64_tr_b16 v[186:187], v8 offset:29184
s_waitcnt lgkmcnt(12)
v_mfma_f32_16x16x32_bf16 a[24:27], v[192:195], v[92:95], a[24:27]
v_mfma_f32_16x16x32_bf16 a[96:99], v[192:195], v[164:167], a[96:99]
ds_read_b64_tr_b16 v[188:189], v9 offset:28672
ds_read_b64_tr_b16 v[190:191], v9 offset:29184
s_waitcnt lgkmcnt(12)
v_mfma_f32_16x16x32_bf16 a[28:31], v[196:199], v[92:95], a[28:31]
v_mfma_f32_16x16x32_bf16 a[100:103], v[196:199], v[164:167], a[100:103]
ds_read_b64_tr_b16 v[192:193], v10 offset:28672
ds_read_b64_tr_b16 v[194:195], v10 offset:29184
s_waitcnt lgkmcnt(12)
v_mfma_f32_16x16x32_bf16 a[32:35], v[200:203], v[92:95], a[32:35]
v_mfma_f32_16x16x32_bf16 a[104:107], v[200:203], v[164:167], a[104:107]
ds_read_b64_tr_b16 v[196:197], v11 offset:28672
ds_read_b64_tr_b16 v[198:199], v11 offset:29184
s_waitcnt lgkmcnt(12)
v_mfma_f32_16x16x32_bf16 a[36:39], v[204:207], v[92:95], a[36:39]
v_mfma_f32_16x16x32_bf16 a[108:111], v[204:207], v[164:167], a[108:111]
ds_read_b64_tr_b16 v[200:201], v8 offset:36864
ds_read_b64_tr_b16 v[202:203], v8 offset:37376
s_waitcnt lgkmcnt(12)
v_mfma_f32_16x16x32_bf16 a[40:43], v[176:179], v[92:95], a[40:43]
v_mfma_f32_16x16x32_bf16 a[112:115], v[176:179], v[164:167], a[112:115]
ds_read_b64_tr_b16 v[204:205], v9 offset:36864
ds_read_b64_tr_b16 v[206:207], v9 offset:37376
s_waitcnt lgkmcnt(12)
v_mfma_f32_16x16x32_bf16 a[44:47], v[180:183], v[92:95], a[44:47]
v_mfma_f32_16x16x32_bf16 a[116:119], v[180:183], v[164:167], a[116:119]
s_waitcnt vmcnt(0)
s_barrier
v_subrev_u32 v8, 122880, v8
v_subrev_u32 v9, 122880, v9
v_subrev_u32 v10, 122880, v10
v_subrev_u32 v11, 122880, v11
ds_read_b64_tr_b16 v[176:177], v8 offset:0
ds_read_b64_tr_b16 v[178:179], v8 offset:512
s_waitcnt lgkmcnt(12)
v_mfma_f32_16x16x32_bf16 a[48:51], v[184:187], v[92:95], a[48:51]
v_mfma_f32_16x16x32_bf16 a[120:123], v[184:187], v[164:167], a[120:123]
ds_read_b64_tr_b16 v[180:181], v9 offset:0
ds_read_b64_tr_b16 v[182:183], v9 offset:512
s_waitcnt lgkmcnt(12)
v_mfma_f32_16x16x32_bf16 a[52:55], v[188:191], v[92:95], a[52:55]
v_mfma_f32_16x16x32_bf16 a[124:127], v[188:191], v[164:167], a[124:127]
ds_read_b64_tr_b16 v[184:185], v10 offset:0
ds_read_b64_tr_b16 v[186:187], v10 offset:512
s_waitcnt lgkmcnt(12)
v_mfma_f32_16x16x32_bf16 a[56:59], v[192:195], v[92:95], a[56:59]
v_mfma_f32_16x16x32_bf16 a[128:131], v[192:195], v[164:167], a[128:131]
ds_read_b64_tr_b16 v[188:189], v11 offset:0
ds_read_b64_tr_b16 v[190:191], v11 offset:512
s_waitcnt lgkmcnt(12)
v_mfma_f32_16x16x32_bf16 a[60:63], v[196:199], v[92:95], a[60:63]
v_mfma_f32_16x16x32_bf16 a[132:135], v[196:199], v[164:167], a[132:135]
ds_read_b64_tr_b16 v[192:193], v8 offset:8192
ds_read_b64_tr_b16 v[194:195], v8 offset:8704
s_waitcnt lgkmcnt(12)
v_mfma_f32_16x16x32_bf16 a[64:67], v[200:203], v[92:95], a[64:67]
v_mfma_f32_16x16x32_bf16 a[136:139], v[200:203], v[164:167], a[136:139]
ds_read_b64_tr_b16 v[196:197], v9 offset:8192
ds_read_b64_tr_b16 v[198:199], v9 offset:8704
s_waitcnt lgkmcnt(12)
v_mfma_f32_16x16x32_bf16 a[68:71], v[204:207], v[92:95], a[68:71]
v_mfma_f32_16x16x32_bf16 a[140:143], v[204:207], v[164:167], a[140:143]
ds_read_b64_tr_b16 v[200:201], v10 offset:8192
ds_read_b64_tr_b16 v[202:203], v10 offset:8704
s_waitcnt lgkmcnt(12)
v_mfma_f32_16x16x32_bf16 a[0:3], v[176:179], v[96:99], a[0:3]
v_mfma_f32_16x16x32_bf16 a[72:75], v[176:179], v[168:171], a[72:75]
ds_read_b64_tr_b16 v[204:205], v11 offset:8192
ds_read_b64_tr_b16 v[206:207], v11 offset:8704
s_waitcnt lgkmcnt(12)
v_mfma_f32_16x16x32_bf16 a[4:7], v[180:183], v[96:99], a[4:7]
v_mfma_f32_16x16x32_bf16 a[76:79], v[180:183], v[168:171], a[76:79]
ds_read_b64_tr_b16 v[176:177], v8 offset:16384
ds_read_b64_tr_b16 v[178:179], v8 offset:16896
s_waitcnt lgkmcnt(12)
v_mfma_f32_16x16x32_bf16 a[8:11], v[184:187], v[96:99], a[8:11]
v_mfma_f32_16x16x32_bf16 a[80:83], v[184:187], v[168:171], a[80:83]
ds_read_b64_tr_b16 v[180:181], v9 offset:16384
ds_read_b64_tr_b16 v[182:183], v9 offset:16896
s_waitcnt lgkmcnt(12)
v_mfma_f32_16x16x32_bf16 a[12:15], v[188:191], v[96:99], a[12:15]
v_mfma_f32_16x16x32_bf16 a[84:87], v[188:191], v[168:171], a[84:87]
ds_read_b64_tr_b16 v[184:185], v10 offset:16384
ds_read_b64_tr_b16 v[186:187], v10 offset:16896
s_waitcnt lgkmcnt(12)
v_mfma_f32_16x16x32_bf16 a[16:19], v[192:195], v[96:99], a[16:19]
v_mfma_f32_16x16x32_bf16 a[88:91], v[192:195], v[168:171], a[88:91]
ds_read_b64_tr_b16 v[188:189], v11 offset:16384
ds_read_b64_tr_b16 v[190:191], v11 offset:16896
s_waitcnt lgkmcnt(12)
v_mfma_f32_16x16x32_bf16 a[20:23], v[196:199], v[96:99], a[20:23]
v_mfma_f32_16x16x32_bf16 a[92:95], v[196:199], v[168:171], a[92:95]
ds_read_b64_tr_b16 v[192:193], v8 offset:24576
ds_read_b64_tr_b16 v[194:195], v8 offset:25088
s_waitcnt lgkmcnt(12)
v_mfma_f32_16x16x32_bf16 a[24:27], v[200:203], v[96:99], a[24:27]
v_mfma_f32_16x16x32_bf16 a[96:99], v[200:203], v[168:171], a[96:99]
ds_read_b64_tr_b16 v[196:197], v9 offset:24576
ds_read_b64_tr_b16 v[198:199], v9 offset:25088
s_waitcnt lgkmcnt(12)
v_mfma_f32_16x16x32_bf16 a[28:31], v[204:207], v[96:99], a[28:31]
v_mfma_f32_16x16x32_bf16 a[100:103], v[204:207], v[168:171], a[100:103]
ds_read_b64_tr_b16 v[200:201], v10 offset:24576
ds_read_b64_tr_b16 v[202:203], v10 offset:25088
s_waitcnt lgkmcnt(12)
v_mfma_f32_16x16x32_bf16 a[32:35], v[176:179], v[96:99], a[32:35]
v_mfma_f32_16x16x32_bf16 a[104:107], v[176:179], v[168:171], a[104:107]
ds_read_b64_tr_b16 v[204:205], v11 offset:24576
ds_read_b64_tr_b16 v[206:207], v11 offset:25088
s_waitcnt lgkmcnt(12)
v_mfma_f32_16x16x32_bf16 a[36:39], v[180:183], v[96:99], a[36:39]
v_mfma_f32_16x16x32_bf16 a[108:111], v[180:183], v[168:171], a[108:111]
ds_read_b64_tr_b16 v[176:177], v8 offset:32768
ds_read_b64_tr_b16 v[178:179], v8 offset:33280
s_waitcnt lgkmcnt(12)
v_mfma_f32_16x16x32_bf16 a[40:43], v[184:187], v[96:99], a[40:43]
v_mfma_f32_16x16x32_bf16 a[112:115], v[184:187], v[168:171], a[112:115]
ds_read_b64_tr_b16 v[180:181], v9 offset:32768
ds_read_b64_tr_b16 v[182:183], v9 offset:33280
s_waitcnt lgkmcnt(12)
v_mfma_f32_16x16x32_bf16 a[44:47], v[188:191], v[96:99], a[44:47]
v_mfma_f32_16x16x32_bf16 a[116:119], v[188:191], v[168:171], a[116:119]
ds_read_b64_tr_b16 v[184:185], v8 offset:4096
ds_read_b64_tr_b16 v[186:187], v8 offset:4608
s_waitcnt lgkmcnt(12)
v_mfma_f32_16x16x32_bf16 a[48:51], v[192:195], v[96:99], a[48:51]
v_mfma_f32_16x16x32_bf16 a[120:123], v[192:195], v[168:171], a[120:123]
ds_read_b64_tr_b16 v[188:189], v9 offset:4096
ds_read_b64_tr_b16 v[190:191], v9 offset:4608
s_waitcnt lgkmcnt(12)
v_mfma_f32_16x16x32_bf16 a[52:55], v[196:199], v[96:99], a[52:55]
v_mfma_f32_16x16x32_bf16 a[124:127], v[196:199], v[168:171], a[124:127]
ds_read_b64_tr_b16 v[192:193], v10 offset:4096
ds_read_b64_tr_b16 v[194:195], v10 offset:4608
s_waitcnt lgkmcnt(12)
v_mfma_f32_16x16x32_bf16 a[56:59], v[200:203], v[96:99], a[56:59]
v_mfma_f32_16x16x32_bf16 a[128:131], v[200:203], v[168:171], a[128:131]
ds_read_b64_tr_b16 v[196:197], v11 offset:4096
ds_read_b64_tr_b16 v[198:199], v11 offset:4608
s_waitcnt lgkmcnt(12)
v_mfma_f32_16x16x32_bf16 a[60:63], v[204:207], v[96:99], a[60:63]
v_mfma_f32_16x16x32_bf16 a[132:135], v[204:207], v[168:171], a[132:135]
ds_read_b64_tr_b16 v[200:201], v8 offset:12288
ds_read_b64_tr_b16 v[202:203], v8 offset:12800
s_waitcnt lgkmcnt(12)
v_mfma_f32_16x16x32_bf16 a[64:67], v[176:179], v[96:99], a[64:67]
v_mfma_f32_16x16x32_bf16 a[136:139], v[176:179], v[168:171], a[136:139]
ds_read_b64_tr_b16 v[204:205], v9 offset:12288
ds_read_b64_tr_b16 v[206:207], v9 offset:12800
s_waitcnt lgkmcnt(12)
v_mfma_f32_16x16x32_bf16 a[68:71], v[180:183], v[96:99], a[68:71]
v_mfma_f32_16x16x32_bf16 a[140:143], v[180:183], v[168:171], a[140:143]
ds_read_b64_tr_b16 v[176:177], v10 offset:12288
ds_read_b64_tr_b16 v[178:179], v10 offset:12800
s_waitcnt lgkmcnt(12)
v_mfma_f32_16x16x32_bf16 a[0:3], v[184:187], v[100:103], a[0:3]
v_mfma_f32_16x16x32_bf16 a[72:75], v[184:187], v[172:175], a[72:75]
ds_read_b64_tr_b16 v[180:181], v11 offset:12288
ds_read_b64_tr_b16 v[182:183], v11 offset:12800
s_waitcnt lgkmcnt(12)
v_mfma_f32_16x16x32_bf16 a[4:7], v[188:191], v[100:103], a[4:7]
v_mfma_f32_16x16x32_bf16 a[76:79], v[188:191], v[172:175], a[76:79]
ds_read_b64_tr_b16 v[184:185], v8 offset:20480
ds_read_b64_tr_b16 v[186:187], v8 offset:20992
s_waitcnt lgkmcnt(12)
v_mfma_f32_16x16x32_bf16 a[8:11], v[192:195], v[100:103], a[8:11]
v_mfma_f32_16x16x32_bf16 a[80:83], v[192:195], v[172:175], a[80:83]
ds_read_b64_tr_b16 v[188:189], v9 offset:20480
ds_read_b64_tr_b16 v[190:191], v9 offset:20992
s_waitcnt lgkmcnt(12)
v_mfma_f32_16x16x32_bf16 a[12:15], v[196:199], v[100:103], a[12:15]
v_mfma_f32_16x16x32_bf16 a[84:87], v[196:199], v[172:175], a[84:87]
ds_read_b64_tr_b16 v[192:193], v10 offset:20480
ds_read_b64_tr_b16 v[194:195], v10 offset:20992
s_waitcnt lgkmcnt(12)
v_mfma_f32_16x16x32_bf16 a[16:19], v[200:203], v[100:103], a[16:19]
v_mfma_f32_16x16x32_bf16 a[88:91], v[200:203], v[172:175], a[88:91]
ds_read_b64_tr_b16 v[196:197], v11 offset:20480
ds_read_b64_tr_b16 v[198:199], v11 offset:20992
s_waitcnt lgkmcnt(12)
v_mfma_f32_16x16x32_bf16 a[20:23], v[204:207], v[100:103], a[20:23]
v_mfma_f32_16x16x32_bf16 a[92:95], v[204:207], v[172:175], a[92:95]
ds_read_b64_tr_b16 v[200:201], v8 offset:28672
ds_read_b64_tr_b16 v[202:203], v8 offset:29184
s_waitcnt lgkmcnt(12)
v_mfma_f32_16x16x32_bf16 a[24:27], v[176:179], v[100:103], a[24:27]
v_mfma_f32_16x16x32_bf16 a[96:99], v[176:179], v[172:175], a[96:99]
ds_read_b64_tr_b16 v[204:205], v9 offset:28672
ds_read_b64_tr_b16 v[206:207], v9 offset:29184
s_waitcnt lgkmcnt(12)
v_mfma_f32_16x16x32_bf16 a[28:31], v[180:183], v[100:103], a[28:31]
v_mfma_f32_16x16x32_bf16 a[100:103], v[180:183], v[172:175], a[100:103]
ds_read_b64_tr_b16 v[176:177], v10 offset:28672
ds_read_b64_tr_b16 v[178:179], v10 offset:29184
s_waitcnt lgkmcnt(12)
v_mfma_f32_16x16x32_bf16 a[32:35], v[184:187], v[100:103], a[32:35]
v_mfma_f32_16x16x32_bf16 a[104:107], v[184:187], v[172:175], a[104:107]
ds_read_b64_tr_b16 v[180:181], v11 offset:28672
ds_read_b64_tr_b16 v[182:183], v11 offset:29184
s_waitcnt lgkmcnt(12)
v_mfma_f32_16x16x32_bf16 a[36:39], v[188:191], v[100:103], a[36:39]
v_mfma_f32_16x16x32_bf16 a[108:111], v[188:191], v[172:175], a[108:111]
ds_read_b64_tr_b16 v[184:185], v8 offset:36864
ds_read_b64_tr_b16 v[186:187], v8 offset:37376
s_waitcnt lgkmcnt(12)
v_mfma_f32_16x16x32_bf16 a[40:43], v[192:195], v[100:103], a[40:43]
v_mfma_f32_16x16x32_bf16 a[112:115], v[192:195], v[172:175], a[112:115]
ds_read_b64_tr_b16 v[188:189], v9 offset:36864
ds_read_b64_tr_b16 v[190:191], v9 offset:37376
s_waitcnt lgkmcnt(12)
v_mfma_f32_16x16x32_bf16 a[44:47], v[196:199], v[100:103], a[44:47]
v_mfma_f32_16x16x32_bf16 a[116:119], v[196:199], v[172:175], a[116:119]
s_waitcnt lgkmcnt(10)
v_mfma_f32_16x16x32_bf16 a[48:51], v[200:203], v[100:103], a[48:51]
v_mfma_f32_16x16x32_bf16 a[120:123], v[200:203], v[172:175], a[120:123]
s_waitcnt lgkmcnt(8)
v_mfma_f32_16x16x32_bf16 a[52:55], v[204:207], v[100:103], a[52:55]
v_mfma_f32_16x16x32_bf16 a[124:127], v[204:207], v[172:175], a[124:127]
s_waitcnt lgkmcnt(6)
v_mfma_f32_16x16x32_bf16 a[56:59], v[176:179], v[100:103], a[56:59]
v_mfma_f32_16x16x32_bf16 a[128:131], v[176:179], v[172:175], a[128:131]
s_waitcnt lgkmcnt(4)
v_mfma_f32_16x16x32_bf16 a[60:63], v[180:183], v[100:103], a[60:63]
v_mfma_f32_16x16x32_bf16 a[132:135], v[180:183], v[172:175], a[132:135]
s_waitcnt lgkmcnt(2)
v_mfma_f32_16x16x32_bf16 a[64:67], v[184:187], v[100:103], a[64:67]
v_mfma_f32_16x16x32_bf16 a[136:139], v[184:187], v[172:175], a[136:139]
s_waitcnt lgkmcnt(0)
v_mfma_f32_16x16x32_bf16 a[68:71], v[188:191], v[100:103], a[68:71]
v_mfma_f32_16x16x32_bf16 a[140:143], v[188:191], v[172:175], a[140:143]
v_dot2_f32_bf16 v248, v32, s82, v248
v_dot2_f32_bf16 v250, v32, v32, v250
v_dot2_f32_bf16 v249, v104, s82, v249
v_dot2_f32_bf16 v251, v104, v104, v251
v_dot2_f32_bf16 v248, v33, s82, v248
v_dot2_f32_bf16 v250, v33, v33, v250
v_dot2_f32_bf16 v249, v105, s82, v249
v_dot2_f32_bf16 v251, v105, v105, v251
v_dot2_f32_bf16 v248, v34, s82, v248
v_dot2_f32_bf16 v250, v34, v34, v250
v_dot2_f32_bf16 v249, v106, s82, v249
v_dot2_f32_bf16 v251, v106, v106, v251
v_dot2_f32_bf16 v248, v35, s82, v248
v_dot2_f32_bf16 v250, v35, v35, v250
v_dot2_f32_bf16 v249, v107, s82, v249
v_dot2_f32_bf16 v251, v107, v107, v251
v_dot2_f32_bf16 v248, v36, s82, v248
v_dot2_f32_bf16 v250, v36, v36, v250
v_dot2_f32_bf16 v249, v108, s82, v249
v_dot2_f32_bf16 v251, v108, v108, v251
v_dot2_f32_bf16 v248, v37, s82, v248
v_dot2_f32_bf16 v250, v37, v37, v250
v_dot2_f32_bf16 v249, v109, s82, v249
v_dot2_f32_bf16 v251, v109, v109, v251
v_dot2_f32_bf16 v248, v38, s82, v248
v_dot2_f32_bf16 v250, v38, v38, v250
v_dot2_f32_bf16 v249, v110, s82, v249
v_dot2_f32_bf16 v251, v110, v110, v251
v_dot2_f32_bf16 v248, v39, s82, v248
v_dot2_f32_bf16 v250, v39, v39, v250
v_dot2_f32_bf16 v249, v111, s82, v249
v_dot2_f32_bf16 v251, v111, v111, v251
v_dot2_f32_bf16 v248, v40, s82, v248
v_dot2_f32_bf16 v250, v40, v40, v250
v_dot2_f32_bf16 v249, v112, s82, v249
v_dot2_f32_bf16 v251, v112, v112, v251
v_dot2_f32_bf16 v248, v41, s82, v248
v_dot2_f32_bf16 v250, v41, v41, v250
v_dot2_f32_bf16 v249, v113, s82, v249
v_dot2_f32_bf16 v251, v113, v113, v251
v_dot2_f32_bf16 v248, v42, s82, v248
v_dot2_f32_bf16 v250, v42, v42, v250
v_dot2_f32_bf16 v249, v114, s82, v249
v_dot2_f32_bf16 v251, v114, v114, v251
v_dot2_f32_bf16 v248, v43, s82, v248
v_dot2_f32_bf16 v250, v43, v43, v250
v_dot2_f32_bf16 v249, v115, s82, v249
v_dot2_f32_bf16 v251, v115, v115, v251
v_dot2_f32_bf16 v248, v44, s82, v248
v_dot2_f32_bf16 v250, v44, v44, v250
v_dot2_f32_bf16 v249, v116, s82, v249
v_dot2_f32_bf16 v251, v116, v116, v251
v_dot2_f32_bf16 v248, v45, s82, v248
v_dot2_f32_bf16 v250, v45, v45, v250
v_dot2_f32_bf16 v249, v117, s82, v249
v_dot2_f32_bf16 v251, v117, v117, v251
v_dot2_f32_bf16 v248, v46, s82, v248
v_dot2_f32_bf16 v250, v46, v46, v250
v_dot2_f32_bf16 v249, v118, s82, v249
v_dot2_f32_bf16 v251, v118, v118, v251
v_dot2_f32_bf16 v248, v47, s82, v248
v_dot2_f32_bf16 v250, v47, v47, v250
v_dot2_f32_bf16 v249, v119, s82, v249
v_dot2_f32_bf16 v251, v119, v119, v251
v_dot2_f32_bf16 v248, v48, s82, v248
v_dot2_f32_bf16 v250, v48, v48, v250
v_dot2_f32_bf16 v249, v120, s82, v249
v_dot2_f32_bf16 v251, v120, v120, v251
v_dot2_f32_bf16 v248, v49, s82, v248
v_dot2_f32_bf16 v250, v49, v49, v250
v_dot2_f32_bf16 v249, v121, s82, v249
v_dot2_f32_bf16 v251, v121, v121, v251
v_dot2_f32_bf16 v248, v50, s82, v248
v_dot2_f32_bf16 v250, v50, v50, v250
v_dot2_f32_bf16 v249, v122, s82, v249
v_dot2_f32_bf16 v251, v122, v122, v251
v_dot2_f32_bf16 v248, v51, s82, v248
v_dot2_f32_bf16 v250, v51, v51, v250
v_dot2_f32_bf16 v249, v123, s82, v249
v_dot2_f32_bf16 v251, v123, v123, v251
v_dot2_f32_bf16 v248, v52, s82, v248
v_dot2_f32_bf16 v250, v52, v52, v250
v_dot2_f32_bf16 v249, v124, s82, v249
v_dot2_f32_bf16 v251, v124, v124, v251
v_dot2_f32_bf16 v248, v53, s82, v248
v_dot2_f32_bf16 v250, v53, v53, v250
v_dot2_f32_bf16 v249, v125, s82, v249
v_dot2_f32_bf16 v251, v125, v125, v251
v_dot2_f32_bf16 v248, v54, s82, v248
v_dot2_f32_bf16 v250, v54, v54, v250
v_dot2_f32_bf16 v249, v126, s82, v249
v_dot2_f32_bf16 v251, v126, v126, v251
v_dot2_f32_bf16 v248, v55, s82, v248
v_dot2_f32_bf16 v250, v55, v55, v250
v_dot2_f32_bf16 v249, v127, s82, v249
v_dot2_f32_bf16 v251, v127, v127, v251
v_dot2_f32_bf16 v248, v56, s82, v248
v_dot2_f32_bf16 v250, v56, v56, v250
v_dot2_f32_bf16 v249, v128, s82, v249
v_dot2_f32_bf16 v251, v128, v128, v251
v_dot2_f32_bf16 v248, v57, s82, v248
v_dot2_f32_bf16 v250, v57, v57, v250
v_dot2_f32_bf16 v249, v129, s82, v249
v_dot2_f32_bf16 v251, v129, v129, v251
v_dot2_f32_bf16 v248, v58, s82, v248
v_dot2_f32_bf16 v250, v58, v58, v250
v_dot2_f32_bf16 v249, v130, s82, v249
v_dot2_f32_bf16 v251, v130, v130, v251
v_dot2_f32_bf16 v248, v59, s82, v248
v_dot2_f32_bf16 v250, v59, v59, v250
v_dot2_f32_bf16 v249, v131, s82, v249
v_dot2_f32_bf16 v251, v131, v131, v251
v_dot2_f32_bf16 v248, v60, s82, v248
v_dot2_f32_bf16 v250, v60, v60, v250
v_dot2_f32_bf16 v249, v132, s82, v249
v_dot2_f32_bf16 v251, v132, v132, v251
v_dot2_f32_bf16 v248, v61, s82, v248
v_dot2_f32_bf16 v250, v61, v61, v250
v_dot2_f32_bf16 v249, v133, s82, v249
v_dot2_f32_bf16 v251, v133, v133, v251
v_dot2_f32_bf16 v248, v62, s82, v248
v_dot2_f32_bf16 v250, v62, v62, v250
v_dot2_f32_bf16 v249, v134, s82, v249
v_dot2_f32_bf16 v251, v134, v134, v251
v_dot2_f32_bf16 v248, v63, s82, v248
v_dot2_f32_bf16 v250, v63, v63, v250
v_dot2_f32_bf16 v249, v135, s82, v249
v_dot2_f32_bf16 v251, v135, v135, v251
v_dot2_f32_bf16 v248, v64, s82, v248
v_dot2_f32_bf16 v250, v64, v64, v250
v_dot2_f32_bf16 v249, v136, s82, v249
v_dot2_f32_bf16 v251, v136, v136, v251
v_dot2_f32_bf16 v248, v65, s82, v248
v_dot2_f32_bf16 v250, v65, v65, v250
v_dot2_f32_bf16 v249, v137, s82, v249
v_dot2_f32_bf16 v251, v137, v137, v251
v_dot2_f32_bf16 v248, v66, s82, v248
v_dot2_f32_bf16 v250, v66, v66, v250
v_dot2_f32_bf16 v249, v138, s82, v249
v_dot2_f32_bf16 v251, v138, v138, v251
v_dot2_f32_bf16 v248, v67, s82, v248
v_dot2_f32_bf16 v250, v67, v67, v250
v_dot2_f32_bf16 v249, v139, s82, v249
v_dot2_f32_bf16 v251, v139, v139, v251
v_dot2_f32_bf16 v248, v68, s82, v248
v_dot2_f32_bf16 v250, v68, v68, v250
v_dot2_f32_bf16 v249, v140, s82, v249
v_dot2_f32_bf16 v251, v140, v140, v251
v_dot2_f32_bf16 v248, v69, s82, v248
v_dot2_f32_bf16 v250, v69, v69, v250
v_dot2_f32_bf16 v249, v141, s82, v249
v_dot2_f32_bf16 v251, v141, v141, v251
v_dot2_f32_bf16 v248, v70, s82, v248
v_dot2_f32_bf16 v250, v70, v70, v250
v_dot2_f32_bf16 v249, v142, s82, v249
v_dot2_f32_bf16 v251, v142, v142, v251
v_dot2_f32_bf16 v248, v71, s82, v248
v_dot2_f32_bf16 v250, v71, v71, v250
v_dot2_f32_bf16 v249, v143, s82, v249
v_dot2_f32_bf16 v251, v143, v143, v251
v_dot2_f32_bf16 v248, v72, s82, v248
v_dot2_f32_bf16 v250, v72, v72, v250
v_dot2_f32_bf16 v249, v144, s82, v249
v_dot2_f32_bf16 v251, v144, v144, v251
v_dot2_f32_bf16 v248, v73, s82, v248
v_dot2_f32_bf16 v250, v73, v73, v250
v_dot2_f32_bf16 v249, v145, s82, v249
v_dot2_f32_bf16 v251, v145, v145, v251
v_dot2_f32_bf16 v248, v74, s82, v248
v_dot2_f32_bf16 v250, v74, v74, v250
v_dot2_f32_bf16 v249, v146, s82, v249
v_dot2_f32_bf16 v251, v146, v146, v251
v_dot2_f32_bf16 v248, v75, s82, v248
v_dot2_f32_bf16 v250, v75, v75, v250
v_dot2_f32_bf16 v249, v147, s82, v249
v_dot2_f32_bf16 v251, v147, v147, v251
v_dot2_f32_bf16 v248, v76, s82, v248
v_dot2_f32_bf16 v250, v76, v76, v250
v_dot2_f32_bf16 v249, v148, s82, v249
v_dot2_f32_bf16 v251, v148, v148, v251
v_dot2_f32_bf16 v248, v77, s82, v248
v_dot2_f32_bf16 v250, v77, v77, v250
v_dot2_f32_bf16 v249, v149, s82, v249
v_dot2_f32_bf16 v251, v149, v149, v251
v_dot2_f32_bf16 v248, v78, s82, v248
v_dot2_f32_bf16 v250, v78, v78, v250
v_dot2_f32_bf16 v249, v150, s82, v249
v_dot2_f32_bf16 v251, v150, v150, v251
v_dot2_f32_bf16 v248, v79, s82, v248
v_dot2_f32_bf16 v250, v79, v79, v250
v_dot2_f32_bf16 v249, v151, s82, v249
v_dot2_f32_bf16 v251, v151, v151, v251
v_dot2_f32_bf16 v248, v80, s82, v248
v_dot2_f32_bf16 v250, v80, v80, v250
v_dot2_f32_bf16 v249, v152, s82, v249
v_dot2_f32_bf16 v251, v152, v152, v251
v_dot2_f32_bf16 v248, v81, s82, v248
v_dot2_f32_bf16 v250, v81, v81, v250
v_dot2_f32_bf16 v249, v153, s82, v249
v_dot2_f32_bf16 v251, v153, v153, v251
v_dot2_f32_bf16 v248, v82, s82, v248
v_dot2_f32_bf16 v250, v82, v82, v250
v_dot2_f32_bf16 v249, v154, s82, v249
v_dot2_f32_bf16 v251, v154, v154, v251
v_dot2_f32_bf16 v248, v83, s82, v248
v_dot2_f32_bf16 v250, v83, v83, v250
v_dot2_f32_bf16 v249, v155, s82, v249
v_dot2_f32_bf16 v251, v155, v155, v251
v_dot2_f32_bf16 v248, v84, s82, v248
v_dot2_f32_bf16 v250, v84, v84, v250
v_dot2_f32_bf16 v249, v156, s82, v249
v_dot2_f32_bf16 v251, v156, v156, v251
v_dot2_f32_bf16 v248, v85, s82, v248
v_dot2_f32_bf16 v250, v85, v85, v250
v_dot2_f32_bf16 v249, v157, s82, v249
v_dot2_f32_bf16 v251, v157, v157, v251
v_dot2_f32_bf16 v248, v86, s82, v248
v_dot2_f32_bf16 v250, v86, v86, v250
v_dot2_f32_bf16 v249, v158, s82, v249
v_dot2_f32_bf16 v251, v158, v158, v251
v_dot2_f32_bf16 v248, v87, s82, v248
v_dot2_f32_bf16 v250, v87, v87, v250
v_dot2_f32_bf16 v249, v159, s82, v249
v_dot2_f32_bf16 v251, v159, v159, v251
v_dot2_f32_bf16 v248, v88, s82, v248
v_dot2_f32_bf16 v250, v88, v88, v250
v_dot2_f32_bf16 v249, v160, s82, v249
v_dot2_f32_bf16 v251, v160, v160, v251
v_dot2_f32_bf16 v248, v89, s82, v248
v_dot2_f32_bf16 v250, v89, v89, v250
v_dot2_f32_bf16 v249, v161, s82, v249
v_dot2_f32_bf16 v251, v161, v161, v251
v_dot2_f32_bf16 v248, v90, s82, v248
v_dot2_f32_bf16 v250, v90, v90, v250
v_dot2_f32_bf16 v249, v162, s82, v249
v_dot2_f32_bf16 v251, v162, v162, v251
v_dot2_f32_bf16 v248, v91, s82, v248
v_dot2_f32_bf16 v250, v91, v91, v250
v_dot2_f32_bf16 v249, v163, s82, v249
v_dot2_f32_bf16 v251, v163, v163, v251
v_dot2_f32_bf16 v248, v92, s82, v248
v_dot2_f32_bf16 v250, v92, v92, v250
v_dot2_f32_bf16 v249, v164, s82, v249
v_dot2_f32_bf16 v251, v164, v164, v251
v_dot2_f32_bf16 v248, v93, s82, v248
v_dot2_f32_bf16 v250, v93, v93, v250
v_dot2_f32_bf16 v249, v165, s82, v249
v_dot2_f32_bf16 v251, v165, v165, v251
v_dot2_f32_bf16 v248, v94, s82, v248
v_dot2_f32_bf16 v250, v94, v94, v250
v_dot2_f32_bf16 v249, v166, s82, v249
v_dot2_f32_bf16 v251, v166, v166, v251
v_dot2_f32_bf16 v248, v95, s82, v248
v_dot2_f32_bf16 v250, v95, v95, v250
v_dot2_f32_bf16 v249, v167, s82, v249
v_dot2_f32_bf16 v251, v167, v167, v251
v_dot2_f32_bf16 v248, v96, s82, v248
v_dot2_f32_bf16 v250, v96, v96, v250
v_dot2_f32_bf16 v249, v168, s82, v249
v_dot2_f32_bf16 v251, v168, v168, v251
v_dot2_f32_bf16 v248, v97, s82, v248
v_dot2_f32_bf16 v250, v97, v97, v250
v_dot2_f32_bf16 v249, v169, s82, v249
v_dot2_f32_bf16 v251, v169, v169, v251
v_dot2_f32_bf16 v248, v98, s82, v248
v_dot2_f32_bf16 v250, v98, v98, v250
v_dot2_f32_bf16 v249, v170, s82, v249
v_dot2_f32_bf16 v251, v170, v170, v251
v_dot2_f32_bf16 v248, v99, s82, v248
v_dot2_f32_bf16 v250, v99, v99, v250
v_dot2_f32_bf16 v249, v171, s82, v249
v_dot2_f32_bf16 v251, v171, v171, v251
v_dot2_f32_bf16 v248, v100, s82, v248
v_dot2_f32_bf16 v250, v100, v100, v250
v_dot2_f32_bf16 v249, v172, s82, v249
v_dot2_f32_bf16 v251, v172, v172, v251
v_dot2_f32_bf16 v248, v101, s82, v248
v_dot2_f32_bf16 v250, v101, v101, v250
v_dot2_f32_bf16 v249, v173, s82, v249
v_dot2_f32_bf16 v251, v173, v173, v251
v_dot2_f32_bf16 v248, v102, s82, v248
v_dot2_f32_bf16 v250, v102, v102, v250
v_dot2_f32_bf16 v249, v174, s82, v249
v_dot2_f32_bf16 v251, v174, v174, v251
v_dot2_f32_bf16 v248, v103, s82, v248
v_dot2_f32_bf16 v250, v103, v103, v250
v_dot2_f32_bf16 v249, v175, s82, v249
v_dot2_f32_bf16 v251, v175, v175, v251
s_nop 3
v_permlane32_swap_b32 v248, v250
v_add_f32 v248, v248, v250
v_mov_b32 v240, v248
s_nop 1
v_permlane16_swap_b32 v248, v240
v_add_f32 v248, v248, v240
v_mov_b32 v250, v248
s_nop 1
v_permlane32_swap_b32 v248, v250
v_mul_f32 v248, 0x3ae38e39, v248
v_mul_f32 v250, 0x3ae38e39, v250
v_fma_f32 v250, -v248, v248, v250
v_max_f32 v250, 0, v250
v_add_f32 v250, 0x3727c5ac, v250
v_rsq_f32 v252, v250
s_nop 0
v_mul_f32 v254, v248, v252
v_sub_f32 v254, 0, v254
v_permlane32_swap_b32 v249, v251
v_add_f32 v249, v249, v251
v_mov_b32 v240, v249
s_nop 1
v_permlane16_swap_b32 v249, v240
v_add_f32 v249, v249, v240
v_mov_b32 v251, v249
s_nop 1
v_permlane32_swap_b32 v249, v251
v_mul_f32 v249, 0x3ae38e39, v249
v_mul_f32 v251, 0x3ae38e39, v251
v_fma_f32 v251, -v249, v249, v251
v_max_f32 v251, 0, v251
v_add_f32 v251, 0x3727c5ac, v251
v_rsq_f32 v253, v251
s_nop 0
v_mul_f32 v255, v249, v253
v_sub_f32 v255, 0, v255
s_nop 7
s_mul_i32 s74, s70, 147456
s_mul_i32 s75, s59, 9216
s_add_u32 s74, s74, s75
s_add_u32 s74, s74, 20971520
v_lshrrev_b32 v5, 1, v2
v_lshlrev_b32 v5, 8, v5
v_lshl_add_u32 v5, v3, 4, v5
v_and_b32 v6, 1, v2
v_lshl_add_u32 v5, v6, 9, v5
v_accvgpr_read_b32 v44, a144
v_accvgpr_read_b32 v45, a145
v_lshlrev_b32 v40, 16, v44
v_and_b32 v41, 0xffff0000, v44
v_lshlrev_b32 v42, 16, v45
v_and_b32 v43, 0xffff0000, v45
v_accvgpr_read_b32 v44, a180
v_accvgpr_read_b32 v45, a181
v_accvgpr_read_b32 v46, a182
v_accvgpr_read_b32 v47, a183
v_accvgpr_read_b32 v48, a0
v_accvgpr_read_b32 v49, a1
v_accvgpr_read_b32 v50, a2
v_accvgpr_read_b32 v51, a3
v_pk_fma_f32 v[48:49], v[48:49], v[252:253], v[40:41] op_sel:[0,0,0] op_sel_hi:[1,0,1]
v_pk_fma_f32 v[50:51], v[50:51], v[252:253], v[42:43] op_sel:[0,0,0] op_sel_hi:[1,0,1]
v_pk_fma_f32 v[48:49], v[44:45], v[254:255], v[48:49] op_sel:[0,0,0] op_sel_hi:[1,0,1]
v_pk_fma_f32 v[50:51], v[46:47], v[254:255], v[50:51] op_sel:[0,0,0] op_sel_hi:[1,0,1]
v_max_f32 v48, 0, v48
v_max_f32 v49, 0, v49
v_max_f32 v50, 0, v50
v_max_f32 v51, 0, v51
v_pk_mul_f32 v[48:49], v[48:49], v[48:49]
v_pk_mul_f32 v[50:51], v[50:51], v[50:51]
v_cvt_pk_bf16_f32 v32, v48, v49
v_cvt_pk_bf16_f32 v33, v50, v51
v_accvgpr_read_b32 v52, a72
v_accvgpr_read_b32 v53, a73
v_accvgpr_read_b32 v54, a74
v_accvgpr_read_b32 v55, a75
v_pk_fma_f32 v[52:53], v[52:53], v[252:253], v[40:41] op_sel:[0,1,0] op_sel_hi:[1,1,1]
v_pk_fma_f32 v[54:55], v[54:55], v[252:253], v[42:43] op_sel:[0,1,0] op_sel_hi:[1,1,1]
v_pk_fma_f32 v[52:53], v[44:45], v[254:255], v[52:53] op_sel:[0,1,0] op_sel_hi:[1,1,1]
v_pk_fma_f32 v[54:55], v[46:47], v[254:255], v[54:55] op_sel:[0,1,0] op_sel_hi:[1,1,1]
v_max_f32 v52, 0, v52
v_max_f32 v53, 0, v53
v_max_f32 v54, 0, v54
v_max_f32 v55, 0, v55
v_pk_mul_f32 v[52:53], v[52:53], v[52:53]
v_pk_mul_f32 v[54:55], v[54:55], v[54:55]
v_cvt_pk_bf16_f32 v36, v52, v53
v_cvt_pk_bf16_f32 v37, v54, v55
v_accvgpr_read_b32 v68, a146
v_accvgpr_read_b32 v69, a147
v_lshlrev_b32 v64, 16, v68
v_and_b32 v65, 0xffff0000, v68
v_lshlrev_b32 v66, 16, v69
v_and_b32 v67, 0xffff0000, v69
v_accvgpr_read_b32 v68, a184
v_accvgpr_read_b32 v69, a185
v_accvgpr_read_b32 v70, a186
v_accvgpr_read_b32 v71, a187
v_accvgpr_read_b32 v72, a4
v_accvgpr_read_b32 v73, a5
v_accvgpr_read_b32 v74, a6
v_accvgpr_read_b32 v75, a7
v_pk_fma_f32 v[72:73], v[72:73], v[252:253], v[64:65] op_sel:[0,0,0] op_sel_hi:[1,0,1]
v_pk_fma_f32 v[74:75], v[74:75], v[252:253], v[66:67] op_sel:[0,0,0] op_sel_hi:[1,0,1]
v_pk_fma_f32 v[72:73], v[68:69], v[254:255], v[72:73] op_sel:[0,0,0] op_sel_hi:[1,0,1]
v_pk_fma_f32 v[74:75], v[70:71], v[254:255], v[74:75] op_sel:[0,0,0] op_sel_hi:[1,0,1]
v_max_f32 v72, 0, v72
v_max_f32 v73, 0, v73
v_max_f32 v74, 0, v74
v_max_f32 v75, 0, v75
v_pk_mul_f32 v[72:73], v[72:73], v[72:73]
v_pk_mul_f32 v[74:75], v[74:75], v[74:75]
v_cvt_pk_bf16_f32 v34, v72, v73
v_cvt_pk_bf16_f32 v35, v74, v75
v_accvgpr_read_b32 v76, a76
v_accvgpr_read_b32 v77, a77
v_accvgpr_read_b32 v78, a78
v_accvgpr_read_b32 v79, a79
v_pk_fma_f32 v[76:77], v[76:77], v[252:253], v[64:65] op_sel:[0,1,0] op_sel_hi:[1,1,1]
v_pk_fma_f32 v[78:79], v[78:79], v[252:253], v[66:67] op_sel:[0,1,0] op_sel_hi:[1,1,1]
v_pk_fma_f32 v[76:77], v[68:69], v[254:255], v[76:77] op_sel:[0,1,0] op_sel_hi:[1,1,1]
v_pk_fma_f32 v[78:79], v[70:71], v[254:255], v[78:79] op_sel:[0,1,0] op_sel_hi:[1,1,1]
v_max_f32 v76, 0, v76
v_max_f32 v77, 0, v77
v_max_f32 v78, 0, v78
v_max_f32 v79, 0, v79
v_pk_mul_f32 v[76:77], v[76:77], v[76:77]
v_pk_mul_f32 v[78:79], v[78:79], v[78:79]
v_cvt_pk_bf16_f32 v38, v76, v77
v_cvt_pk_bf16_f32 v39, v78, v79
v_permlane16_swap_b32 v32, v34
v_permlane16_swap_b32 v33, v35
s_add_u32 s77, s74, 0
buffer_store_dwordx4 v[32:35], v5, s[16:19], s77 offen offset:0 sc1
v_permlane16_swap_b32 v36, v38
v_permlane16_swap_b32 v37, v39
s_add_u32 s77, s74, 147456
buffer_store_dwordx4 v[36:39], v5, s[16:19], s77 offen offset:0 sc1
v_accvgpr_read_b32 v108, a148
v_accvgpr_read_b32 v109, a149
v_lshlrev_b32 v104, 16, v108
v_and_b32 v105, 0xffff0000, v108
v_lshlrev_b32 v106, 16, v109
v_and_b32 v107, 0xffff0000, v109
v_accvgpr_read_b32 v108, a188
v_accvgpr_read_b32 v109, a189
v_accvgpr_read_b32 v110, a190
v_accvgpr_read_b32 v111, a191
v_accvgpr_read_b32 v112, a8
v_accvgpr_read_b32 v113, a9
v_accvgpr_read_b32 v114, a10
v_accvgpr_read_b32 v115, a11
v_pk_fma_f32 v[112:113], v[112:113], v[252:253], v[104:105] op_sel:[0,0,0] op_sel_hi:[1,0,1]
v_pk_fma_f32 v[114:115], v[114:115], v[252:253], v[106:107] op_sel:[0,0,0] op_sel_hi:[1,0,1]
v_pk_fma_f32 v[112:113], v[108:109], v[254:255], v[112:113] op_sel:[0,0,0] op_sel_hi:[1,0,1]
v_pk_fma_f32 v[114:115], v[110:111], v[254:255], v[114:115] op_sel:[0,0,0] op_sel_hi:[1,0,1]
v_max_f32 v112, 0, v112
v_max_f32 v113, 0, v113
v_max_f32 v114, 0, v114
v_max_f32 v115, 0, v115
v_pk_mul_f32 v[112:113], v[112:113], v[112:113]
v_pk_mul_f32 v[114:115], v[114:115], v[114:115]
v_cvt_pk_bf16_f32 v96, v112, v113
v_cvt_pk_bf16_f32 v97, v114, v115
v_accvgpr_read_b32 v116, a80
v_accvgpr_read_b32 v117, a81
v_accvgpr_read_b32 v118, a82
v_accvgpr_read_b32 v119, a83
v_pk_fma_f32 v[116:117], v[116:117], v[252:253], v[104:105] op_sel:[0,1,0] op_sel_hi:[1,1,1]
v_pk_fma_f32 v[118:119], v[118:119], v[252:253], v[106:107] op_sel:[0,1,0] op_sel_hi:[1,1,1]
v_pk_fma_f32 v[116:117], v[108:109], v[254:255], v[116:117] op_sel:[0,1,0] op_sel_hi:[1,1,1]
v_pk_fma_f32 v[118:119], v[110:111], v[254:255], v[118:119] op_sel:[0,1,0] op_sel_hi:[1,1,1]
v_max_f32 v116, 0, v116
v_max_f32 v117, 0, v117
v_max_f32 v118, 0, v118
v_max_f32 v119, 0, v119
v_pk_mul_f32 v[116:117], v[116:117], v[116:117]
v_pk_mul_f32 v[118:119], v[118:119], v[118:119]
v_cvt_pk_bf16_f32 v100, v116, v117
v_cvt_pk_bf16_f32 v101, v118, v119
v_accvgpr_read_b32 v132, a150
v_accvgpr_read_b32 v133, a151
v_lshlrev_b32 v128, 16, v132
v_and_b32 v129, 0xffff0000, v132
v_lshlrev_b32 v130, 16, v133
v_and_b32 v131, 0xffff0000, v133
v_accvgpr_read_b32 v132, a192
v_accvgpr_read_b32 v133, a193
v_accvgpr_read_b32 v134, a194
v_accvgpr_read_b32 v135, a195
v_accvgpr_read_b32 v136, a12
v_accvgpr_read_b32 v137, a13
v_accvgpr_read_b32 v138, a14
v_accvgpr_read_b32 v139, a15
v_pk_fma_f32 v[136:137], v[136:137], v[252:253], v[128:129] op_sel:[0,0,0] op_sel_hi:[1,0,1]
v_pk_fma_f32 v[138:139], v[138:139], v[252:253], v[130:131] op_sel:[0,0,0] op_sel_hi:[1,0,1]
v_pk_fma_f32 v[136:137], v[132:133], v[254:255], v[136:137] op_sel:[0,0,0] op_sel_hi:[1,0,1]
v_pk_fma_f32 v[138:139], v[134:135], v[254:255], v[138:139] op_sel:[0,0,0] op_sel_hi:[1,0,1]
v_max_f32 v136, 0, v136
v_max_f32 v137, 0, v137
v_max_f32 v138, 0, v138
v_max_f32 v139, 0, v139
v_pk_mul_f32 v[136:137], v[136:137], v[136:137]
v_pk_mul_f32 v[138:139], v[138:139], v[138:139]
v_cvt_pk_bf16_f32 v98, v136, v137
v_cvt_pk_bf16_f32 v99, v138, v139
v_accvgpr_read_b32 v140, a84
v_accvgpr_read_b32 v141, a85
v_accvgpr_read_b32 v142, a86
v_accvgpr_read_b32 v143, a87
v_pk_fma_f32 v[140:141], v[140:141], v[252:253], v[128:129] op_sel:[0,1,0] op_sel_hi:[1,1,1]
v_pk_fma_f32 v[142:143], v[142:143], v[252:253], v[130:131] op_sel:[0,1,0] op_sel_hi:[1,1,1]
v_pk_fma_f32 v[140:141], v[132:133], v[254:255], v[140:141] op_sel:[0,1,0] op_sel_hi:[1,1,1]
v_pk_fma_f32 v[142:143], v[134:135], v[254:255], v[142:143] op_sel:[0,1,0] op_sel_hi:[1,1,1]
v_max_f32 v140, 0, v140
v_max_f32 v141, 0, v141
v_max_f32 v142, 0, v142
v_max_f32 v143, 0, v143
v_pk_mul_f32 v[140:141], v[140:141], v[140:141]
v_pk_mul_f32 v[142:143], v[142:143], v[142:143]
v_cvt_pk_bf16_f32 v102, v140, v141
v_cvt_pk_bf16_f32 v103, v142, v143
v_permlane16_swap_b32 v96, v98
v_permlane16_swap_b32 v97, v99
s_add_u32 s77, s74, 0
buffer_store_dwordx4 v[96:99], v5, s[16:19], s77 offen offset:1024 sc1
v_permlane16_swap_b32 v100, v102
v_permlane16_swap_b32 v101, v103
s_add_u32 s77, s74, 147456
buffer_store_dwordx4 v[100:103], v5, s[16:19], s77 offen offset:1024 sc1
v_accvgpr_read_b32 v44, a152
v_accvgpr_read_b32 v45, a153
v_lshlrev_b32 v40, 16, v44
v_and_b32 v41, 0xffff0000, v44
v_lshlrev_b32 v42, 16, v45
v_and_b32 v43, 0xffff0000, v45
v_accvgpr_read_b32 v44, a196
v_accvgpr_read_b32 v45, a197
v_accvgpr_read_b32 v46, a198
v_accvgpr_read_b32 v47, a199
v_accvgpr_read_b32 v48, a16
v_accvgpr_read_b32 v49, a17
v_accvgpr_read_b32 v50, a18
v_accvgpr_read_b32 v51, a19
v_pk_fma_f32 v[48:49], v[48:49], v[252:253], v[40:41] op_sel:[0,0,0] op_sel_hi:[1,0,1]
v_pk_fma_f32 v[50:51], v[50:51], v[252:253], v[42:43] op_sel:[0,0,0] op_sel_hi:[1,0,1]
v_pk_fma_f32 v[48:49], v[44:45], v[254:255], v[48:49] op_sel:[0,0,0] op_sel_hi:[1,0,1]
v_pk_fma_f32 v[50:51], v[46:47], v[254:255], v[50:51] op_sel:[0,0,0] op_sel_hi:[1,0,1]
v_max_f32 v48, 0, v48
v_max_f32 v49, 0, v49
v_max_f32 v50, 0, v50
v_max_f32 v51, 0, v51
v_pk_mul_f32 v[48:49], v[48:49], v[48:49]
v_pk_mul_f32 v[50:51], v[50:51], v[50:51]
v_cvt_pk_bf16_f32 v32, v48, v49
v_cvt_pk_bf16_f32 v33, v50, v51
v_accvgpr_read_b32 v52, a88
v_accvgpr_read_b32 v53, a89
v_accvgpr_read_b32 v54, a90
v_accvgpr_read_b32 v55, a91
v_pk_fma_f32 v[52:53], v[52:53], v[252:253], v[40:41] op_sel:[0,1,0] op_sel_hi:[1,1,1]
v_pk_fma_f32 v[54:55], v[54:55], v[252:253], v[42:43] op_sel:[0,1,0] op_sel_hi:[1,1,1]
v_pk_fma_f32 v[52:53], v[44:45], v[254:255], v[52:53] op_sel:[0,1,0] op_sel_hi:[1,1,1]
v_pk_fma_f32 v[54:55], v[46:47], v[254:255], v[54:55] op_sel:[0,1,0] op_sel_hi:[1,1,1]
v_max_f32 v52, 0, v52
v_max_f32 v53, 0, v53
v_max_f32 v54, 0, v54
v_max_f32 v55, 0, v55
v_pk_mul_f32 v[52:53], v[52:53], v[52:53]
v_pk_mul_f32 v[54:55], v[54:55], v[54:55]
v_cvt_pk_bf16_f32 v36, v52, v53
v_cvt_pk_bf16_f32 v37, v54, v55
v_accvgpr_read_b32 v68, a154
v_accvgpr_read_b32 v69, a155
v_lshlrev_b32 v64, 16, v68
v_and_b32 v65, 0xffff0000, v68
v_lshlrev_b32 v66, 16, v69
v_and_b32 v67, 0xffff0000, v69
v_accvgpr_read_b32 v68, a200
v_accvgpr_read_b32 v69, a201
v_accvgpr_read_b32 v70, a202
v_accvgpr_read_b32 v71, a203
v_accvgpr_read_b32 v72, a20
v_accvgpr_read_b32 v73, a21
v_accvgpr_read_b32 v74, a22
v_accvgpr_read_b32 v75, a23
v_pk_fma_f32 v[72:73], v[72:73], v[252:253], v[64:65] op_sel:[0,0,0] op_sel_hi:[1,0,1]
v_pk_fma_f32 v[74:75], v[74:75], v[252:253], v[66:67] op_sel:[0,0,0] op_sel_hi:[1,0,1]
v_pk_fma_f32 v[72:73], v[68:69], v[254:255], v[72:73] op_sel:[0,0,0] op_sel_hi:[1,0,1]
v_pk_fma_f32 v[74:75], v[70:71], v[254:255], v[74:75] op_sel:[0,0,0] op_sel_hi:[1,0,1]
v_max_f32 v72, 0, v72
v_max_f32 v73, 0, v73
v_max_f32 v74, 0, v74
v_max_f32 v75, 0, v75
v_pk_mul_f32 v[72:73], v[72:73], v[72:73]
v_pk_mul_f32 v[74:75], v[74:75], v[74:75]
v_cvt_pk_bf16_f32 v34, v72, v73
v_cvt_pk_bf16_f32 v35, v74, v75
v_accvgpr_read_b32 v76, a92
v_accvgpr_read_b32 v77, a93
v_accvgpr_read_b32 v78, a94
v_accvgpr_read_b32 v79, a95
v_pk_fma_f32 v[76:77], v[76:77], v[252:253], v[64:65] op_sel:[0,1,0] op_sel_hi:[1,1,1]
v_pk_fma_f32 v[78:79], v[78:79], v[252:253], v[66:67] op_sel:[0,1,0] op_sel_hi:[1,1,1]
v_pk_fma_f32 v[76:77], v[68:69], v[254:255], v[76:77] op_sel:[0,1,0] op_sel_hi:[1,1,1]
v_pk_fma_f32 v[78:79], v[70:71], v[254:255], v[78:79] op_sel:[0,1,0] op_sel_hi:[1,1,1]
v_max_f32 v76, 0, v76
v_max_f32 v77, 0, v77
v_max_f32 v78, 0, v78
v_max_f32 v79, 0, v79
v_pk_mul_f32 v[76:77], v[76:77], v[76:77]
v_pk_mul_f32 v[78:79], v[78:79], v[78:79]
v_cvt_pk_bf16_f32 v38, v76, v77
v_cvt_pk_bf16_f32 v39, v78, v79
v_permlane16_swap_b32 v32, v34
v_permlane16_swap_b32 v33, v35
s_add_u32 s77, s74, 0
buffer_store_dwordx4 v[32:35], v5, s[16:19], s77 offen offset:2048 sc1
v_permlane16_swap_b32 v36, v38
v_permlane16_swap_b32 v37, v39
s_add_u32 s77, s74, 147456
buffer_store_dwordx4 v[36:39], v5, s[16:19], s77 offen offset:2048 sc1
v_accvgpr_read_b32 v108, a156
v_accvgpr_read_b32 v109, a157
v_lshlrev_b32 v104, 16, v108
v_and_b32 v105, 0xffff0000, v108
v_lshlrev_b32 v106, 16, v109
v_and_b32 v107, 0xffff0000, v109
v_accvgpr_read_b32 v108, a204
v_accvgpr_read_b32 v109, a205
v_accvgpr_read_b32 v110, a206
v_accvgpr_read_b32 v111, a207
v_accvgpr_read_b32 v112, a24
v_accvgpr_read_b32 v113, a25
v_accvgpr_read_b32 v114, a26
v_accvgpr_read_b32 v115, a27
v_pk_fma_f32 v[112:113], v[112:113], v[252:253], v[104:105] op_sel:[0,0,0] op_sel_hi:[1,0,1]
v_pk_fma_f32 v[114:115], v[114:115], v[252:253], v[106:107] op_sel:[0,0,0] op_sel_hi:[1,0,1]
v_pk_fma_f32 v[112:113], v[108:109], v[254:255], v[112:113] op_sel:[0,0,0] op_sel_hi:[1,0,1]
v_pk_fma_f32 v[114:115], v[110:111], v[254:255], v[114:115] op_sel:[0,0,0] op_sel_hi:[1,0,1]
v_max_f32 v112, 0, v112
v_max_f32 v113, 0, v113
v_max_f32 v114, 0, v114
v_max_f32 v115, 0, v115
v_pk_mul_f32 v[112:113], v[112:113], v[112:113]
v_pk_mul_f32 v[114:115], v[114:115], v[114:115]
v_cvt_pk_bf16_f32 v96, v112, v113
v_cvt_pk_bf16_f32 v97, v114, v115
v_accvgpr_read_b32 v116, a96
v_accvgpr_read_b32 v117, a97
v_accvgpr_read_b32 v118, a98
v_accvgpr_read_b32 v119, a99
v_pk_fma_f32 v[116:117], v[116:117], v[252:253], v[104:105] op_sel:[0,1,0] op_sel_hi:[1,1,1]
v_pk_fma_f32 v[118:119], v[118:119], v[252:253], v[106:107] op_sel:[0,1,0] op_sel_hi:[1,1,1]
v_pk_fma_f32 v[116:117], v[108:109], v[254:255], v[116:117] op_sel:[0,1,0] op_sel_hi:[1,1,1]
v_pk_fma_f32 v[118:119], v[110:111], v[254:255], v[118:119] op_sel:[0,1,0] op_sel_hi:[1,1,1]
v_max_f32 v116, 0, v116
v_max_f32 v117, 0, v117
v_max_f32 v118, 0, v118
v_max_f32 v119, 0, v119
v_pk_mul_f32 v[116:117], v[116:117], v[116:117]
v_pk_mul_f32 v[118:119], v[118:119], v[118:119]
v_cvt_pk_bf16_f32 v100, v116, v117
v_cvt_pk_bf16_f32 v101, v118, v119
v_accvgpr_read_b32 v132, a158
v_accvgpr_read_b32 v133, a159
v_lshlrev_b32 v128, 16, v132
v_and_b32 v129, 0xffff0000, v132
v_lshlrev_b32 v130, 16, v133
v_and_b32 v131, 0xffff0000, v133
v_accvgpr_read_b32 v132, a208
v_accvgpr_read_b32 v133, a209
v_accvgpr_read_b32 v134, a210
v_accvgpr_read_b32 v135, a211
v_accvgpr_read_b32 v136, a28
v_accvgpr_read_b32 v137, a29
v_accvgpr_read_b32 v138, a30
v_accvgpr_read_b32 v139, a31
v_pk_fma_f32 v[136:137], v[136:137], v[252:253], v[128:129] op_sel:[0,0,0] op_sel_hi:[1,0,1]
v_pk_fma_f32 v[138:139], v[138:139], v[252:253], v[130:131] op_sel:[0,0,0] op_sel_hi:[1,0,1]
v_pk_fma_f32 v[136:137], v[132:133], v[254:255], v[136:137] op_sel:[0,0,0] op_sel_hi:[1,0,1]
v_pk_fma_f32 v[138:139], v[134:135], v[254:255], v[138:139] op_sel:[0,0,0] op_sel_hi:[1,0,1]
v_max_f32 v136, 0, v136
v_max_f32 v137, 0, v137
v_max_f32 v138, 0, v138
v_max_f32 v139, 0, v139
v_pk_mul_f32 v[136:137], v[136:137], v[136:137]
v_pk_mul_f32 v[138:139], v[138:139], v[138:139]
v_cvt_pk_bf16_f32 v98, v136, v137
v_cvt_pk_bf16_f32 v99, v138, v139
v_accvgpr_read_b32 v140, a100
v_accvgpr_read_b32 v141, a101
v_accvgpr_read_b32 v142, a102
v_accvgpr_read_b32 v143, a103
v_pk_fma_f32 v[140:141], v[140:141], v[252:253], v[128:129] op_sel:[0,1,0] op_sel_hi:[1,1,1]
v_pk_fma_f32 v[142:143], v[142:143], v[252:253], v[130:131] op_sel:[0,1,0] op_sel_hi:[1,1,1]
v_pk_fma_f32 v[140:141], v[132:133], v[254:255], v[140:141] op_sel:[0,1,0] op_sel_hi:[1,1,1]
v_pk_fma_f32 v[142:143], v[134:135], v[254:255], v[142:143] op_sel:[0,1,0] op_sel_hi:[1,1,1]
v_max_f32 v140, 0, v140
v_max_f32 v141, 0, v141
v_max_f32 v142, 0, v142
v_max_f32 v143, 0, v143
v_pk_mul_f32 v[140:141], v[140:141], v[140:141]
v_pk_mul_f32 v[142:143], v[142:143], v[142:143]
v_cvt_pk_bf16_f32 v102, v140, v141
v_cvt_pk_bf16_f32 v103, v142, v143
v_permlane16_swap_b32 v96, v98
v_permlane16_swap_b32 v97, v99
s_add_u32 s77, s74, 0
buffer_store_dwordx4 v[96:99], v5, s[16:19], s77 offen offset:3072 sc1
v_permlane16_swap_b32 v100, v102
v_permlane16_swap_b32 v101, v103
s_add_u32 s77, s74, 147456
buffer_store_dwordx4 v[100:103], v5, s[16:19], s77 offen offset:3072 sc1
v_accvgpr_read_b32 v44, a160
v_accvgpr_read_b32 v45, a161
v_lshlrev_b32 v40, 16, v44
v_and_b32 v41, 0xffff0000, v44
v_lshlrev_b32 v42, 16, v45
v_and_b32 v43, 0xffff0000, v45
v_accvgpr_read_b32 v44, a212
v_accvgpr_read_b32 v45, a213
v_accvgpr_read_b32 v46, a214
v_accvgpr_read_b32 v47, a215
v_accvgpr_read_b32 v48, a32
v_accvgpr_read_b32 v49, a33
v_accvgpr_read_b32 v50, a34
v_accvgpr_read_b32 v51, a35
v_pk_fma_f32 v[48:49], v[48:49], v[252:253], v[40:41] op_sel:[0,0,0] op_sel_hi:[1,0,1]
v_pk_fma_f32 v[50:51], v[50:51], v[252:253], v[42:43] op_sel:[0,0,0] op_sel_hi:[1,0,1]
v_pk_fma_f32 v[48:49], v[44:45], v[254:255], v[48:49] op_sel:[0,0,0] op_sel_hi:[1,0,1]
v_pk_fma_f32 v[50:51], v[46:47], v[254:255], v[50:51] op_sel:[0,0,0] op_sel_hi:[1,0,1]
v_max_f32 v48, 0, v48
v_max_f32 v49, 0, v49
v_max_f32 v50, 0, v50
v_max_f32 v51, 0, v51
v_pk_mul_f32 v[48:49], v[48:49], v[48:49]
v_pk_mul_f32 v[50:51], v[50:51], v[50:51]
v_cvt_pk_bf16_f32 v32, v48, v49
v_cvt_pk_bf16_f32 v33, v50, v51
v_accvgpr_read_b32 v52, a104
v_accvgpr_read_b32 v53, a105
v_accvgpr_read_b32 v54, a106
v_accvgpr_read_b32 v55, a107
v_pk_fma_f32 v[52:53], v[52:53], v[252:253], v[40:41] op_sel:[0,1,0] op_sel_hi:[1,1,1]
v_pk_fma_f32 v[54:55], v[54:55], v[252:253], v[42:43] op_sel:[0,1,0] op_sel_hi:[1,1,1]
v_pk_fma_f32 v[52:53], v[44:45], v[254:255], v[52:53] op_sel:[0,1,0] op_sel_hi:[1,1,1]
v_pk_fma_f32 v[54:55], v[46:47], v[254:255], v[54:55] op_sel:[0,1,0] op_sel_hi:[1,1,1]
v_max_f32 v52, 0, v52
v_max_f32 v53, 0, v53
v_max_f32 v54, 0, v54
v_max_f32 v55, 0, v55
v_pk_mul_f32 v[52:53], v[52:53], v[52:53]
v_pk_mul_f32 v[54:55], v[54:55], v[54:55]
v_cvt_pk_bf16_f32 v36, v52, v53
v_cvt_pk_bf16_f32 v37, v54, v55
v_accvgpr_read_b32 v68, a162
v_accvgpr_read_b32 v69, a163
v_lshlrev_b32 v64, 16, v68
v_and_b32 v65, 0xffff0000, v68
v_lshlrev_b32 v66, 16, v69
v_and_b32 v67, 0xffff0000, v69
v_accvgpr_read_b32 v68, a216
v_accvgpr_read_b32 v69, a217
v_accvgpr_read_b32 v70, a218
v_accvgpr_read_b32 v71, a219
v_accvgpr_read_b32 v72, a36
v_accvgpr_read_b32 v73, a37
v_accvgpr_read_b32 v74, a38
v_accvgpr_read_b32 v75, a39
v_pk_fma_f32 v[72:73], v[72:73], v[252:253], v[64:65] op_sel:[0,0,0] op_sel_hi:[1,0,1]
v_pk_fma_f32 v[74:75], v[74:75], v[252:253], v[66:67] op_sel:[0,0,0] op_sel_hi:[1,0,1]
v_pk_fma_f32 v[72:73], v[68:69], v[254:255], v[72:73] op_sel:[0,0,0] op_sel_hi:[1,0,1]
v_pk_fma_f32 v[74:75], v[70:71], v[254:255], v[74:75] op_sel:[0,0,0] op_sel_hi:[1,0,1]
v_max_f32 v72, 0, v72
v_max_f32 v73, 0, v73
v_max_f32 v74, 0, v74
v_max_f32 v75, 0, v75
v_pk_mul_f32 v[72:73], v[72:73], v[72:73]
v_pk_mul_f32 v[74:75], v[74:75], v[74:75]
v_cvt_pk_bf16_f32 v34, v72, v73
v_cvt_pk_bf16_f32 v35, v74, v75
v_accvgpr_read_b32 v76, a108
v_accvgpr_read_b32 v77, a109
v_accvgpr_read_b32 v78, a110
v_accvgpr_read_b32 v79, a111
v_pk_fma_f32 v[76:77], v[76:77], v[252:253], v[64:65] op_sel:[0,1,0] op_sel_hi:[1,1,1]
v_pk_fma_f32 v[78:79], v[78:79], v[252:253], v[66:67] op_sel:[0,1,0] op_sel_hi:[1,1,1]
v_pk_fma_f32 v[76:77], v[68:69], v[254:255], v[76:77] op_sel:[0,1,0] op_sel_hi:[1,1,1]
v_pk_fma_f32 v[78:79], v[70:71], v[254:255], v[78:79] op_sel:[0,1,0] op_sel_hi:[1,1,1]
v_max_f32 v76, 0, v76
v_max_f32 v77, 0, v77
v_max_f32 v78, 0, v78
v_max_f32 v79, 0, v79
v_pk_mul_f32 v[76:77], v[76:77], v[76:77]
v_pk_mul_f32 v[78:79], v[78:79], v[78:79]
v_cvt_pk_bf16_f32 v38, v76, v77
v_cvt_pk_bf16_f32 v39, v78, v79
v_permlane16_swap_b32 v32, v34
v_permlane16_swap_b32 v33, v35
s_add_u32 s77, s74, 4096
buffer_store_dwordx4 v[32:35], v5, s[16:19], s77 offen offset:0 sc1
v_permlane16_swap_b32 v36, v38
v_permlane16_swap_b32 v37, v39
s_add_u32 s77, s74, 151552
buffer_store_dwordx4 v[36:39], v5, s[16:19], s77 offen offset:0 sc1
v_accvgpr_read_b32 v108, a164
v_accvgpr_read_b32 v109, a165
v_lshlrev_b32 v104, 16, v108
v_and_b32 v105, 0xffff0000, v108
v_lshlrev_b32 v106, 16, v109
v_and_b32 v107, 0xffff0000, v109
v_accvgpr_read_b32 v108, a220
v_accvgpr_read_b32 v109, a221
v_accvgpr_read_b32 v110, a222
v_accvgpr_read_b32 v111, a223
v_accvgpr_read_b32 v112, a40
v_accvgpr_read_b32 v113, a41
v_accvgpr_read_b32 v114, a42
v_accvgpr_read_b32 v115, a43
v_pk_fma_f32 v[112:113], v[112:113], v[252:253], v[104:105] op_sel:[0,0,0] op_sel_hi:[1,0,1]
v_pk_fma_f32 v[114:115], v[114:115], v[252:253], v[106:107] op_sel:[0,0,0] op_sel_hi:[1,0,1]
v_pk_fma_f32 v[112:113], v[108:109], v[254:255], v[112:113] op_sel:[0,0,0] op_sel_hi:[1,0,1]
v_pk_fma_f32 v[114:115], v[110:111], v[254:255], v[114:115] op_sel:[0,0,0] op_sel_hi:[1,0,1]
v_max_f32 v112, 0, v112
v_max_f32 v113, 0, v113
v_max_f32 v114, 0, v114
v_max_f32 v115, 0, v115
v_pk_mul_f32 v[112:113], v[112:113], v[112:113]
v_pk_mul_f32 v[114:115], v[114:115], v[114:115]
v_cvt_pk_bf16_f32 v96, v112, v113
v_cvt_pk_bf16_f32 v97, v114, v115
v_accvgpr_read_b32 v116, a112
v_accvgpr_read_b32 v117, a113
v_accvgpr_read_b32 v118, a114
v_accvgpr_read_b32 v119, a115
v_pk_fma_f32 v[116:117], v[116:117], v[252:253], v[104:105] op_sel:[0,1,0] op_sel_hi:[1,1,1]
v_pk_fma_f32 v[118:119], v[118:119], v[252:253], v[106:107] op_sel:[0,1,0] op_sel_hi:[1,1,1]
v_pk_fma_f32 v[116:117], v[108:109], v[254:255], v[116:117] op_sel:[0,1,0] op_sel_hi:[1,1,1]
v_pk_fma_f32 v[118:119], v[110:111], v[254:255], v[118:119] op_sel:[0,1,0] op_sel_hi:[1,1,1]
v_max_f32 v116, 0, v116
v_max_f32 v117, 0, v117
v_max_f32 v118, 0, v118
v_max_f32 v119, 0, v119
v_pk_mul_f32 v[116:117], v[116:117], v[116:117]
v_pk_mul_f32 v[118:119], v[118:119], v[118:119]
v_cvt_pk_bf16_f32 v100, v116, v117
v_cvt_pk_bf16_f32 v101, v118, v119
v_accvgpr_read_b32 v132, a166
v_accvgpr_read_b32 v133, a167
v_lshlrev_b32 v128, 16, v132
v_and_b32 v129, 0xffff0000, v132
v_lshlrev_b32 v130, 16, v133
v_and_b32 v131, 0xffff0000, v133
v_accvgpr_read_b32 v132, a224
v_accvgpr_read_b32 v133, a225
v_accvgpr_read_b32 v134, a226
v_accvgpr_read_b32 v135, a227
v_accvgpr_read_b32 v136, a44
v_accvgpr_read_b32 v137, a45
v_accvgpr_read_b32 v138, a46
v_accvgpr_read_b32 v139, a47
v_pk_fma_f32 v[136:137], v[136:137], v[252:253], v[128:129] op_sel:[0,0,0] op_sel_hi:[1,0,1]
v_pk_fma_f32 v[138:139], v[138:139], v[252:253], v[130:131] op_sel:[0,0,0] op_sel_hi:[1,0,1]
v_pk_fma_f32 v[136:137], v[132:133], v[254:255], v[136:137] op_sel:[0,0,0] op_sel_hi:[1,0,1]
v_pk_fma_f32 v[138:139], v[134:135], v[254:255], v[138:139] op_sel:[0,0,0] op_sel_hi:[1,0,1]
v_max_f32 v136, 0, v136
v_max_f32 v137, 0, v137
v_max_f32 v138, 0, v138
v_max_f32 v139, 0, v139
v_pk_mul_f32 v[136:137], v[136:137], v[136:137]
v_pk_mul_f32 v[138:139], v[138:139], v[138:139]
v_cvt_pk_bf16_f32 v98, v136, v137
v_cvt_pk_bf16_f32 v99, v138, v139
v_accvgpr_read_b32 v140, a116
v_accvgpr_read_b32 v141, a117
v_accvgpr_read_b32 v142, a118
v_accvgpr_read_b32 v143, a119
v_pk_fma_f32 v[140:141], v[140:141], v[252:253], v[128:129] op_sel:[0,1,0] op_sel_hi:[1,1,1]
v_pk_fma_f32 v[142:143], v[142:143], v[252:253], v[130:131] op_sel:[0,1,0] op_sel_hi:[1,1,1]
v_pk_fma_f32 v[140:141], v[132:133], v[254:255], v[140:141] op_sel:[0,1,0] op_sel_hi:[1,1,1]
v_pk_fma_f32 v[142:143], v[134:135], v[254:255], v[142:143] op_sel:[0,1,0] op_sel_hi:[1,1,1]
v_max_f32 v140, 0, v140
v_max_f32 v141, 0, v141
v_max_f32 v142, 0, v142
v_max_f32 v143, 0, v143
v_pk_mul_f32 v[140:141], v[140:141], v[140:141]
v_pk_mul_f32 v[142:143], v[142:143], v[142:143]
v_cvt_pk_bf16_f32 v102, v140, v141
v_cvt_pk_bf16_f32 v103, v142, v143
v_permlane16_swap_b32 v96, v98
v_permlane16_swap_b32 v97, v99
s_add_u32 s77, s74, 4096
buffer_store_dwordx4 v[96:99], v5, s[16:19], s77 offen offset:1024 sc1
v_permlane16_swap_b32 v100, v102
v_permlane16_swap_b32 v101, v103
s_add_u32 s77, s74, 151552
buffer_store_dwordx4 v[100:103], v5, s[16:19], s77 offen offset:1024 sc1
v_accvgpr_read_b32 v44, a168
v_accvgpr_read_b32 v45, a169
v_lshlrev_b32 v40, 16, v44
v_and_b32 v41, 0xffff0000, v44
v_lshlrev_b32 v42, 16, v45
v_and_b32 v43, 0xffff0000, v45
v_accvgpr_read_b32 v44, a228
v_accvgpr_read_b32 v45, a229
v_accvgpr_read_b32 v46, a230
v_accvgpr_read_b32 v47, a231
v_accvgpr_read_b32 v48, a48
v_accvgpr_read_b32 v49, a49
v_accvgpr_read_b32 v50, a50
v_accvgpr_read_b32 v51, a51
v_pk_fma_f32 v[48:49], v[48:49], v[252:253], v[40:41] op_sel:[0,0,0] op_sel_hi:[1,0,1]
v_pk_fma_f32 v[50:51], v[50:51], v[252:253], v[42:43] op_sel:[0,0,0] op_sel_hi:[1,0,1]
v_pk_fma_f32 v[48:49], v[44:45], v[254:255], v[48:49] op_sel:[0,0,0] op_sel_hi:[1,0,1]
v_pk_fma_f32 v[50:51], v[46:47], v[254:255], v[50:51] op_sel:[0,0,0] op_sel_hi:[1,0,1]
v_max_f32 v48, 0, v48
v_max_f32 v49, 0, v49
v_max_f32 v50, 0, v50
v_max_f32 v51, 0, v51
v_pk_mul_f32 v[48:49], v[48:49], v[48:49]
v_pk_mul_f32 v[50:51], v[50:51], v[50:51]
v_cvt_pk_bf16_f32 v32, v48, v49
v_cvt_pk_bf16_f32 v33, v50, v51
v_accvgpr_read_b32 v52, a120
v_accvgpr_read_b32 v53, a121
v_accvgpr_read_b32 v54, a122
v_accvgpr_read_b32 v55, a123
v_pk_fma_f32 v[52:53], v[52:53], v[252:253], v[40:41] op_sel:[0,1,0] op_sel_hi:[1,1,1]
v_pk_fma_f32 v[54:55], v[54:55], v[252:253], v[42:43] op_sel:[0,1,0] op_sel_hi:[1,1,1]
v_pk_fma_f32 v[52:53], v[44:45], v[254:255], v[52:53] op_sel:[0,1,0] op_sel_hi:[1,1,1]
v_pk_fma_f32 v[54:55], v[46:47], v[254:255], v[54:55] op_sel:[0,1,0] op_sel_hi:[1,1,1]
v_max_f32 v52, 0, v52
v_max_f32 v53, 0, v53
v_max_f32 v54, 0, v54
v_max_f32 v55, 0, v55
v_pk_mul_f32 v[52:53], v[52:53], v[52:53]
v_pk_mul_f32 v[54:55], v[54:55], v[54:55]
v_cvt_pk_bf16_f32 v36, v52, v53
v_cvt_pk_bf16_f32 v37, v54, v55
v_accvgpr_read_b32 v68, a170
v_accvgpr_read_b32 v69, a171
v_lshlrev_b32 v64, 16, v68
v_and_b32 v65, 0xffff0000, v68
v_lshlrev_b32 v66, 16, v69
v_and_b32 v67, 0xffff0000, v69
v_accvgpr_read_b32 v68, a232
v_accvgpr_read_b32 v69, a233
v_accvgpr_read_b32 v70, a234
v_accvgpr_read_b32 v71, a235
v_accvgpr_read_b32 v72, a52
v_accvgpr_read_b32 v73, a53
v_accvgpr_read_b32 v74, a54
v_accvgpr_read_b32 v75, a55
v_pk_fma_f32 v[72:73], v[72:73], v[252:253], v[64:65] op_sel:[0,0,0] op_sel_hi:[1,0,1]
v_pk_fma_f32 v[74:75], v[74:75], v[252:253], v[66:67] op_sel:[0,0,0] op_sel_hi:[1,0,1]
v_pk_fma_f32 v[72:73], v[68:69], v[254:255], v[72:73] op_sel:[0,0,0] op_sel_hi:[1,0,1]
v_pk_fma_f32 v[74:75], v[70:71], v[254:255], v[74:75] op_sel:[0,0,0] op_sel_hi:[1,0,1]
v_max_f32 v72, 0, v72
v_max_f32 v73, 0, v73
v_max_f32 v74, 0, v74
v_max_f32 v75, 0, v75
v_pk_mul_f32 v[72:73], v[72:73], v[72:73]
v_pk_mul_f32 v[74:75], v[74:75], v[74:75]
v_cvt_pk_bf16_f32 v34, v72, v73
v_cvt_pk_bf16_f32 v35, v74, v75
v_accvgpr_read_b32 v76, a124
v_accvgpr_read_b32 v77, a125
v_accvgpr_read_b32 v78, a126
v_accvgpr_read_b32 v79, a127
v_pk_fma_f32 v[76:77], v[76:77], v[252:253], v[64:65] op_sel:[0,1,0] op_sel_hi:[1,1,1]
v_pk_fma_f32 v[78:79], v[78:79], v[252:253], v[66:67] op_sel:[0,1,0] op_sel_hi:[1,1,1]
v_pk_fma_f32 v[76:77], v[68:69], v[254:255], v[76:77] op_sel:[0,1,0] op_sel_hi:[1,1,1]
v_pk_fma_f32 v[78:79], v[70:71], v[254:255], v[78:79] op_sel:[0,1,0] op_sel_hi:[1,1,1]
v_max_f32 v76, 0, v76
v_max_f32 v77, 0, v77
v_max_f32 v78, 0, v78
v_max_f32 v79, 0, v79
v_pk_mul_f32 v[76:77], v[76:77], v[76:77]
v_pk_mul_f32 v[78:79], v[78:79], v[78:79]
v_cvt_pk_bf16_f32 v38, v76, v77
v_cvt_pk_bf16_f32 v39, v78, v79
v_permlane16_swap_b32 v32, v34
v_permlane16_swap_b32 v33, v35
s_add_u32 s77, s74, 4096
buffer_store_dwordx4 v[32:35], v5, s[16:19], s77 offen offset:2048 sc1
v_permlane16_swap_b32 v36, v38
v_permlane16_swap_b32 v37, v39
s_add_u32 s77, s74, 151552
buffer_store_dwordx4 v[36:39], v5, s[16:19], s77 offen offset:2048 sc1
v_accvgpr_read_b32 v108, a172
v_accvgpr_read_b32 v109, a173
v_lshlrev_b32 v104, 16, v108
v_and_b32 v105, 0xffff0000, v108
v_lshlrev_b32 v106, 16, v109
v_and_b32 v107, 0xffff0000, v109
v_accvgpr_read_b32 v108, a236
v_accvgpr_read_b32 v109, a237
v_accvgpr_read_b32 v110, a238
v_accvgpr_read_b32 v111, a239
v_accvgpr_read_b32 v112, a56
v_accvgpr_read_b32 v113, a57
v_accvgpr_read_b32 v114, a58
v_accvgpr_read_b32 v115, a59
v_pk_fma_f32 v[112:113], v[112:113], v[252:253], v[104:105] op_sel:[0,0,0] op_sel_hi:[1,0,1]
v_pk_fma_f32 v[114:115], v[114:115], v[252:253], v[106:107] op_sel:[0,0,0] op_sel_hi:[1,0,1]
v_pk_fma_f32 v[112:113], v[108:109], v[254:255], v[112:113] op_sel:[0,0,0] op_sel_hi:[1,0,1]
v_pk_fma_f32 v[114:115], v[110:111], v[254:255], v[114:115] op_sel:[0,0,0] op_sel_hi:[1,0,1]
v_max_f32 v112, 0, v112
v_max_f32 v113, 0, v113
v_max_f32 v114, 0, v114
v_max_f32 v115, 0, v115
v_pk_mul_f32 v[112:113], v[112:113], v[112:113]
v_pk_mul_f32 v[114:115], v[114:115], v[114:115]
v_cvt_pk_bf16_f32 v96, v112, v113
v_cvt_pk_bf16_f32 v97, v114, v115
v_accvgpr_read_b32 v116, a128
v_accvgpr_read_b32 v117, a129
v_accvgpr_read_b32 v118, a130
v_accvgpr_read_b32 v119, a131
v_pk_fma_f32 v[116:117], v[116:117], v[252:253], v[104:105] op_sel:[0,1,0] op_sel_hi:[1,1,1]
v_pk_fma_f32 v[118:119], v[118:119], v[252:253], v[106:107] op_sel:[0,1,0] op_sel_hi:[1,1,1]
v_pk_fma_f32 v[116:117], v[108:109], v[254:255], v[116:117] op_sel:[0,1,0] op_sel_hi:[1,1,1]
v_pk_fma_f32 v[118:119], v[110:111], v[254:255], v[118:119] op_sel:[0,1,0] op_sel_hi:[1,1,1]
v_max_f32 v116, 0, v116
v_max_f32 v117, 0, v117
v_max_f32 v118, 0, v118
v_max_f32 v119, 0, v119
v_pk_mul_f32 v[116:117], v[116:117], v[116:117]
v_pk_mul_f32 v[118:119], v[118:119], v[118:119]
v_cvt_pk_bf16_f32 v100, v116, v117
v_cvt_pk_bf16_f32 v101, v118, v119
v_accvgpr_read_b32 v132, a174
v_accvgpr_read_b32 v133, a175
v_lshlrev_b32 v128, 16, v132
v_and_b32 v129, 0xffff0000, v132
v_lshlrev_b32 v130, 16, v133
v_and_b32 v131, 0xffff0000, v133
v_accvgpr_read_b32 v132, a240
v_accvgpr_read_b32 v133, a241
v_accvgpr_read_b32 v134, a242
v_accvgpr_read_b32 v135, a243
v_accvgpr_read_b32 v136, a60
v_accvgpr_read_b32 v137, a61
v_accvgpr_read_b32 v138, a62
v_accvgpr_read_b32 v139, a63
v_pk_fma_f32 v[136:137], v[136:137], v[252:253], v[128:129] op_sel:[0,0,0] op_sel_hi:[1,0,1]
v_pk_fma_f32 v[138:139], v[138:139], v[252:253], v[130:131] op_sel:[0,0,0] op_sel_hi:[1,0,1]
v_pk_fma_f32 v[136:137], v[132:133], v[254:255], v[136:137] op_sel:[0,0,0] op_sel_hi:[1,0,1]
v_pk_fma_f32 v[138:139], v[134:135], v[254:255], v[138:139] op_sel:[0,0,0] op_sel_hi:[1,0,1]
v_max_f32 v136, 0, v136
v_max_f32 v137, 0, v137
v_max_f32 v138, 0, v138
v_max_f32 v139, 0, v139
v_pk_mul_f32 v[136:137], v[136:137], v[136:137]
v_pk_mul_f32 v[138:139], v[138:139], v[138:139]
v_cvt_pk_bf16_f32 v98, v136, v137
v_cvt_pk_bf16_f32 v99, v138, v139
v_accvgpr_read_b32 v140, a132
v_accvgpr_read_b32 v141, a133
v_accvgpr_read_b32 v142, a134
v_accvgpr_read_b32 v143, a135
v_pk_fma_f32 v[140:141], v[140:141], v[252:253], v[128:129] op_sel:[0,1,0] op_sel_hi:[1,1,1]
v_pk_fma_f32 v[142:143], v[142:143], v[252:253], v[130:131] op_sel:[0,1,0] op_sel_hi:[1,1,1]
v_pk_fma_f32 v[140:141], v[132:133], v[254:255], v[140:141] op_sel:[0,1,0] op_sel_hi:[1,1,1]
v_pk_fma_f32 v[142:143], v[134:135], v[254:255], v[142:143] op_sel:[0,1,0] op_sel_hi:[1,1,1]
v_max_f32 v140, 0, v140
v_max_f32 v141, 0, v141
v_max_f32 v142, 0, v142
v_max_f32 v143, 0, v143
v_pk_mul_f32 v[140:141], v[140:141], v[140:141]
v_pk_mul_f32 v[142:143], v[142:143], v[142:143]
v_cvt_pk_bf16_f32 v102, v140, v141
v_cvt_pk_bf16_f32 v103, v142, v143
v_permlane16_swap_b32 v96, v98
v_permlane16_swap_b32 v97, v99
s_add_u32 s77, s74, 4096
buffer_store_dwordx4 v[96:99], v5, s[16:19], s77 offen offset:3072 sc1
v_permlane16_swap_b32 v100, v102
v_permlane16_swap_b32 v101, v103
s_add_u32 s77, s74, 151552
buffer_store_dwordx4 v[100:103], v5, s[16:19], s77 offen offset:3072 sc1
v_accvgpr_read_b32 v44, a176
v_accvgpr_read_b32 v45, a177
v_lshlrev_b32 v40, 16, v44
v_and_b32 v41, 0xffff0000, v44
v_lshlrev_b32 v42, 16, v45
v_and_b32 v43, 0xffff0000, v45
v_accvgpr_read_b32 v44, a244
v_accvgpr_read_b32 v45, a245
v_accvgpr_read_b32 v46, a246
v_accvgpr_read_b32 v47, a247
v_accvgpr_read_b32 v48, a64
v_accvgpr_read_b32 v49, a65
v_accvgpr_read_b32 v50, a66
v_accvgpr_read_b32 v51, a67
v_pk_fma_f32 v[48:49], v[48:49], v[252:253], v[40:41] op_sel:[0,0,0] op_sel_hi:[1,0,1]
v_pk_fma_f32 v[50:51], v[50:51], v[252:253], v[42:43] op_sel:[0,0,0] op_sel_hi:[1,0,1]
v_pk_fma_f32 v[48:49], v[44:45], v[254:255], v[48:49] op_sel:[0,0,0] op_sel_hi:[1,0,1]
v_pk_fma_f32 v[50:51], v[46:47], v[254:255], v[50:51] op_sel:[0,0,0] op_sel_hi:[1,0,1]
v_max_f32 v48, 0, v48
v_max_f32 v49, 0, v49
v_max_f32 v50, 0, v50
v_max_f32 v51, 0, v51
v_pk_mul_f32 v[48:49], v[48:49], v[48:49]
v_pk_mul_f32 v[50:51], v[50:51], v[50:51]
v_cvt_pk_bf16_f32 v32, v48, v49
v_cvt_pk_bf16_f32 v33, v50, v51
v_accvgpr_read_b32 v52, a136
v_accvgpr_read_b32 v53, a137
v_accvgpr_read_b32 v54, a138
v_accvgpr_read_b32 v55, a139
v_pk_fma_f32 v[52:53], v[52:53], v[252:253], v[40:41] op_sel:[0,1,0] op_sel_hi:[1,1,1]
v_pk_fma_f32 v[54:55], v[54:55], v[252:253], v[42:43] op_sel:[0,1,0] op_sel_hi:[1,1,1]
v_pk_fma_f32 v[52:53], v[44:45], v[254:255], v[52:53] op_sel:[0,1,0] op_sel_hi:[1,1,1]
v_pk_fma_f32 v[54:55], v[46:47], v[254:255], v[54:55] op_sel:[0,1,0] op_sel_hi:[1,1,1]
v_max_f32 v52, 0, v52
v_max_f32 v53, 0, v53
v_max_f32 v54, 0, v54
v_max_f32 v55, 0, v55
v_pk_mul_f32 v[52:53], v[52:53], v[52:53]
v_pk_mul_f32 v[54:55], v[54:55], v[54:55]
v_cvt_pk_bf16_f32 v36, v52, v53
v_cvt_pk_bf16_f32 v37, v54, v55
v_accvgpr_read_b32 v68, a178
v_accvgpr_read_b32 v69, a179
v_lshlrev_b32 v64, 16, v68
v_and_b32 v65, 0xffff0000, v68
v_lshlrev_b32 v66, 16, v69
v_and_b32 v67, 0xffff0000, v69
v_accvgpr_read_b32 v68, a248
v_accvgpr_read_b32 v69, a249
v_accvgpr_read_b32 v70, a250
v_accvgpr_read_b32 v71, a251
v_accvgpr_read_b32 v72, a68
v_accvgpr_read_b32 v73, a69
v_accvgpr_read_b32 v74, a70
v_accvgpr_read_b32 v75, a71
v_pk_fma_f32 v[72:73], v[72:73], v[252:253], v[64:65] op_sel:[0,0,0] op_sel_hi:[1,0,1]
v_pk_fma_f32 v[74:75], v[74:75], v[252:253], v[66:67] op_sel:[0,0,0] op_sel_hi:[1,0,1]
v_pk_fma_f32 v[72:73], v[68:69], v[254:255], v[72:73] op_sel:[0,0,0] op_sel_hi:[1,0,1]
v_pk_fma_f32 v[74:75], v[70:71], v[254:255], v[74:75] op_sel:[0,0,0] op_sel_hi:[1,0,1]
v_max_f32 v72, 0, v72
v_max_f32 v73, 0, v73
v_max_f32 v74, 0, v74
v_max_f32 v75, 0, v75
v_pk_mul_f32 v[72:73], v[72:73], v[72:73]
v_pk_mul_f32 v[74:75], v[74:75], v[74:75]
v_cvt_pk_bf16_f32 v34, v72, v73
v_cvt_pk_bf16_f32 v35, v74, v75
v_accvgpr_read_b32 v76, a140
v_accvgpr_read_b32 v77, a141
v_accvgpr_read_b32 v78, a142
v_accvgpr_read_b32 v79, a143
v_pk_fma_f32 v[76:77], v[76:77], v[252:253], v[64:65] op_sel:[0,1,0] op_sel_hi:[1,1,1]
v_pk_fma_f32 v[78:79], v[78:79], v[252:253], v[66:67] op_sel:[0,1,0] op_sel_hi:[1,1,1]
v_pk_fma_f32 v[76:77], v[68:69], v[254:255], v[76:77] op_sel:[0,1,0] op_sel_hi:[1,1,1]
v_pk_fma_f32 v[78:79], v[70:71], v[254:255], v[78:79] op_sel:[0,1,0] op_sel_hi:[1,1,1]
v_max_f32 v76, 0, v76
v_max_f32 v77, 0, v77
v_max_f32 v78, 0, v78
v_max_f32 v79, 0, v79
v_pk_mul_f32 v[76:77], v[76:77], v[76:77]
v_pk_mul_f32 v[78:79], v[78:79], v[78:79]
v_cvt_pk_bf16_f32 v38, v76, v77
v_cvt_pk_bf16_f32 v39, v78, v79
v_permlane16_swap_b32 v32, v34
v_permlane16_swap_b32 v33, v35
s_add_u32 s77, s74, 8192
buffer_store_dwordx4 v[32:35], v5, s[16:19], s77 offen offset:0 sc1
v_permlane16_swap_b32 v36, v38
v_permlane16_swap_b32 v37, v39
s_add_u32 s77, s74, 155648
buffer_store_dwordx4 v[36:39], v5, s[16:19], s77 offen offset:0 sc1
k3_end:
s_endpgm

.globl k4_l0_kernel
.p2align 8
.type k4_l0_kernel,@function
k4_l0_kernel:
s_mov_b32 s92, 0
s_branch k4_body
.globl k4_l1_kernel
.p2align 8
.type k4_l1_kernel,@function
k4_l1_kernel:
s_mov_b32 s92, 1
s_branch k4_body
.p2align 6
k4_body:
s_cmp_ge_u32 s2, 256
s_cbranch_scc1 k4_end
s_load_dwordx16 s[32:47], s[0:1], 0
s_load_dwordx8 s[48:55], s[0:1], 64
v_and_b32 v1, 63, v0
v_lshrrev_b32 v2, 4, v1
v_and_b32 v3, 15, v1
v_lshrrev_b32 v4, 6, v0
s_nop 0
v_readfirstlane_b32 s3, v4
v_lshrrev_b32 v5, 1, v2
v_lshlrev_b32 v5, 8, v5
v_lshl_add_u32 v5, v3, 4, v5
v_and_b32 v6, 1, v2
v_lshl_add_u32 v26, v6, 3, v5
s_waitcnt lgkmcnt(0)
s_mov_b32 s16, s54
s_and_b32 s17, s55, 0xffff
s_mov_b32 s18, 67108864
s_mov_b32 s19, 0x20000
s_and_b32 s64, s2, 7
s_lshr_b32 s60, s64, 1
s_and_b32 s64, s64, 1
s_lshl_b32 s64, s64, 3
s_lshr_b32 s65, s2, 5
s_add_u32 s58, s64, s65
s_lshr_b32 s65, s2, 3
s_and_b32 s59, s65, 3
s_mov_b32 s12, s46
s_and_b32 s13, s47, 0xffff
s_mov_b32 s14, 5308416
s_mov_b32 s15, 0x20000
s_lshl_b32 s70, s58, 3
s_lshl_b32 s71, s3, 1
s_add_u32 s70, s70, s71
s_mul_i32 s72, s70, 147456
s_mul_i32 s73, s60, 36864
s_add_u32 s73, s73, s72
s_add_u32 s73, s73, 20971520
v_lshlrev_b32 v27, 4, v1
s_add_u32 s78, s73, 0
buffer_load_dwordx4 v[32:35], v27, s[16:19], s78 offen offset:0
s_add_u32 s78, s73, 147456
buffer_load_dwordx4 v[104:107], v27, s[16:19], s78 offen offset:0
s_add_u32 s78, s73, 0
buffer_load_dwordx4 v[36:39], v27, s[16:19], s78 offen offset:1024
s_add_u32 s78, s73, 147456
buffer_load_dwordx4 v[108:111], v27, s[16:19], s78 offen offset:1024
s_add_u32 s78, s73, 0
buffer_load_dwordx4 v[40:43], v27, s[16:19], s78 offen offset:2048
s_add_u32 s78, s73, 147456
buffer_load_dwordx4 v[112:115], v27, s[16:19], s78 offen offset:2048
s_add_u32 s78, s73, 0
buffer_load_dwordx4 v[44:47], v27, s[16:19], s78 offen offset:3072
s_add_u32 s78, s73, 147456
buffer_load_dwordx4 v[116:119], v27, s[16:19], s78 offen offset:3072
s_add_u32 s78, s73, 4096
buffer_load_dwordx4 v[48:51], v27, s[16:19], s78 offen offset:0
s_add_u32 s78, s73, 151552
buffer_load_dwordx4 v[120:123], v27, s[16:19], s78 offen offset:0
s_add_u32 s78, s73, 4096
buffer_load_dwordx4 v[52:55], v27, s[16:19], s78 offen offset:1024
s_add_u32 s78, s73, 151552
buffer_load_dwordx4 v[124:127], v27, s[16:19], s78 offen offset:1024
s_mul_i32 s65, s59, 288
s_and_b32 s66, s65, 0xffffff80
s_lshl_b32 s67, s59, 1
v_lshrrev_b32 v208, 3, v1
s_mov_b32 s89, 1152
v_mul_lo_u32 v209, v208, s89
v_bfe_u32 v210, v1, 4, 1
v_lshlrev_b32 v210, 1, v210
v_and_b32 v211, 7, v1
v_xor_b32 v211, v211, v210
v_lshl_add_u32 v16, v211, 4, v209
v_xor_b32 v211, 4, v211
v_lshl_add_u32 v17, v211, 4, v209
s_mul_i32 s56, s3, 3072
s_and_b32 s89, s3, 1
s_cmp_eq_u32 s89, 1
s_cselect_b64 s[90:91], -1, 0
v_mov_b32 v208, v16
v_cndmask_b32 v16, v16, v17, s[90:91]
v_cndmask_b32 v17, v17, v208, s[90:91]
s_mul_i32 s74, s60, 1327104
s_mul_i32 s61, s3, 27648
s_add_u32 s61, s61, s74
s_add_u32 s84, s66, s61
s_add_u32 s85, s66, s61
s_add_u32 s85, s85, 128
s_add_u32 s86, s66, s61
s_add_u32 s86, s86, 256
s_add_u32 s57, s84, 0
s_add_u32 m0, s56, 0
s_nop 0
buffer_load_dwordx4 v16, s[12:15], s57 offen lds
s_add_u32 s57, s85, 0
s_add_u32 m0, s56, 12288
s_nop 0
buffer_load_dwordx4 v16, s[12:15], s57 offen lds
s_add_u32 s57, s86, 0
s_add_u32 m0, s56, 24576
s_nop 0
buffer_load_dwordx4 v16, s[12:15], s57 offen lds
s_add_u32 s57, s84, 9216
s_add_u32 m0, s56, 1024
s_nop 0
buffer_load_dwordx4 v17, s[12:15], s57 offen lds
s_add_u32 s57, s85, 9216
s_add_u32 m0, s56, 13312
s_nop 0
buffer_load_dwordx4 v17, s[12:15], s57 offen lds
s_add_u32 s57, s86, 9216
s_add_u32 m0, s56, 25600
s_nop 0
buffer_load_dwordx4 v17, s[12:15], s57 offen lds
s_add_u32 s57, s84, 18432
s_add_u32 m0, s56, 2048
s_nop 0
buffer_load_dwordx4 v16, s[12:15], s57 offen lds
s_add_u32 s57, s85, 18432
s_add_u32 m0, s56, 14336
s_nop 0
buffer_load_dwordx4 v16, s[12:15], s57 offen lds
s_add_u32 s57, s86, 18432
s_add_u32 m0, s56, 26624
s_nop 0
buffer_load_dwordx4 v16, s[12:15], s57 offen lds
s_add_u32 s57, s84, 110592
s_add_u32 m0, s56, 36864
s_nop 0
buffer_load_dwordx4 v16, s[12:15], s57 offen lds
s_add_u32 s57, s85, 110592
s_add_u32 m0, s56, 49152
s_nop 0
buffer_load_dwordx4 v16, s[12:15], s57 offen lds
s_add_u32 s57, s86, 110592
s_add_u32 m0, s56, 61440
s_nop 0
buffer_load_dwordx4 v16, s[12:15], s57 offen lds
s_add_u32 s57, s84, 119808
s_add_u32 m0, s56, 37888
s_nop 0
buffer_load_dwordx4 v17, s[12:15], s57 offen lds
s_add_u32 s57, s85, 119808
s_add_u32 m0, s56, 50176
s_nop 0
buffer_load_dwordx4 v17, s[12:15], s57 offen lds
s_add_u32 s57, s86, 119808
s_add_u32 m0, s56, 62464
s_nop 0
buffer_load_dwordx4 v17, s[12:15], s57 offen lds
s_add_u32 s57, s84, 129024
s_add_u32 m0, s56, 38912
s_nop 0
buffer_load_dwordx4 v16, s[12:15], s57 offen lds
s_add_u32 s57, s85, 129024
s_add_u32 m0, s56, 51200
s_nop 0
buffer_load_dwordx4 v16, s[12:15], s57 offen lds
s_add_u32 s57, s86, 129024
s_add_u32 m0, s56, 63488
s_nop 0
buffer_load_dwordx4 v16, s[12:15], s57 offen lds
v_lshrrev_b32 v208, 2, v3
v_bfe_u32 v209, v3, 3, 1
v_and_b32 v210, 1, v2
v_lshl_or_b32 v209, v210, 1, v209
v_lshlrev_b32 v209, 1, v209
v_lshl_add_u32 v208, v2, 3, v208
v_bfe_u32 v211, v3, 1, 1
v_add_u32 v211, s67, v211
v_lshrrev_b32 v212, 3, v211
v_and_b32 v211, 7, v211
v_xor_b32 v211, v211, v209
v_lshlrev_b32 v208, 7, v208
v_lshl_add_u32 v208, v211, 4, v208
v_mul_u32_u24 v212, 12288, v212
v_add_u32 v208, v208, v212
v_and_b32 v210, 1, v3
v_lshl_add_u32 v8, v210, 3, v208
v_lshrrev_b32 v208, 2, v3
v_bfe_u32 v209, v3, 3, 1
v_and_b32 v210, 1, v2
v_lshl_or_b32 v209, v210, 1, v209
v_lshlrev_b32 v209, 1, v209
v_lshl_add_u32 v208, v2, 3, v208
v_bfe_u32 v211, v3, 1, 1
v_add_u32 v211, s67, v211
v_add_u32 v211, 2, v211
v_lshrrev_b32 v212, 3, v211
v_and_b32 v211, 7, v211
v_xor_b32 v211, v211, v209
v_lshlrev_b32 v208, 7, v208
v_lshl_add_u32 v208, v211, 4, v208
v_mul_u32_u24 v212, 12288, v212
v_add_u32 v208, v208, v212
v_and_b32 v210, 1, v3
v_lshl_add_u32 v9, v210, 3, v208
v_lshrrev_b32 v208, 2, v3
v_bfe_u32 v209, v3, 3, 1
v_and_b32 v210, 1, v2
v_lshl_or_b32 v209, v210, 1, v209
v_lshlrev_b32 v209, 1, v209
v_lshl_add_u32 v208, v2, 3, v208
v_bfe_u32 v211, v3, 1, 1
v_add_u32 v211, s67, v211
v_add_u32 v211, 4, v211
v_lshrrev_b32 v212, 3, v211
v_and_b32 v211, 7, v211
v_xor_b32 v211, v211, v209
v_lshlrev_b32 v208, 7, v208
v_lshl_add_u32 v208, v211, 4, v208
v_mul_u32_u24 v212, 12288, v212
v_add_u32 v208, v208, v212
v_and_b32 v210, 1, v3
v_lshl_add_u32 v10, v210, 3, v208
v_lshrrev_b32 v208, 2, v3
v_bfe_u32 v209, v3, 3, 1
v_and_b32 v210, 1, v2
v_lshl_or_b32 v209, v210, 1, v209
v_lshlrev_b32 v209, 1, v209
v_lshl_add_u32 v208, v2, 3, v208
v_bfe_u32 v211, v3, 1, 1
v_add_u32 v211, s67, v211
v_add_u32 v211, 6, v211
v_lshrrev_b32 v212, 3, v211
v_and_b32 v211, 7, v211
v_xor_b32 v211, v211, v209
v_lshlrev_b32 v208, 7, v208
v_lshl_add_u32 v208, v211, 4, v208
v_mul_u32_u24 v212, 12288, v212
v_add_u32 v208, v208, v212
v_and_b32 v210, 1, v3
v_lshl_add_u32 v11, v210, 3, v208
s_waitcnt vmcnt(9)
s_barrier
ds_read_b64_tr_b16 v[176:177], v8 offset:0
ds_read_b64_tr_b16 v[178:179], v8 offset:512
ds_read_b64_tr_b16 v[180:181], v9 offset:0
ds_read_b64_tr_b16 v[182:183], v9 offset:512
ds_read_b64_tr_b16 v[184:185], v10 offset:0
ds_read_b64_tr_b16 v[186:187], v10 offset:512
ds_read_b64_tr_b16 v[188:189], v11 offset:0
ds_read_b64_tr_b16 v[190:191], v11 offset:512
ds_read_b64_tr_b16 v[192:193], v8 offset:12288
ds_read_b64_tr_b16 v[194:195], v8 offset:12800
ds_read_b64_tr_b16 v[196:197], v9 offset:12288
ds_read_b64_tr_b16 v[198:199], v9 offset:12800
ds_read_b64_tr_b16 v[200:201], v10 offset:12288
ds_read_b64_tr_b16 v[202:203], v10 offset:12800
s_waitcnt lgkmcnt(12)
v_mfma_f32_16x16x32_bf16 a[0:3], v[176:179], v[32:35], 0
s_add_u32 s78, s73, 4096
buffer_load_dwordx4 v[56:59], v27, s[16:19], s78 offen offset:2048
v_mfma_f32_16x16x32_bf16 a[36:39], v[176:179], v[104:107], 0
ds_read_b64_tr_b16 v[204:205], v11 offset:12288
ds_read_b64_tr_b16 v[206:207], v11 offset:12800
s_waitcnt lgkmcnt(12)
v_mfma_f32_16x16x32_bf16 a[4:7], v[180:183], v[32:35], 0
v_mfma_f32_16x16x32_bf16 a[40:43], v[180:183], v[104:107], 0
s_add_u32 s78, s73, 151552
buffer_load_dwordx4 v[128:131], v27, s[16:19], s78 offen offset:2048
ds_read_b64_tr_b16 v[176:177], v8 offset:24576
ds_read_b64_tr_b16 v[178:179], v8 offset:25088
s_waitcnt lgkmcnt(12)
v_mfma_f32_16x16x32_bf16 a[8:11], v[184:187], v[32:35], 0
v_mfma_f32_16x16x32_bf16 a[44:47], v[184:187], v[104:107], 0
ds_read_b64_tr_b16 v[180:181], v8 offset:4096
ds_read_b64_tr_b16 v[182:183], v8 offset:4608
s_waitcnt lgkmcnt(12)
v_mfma_f32_16x16x32_bf16 a[12:15], v[188:191], v[32:35], 0
s_add_u32 s78, s73, 4096
buffer_load_dwordx4 v[60:63], v27, s[16:19], s78 offen offset:3072
v_mfma_f32_16x16x32_bf16 a[48:51], v[188:191], v[104:107], 0
ds_read_b64_tr_b16 v[184:185], v9 offset:4096
ds_read_b64_tr_b16 v[186:187], v9 offset:4608
s_waitcnt lgkmcnt(12)
v_mfma_f32_16x16x32_bf16 a[16:19], v[192:195], v[32:35], 0
s_add_u32 s78, s73, 151552
buffer_load_dwordx4 v[132:135], v27, s[16:19], s78 offen offset:3072
v_mfma_f32_16x16x32_bf16 a[52:55], v[192:195], v[104:107], 0
ds_read_b64_tr_b16 v[188:189], v10 offset:4096
ds_read_b64_tr_b16 v[190:191], v10 offset:4608
s_waitcnt lgkmcnt(12)
v_mfma_f32_16x16x32_bf16 a[20:23], v[196:199], v[32:35], 0
v_mfma_f32_16x16x32_bf16 a[56:59], v[196:199], v[104:107], 0
s_add_u32 s78, s73, 8192
buffer_load_dwordx4 v[64:67], v27, s[16:19], s78 offen offset:0
ds_read_b64_tr_b16 v[192:193], v11 offset:4096
ds_read_b64_tr_b16 v[194:195], v11 offset:4608
s_waitcnt lgkmcnt(12)
v_mfma_f32_16x16x32_bf16 a[24:27], v[200:203], v[32:35], 0
v_mfma_f32_16x16x32_bf16 a[60:63], v[200:203], v[104:107], 0
ds_read_b64_tr_b16 v[196:197], v8 offset:16384
ds_read_b64_tr_b16 v[198:199], v8 offset:16896
s_waitcnt lgkmcnt(12)
v_mfma_f32_16x16x32_bf16 a[28:31], v[204:207], v[32:35], 0
s_add_u32 s78, s73, 155648
buffer_load_dwordx4 v[136:139], v27, s[16:19], s78 offen offset:0
v_mfma_f32_16x16x32_bf16 a[64:67], v[204:207], v[104:107], 0
ds_read_b64_tr_b16 v[200:201], v9 offset:16384
ds_read_b64_tr_b16 v[202:203], v9 offset:16896
s_waitcnt lgkmcnt(12)
v_mfma_f32_16x16x32_bf16 a[32:35], v[176:179], v[32:35], 0
s_add_u32 s57, s84, 221184
s_add_u32 m0, s56, 73728
s_nop 0
buffer_load_dwordx4 v16, s[12:15], s57 offen lds
v_mfma_f32_16x16x32_bf16 a[68:71], v[176:179], v[104:107], 0
ds_read_b64_tr_b16 v[204:205], v10 offset:16384
ds_read_b64_tr_b16 v[206:207], v10 offset:16896
s_waitcnt lgkmcnt(12)
v_mfma_f32_16x16x32_bf16 a[0:3], v[180:183], v[36:39], a[0:3]
v_mfma_f32_16x16x32_bf16 a[36:39], v[180:183], v[108:111], a[36:39]
s_add_u32 s57, s85, 221184
s_add_u32 m0, s56, 86016
s_nop 0
buffer_load_dwordx4 v16, s[12:15], s57 offen lds
ds_read_b64_tr_b16 v[176:177], v11 offset:16384
ds_read_b64_tr_b16 v[178:179], v11 offset:16896
s_waitcnt lgkmcnt(12)
v_mfma_f32_16x16x32_bf16 a[4:7], v[184:187], v[36:39], a[4:7]
v_mfma_f32_16x16x32_bf16 a[40:43], v[184:187], v[108:111], a[40:43]
ds_read_b64_tr_b16 v[180:181], v8 offset:28672
ds_read_b64_tr_b16 v[182:183], v8 offset:29184
s_waitcnt lgkmcnt(12)
v_mfma_f32_16x16x32_bf16 a[8:11], v[188:191], v[36:39], a[8:11]
s_add_u32 s57, s86, 221184
s_add_u32 m0, s56, 98304
s_nop 0
buffer_load_dwordx4 v16, s[12:15], s57 offen lds
v_mfma_f32_16x16x32_bf16 a[44:47], v[188:191], v[108:111], a[44:47]
ds_read_b64_tr_b16 v[184:185], v8 offset:8192
ds_read_b64_tr_b16 v[186:187], v8 offset:8704
s_waitcnt lgkmcnt(12)
v_mfma_f32_16x16x32_bf16 a[12:15], v[192:195], v[36:39], a[12:15]
s_add_u32 s57, s84, 230400
s_add_u32 m0, s56, 74752
s_nop 0
buffer_load_dwordx4 v17, s[12:15], s57 offen lds
v_mfma_f32_16x16x32_bf16 a[48:51], v[192:195], v[108:111], a[48:51]
ds_read_b64_tr_b16 v[188:189], v9 offset:8192
ds_read_b64_tr_b16 v[190:191], v9 offset:8704
s_waitcnt lgkmcnt(12)
v_mfma_f32_16x16x32_bf16 a[16:19], v[196:199], v[36:39], a[16:19]
v_mfma_f32_16x16x32_bf16 a[52:55], v[196:199], v[108:111], a[52:55]
s_add_u32 s57, s85, 230400
s_add_u32 m0, s56, 87040
s_nop 0
buffer_load_dwordx4 v17, s[12:15], s57 offen lds
ds_read_b64_tr_b16 v[192:193], v10 offset:8192
ds_read_b64_tr_b16 v[194:195], v10 offset:8704
s_waitcnt lgkmcnt(12)
v_mfma_f32_16x16x32_bf16 a[20:23], v[200:203], v[36:39], a[20:23]
v_mfma_f32_16x16x32_bf16 a[56:59], v[200:203], v[108:111], a[56:59]
ds_read_b64_tr_b16 v[196:197], v11 offset:8192
ds_read_b64_tr_b16 v[198:199], v11 offset:8704
s_waitcnt lgkmcnt(12)
v_mfma_f32_16x16x32_bf16 a[24:27], v[204:207], v[36:39], a[24:27]
s_add_u32 s57, s86, 230400
s_add_u32 m0, s56, 99328
s_nop 0
buffer_load_dwordx4 v17, s[12:15], s57 offen lds
v_mfma_f32_16x16x32_bf16 a[60:63], v[204:207], v[108:111], a[60:63]
ds_read_b64_tr_b16 v[200:201], v8 offset:20480
ds_read_b64_tr_b16 v[202:203], v8 offset:20992
s_waitcnt lgkmcnt(12)
v_mfma_f32_16x16x32_bf16 a[28:31], v[176:179], v[36:39], a[28:31]
s_add_u32 s57, s84, 239616
s_add_u32 m0, s56, 75776
s_nop 0
buffer_load_dwordx4 v16, s[12:15], s57 offen lds
v_mfma_f32_16x16x32_bf16 a[64:67], v[176:179], v[108:111], a[64:67]
ds_read_b64_tr_b16 v[204:205], v9 offset:20480
ds_read_b64_tr_b16 v[206:207], v9 offset:20992
s_waitcnt lgkmcnt(12)
v_mfma_f32_16x16x32_bf16 a[32:35], v[180:183], v[36:39], a[32:35]
v_mfma_f32_16x16x32_bf16 a[68:71], v[180:183], v[108:111], a[68:71]
s_add_u32 s57, s85, 239616
s_add_u32 m0, s56, 88064
s_nop 0
buffer_load_dwordx4 v16, s[12:15], s57 offen lds
ds_read_b64_tr_b16 v[176:177], v10 offset:20480
ds_read_b64_tr_b16 v[178:179], v10 offset:20992
s_waitcnt lgkmcnt(12)
v_mfma_f32_16x16x32_bf16 a[0:3], v[184:187], v[40:43], a[0:3]
v_mfma_f32_16x16x32_bf16 a[36:39], v[184:187], v[112:115], a[36:39]
ds_read_b64_tr_b16 v[180:181], v11 offset:20480
ds_read_b64_tr_b16 v[182:183], v11 offset:20992
s_waitcnt lgkmcnt(12)
v_mfma_f32_16x16x32_bf16 a[4:7], v[188:191], v[40:43], a[4:7]
s_add_u32 s57, s86, 239616
s_add_u32 m0, s56, 100352
s_nop 0
buffer_load_dwordx4 v16, s[12:15], s57 offen lds
v_mfma_f32_16x16x32_bf16 a[40:43], v[188:191], v[112:115], a[40:43]
ds_read_b64_tr_b16 v[184:185], v8 offset:32768
ds_read_b64_tr_b16 v[186:187], v8 offset:33280
s_waitcnt lgkmcnt(12)
v_mfma_f32_16x16x32_bf16 a[8:11], v[192:195], v[40:43], a[8:11]
v_mfma_f32_16x16x32_bf16 a[44:47], v[192:195], v[112:115], a[44:47]
s_waitcnt vmcnt(15)
s_barrier
v_add_u32 v8, 36864, v8
v_add_u32 v9, 36864, v9
v_add_u32 v10, 36864, v10
v_add_u32 v11, 36864, v11
ds_read_b64_tr_b16 v[188:189], v8 offset:0
ds_read_b64_tr_b16 v[190:191], v8 offset:512
s_waitcnt lgkmcnt(12)
v_mfma_f32_16x16x32_bf16 a[12:15], v[196:199], v[40:43], a[12:15]
v_mfma_f32_16x16x32_bf16 a[48:51], v[196:199], v[112:115], a[48:51]
ds_read_b64_tr_b16 v[192:193], v9 offset:0
ds_read_b64_tr_b16 v[194:195], v9 offset:512
s_waitcnt lgkmcnt(12)
v_mfma_f32_16x16x32_bf16 a[16:19], v[200:203], v[40:43], a[16:19]
v_mfma_f32_16x16x32_bf16 a[52:55], v[200:203], v[112:115], a[52:55]
ds_read_b64_tr_b16 v[196:197], v10 offset:0
ds_read_b64_tr_b16 v[198:199], v10 offset:512
s_waitcnt lgkmcnt(12)
v_mfma_f32_16x16x32_bf16 a[20:23], v[204:207], v[40:43], a[20:23]
v_mfma_f32_16x16x32_bf16 a[56:59], v[204:207], v[112:115], a[56:59]
ds_read_b64_tr_b16 v[200:201], v11 offset:0
ds_read_b64_tr_b16 v[202:203], v11 offset:512
s_waitcnt lgkmcnt(12)
v_mfma_f32_16x16x32_bf16 a[24:27], v[176:179], v[40:43], a[24:27]
v_mfma_f32_16x16x32_bf16 a[60:63], v[176:179], v[112:115], a[60:63]
ds_read_b64_tr_b16 v[204:205], v8 offset:12288
ds_read_b64_tr_b16 v[206:207], v8 offset:12800
s_waitcnt lgkmcnt(12)
v_mfma_f32_16x16x32_bf16 a[28:31], v[180:183], v[40:43], a[28:31]
v_mfma_f32_16x16x32_bf16 a[64:67], v[180:183], v[112:115], a[64:67]
ds_read_b64_tr_b16 v[176:177], v9 offset:12288
ds_read_b64_tr_b16 v[178:179], v9 offset:12800
s_waitcnt lgkmcnt(12)
v_mfma_f32_16x16x32_bf16 a[32:35], v[184:187], v[40:43], a[32:35]
v_mfma_f32_16x16x32_bf16 a[68:71], v[184:187], v[112:115], a[68:71]
ds_read_b64_tr_b16 v[180:181], v10 offset:12288
ds_read_b64_tr_b16 v[182:183], v10 offset:12800
s_waitcnt lgkmcnt(12)
v_mfma_f32_16x16x32_bf16 a[0:3], v[188:191], v[44:47], a[0:3]
s_add_u32 s78, s73, 8192
buffer_load_dwordx4 v[68:71], v27, s[16:19], s78 offen offset:1024
v_mfma_f32_16x16x32_bf16 a[36:39], v[188:191], v[116:119], a[36:39]
ds_read_b64_tr_b16 v[184:185], v11 offset:12288
ds_read_b64_tr_b16 v[186:187], v11 offset:12800
s_waitcnt lgkmcnt(12)
v_mfma_f32_16x16x32_bf16 a[4:7], v[192:195], v[44:47], a[4:7]
v_mfma_f32_16x16x32_bf16 a[40:43], v[192:195], v[116:119], a[40:43]
s_add_u32 s78, s73, 155648
buffer_load_dwordx4 v[140:143], v27, s[16:19], s78 offen offset:1024
ds_read_b64_tr_b16 v[188:189], v8 offset:24576
ds_read_b64_tr_b16 v[190:191], v8 offset:25088
s_waitcnt lgkmcnt(12)
v_mfma_f32_16x16x32_bf16 a[8:11], v[196:199], v[44:47], a[8:11]
v_mfma_f32_16x16x32_bf16 a[44:47], v[196:199], v[116:119], a[44:47]
ds_read_b64_tr_b16 v[192:193], v8 offset:4096
ds_read_b64_tr_b16 v[194:195], v8 offset:4608
s_waitcnt lgkmcnt(12)
v_mfma_f32_16x16x32_bf16 a[12:15], v[200:203], v[44:47], a[12:15]
s_add_u32 s78, s73, 8192
buffer_load_dwordx4 v[72:75], v27, s[16:19], s78 offen offset:2048
v_mfma_f32_16x16x32_bf16 a[48:51], v[200:203], v[116:119], a[48:51]
ds_read_b64_tr_b16 v[196:197], v9 offset:4096
ds_read_b64_tr_b16 v[198:199], v9 offset:4608
s_waitcnt lgkmcnt(12)
v_mfma_f32_16x16x32_bf16 a[16:19], v[204:207], v[44:47], a[16:19]
s_add_u32 s78, s73, 155648
buffer_load_dwordx4 v[144:147], v27, s[16:19], s78 offen offset:2048
v_mfma_f32_16x16x32_bf16 a[52:55], v[204:207], v[116:119], a[52:55]
ds_read_b64_tr_b16 v[200:201], v10 offset:4096
ds_read_b64_tr_b16 v[202:203], v10 offset:4608
s_waitcnt lgkmcnt(12)
v_mfma_f32_16x16x32_bf16 a[20:23], v[176:179], v[44:47], a[20:23]
v_mfma_f32_16x16x32_bf16 a[56:59], v[176:179], v[116:119], a[56:59]
s_add_u32 s78, s73, 8192
buffer_load_dwordx4 v[76:79], v27, s[16:19], s78 offen offset:3072
ds_read_b64_tr_b16 v[204:205], v11 offset:4096
ds_read_b64_tr_b16 v[206:207], v11 offset:4608
s_waitcnt lgkmcnt(12)
v_mfma_f32_16x16x32_bf16 a[24:27], v[180:183], v[44:47], a[24:27]
v_mfma_f32_16x16x32_bf16 a[60:63], v[180:183], v[116:119], a[60:63]
ds_read_b64_tr_b16 v[176:177], v8 offset:16384
ds_read_b64_tr_b16 v[178:179], v8 offset:16896
s_waitcnt lgkmcnt(12)
v_mfma_f32_16x16x32_bf16 a[28:31], v[184:187], v[44:47], a[28:31]
s_add_u32 s78, s73, 155648
buffer_load_dwordx4 v[148:151], v27, s[16:19], s78 offen offset:3072
v_mfma_f32_16x16x32_bf16 a[64:67], v[184:187], v[116:119], a[64:67]
ds_read_b64_tr_b16 v[180:181], v9 offset:16384
ds_read_b64_tr_b16 v[182:183], v9 offset:16896
s_waitcnt lgkmcnt(12)
v_mfma_f32_16x16x32_bf16 a[32:35], v[188:191], v[44:47], a[32:35]
s_add_u32 s57, s84, 331776
s_add_u32 m0, s56, 110592
s_nop 0
buffer_load_dwordx4 v16, s[12:15], s57 offen lds
v_mfma_f32_16x16x32_bf16 a[68:71], v[188:191], v[116:119], a[68:71]
ds_read_b64_tr_b16 v[184:185], v10 offset:16384
ds_read_b64_tr_b16 v[186:187], v10 offset:16896
s_waitcnt lgkmcnt(12)
v_mfma_f32_16x16x32_bf16 a[0:3], v[192:195], v[48:51], a[0:3]
v_mfma_f32_16x16x32_bf16 a[36:39], v[192:195], v[120:123], a[36:39]
s_add_u32 s57, s85, 331776
s_add_u32 m0, s56, 122880
s_nop 0
buffer_load_dwordx4 v16, s[12:15], s57 offen lds
ds_read_b64_tr_b16 v[188:189], v11 offset:16384
ds_read_b64_tr_b16 v[190:191], v11 offset:16896
s_waitcnt lgkmcnt(12)
v_mfma_f32_16x16x32_bf16 a[4:7], v[196:199], v[48:51], a[4:7]
v_mfma_f32_16x16x32_bf16 a[40:43], v[196:199], v[120:123], a[40:43]
ds_read_b64_tr_b16 v[192:193], v8 offset:28672
ds_read_b64_tr_b16 v[194:195], v8 offset:29184
s_waitcnt lgkmcnt(12)
v_mfma_f32_16x16x32_bf16 a[8:11], v[200:203], v[48:51], a[8:11]
s_add_u32 s57, s86, 331776
s_add_u32 m0, s56, 135168
s_nop 0
buffer_load_dwordx4 v16, s[12:15], s57 offen lds
v_mfma_f32_16x16x32_bf16 a[44:47], v[200:203], v[120:123], a[44:47]
ds_read_b64_tr_b16 v[196:197], v8 offset:8192
ds_read_b64_tr_b16 v[198:199], v8 offset:8704
s_waitcnt lgkmcnt(12)
v_mfma_f32_16x16x32_bf16 a[12:15], v[204:207], v[48:51], a[12:15]
s_add_u32 s57, s84, 340992
s_add_u32 m0, s56, 111616
s_nop 0
buffer_load_dwordx4 v17, s[12:15], s57 offen lds
v_mfma_f32_16x16x32_bf16 a[48:51], v[204:207], v[120:123], a[48:51]
ds_read_b64_tr_b16 v[200:201], v9 offset:8192
ds_read_b64_tr_b16 v[202:203], v9 offset:8704
s_waitcnt lgkmcnt(12)
v_mfma_f32_16x16x32_bf16 a[16:19], v[176:179], v[48:51], a[16:19]
v_mfma_f32_16x16x32_bf16 a[52:55], v[176:179], v[120:123], a[52:55]
s_add_u32 s57, s85, 340992
s_add_u32 m0, s56, 123904
s_nop 0
buffer_load_dwordx4 v17, s[12:15], s57 offen lds
ds_read_b64_tr_b16 v[204:205], v10 offset:8192
ds_read_b64_tr_b16 v[206:207], v10 offset:8704
s_waitcnt lgkmcnt(12)
v_mfma_f32_16x16x32_bf16 a[20:23], v[180:183], v[48:51], a[20:23]
v_mfma_f32_16x16x32_bf16 a[56:59], v[180:183], v[120:123], a[56:59]
ds_read_b64_tr_b16 v[176:177], v11 offset:8192
ds_read_b64_tr_b16 v[178:179], v11 offset:8704
s_waitcnt lgkmcnt(12)
v_mfma_f32_16x16x32_bf16 a[24:27], v[184:187], v[48:51], a[24:27]
s_add_u32 s57, s86, 340992
s_add_u32 m0, s56, 136192
s_nop 0
buffer_load_dwordx4 v17, s[12:15], s57 offen lds
v_mfma_f32_16x16x32_bf16 a[60:63], v[184:187], v[120:123], a[60:63]
ds_read_b64_tr_b16 v[180:181], v8 offset:20480
ds_read_b64_tr_b16 v[182:183], v8 offset:20992
s_waitcnt lgkmcnt(12)
v_mfma_f32_16x16x32_bf16 a[28:31], v[188:191], v[48:51], a[28:31]
s_add_u32 s57, s84, 350208
s_add_u32 m0, s56, 112640
s_nop 0
buffer_load_dwordx4 v16, s[12:15], s57 offen lds
v_mfma_f32_16x16x32_bf16 a[64:67], v[188:191], v[120:123], a[64:67]
ds_read_b64_tr_b16 v[184:185], v9 offset:20480
ds_read_b64_tr_b16 v[186:187], v9 offset:20992
s_waitcnt lgkmcnt(12)
v_mfma_f32_16x16x32_bf16 a[32:35], v[192:195], v[48:51], a[32:35]
v_mfma_f32_16x16x32_bf16 a[68:71], v[192:195], v[120:123], a[68:71]
s_add_u32 s57, s85, 350208
s_add_u32 m0, s56, 124928
s_nop 0
buffer_load_dwordx4 v16, s[12:15], s57 offen lds
ds_read_b64_tr_b16 v[188:189], v10 offset:20480
ds_read_b64_tr_b16 v[190:191], v10 offset:20992
s_waitcnt lgkmcnt(12)
v_mfma_f32_16x16x32_bf16 a[0:3], v[196:199], v[52:55], a[0:3]
v_mfma_f32_16x16x32_bf16 a[36:39], v[196:199], v[124:127], a[36:39]
ds_read_b64_tr_b16 v[192:193], v11 offset:20480
ds_read_b64_tr_b16 v[194:195], v11 offset:20992
s_waitcnt lgkmcnt(12)
v_mfma_f32_16x16x32_bf16 a[4:7], v[200:203], v[52:55], a[4:7]
s_add_u32 s57, s86, 350208
s_add_u32 m0, s56, 137216
s_nop 0
buffer_load_dwordx4 v16, s[12:15], s57 offen lds
v_mfma_f32_16x16x32_bf16 a[40:43], v[200:203], v[124:127], a[40:43]
ds_read_b64_tr_b16 v[196:197], v8 offset:32768
ds_read_b64_tr_b16 v[198:199], v8 offset:33280
s_waitcnt lgkmcnt(12)
v_mfma_f32_16x16x32_bf16 a[8:11], v[204:207], v[52:55], a[8:11]
v_mfma_f32_16x16x32_bf16 a[44:47], v[204:207], v[124:127], a[44:47]
s_waitcnt vmcnt(15)
s_barrier
v_add_u32 v8, 36864, v8
v_add_u32 v9, 36864, v9
v_add_u32 v10, 36864, v10
v_add_u32 v11, 36864, v11
ds_read_b64_tr_b16 v[200:201], v8 offset:0
ds_read_b64_tr_b16 v[202:203], v8 offset:512
s_waitcnt lgkmcnt(12)
v_mfma_f32_16x16x32_bf16 a[12:15], v[176:179], v[52:55], a[12:15]
v_mfma_f32_16x16x32_bf16 a[48:51], v[176:179], v[124:127], a[48:51]
ds_read_b64_tr_b16 v[204:205], v9 offset:0
ds_read_b64_tr_b16 v[206:207], v9 offset:512
s_waitcnt lgkmcnt(12)
v_mfma_f32_16x16x32_bf16 a[16:19], v[180:183], v[52:55], a[16:19]
v_mfma_f32_16x16x32_bf16 a[52:55], v[180:183], v[124:127], a[52:55]
ds_read_b64_tr_b16 v[176:177], v10 offset:0
ds_read_b64_tr_b16 v[178:179], v10 offset:512
s_waitcnt lgkmcnt(12)
v_mfma_f32_16x16x32_bf16 a[20:23], v[184:187], v[52:55], a[20:23]
v_mfma_f32_16x16x32_bf16 a[56:59], v[184:187], v[124:127], a[56:59]
ds_read_b64_tr_b16 v[180:181], v11 offset:0
ds_read_b64_tr_b16 v[182:183], v11 offset:512
s_waitcnt lgkmcnt(12)
v_mfma_f32_16x16x32_bf16 a[24:27], v[188:191], v[52:55], a[24:27]
v_mfma_f32_16x16x32_bf16 a[60:63], v[188:191], v[124:127], a[60:63]
ds_read_b64_tr_b16 v[184:185], v8 offset:12288
ds_read_b64_tr_b16 v[186:187], v8 offset:12800
s_waitcnt lgkmcnt(12)
v_mfma_f32_16x16x32_bf16 a[28:31], v[192:195], v[52:55], a[28:31]
v_mfma_f32_16x16x32_bf16 a[64:67], v[192:195], v[124:127], a[64:67]
ds_read_b64_tr_b16 v[188:189], v9 offset:12288
ds_read_b64_tr_b16 v[190:191], v9 offset:12800
s_waitcnt lgkmcnt(12)
v_mfma_f32_16x16x32_bf16 a[32:35], v[196:199], v[52:55], a[32:35]
v_mfma_f32_16x16x32_bf16 a[68:71], v[196:199], v[124:127], a[68:71]
ds_read_b64_tr_b16 v[192:193], v10 offset:12288
ds_read_b64_tr_b16 v[194:195], v10 offset:12800
s_waitcnt lgkmcnt(12)
v_mfma_f32_16x16x32_bf16 a[0:3], v[200:203], v[56:59], a[0:3]
s_add_u32 s78, s73, 12288
buffer_load_dwordx4 v[80:83], v27, s[16:19], s78 offen offset:0
v_mfma_f32_16x16x32_bf16 a[36:39], v[200:203], v[128:131], a[36:39]
ds_read_b64_tr_b16 v[196:197], v11 offset:12288
ds_read_b64_tr_b16 v[198:199], v11 offset:12800
s_waitcnt lgkmcnt(12)
v_mfma_f32_16x16x32_bf16 a[4:7], v[204:207], v[56:59], a[4:7]
v_mfma_f32_16x16x32_bf16 a[40:43], v[204:207], v[128:131], a[40:43]
s_add_u32 s78, s73, 159744
buffer_load_dwordx4 v[152:155], v27, s[16:19], s78 offen offset:0
ds_read_b64_tr_b16 v[200:201], v8 offset:24576
ds_read_b64_tr_b16 v[202:203], v8 offset:25088
s_waitcnt lgkmcnt(12)
v_mfma_f32_16x16x32_bf16 a[8:11], v[176:179], v[56:59], a[8:11]
v_mfma_f32_16x16x32_bf16 a[44:47], v[176:179], v[128:131], a[44:47]
ds_read_b64_tr_b16 v[204:205], v8 offset:4096
ds_read_b64_tr_b16 v[206:207], v8 offset:4608
s_waitcnt lgkmcnt(12)
v_mfma_f32_16x16x32_bf16 a[12:15], v[180:183], v[56:59], a[12:15]
s_add_u32 s78, s73, 12288
buffer_load_dwordx4 v[84:87], v27, s[16:19], s78 offen offset:1024
v_mfma_f32_16x16x32_bf16 a[48:51], v[180:183], v[128:131], a[48:51]
ds_read_b64_tr_b16 v[176:177], v9 offset:4096
ds_read_b64_tr_b16 v[178:179], v9 offset:4608
s_waitcnt lgkmcnt(12)
v_mfma_f32_16x16x32_bf16 a[16:19], v[184:187], v[56:59], a[16:19]
s_add_u32 s78, s73, 159744
buffer_load_dwordx4 v[156:159], v27, s[16:19], s78 offen offset:1024
v_mfma_f32_16x16x32_bf16 a[52:55], v[184:187], v[128:131], a[52:55]
ds_read_b64_tr_b16 v[180:181], v10 offset:4096
ds_read_b64_tr_b16 v[182:183], v10 offset:4608
s_waitcnt lgkmcnt(12)
v_mfma_f32_16x16x32_bf16 a[20:23], v[188:191], v[56:59], a[20:23]
v_mfma_f32_16x16x32_bf16 a[56:59], v[188:191], v[128:131], a[56:59]
s_add_u32 s78, s73, 12288
buffer_load_dwordx4 v[88:91], v27, s[16:19], s78 offen offset:2048
ds_read_b64_tr_b16 v[184:185], v11 offset:4096
ds_read_b64_tr_b16 v[186:187], v11 offset:4608
s_waitcnt lgkmcnt(12)
v_mfma_f32_16x16x32_bf16 a[24:27], v[192:195], v[56:59], a[24:27]
v_mfma_f32_16x16x32_bf16 a[60:63], v[192:195], v[128:131], a[60:63]
ds_read_b64_tr_b16 v[188:189], v8 offset:16384
ds_read_b64_tr_b16 v[190:191], v8 offset:16896
s_waitcnt lgkmcnt(12)
v_mfma_f32_16x16x32_bf16 a[28:31], v[196:199], v[56:59], a[28:31]
s_add_u32 s78, s73, 159744
buffer_load_dwordx4 v[160:163], v27, s[16:19], s78 offen offset:2048
v_mfma_f32_16x16x32_bf16 a[64:67], v[196:199], v[128:131], a[64:67]
ds_read_b64_tr_b16 v[192:193], v9 offset:16384
ds_read_b64_tr_b16 v[194:195], v9 offset:16896
s_waitcnt lgkmcnt(12)
v_mfma_f32_16x16x32_bf16 a[32:35], v[200:203], v[56:59], a[32:35]
s_add_u32 s57, s84, 442368
s_add_u32 m0, s56, 0
s_nop 0
buffer_load_dwordx4 v16, s[12:15], s57 offen lds
v_mfma_f32_16x16x32_bf16 a[68:71], v[200:203], v[128:131], a[68:71]
ds_read_b64_tr_b16 v[196:197], v10 offset:16384
ds_read_b64_tr_b16 v[198:199], v10 offset:16896
s_waitcnt lgkmcnt(12)
v_mfma_f32_16x16x32_bf16 a[0:3], v[204:207], v[60:63], a[0:3]
v_mfma_f32_16x16x32_bf16 a[36:39], v[204:207], v[132:135], a[36:39]
s_add_u32 s57, s85, 442368
s_add_u32 m0, s56, 12288
s_nop 0
buffer_load_dwordx4 v16, s[12:15], s57 offen lds
ds_read_b64_tr_b16 v[200:201], v11 offset:16384
ds_read_b64_tr_b16 v[202:203], v11 offset:16896
s_waitcnt lgkmcnt(12)
v_mfma_f32_16x16x32_bf16 a[4:7], v[176:179], v[60:63], a[4:7]
v_mfma_f32_16x16x32_bf16 a[40:43], v[176:179], v[132:135], a[40:43]
ds_read_b64_tr_b16 v[204:205], v8 offset:28672
ds_read_b64_tr_b16 v[206:207], v8 offset:29184
s_waitcnt lgkmcnt(12)
v_mfma_f32_16x16x32_bf16 a[8:11], v[180:183], v[60:63], a[8:11]
s_add_u32 s57, s86, 442368
s_add_u32 m0, s56, 24576
s_nop 0
buffer_load_dwordx4 v16, s[12:15], s57 offen lds
v_mfma_f32_16x16x32_bf16 a[44:47], v[180:183], v[132:135], a[44:47]
ds_read_b64_tr_b16 v[176:177], v8 offset:8192
ds_read_b64_tr_b16 v[178:179], v8 offset:8704
s_waitcnt lgkmcnt(12)
v_mfma_f32_16x16x32_bf16 a[12:15], v[184:187], v[60:63], a[12:15]
s_add_u32 s57, s84, 451584
s_add_u32 m0, s56, 1024
s_nop 0
buffer_load_dwordx4 v17, s[12:15], s57 offen lds
v_mfma_f32_16x16x32_bf16 a[48:51], v[184:187], v[132:135], a[48:51]
ds_read_b64_tr_b16 v[180:181], v9 offset:8192
ds_read_b64_tr_b16 v[182:183], v9 offset:8704
s_waitcnt lgkmcnt(12)
v_mfma_f32_16x16x32_bf16 a[16:19], v[188:191], v[60:63], a[16:19]
v_mfma_f32_16x16x32_bf16 a[52:55], v[188:191], v[132:135], a[52:55]
s_add_u32 s57, s85, 451584
s_add_u32 m0, s56, 13312
s_nop 0
buffer_load_dwordx4 v17, s[12:15], s57 offen lds
ds_read_b64_tr_b16 v[184:185], v10 offset:8192
ds_read_b64_tr_b16 v[186:187], v10 offset:8704
s_waitcnt lgkmcnt(12)
v_mfma_f32_16x16x32_bf16 a[20:23], v[192:195], v[60:63], a[20:23]
v_mfma_f32_16x16x32_bf16 a[56:59], v[192:195], v[132:135], a[56:59]
ds_read_b64_tr_b16 v[188:189], v11 offset:8192
ds_read_b64_tr_b16 v[190:191], v11 offset:8704
s_waitcnt lgkmcnt(12)
v_mfma_f32_16x16x32_bf16 a[24:27], v[196:199], v[60:63], a[24:27]
s_add_u32 s57, s86, 451584
s_add_u32 m0, s56, 25600
s_nop 0
buffer_load_dwordx4 v17, s[12:15], s57 offen lds
v_mfma_f32_16x16x32_bf16 a[60:63], v[196:199], v[132:135], a[60:63]
ds_read_b64_tr_b16 v[192:193], v8 offset:20480
ds_read_b64_tr_b16 v[194:195], v8 offset:20992
s_waitcnt lgkmcnt(12)
v_mfma_f32_16x16x32_bf16 a[28:31], v[200:203], v[60:63], a[28:31]
s_add_u32 s57, s84, 460800
s_add_u32 m0, s56, 2048
s_nop 0
buffer_load_dwordx4 v16, s[12:15], s57 offen lds
v_mfma_f32_16x16x32_bf16 a[64:67], v[200:203], v[132:135], a[64:67]
ds_read_b64_tr_b16 v[196:197], v9 offset:20480
ds_read_b64_tr_b16 v[198:199], v9 offset:20992
s_waitcnt lgkmcnt(12)
v_mfma_f32_16x16x32_bf16 a[32:35], v[204:207], v[60:63], a[32:35]
v_mfma_f32_16x16x32_bf16 a[68:71], v[204:207], v[132:135], a[68:71]
s_add_u32 s57, s85, 460800
s_add_u32 m0, s56, 14336
s_nop 0
buffer_load_dwordx4 v16, s[12:15], s57 offen lds
ds_read_b64_tr_b16 v[200:201], v10 offset:20480
ds_read_b64_tr_b16 v[202:203], v10 offset:20992
s_waitcnt lgkmcnt(12)
v_mfma_f32_16x16x32_bf16 a[0:3], v[176:179], v[64:67], a[0:3]
v_mfma_f32_16x16x32_bf16 a[36:39], v[176:179], v[136:139], a[36:39]
ds_read_b64_tr_b16 v[204:205], v11 offset:20480
ds_read_b64_tr_b16 v[206:207], v11 offset:20992
s_waitcnt lgkmcnt(12)
v_mfma_f32_16x16x32_bf16 a[4:7], v[180:183], v[64:67], a[4:7]
s_add_u32 s57, s86, 460800
s_add_u32 m0, s56, 26624
s_nop 0
buffer_load_dwordx4 v16, s[12:15], s57 offen lds
v_mfma_f32_16x16x32_bf16 a[40:43], v[180:183], v[136:139], a[40:43]
ds_read_b64_tr_b16 v[176:177], v8 offset:32768
ds_read_b64_tr_b16 v[178:179], v8 offset:33280
s_waitcnt lgkmcnt(12)
v_mfma_f32_16x16x32_bf16 a[8:11], v[184:187], v[64:67], a[8:11]
v_mfma_f32_16x16x32_bf16 a[44:47], v[184:187], v[136:139], a[44:47]
s_waitcnt vmcnt(15)
s_barrier
v_add_u32 v8, 36864, v8
v_add_u32 v9, 36864, v9
v_add_u32 v10, 36864, v10
v_add_u32 v11, 36864, v11
ds_read_b64_tr_b16 v[180:181], v8 offset:0
ds_read_b64_tr_b16 v[182:183], v8 offset:512
s_waitcnt lgkmcnt(12)
v_mfma_f32_16x16x32_bf16 a[12:15], v[188:191], v[64:67], a[12:15]
v_mfma_f32_16x16x32_bf16 a[48:51], v[188:191], v[136:139], a[48:51]
ds_read_b64_tr_b16 v[184:185], v9 offset:0
ds_read_b64_tr_b16 v[186:187], v9 offset:512
s_waitcnt lgkmcnt(12)
v_mfma_f32_16x16x32_bf16 a[16:19], v[192:195], v[64:67], a[16:19]
v_mfma_f32_16x16x32_bf16 a[52:55], v[192:195], v[136:139], a[52:55]
ds_read_b64_tr_b16 v[188:189], v10 offset:0
ds_read_b64_tr_b16 v[190:191], v10 offset:512
s_waitcnt lgkmcnt(12)
v_mfma_f32_16x16x32_bf16 a[20:23], v[196:199], v[64:67], a[20:23]
v_mfma_f32_16x16x32_bf16 a[56:59], v[196:199], v[136:139], a[56:59]
ds_read_b64_tr_b16 v[192:193], v11 offset:0
ds_read_b64_tr_b16 v[194:195], v11 offset:512
s_waitcnt lgkmcnt(12)
v_mfma_f32_16x16x32_bf16 a[24:27], v[200:203], v[64:67], a[24:27]
v_mfma_f32_16x16x32_bf16 a[60:63], v[200:203], v[136:139], a[60:63]
ds_read_b64_tr_b16 v[196:197], v8 offset:12288
ds_read_b64_tr_b16 v[198:199], v8 offset:12800
s_waitcnt lgkmcnt(12)
v_mfma_f32_16x16x32_bf16 a[28:31], v[204:207], v[64:67], a[28:31]
v_mfma_f32_16x16x32_bf16 a[64:67], v[204:207], v[136:139], a[64:67]
ds_read_b64_tr_b16 v[200:201], v9 offset:12288
ds_read_b64_tr_b16 v[202:203], v9 offset:12800
s_waitcnt lgkmcnt(12)
v_mfma_f32_16x16x32_bf16 a[32:35], v[176:179], v[64:67], a[32:35]
v_mfma_f32_16x16x32_bf16 a[68:71], v[176:179], v[136:139], a[68:71]
ds_read_b64_tr_b16 v[204:205], v10 offset:12288
ds_read_b64_tr_b16 v[206:207], v10 offset:12800
s_waitcnt lgkmcnt(12)
v_mfma_f32_16x16x32_bf16 a[0:3], v[180:183], v[68:71], a[0:3]
s_add_u32 s78, s73, 12288
buffer_load_dwordx4 v[92:95], v27, s[16:19], s78 offen offset:3072
v_mfma_f32_16x16x32_bf16 a[36:39], v[180:183], v[140:143], a[36:39]
ds_read_b64_tr_b16 v[176:177], v11 offset:12288
ds_read_b64_tr_b16 v[178:179], v11 offset:12800
s_waitcnt lgkmcnt(12)
v_mfma_f32_16x16x32_bf16 a[4:7], v[184:187], v[68:71], a[4:7]
v_mfma_f32_16x16x32_bf16 a[40:43], v[184:187], v[140:143], a[40:43]
s_add_u32 s78, s73, 159744
buffer_load_dwordx4 v[164:167], v27, s[16:19], s78 offen offset:3072
ds_read_b64_tr_b16 v[180:181], v8 offset:24576
ds_read_b64_tr_b16 v[182:183], v8 offset:25088
s_waitcnt lgkmcnt(12)
v_mfma_f32_16x16x32_bf16 a[8:11], v[188:191], v[68:71], a[8:11]
v_mfma_f32_16x16x32_bf16 a[44:47], v[188:191], v[140:143], a[44:47]
ds_read_b64_tr_b16 v[184:185], v8 offset:4096
ds_read_b64_tr_b16 v[186:187], v8 offset:4608
s_waitcnt lgkmcnt(12)
v_mfma_f32_16x16x32_bf16 a[12:15], v[192:195], v[68:71], a[12:15]
s_add_u32 s78, s73, 16384
buffer_load_dwordx4 v[96:99], v27, s[16:19], s78 offen offset:0
v_mfma_f32_16x16x32_bf16 a[48:51], v[192:195], v[140:143], a[48:51]
ds_read_b64_tr_b16 v[188:189], v9 offset:4096
ds_read_b64_tr_b16 v[190:191], v9 offset:4608
s_waitcnt lgkmcnt(12)
v_mfma_f32_16x16x32_bf16 a[16:19], v[196:199], v[68:71], a[16:19]
s_add_u32 s78, s73, 163840
buffer_load_dwordx4 v[168:171], v27, s[16:19], s78 offen offset:0
v_mfma_f32_16x16x32_bf16 a[52:55], v[196:199], v[140:143], a[52:55]
ds_read_b64_tr_b16 v[192:193], v10 offset:4096
ds_read_b64_tr_b16 v[194:195], v10 offset:4608
s_waitcnt lgkmcnt(12)
v_mfma_f32_16x16x32_bf16 a[20:23], v[200:203], v[68:71], a[20:23]
v_mfma_f32_16x16x32_bf16 a[56:59], v[200:203], v[140:143], a[56:59]
s_add_u32 s78, s73, 16384
buffer_load_dwordx4 v[100:103], v27, s[16:19], s78 offen offset:1024
ds_read_b64_tr_b16 v[196:197], v11 offset:4096
ds_read_b64_tr_b16 v[198:199], v11 offset:4608
s_waitcnt lgkmcnt(12)
v_mfma_f32_16x16x32_bf16 a[24:27], v[204:207], v[68:71], a[24:27]
v_mfma_f32_16x16x32_bf16 a[60:63], v[204:207], v[140:143], a[60:63]
ds_read_b64_tr_b16 v[200:201], v8 offset:16384
ds_read_b64_tr_b16 v[202:203], v8 offset:16896
s_waitcnt lgkmcnt(12)
v_mfma_f32_16x16x32_bf16 a[28:31], v[176:179], v[68:71], a[28:31]
s_add_u32 s78, s73, 163840
buffer_load_dwordx4 v[172:175], v27, s[16:19], s78 offen offset:1024
v_mfma_f32_16x16x32_bf16 a[64:67], v[176:179], v[140:143], a[64:67]
ds_read_b64_tr_b16 v[204:205], v9 offset:16384
ds_read_b64_tr_b16 v[206:207], v9 offset:16896
s_waitcnt lgkmcnt(12)
v_mfma_f32_16x16x32_bf16 a[32:35], v[180:183], v[68:71], a[32:35]
s_add_u32 s57, s84, 552960
s_add_u32 m0, s56, 36864
s_nop 0
buffer_load_dwordx4 v16, s[12:15], s57 offen lds
v_mfma_f32_16x16x32_bf16 a[68:71], v[180:183], v[140:143], a[68:71]
ds_read_b64_tr_b16 v[176:177], v10 offset:16384
ds_read_b64_tr_b16 v[178:179], v10 offset:16896
s_waitcnt lgkmcnt(12)
v_mfma_f32_16x16x32_bf16 a[0:3], v[184:187], v[72:75], a[0:3]
v_mfma_f32_16x16x32_bf16 a[36:39], v[184:187], v[144:147], a[36:39]
s_add_u32 s57, s85, 552960
s_add_u32 m0, s56, 49152
s_nop 0
buffer_load_dwordx4 v16, s[12:15], s57 offen lds
ds_read_b64_tr_b16 v[180:181], v11 offset:16384
ds_read_b64_tr_b16 v[182:183], v11 offset:16896
s_waitcnt lgkmcnt(12)
v_mfma_f32_16x16x32_bf16 a[4:7], v[188:191], v[72:75], a[4:7]
v_mfma_f32_16x16x32_bf16 a[40:43], v[188:191], v[144:147], a[40:43]
ds_read_b64_tr_b16 v[184:185], v8 offset:28672
ds_read_b64_tr_b16 v[186:187], v8 offset:29184
s_waitcnt lgkmcnt(12)
v_mfma_f32_16x16x32_bf16 a[8:11], v[192:195], v[72:75], a[8:11]
s_add_u32 s57, s86, 552960
s_add_u32 m0, s56, 61440
s_nop 0
buffer_load_dwordx4 v16, s[12:15], s57 offen lds
v_mfma_f32_16x16x32_bf16 a[44:47], v[192:195], v[144:147], a[44:47]
ds_read_b64_tr_b16 v[188:189], v8 offset:8192
ds_read_b64_tr_b16 v[190:191], v8 offset:8704
s_waitcnt lgkmcnt(12)
v_mfma_f32_16x16x32_bf16 a[12:15], v[196:199], v[72:75], a[12:15]
s_add_u32 s57, s84, 562176
s_add_u32 m0, s56, 37888
s_nop 0
buffer_load_dwordx4 v17, s[12:15], s57 offen lds
v_mfma_f32_16x16x32_bf16 a[48:51], v[196:199], v[144:147], a[48:51]
ds_read_b64_tr_b16 v[192:193], v9 offset:8192
ds_read_b64_tr_b16 v[194:195], v9 offset:8704
s_waitcnt lgkmcnt(12)
v_mfma_f32_16x16x32_bf16 a[16:19], v[200:203], v[72:75], a[16:19]
v_mfma_f32_16x16x32_bf16 a[52:55], v[200:203], v[144:147], a[52:55]
s_add_u32 s57, s85, 562176
s_add_u32 m0, s56, 50176
s_nop 0
buffer_load_dwordx4 v17, s[12:15], s57 offen lds
ds_read_b64_tr_b16 v[196:197], v10 offset:8192
ds_read_b64_tr_b16 v[198:199], v10 offset:8704
s_waitcnt lgkmcnt(12)
v_mfma_f32_16x16x32_bf16 a[20:23], v[204:207], v[72:75], a[20:23]
v_mfma_f32_16x16x32_bf16 a[56:59], v[204:207], v[144:147], a[56:59]
ds_read_b64_tr_b16 v[200:201], v11 offset:8192
ds_read_b64_tr_b16 v[202:203], v11 offset:8704
s_waitcnt lgkmcnt(12)
v_mfma_f32_16x16x32_bf16 a[24:27], v[176:179], v[72:75], a[24:27]
s_add_u32 s57, s86, 562176
s_add_u32 m0, s56, 62464
s_nop 0
buffer_load_dwordx4 v17, s[12:15], s57 offen lds
v_mfma_f32_16x16x32_bf16 a[60:63], v[176:179], v[144:147], a[60:63]
ds_read_b64_tr_b16 v[204:205], v8 offset:20480
ds_read_b64_tr_b16 v[206:207], v8 offset:20992
s_waitcnt lgkmcnt(12)
v_mfma_f32_16x16x32_bf16 a[28:31], v[180:183], v[72:75], a[28:31]
s_add_u32 s57, s84, 571392
s_add_u32 m0, s56, 38912
s_nop 0
buffer_load_dwordx4 v16, s[12:15], s57 offen lds
v_mfma_f32_16x16x32_bf16 a[64:67], v[180:183], v[144:147], a[64:67]
ds_read_b64_tr_b16 v[176:177], v9 offset:20480
ds_read_b64_tr_b16 v[178:179], v9 offset:20992
s_waitcnt lgkmcnt(12)
v_mfma_f32_16x16x32_bf16 a[32:35], v[184:187], v[72:75], a[32:35]
v_mfma_f32_16x16x32_bf16 a[68:71], v[184:187], v[144:147], a[68:71]
s_add_u32 s57, s85, 571392
s_add_u32 m0, s56, 51200
s_nop 0
buffer_load_dwordx4 v16, s[12:15], s57 offen lds
ds_read_b64_tr_b16 v[180:181], v10 offset:20480
ds_read_b64_tr_b16 v[182:183], v10 offset:20992
s_waitcnt lgkmcnt(12)
v_mfma_f32_16x16x32_bf16 a[0:3], v[188:191], v[76:79], a[0:3]
v_mfma_f32_16x16x32_bf16 a[36:39], v[188:191], v[148:151], a[36:39]
ds_read_b64_tr_b16 v[184:185], v11 offset:20480
ds_read_b64_tr_b16 v[186:187], v11 offset:20992
s_waitcnt lgkmcnt(12)
v_mfma_f32_16x16x32_bf16 a[4:7], v[192:195], v[76:79], a[4:7]
s_add_u32 s57, s86, 571392
s_add_u32 m0, s56, 63488
s_nop 0
buffer_load_dwordx4 v16, s[12:15], s57 offen lds
v_mfma_f32_16x16x32_bf16 a[40:43], v[192:195], v[148:151], a[40:43]
ds_read_b64_tr_b16 v[188:189], v8 offset:32768
ds_read_b64_tr_b16 v[190:191], v8 offset:33280
s_waitcnt lgkmcnt(12)
v_mfma_f32_16x16x32_bf16 a[8:11], v[196:199], v[76:79], a[8:11]
v_mfma_f32_16x16x32_bf16 a[44:47], v[196:199], v[148:151], a[44:47]
s_waitcnt vmcnt(15)
s_barrier
v_subrev_u32 v8, 110592, v8
v_subrev_u32 v9, 110592, v9
v_subrev_u32 v10, 110592, v10
v_subrev_u32 v11, 110592, v11
ds_read_b64_tr_b16 v[192:193], v8 offset:0
ds_read_b64_tr_b16 v[194:195], v8 offset:512
s_waitcnt lgkmcnt(12)
v_mfma_f32_16x16x32_bf16 a[12:15], v[200:203], v[76:79], a[12:15]
v_mfma_f32_16x16x32_bf16 a[48:51], v[200:203], v[148:151], a[48:51]
ds_read_b64_tr_b16 v[196:197], v9 offset:0
ds_read_b64_tr_b16 v[198:199], v9 offset:512
s_waitcnt lgkmcnt(12)
v_mfma_f32_16x16x32_bf16 a[16:19], v[204:207], v[76:79], a[16:19]
v_mfma_f32_16x16x32_bf16 a[52:55], v[204:207], v[148:151], a[52:55]
ds_read_b64_tr_b16 v[200:201], v10 offset:0
ds_read_b64_tr_b16 v[202:203], v10 offset:512
s_waitcnt lgkmcnt(12)
v_mfma_f32_16x16x32_bf16 a[20:23], v[176:179], v[76:79], a[20:23]
v_mfma_f32_16x16x32_bf16 a[56:59], v[176:179], v[148:151], a[56:59]
ds_read_b64_tr_b16 v[204:205], v11 offset:0
ds_read_b64_tr_b16 v[206:207], v11 offset:512
s_waitcnt lgkmcnt(12)
v_mfma_f32_16x16x32_bf16 a[24:27], v[180:183], v[76:79], a[24:27]
v_mfma_f32_16x16x32_bf16 a[60:63], v[180:183], v[148:151], a[60:63]
ds_read_b64_tr_b16 v[176:177], v8 offset:12288
ds_read_b64_tr_b16 v[178:179], v8 offset:12800
s_waitcnt lgkmcnt(12)
v_mfma_f32_16x16x32_bf16 a[28:31], v[184:187], v[76:79], a[28:31]
v_mfma_f32_16x16x32_bf16 a[64:67], v[184:187], v[148:151], a[64:67]
ds_read_b64_tr_b16 v[180:181], v9 offset:12288
ds_read_b64_tr_b16 v[182:183], v9 offset:12800
s_waitcnt lgkmcnt(12)
v_mfma_f32_16x16x32_bf16 a[32:35], v[188:191], v[76:79], a[32:35]
v_mfma_f32_16x16x32_bf16 a[68:71], v[188:191], v[148:151], a[68:71]
ds_read_b64_tr_b16 v[184:185], v10 offset:12288
ds_read_b64_tr_b16 v[186:187], v10 offset:12800
s_waitcnt lgkmcnt(12)
v_mfma_f32_16x16x32_bf16 a[0:3], v[192:195], v[80:83], a[0:3]
s_add_u32 s78, s73, 16384
buffer_load_dwordx4 a[72:75], v27, s[16:19], s78 offen offset:2048
v_mfma_f32_16x16x32_bf16 a[36:39], v[192:195], v[152:155], a[36:39]
ds_read_b64_tr_b16 v[188:189], v11 offset:12288
ds_read_b64_tr_b16 v[190:191], v11 offset:12800
s_waitcnt lgkmcnt(12)
v_mfma_f32_16x16x32_bf16 a[4:7], v[196:199], v[80:83], a[4:7]
v_mfma_f32_16x16x32_bf16 a[40:43], v[196:199], v[152:155], a[40:43]
s_add_u32 s78, s73, 163840
buffer_load_dwordx4 a[144:147], v27, s[16:19], s78 offen offset:2048
ds_read_b64_tr_b16 v[192:193], v8 offset:24576
ds_read_b64_tr_b16 v[194:195], v8 offset:25088
s_waitcnt lgkmcnt(12)
v_mfma_f32_16x16x32_bf16 a[8:11], v[200:203], v[80:83], a[8:11]
v_mfma_f32_16x16x32_bf16 a[44:47], v[200:203], v[152:155], a[44:47]
ds_read_b64_tr_b16 v[196:197], v8 offset:4096
ds_read_b64_tr_b16 v[198:199], v8 offset:4608
s_waitcnt lgkmcnt(12)
v_mfma_f32_16x16x32_bf16 a[12:15], v[204:207], v[80:83], a[12:15]
s_add_u32 s78, s73, 16384
buffer_load_dwordx4 a[76:79], v27, s[16:19], s78 offen offset:3072
v_mfma_f32_16x16x32_bf16 a[48:51], v[204:207], v[152:155], a[48:51]
ds_read_b64_tr_b16 v[200:201], v9 offset:4096
ds_read_b64_tr_b16 v[202:203], v9 offset:4608
s_waitcnt lgkmcnt(12)
v_mfma_f32_16x16x32_bf16 a[16:19], v[176:179], v[80:83], a[16:19]
s_add_u32 s78, s73, 163840
buffer_load_dwordx4 a[148:151], v27, s[16:19], s78 offen offset:3072
v_mfma_f32_16x16x32_bf16 a[52:55], v[176:179], v[152:155], a[52:55]
ds_read_b64_tr_b16 v[204:205], v10 offset:4096
ds_read_b64_tr_b16 v[206:207], v10 offset:4608
s_waitcnt lgkmcnt(12)
v_mfma_f32_16x16x32_bf16 a[20:23], v[180:183], v[80:83], a[20:23]
v_mfma_f32_16x16x32_bf16 a[56:59], v[180:183], v[152:155], a[56:59]
s_add_u32 s78, s73, 20480
buffer_load_dwordx4 a[80:83], v27, s[16:19], s78 offen offset:0
ds_read_b64_tr_b16 v[176:177], v11 offset:4096
ds_read_b64_tr_b16 v[178:179], v11 offset:4608
s_waitcnt lgkmcnt(12)
v_mfma_f32_16x16x32_bf16 a[24:27], v[184:187], v[80:83], a[24:27]
v_mfma_f32_16x16x32_bf16 a[60:63], v[184:187], v[152:155], a[60:63]
ds_read_b64_tr_b16 v[180:181], v8 offset:16384
ds_read_b64_tr_b16 v[182:183], v8 offset:16896
s_waitcnt lgkmcnt(12)
v_mfma_f32_16x16x32_bf16 a[28:31], v[188:191], v[80:83], a[28:31]
s_add_u32 s78, s73, 167936
buffer_load_dwordx4 a[152:155], v27, s[16:19], s78 offen offset:0
v_mfma_f32_16x16x32_bf16 a[64:67], v[188:191], v[152:155], a[64:67]
ds_read_b64_tr_b16 v[184:185], v9 offset:16384
ds_read_b64_tr_b16 v[186:187], v9 offset:16896
s_waitcnt lgkmcnt(12)
v_mfma_f32_16x16x32_bf16 a[32:35], v[192:195], v[80:83], a[32:35]
s_add_u32 s57, s84, 663552
s_add_u32 m0, s56, 73728
s_nop 0
buffer_load_dwordx4 v16, s[12:15], s57 offen lds
v_mfma_f32_16x16x32_bf16 a[68:71], v[192:195], v[152:155], a[68:71]
ds_read_b64_tr_b16 v[188:189], v10 offset:16384
ds_read_b64_tr_b16 v[190:191], v10 offset:16896
s_waitcnt lgkmcnt(12)
v_mfma_f32_16x16x32_bf16 a[0:3], v[196:199], v[84:87], a[0:3]
v_mfma_f32_16x16x32_bf16 a[36:39], v[196:199], v[156:159], a[36:39]
s_add_u32 s57, s85, 663552
s_add_u32 m0, s56, 86016
s_nop 0
buffer_load_dwordx4 v16, s[12:15], s57 offen lds
ds_read_b64_tr_b16 v[192:193], v11 offset:16384
ds_read_b64_tr_b16 v[194:195], v11 offset:16896
s_waitcnt lgkmcnt(12)
v_mfma_f32_16x16x32_bf16 a[4:7], v[200:203], v[84:87], a[4:7]
v_mfma_f32_16x16x32_bf16 a[40:43], v[200:203], v[156:159], a[40:43]
ds_read_b64_tr_b16 v[196:197], v8 offset:28672
ds_read_b64_tr_b16 v[198:199], v8 offset:29184
s_waitcnt lgkmcnt(12)
v_mfma_f32_16x16x32_bf16 a[8:11], v[204:207], v[84:87], a[8:11]
s_add_u32 s57, s86, 663552
s_add_u32 m0, s56, 98304
s_nop 0
buffer_load_dwordx4 v16, s[12:15], s57 offen lds
v_mfma_f32_16x16x32_bf16 a[44:47], v[204:207], v[156:159], a[44:47]
ds_read_b64_tr_b16 v[200:201], v8 offset:8192
ds_read_b64_tr_b16 v[202:203], v8 offset:8704
s_waitcnt lgkmcnt(12)
v_mfma_f32_16x16x32_bf16 a[12:15], v[176:179], v[84:87], a[12:15]
s_add_u32 s57, s84, 672768
s_add_u32 m0, s56, 74752
s_nop 0
buffer_load_dwordx4 v17, s[12:15], s57 offen lds
v_mfma_f32_16x16x32_bf16 a[48:51], v[176:179], v[156:159], a[48:51]
ds_read_b64_tr_b16 v[204:205], v9 offset:8192
ds_read_b64_tr_b16 v[206:207], v9 offset:8704
s_waitcnt lgkmcnt(12)
v_mfma_f32_16x16x32_bf16 a[16:19], v[180:183], v[84:87], a[16:19]
v_mfma_f32_16x16x32_bf16 a[52:55], v[180:183], v[156:159], a[52:55]
s_add_u32 s57, s85, 672768
s_add_u32 m0, s56, 87040
s_nop 0
buffer_load_dwordx4 v17, s[12:15], s57 offen lds
ds_read_b64_tr_b16 v[176:177], v10 offset:8192
ds_read_b64_tr_b16 v[178:179], v10 offset:8704
s_waitcnt lgkmcnt(12)
v_mfma_f32_16x16x32_bf16 a[20:23], v[184:187], v[84:87], a[20:23]
v_mfma_f32_16x16x32_bf16 a[56:59], v[184:187], v[156:159], a[56:59]
ds_read_b64_tr_b16 v[180:181], v11 offset:8192
ds_read_b64_tr_b16 v[182:183], v11 offset:8704
s_waitcnt lgkmcnt(12)
v_mfma_f32_16x16x32_bf16 a[24:27], v[188:191], v[84:87], a[24:27]
s_add_u32 s57, s86, 672768
s_add_u32 m0, s56, 99328
s_nop 0
buffer_load_dwordx4 v17, s[12:15], s57 offen lds
v_mfma_f32_16x16x32_bf16 a[60:63], v[188:191], v[156:159], a[60:63]
ds_read_b64_tr_b16 v[184:185], v8 offset:20480
ds_read_b64_tr_b16 v[186:187], v8 offset:20992
s_waitcnt lgkmcnt(12)
v_mfma_f32_16x16x32_bf16 a[28:31], v[192:195], v[84:87], a[28:31]
s_add_u32 s57, s84, 681984
s_add_u32 m0, s56, 75776
s_nop 0
buffer_load_dwordx4 v16, s[12:15], s57 offen lds
v_mfma_f32_16x16x32_bf16 a[64:67], v[192:195], v[156:159], a[64:67]
ds_read_b64_tr_b16 v[188:189], v9 offset:20480
ds_read_b64_tr_b16 v[190:191], v9 offset:20992
s_waitcnt lgkmcnt(12)
v_mfma_f32_16x16x32_bf16 a[32:35], v[196:199], v[84:87], a[32:35]
v_mfma_f32_16x16x32_bf16 a[68:71], v[196:199], v[156:159], a[68:71]
s_add_u32 s57, s85, 681984
s_add_u32 m0, s56, 88064
s_nop 0
buffer_load_dwordx4 v16, s[12:15], s57 offen lds
ds_read_b64_tr_b16 v[192:193], v10 offset:20480
ds_read_b64_tr_b16 v[194:195], v10 offset:20992
s_waitcnt lgkmcnt(12)
v_mfma_f32_16x16x32_bf16 a[0:3], v[200:203], v[88:91], a[0:3]
v_mfma_f32_16x16x32_bf16 a[36:39], v[200:203], v[160:163], a[36:39]
ds_read_b64_tr_b16 v[196:197], v11 offset:20480
ds_read_b64_tr_b16 v[198:199], v11 offset:20992
s_waitcnt lgkmcnt(12)
v_mfma_f32_16x16x32_bf16 a[4:7], v[204:207], v[88:91], a[4:7]
s_add_u32 s57, s86, 681984
s_add_u32 m0, s56, 100352
s_nop 0
buffer_load_dwordx4 v16, s[12:15], s57 offen lds
v_mfma_f32_16x16x32_bf16 a[40:43], v[204:207], v[160:163], a[40:43]
ds_read_b64_tr_b16 v[200:201], v8 offset:32768
ds_read_b64_tr_b16 v[202:203], v8 offset:33280
s_waitcnt lgkmcnt(12)
v_mfma_f32_16x16x32_bf16 a[8:11], v[176:179], v[88:91], a[8:11]
v_mfma_f32_16x16x32_bf16 a[44:47], v[176:179], v[160:163], a[44:47]
s_waitcnt vmcnt(15)
s_barrier
v_add_u32 v8, 36864, v8
v_add_u32 v9, 36864, v9
v_add_u32 v10, 36864, v10
v_add_u32 v11, 36864, v11
ds_read_b64_tr_b16 v[204:205], v8 offset:0
ds_read_b64_tr_b16 v[206:207], v8 offset:512
s_waitcnt lgkmcnt(12)
v_mfma_f32_16x16x32_bf16 a[12:15], v[180:183], v[88:91], a[12:15]
v_mfma_f32_16x16x32_bf16 a[48:51], v[180:183], v[160:163], a[48:51]
ds_read_b64_tr_b16 v[176:177], v9 offset:0
ds_read_b64_tr_b16 v[178:179], v9 offset:512
s_waitcnt lgkmcnt(12)
v_mfma_f32_16x16x32_bf16 a[16:19], v[184:187], v[88:91], a[16:19]
v_mfma_f32_16x16x32_bf16 a[52:55], v[184:187], v[160:163], a[52:55]
ds_read_b64_tr_b16 v[180:181], v10 offset:0
ds_read_b64_tr_b16 v[182:183], v10 offset:512
s_waitcnt lgkmcnt(12)
v_mfma_f32_16x16x32_bf16 a[20:23], v[188:191], v[88:91], a[20:23]
v_mfma_f32_16x16x32_bf16 a[56:59], v[188:191], v[160:163], a[56:59]
ds_read_b64_tr_b16 v[184:185], v11 offset:0
ds_read_b64_tr_b16 v[186:187], v11 offset:512
s_waitcnt lgkmcnt(12)
v_mfma_f32_16x16x32_bf16 a[24:27], v[192:195], v[88:91], a[24:27]
v_mfma_f32_16x16x32_bf16 a[60:63], v[192:195], v[160:163], a[60:63]
ds_read_b64_tr_b16 v[188:189], v8 offset:12288
ds_read_b64_tr_b16 v[190:191], v8 offset:12800
s_waitcnt lgkmcnt(12)
v_mfma_f32_16x16x32_bf16 a[28:31], v[196:199], v[88:91], a[28:31]
v_mfma_f32_16x16x32_bf16 a[64:67], v[196:199], v[160:163], a[64:67]
ds_read_b64_tr_b16 v[192:193], v9 offset:12288
ds_read_b64_tr_b16 v[194:195], v9 offset:12800
s_waitcnt lgkmcnt(12)
v_mfma_f32_16x16x32_bf16 a[32:35], v[200:203], v[88:91], a[32:35]
v_mfma_f32_16x16x32_bf16 a[68:71], v[200:203], v[160:163], a[68:71]
ds_read_b64_tr_b16 v[196:197], v10 offset:12288
ds_read_b64_tr_b16 v[198:199], v10 offset:12800
s_waitcnt lgkmcnt(12)
v_mfma_f32_16x16x32_bf16 a[0:3], v[204:207], v[92:95], a[0:3]
s_add_u32 s78, s73, 20480
buffer_load_dwordx4 a[84:87], v27, s[16:19], s78 offen offset:1024
v_mfma_f32_16x16x32_bf16 a[36:39], v[204:207], v[164:167], a[36:39]
ds_read_b64_tr_b16 v[200:201], v11 offset:12288
ds_read_b64_tr_b16 v[202:203], v11 offset:12800
s_waitcnt lgkmcnt(12)
v_mfma_f32_16x16x32_bf16 a[4:7], v[176:179], v[92:95], a[4:7]
v_mfma_f32_16x16x32_bf16 a[40:43], v[176:179], v[164:167], a[40:43]
s_add_u32 s78, s73, 167936
buffer_load_dwordx4 a[156:159], v27, s[16:19], s78 offen offset:1024
ds_read_b64_tr_b16 v[204:205], v8 offset:24576
ds_read_b64_tr_b16 v[206:207], v8 offset:25088
s_waitcnt lgkmcnt(12)
v_mfma_f32_16x16x32_bf16 a[8:11], v[180:183], v[92:95], a[8:11]
v_mfma_f32_16x16x32_bf16 a[44:47], v[180:183], v[164:167], a[44:47]
ds_read_b64_tr_b16 v[176:177], v8 offset:4096
ds_read_b64_tr_b16 v[178:179], v8 offset:4608
s_waitcnt lgkmcnt(12)
v_mfma_f32_16x16x32_bf16 a[12:15], v[184:187], v[92:95], a[12:15]
s_add_u32 s78, s73, 20480
buffer_load_dwordx4 a[88:91], v27, s[16:19], s78 offen offset:2048
v_mfma_f32_16x16x32_bf16 a[48:51], v[184:187], v[164:167], a[48:51]
ds_read_b64_tr_b16 v[180:181], v9 offset:4096
ds_read_b64_tr_b16 v[182:183], v9 offset:4608
s_waitcnt lgkmcnt(12)
v_mfma_f32_16x16x32_bf16 a[16:19], v[188:191], v[92:95], a[16:19]
s_add_u32 s78, s73, 167936
buffer_load_dwordx4 a[160:163], v27, s[16:19], s78 offen offset:2048
v_mfma_f32_16x16x32_bf16 a[52:55], v[188:191], v[164:167], a[52:55]
ds_read_b64_tr_b16 v[184:185], v10 offset:4096
ds_read_b64_tr_b16 v[186:187], v10 offset:4608
s_waitcnt lgkmcnt(12)
v_mfma_f32_16x16x32_bf16 a[20:23], v[192:195], v[92:95], a[20:23]
v_mfma_f32_16x16x32_bf16 a[56:59], v[192:195], v[164:167], a[56:59]
s_add_u32 s78, s73, 20480
buffer_load_dwordx4 a[92:95], v27, s[16:19], s78 offen offset:3072
ds_read_b64_tr_b16 v[188:189], v11 offset:4096
ds_read_b64_tr_b16 v[190:191], v11 offset:4608
s_waitcnt lgkmcnt(12)
v_mfma_f32_16x16x32_bf16 a[24:27], v[196:199], v[92:95], a[24:27]
v_mfma_f32_16x16x32_bf16 a[60:63], v[196:199], v[164:167], a[60:63]
ds_read_b64_tr_b16 v[192:193], v8 offset:16384
ds_read_b64_tr_b16 v[194:195], v8 offset:16896
s_waitcnt lgkmcnt(12)
v_mfma_f32_16x16x32_bf16 a[28:31], v[200:203], v[92:95], a[28:31]
s_add_u32 s78, s73, 167936
buffer_load_dwordx4 a[164:167], v27, s[16:19], s78 offen offset:3072
v_mfma_f32_16x16x32_bf16 a[64:67], v[200:203], v[164:167], a[64:67]
ds_read_b64_tr_b16 v[196:197], v9 offset:16384
ds_read_b64_tr_b16 v[198:199], v9 offset:16896
s_waitcnt lgkmcnt(12)
v_mfma_f32_16x16x32_bf16 a[32:35], v[204:207], v[92:95], a[32:35]
s_add_u32 s57, s84, 774144
s_add_u32 m0, s56, 110592
s_nop 0
buffer_load_dwordx4 v16, s[12:15], s57 offen lds
v_mfma_f32_16x16x32_bf16 a[68:71], v[204:207], v[164:167], a[68:71]
ds_read_b64_tr_b16 v[200:201], v10 offset:16384
ds_read_b64_tr_b16 v[202:203], v10 offset:16896
s_waitcnt lgkmcnt(12)
v_mfma_f32_16x16x32_bf16 a[0:3], v[176:179], v[96:99], a[0:3]
v_mfma_f32_16x16x32_bf16 a[36:39], v[176:179], v[168:171], a[36:39]
s_add_u32 s57, s85, 774144
s_add_u32 m0, s56, 122880
s_nop 0
buffer_load_dwordx4 v16, s[12:15], s57 offen lds
ds_read_b64_tr_b16 v[204:205], v11 offset:16384
ds_read_b64_tr_b16 v[206:207], v11 offset:16896
s_waitcnt lgkmcnt(12)
v_mfma_f32_16x16x32_bf16 a[4:7], v[180:183], v[96:99], a[4:7]
v_mfma_f32_16x16x32_bf16 a[40:43], v[180:183], v[168:171], a[40:43]
ds_read_b64_tr_b16 v[176:177], v8 offset:28672
ds_read_b64_tr_b16 v[178:179], v8 offset:29184
s_waitcnt lgkmcnt(12)
v_mfma_f32_16x16x32_bf16 a[8:11], v[184:187], v[96:99], a[8:11]
s_add_u32 s57, s86, 774144
s_add_u32 m0, s56, 135168
s_nop 0
buffer_load_dwordx4 v16, s[12:15], s57 offen lds
v_mfma_f32_16x16x32_bf16 a[44:47], v[184:187], v[168:171], a[44:47]
ds_read_b64_tr_b16 v[180:181], v8 offset:8192
ds_read_b64_tr_b16 v[182:183], v8 offset:8704
s_waitcnt lgkmcnt(12)
v_mfma_f32_16x16x32_bf16 a[12:15], v[188:191], v[96:99], a[12:15]
s_add_u32 s57, s84, 783360
s_add_u32 m0, s56, 111616
s_nop 0
buffer_load_dwordx4 v17, s[12:15], s57 offen lds
v_mfma_f32_16x16x32_bf16 a[48:51], v[188:191], v[168:171], a[48:51]
ds_read_b64_tr_b16 v[184:185], v9 offset:8192
ds_read_b64_tr_b16 v[186:187], v9 offset:8704
s_waitcnt lgkmcnt(12)
v_mfma_f32_16x16x32_bf16 a[16:19], v[192:195], v[96:99], a[16:19]
v_mfma_f32_16x16x32_bf16 a[52:55], v[192:195], v[168:171], a[52:55]
s_add_u32 s57, s85, 783360
s_add_u32 m0, s56, 123904
s_nop 0
buffer_load_dwordx4 v17, s[12:15], s57 offen lds
ds_read_b64_tr_b16 v[188:189], v10 offset:8192
ds_read_b64_tr_b16 v[190:191], v10 offset:8704
s_waitcnt lgkmcnt(12)
v_mfma_f32_16x16x32_bf16 a[20:23], v[196:199], v[96:99], a[20:23]
v_mfma_f32_16x16x32_bf16 a[56:59], v[196:199], v[168:171], a[56:59]
ds_read_b64_tr_b16 v[192:193], v11 offset:8192
ds_read_b64_tr_b16 v[194:195], v11 offset:8704
s_waitcnt lgkmcnt(12)
v_mfma_f32_16x16x32_bf16 a[24:27], v[200:203], v[96:99], a[24:27]
s_add_u32 s57, s86, 783360
s_add_u32 m0, s56, 136192
s_nop 0
buffer_load_dwordx4 v17, s[12:15], s57 offen lds
v_mfma_f32_16x16x32_bf16 a[60:63], v[200:203], v[168:171], a[60:63]
ds_read_b64_tr_b16 v[196:197], v8 offset:20480
ds_read_b64_tr_b16 v[198:199], v8 offset:20992
s_waitcnt lgkmcnt(12)
v_mfma_f32_16x16x32_bf16 a[28:31], v[204:207], v[96:99], a[28:31]
s_add_u32 s57, s84, 792576
s_add_u32 m0, s56, 112640
s_nop 0
buffer_load_dwordx4 v16, s[12:15], s57 offen lds
v_mfma_f32_16x16x32_bf16 a[64:67], v[204:207], v[168:171], a[64:67]
ds_read_b64_tr_b16 v[200:201], v9 offset:20480
ds_read_b64_tr_b16 v[202:203], v9 offset:20992
s_waitcnt lgkmcnt(12)
v_mfma_f32_16x16x32_bf16 a[32:35], v[176:179], v[96:99], a[32:35]
v_mfma_f32_16x16x32_bf16 a[68:71], v[176:179], v[168:171], a[68:71]
s_add_u32 s57, s85, 792576
s_add_u32 m0, s56, 124928
s_nop 0
buffer_load_dwordx4 v16, s[12:15], s57 offen lds
ds_read_b64_tr_b16 v[204:205], v10 offset:20480
ds_read_b64_tr_b16 v[206:207], v10 offset:20992
s_waitcnt lgkmcnt(12)
v_mfma_f32_16x16x32_bf16 a[0:3], v[180:183], v[100:103], a[0:3]
v_mfma_f32_16x16x32_bf16 a[36:39], v[180:183], v[172:175], a[36:39]
ds_read_b64_tr_b16 v[176:177], v11 offset:20480
ds_read_b64_tr_b16 v[178:179], v11 offset:20992
s_waitcnt lgkmcnt(12)
v_mfma_f32_16x16x32_bf16 a[4:7], v[184:187], v[100:103], a[4:7]
s_add_u32 s57, s86, 792576
s_add_u32 m0, s56, 137216
s_nop 0
buffer_load_dwordx4 v16, s[12:15], s57 offen lds
v_mfma_f32_16x16x32_bf16 a[40:43], v[184:187], v[172:175], a[40:43]
ds_read_b64_tr_b16 v[180:181], v8 offset:32768
ds_read_b64_tr_b16 v[182:183], v8 offset:33280
s_waitcnt lgkmcnt(12)
v_mfma_f32_16x16x32_bf16 a[8:11], v[188:191], v[100:103], a[8:11]
v_mfma_f32_16x16x32_bf16 a[44:47], v[188:191], v[172:175], a[44:47]
s_waitcnt vmcnt(15)
s_barrier
v_add_u32 v8, 36864, v8
v_add_u32 v9, 36864, v9
v_add_u32 v10, 36864, v10
v_add_u32 v11, 36864, v11
ds_read_b64_tr_b16 v[184:185], v8 offset:0
ds_read_b64_tr_b16 v[186:187], v8 offset:512
s_waitcnt lgkmcnt(12)
v_mfma_f32_16x16x32_bf16 a[12:15], v[192:195], v[100:103], a[12:15]
v_mfma_f32_16x16x32_bf16 a[48:51], v[192:195], v[172:175], a[48:51]
ds_read_b64_tr_b16 v[188:189], v9 offset:0
ds_read_b64_tr_b16 v[190:191], v9 offset:512
s_waitcnt lgkmcnt(12)
v_mfma_f32_16x16x32_bf16 a[16:19], v[196:199], v[100:103], a[16:19]
v_mfma_f32_16x16x32_bf16 a[52:55], v[196:199], v[172:175], a[52:55]
ds_read_b64_tr_b16 v[192:193], v10 offset:0
ds_read_b64_tr_b16 v[194:195], v10 offset:512
s_waitcnt lgkmcnt(12)
v_mfma_f32_16x16x32_bf16 a[20:23], v[200:203], v[100:103], a[20:23]
v_mfma_f32_16x16x32_bf16 a[56:59], v[200:203], v[172:175], a[56:59]
ds_read_b64_tr_b16 v[196:197], v11 offset:0
ds_read_b64_tr_b16 v[198:199], v11 offset:512
s_waitcnt lgkmcnt(12)
v_mfma_f32_16x16x32_bf16 a[24:27], v[204:207], v[100:103], a[24:27]
v_mfma_f32_16x16x32_bf16 a[60:63], v[204:207], v[172:175], a[60:63]
ds_read_b64_tr_b16 v[200:201], v8 offset:12288
ds_read_b64_tr_b16 v[202:203], v8 offset:12800
s_waitcnt lgkmcnt(12)
v_mfma_f32_16x16x32_bf16 a[28:31], v[176:179], v[100:103], a[28:31]
v_mfma_f32_16x16x32_bf16 a[64:67], v[176:179], v[172:175], a[64:67]
ds_read_b64_tr_b16 v[204:205], v9 offset:12288
ds_read_b64_tr_b16 v[206:207], v9 offset:12800
s_waitcnt lgkmcnt(12)
v_mfma_f32_16x16x32_bf16 a[32:35], v[180:183], v[100:103], a[32:35]
v_mfma_f32_16x16x32_bf16 a[68:71], v[180:183], v[172:175], a[68:71]
ds_read_b64_tr_b16 v[176:177], v10 offset:12288
ds_read_b64_tr_b16 v[178:179], v10 offset:12800
s_waitcnt lgkmcnt(12)
v_mfma_f32_16x16x32_bf16 a[0:3], v[184:187], a[72:75], a[0:3]
s_add_u32 s78, s73, 24576
buffer_load_dwordx4 a[96:99], v27, s[16:19], s78 offen offset:0
v_mfma_f32_16x16x32_bf16 a[36:39], v[184:187], a[144:147], a[36:39]
ds_read_b64_tr_b16 v[180:181], v11 offset:12288
ds_read_b64_tr_b16 v[182:183], v11 offset:12800
s_waitcnt lgkmcnt(12)
v_mfma_f32_16x16x32_bf16 a[4:7], v[188:191], a[72:75], a[4:7]
v_mfma_f32_16x16x32_bf16 a[40:43], v[188:191], a[144:147], a[40:43]
s_add_u32 s78, s73, 172032
buffer_load_dwordx4 a[168:171], v27, s[16:19], s78 offen offset:0
ds_read_b64_tr_b16 v[184:185], v8 offset:24576
ds_read_b64_tr_b16 v[186:187], v8 offset:25088
s_waitcnt lgkmcnt(12)
v_mfma_f32_16x16x32_bf16 a[8:11], v[192:195], a[72:75], a[8:11]
v_mfma_f32_16x16x32_bf16 a[44:47], v[192:195], a[144:147], a[44:47]
ds_read_b64_tr_b16 v[188:189], v8 offset:4096
ds_read_b64_tr_b16 v[190:191], v8 offset:4608
s_waitcnt lgkmcnt(12)
v_mfma_f32_16x16x32_bf16 a[12:15], v[196:199], a[72:75], a[12:15]
s_add_u32 s78, s73, 24576
buffer_load_dwordx4 a[100:103], v27, s[16:19], s78 offen offset:1024
v_mfma_f32_16x16x32_bf16 a[48:51], v[196:199], a[144:147], a[48:51]
ds_read_b64_tr_b16 v[192:193], v9 offset:4096
ds_read_b64_tr_b16 v[194:195], v9 offset:4608
s_waitcnt lgkmcnt(12)
v_mfma_f32_16x16x32_bf16 a[16:19], v[200:203], a[72:75], a[16:19]
s_add_u32 s78, s73, 172032
buffer_load_dwordx4 a[172:175], v27, s[16:19], s78 offen offset:1024
v_mfma_f32_16x16x32_bf16 a[52:55], v[200:203], a[144:147], a[52:55]
ds_read_b64_tr_b16 v[196:197], v10 offset:4096
ds_read_b64_tr_b16 v[198:199], v10 offset:4608
s_waitcnt lgkmcnt(12)
v_mfma_f32_16x16x32_bf16 a[20:23], v[204:207], a[72:75], a[20:23]
v_mfma_f32_16x16x32_bf16 a[56:59], v[204:207], a[144:147], a[56:59]
s_add_u32 s78, s73, 24576
buffer_load_dwordx4 a[104:107], v27, s[16:19], s78 offen offset:2048
ds_read_b64_tr_b16 v[200:201], v11 offset:4096
ds_read_b64_tr_b16 v[202:203], v11 offset:4608
s_waitcnt lgkmcnt(12)
v_mfma_f32_16x16x32_bf16 a[24:27], v[176:179], a[72:75], a[24:27]
v_mfma_f32_16x16x32_bf16 a[60:63], v[176:179], a[144:147], a[60:63]
ds_read_b64_tr_b16 v[204:205], v8 offset:16384
ds_read_b64_tr_b16 v[206:207], v8 offset:16896
s_waitcnt lgkmcnt(12)
v_mfma_f32_16x16x32_bf16 a[28:31], v[180:183], a[72:75], a[28:31]
s_add_u32 s78, s73, 172032
buffer_load_dwordx4 a[176:179], v27, s[16:19], s78 offen offset:2048
v_mfma_f32_16x16x32_bf16 a[64:67], v[180:183], a[144:147], a[64:67]
ds_read_b64_tr_b16 v[176:177], v9 offset:16384
ds_read_b64_tr_b16 v[178:179], v9 offset:16896
s_waitcnt lgkmcnt(12)
v_mfma_f32_16x16x32_bf16 a[32:35], v[184:187], a[72:75], a[32:35]
s_add_u32 s57, s84, 884736
s_add_u32 m0, s56, 0
s_nop 0
buffer_load_dwordx4 v16, s[12:15], s57 offen lds
v_mfma_f32_16x16x32_bf16 a[68:71], v[184:187], a[144:147], a[68:71]
ds_read_b64_tr_b16 v[180:181], v10 offset:16384
ds_read_b64_tr_b16 v[182:183], v10 offset:16896
s_waitcnt lgkmcnt(12)
v_mfma_f32_16x16x32_bf16 a[0:3], v[188:191], a[76:79], a[0:3]
v_mfma_f32_16x16x32_bf16 a[36:39], v[188:191], a[148:151], a[36:39]
s_add_u32 s57, s85, 884736
s_add_u32 m0, s56, 12288
s_nop 0
buffer_load_dwordx4 v16, s[12:15], s57 offen lds
ds_read_b64_tr_b16 v[184:185], v11 offset:16384
ds_read_b64_tr_b16 v[186:187], v11 offset:16896
s_waitcnt lgkmcnt(12)
v_mfma_f32_16x16x32_bf16 a[4:7], v[192:195], a[76:79], a[4:7]
v_mfma_f32_16x16x32_bf16 a[40:43], v[192:195], a[148:151], a[40:43]
ds_read_b64_tr_b16 v[188:189], v8 offset:28672
ds_read_b64_tr_b16 v[190:191], v8 offset:29184
s_waitcnt lgkmcnt(12)
v_mfma_f32_16x16x32_bf16 a[8:11], v[196:199], a[76:79], a[8:11]
s_add_u32 s57, s86, 884736
s_add_u32 m0, s56, 24576
s_nop 0
buffer_load_dwordx4 v16, s[12:15], s57 offen lds
v_mfma_f32_16x16x32_bf16 a[44:47], v[196:199], a[148:151], a[44:47]
ds_read_b64_tr_b16 v[192:193], v8 offset:8192
ds_read_b64_tr_b16 v[194:195], v8 offset:8704
s_waitcnt lgkmcnt(12)
v_mfma_f32_16x16x32_bf16 a[12:15], v[200:203], a[76:79], a[12:15]
s_add_u32 s57, s84, 893952
s_add_u32 m0, s56, 1024
s_nop 0
buffer_load_dwordx4 v17, s[12:15], s57 offen lds
v_mfma_f32_16x16x32_bf16 a[48:51], v[200:203], a[148:151], a[48:51]
ds_read_b64_tr_b16 v[196:197], v9 offset:8192
ds_read_b64_tr_b16 v[198:199], v9 offset:8704
s_waitcnt lgkmcnt(12)
v_mfma_f32_16x16x32_bf16 a[16:19], v[204:207], a[76:79], a[16:19]
v_mfma_f32_16x16x32_bf16 a[52:55], v[204:207], a[148:151], a[52:55]
s_add_u32 s57, s85, 893952
s_add_u32 m0, s56, 13312
s_nop 0
buffer_load_dwordx4 v17, s[12:15], s57 offen lds
ds_read_b64_tr_b16 v[200:201], v10 offset:8192
ds_read_b64_tr_b16 v[202:203], v10 offset:8704
s_waitcnt lgkmcnt(12)
v_mfma_f32_16x16x32_bf16 a[20:23], v[176:179], a[76:79], a[20:23]
v_mfma_f32_16x16x32_bf16 a[56:59], v[176:179], a[148:151], a[56:59]
ds_read_b64_tr_b16 v[204:205], v11 offset:8192
ds_read_b64_tr_b16 v[206:207], v11 offset:8704
s_waitcnt lgkmcnt(12)
v_mfma_f32_16x16x32_bf16 a[24:27], v[180:183], a[76:79], a[24:27]
s_add_u32 s57, s86, 893952
s_add_u32 m0, s56, 25600
s_nop 0
buffer_load_dwordx4 v17, s[12:15], s57 offen lds
v_mfma_f32_16x16x32_bf16 a[60:63], v[180:183], a[148:151], a[60:63]
ds_read_b64_tr_b16 v[176:177], v8 offset:20480
ds_read_b64_tr_b16 v[178:179], v8 offset:20992
s_waitcnt lgkmcnt(12)
v_mfma_f32_16x16x32_bf16 a[28:31], v[184:187], a[76:79], a[28:31]
s_add_u32 s57, s84, 903168
s_add_u32 m0, s56, 2048
s_nop 0
buffer_load_dwordx4 v16, s[12:15], s57 offen lds
v_mfma_f32_16x16x32_bf16 a[64:67], v[184:187], a[148:151], a[64:67]
ds_read_b64_tr_b16 v[180:181], v9 offset:20480
ds_read_b64_tr_b16 v[182:183], v9 offset:20992
s_waitcnt lgkmcnt(12)
v_mfma_f32_16x16x32_bf16 a[32:35], v[188:191], a[76:79], a[32:35]
v_mfma_f32_16x16x32_bf16 a[68:71], v[188:191], a[148:151], a[68:71]
s_add_u32 s57, s85, 903168
s_add_u32 m0, s56, 14336
s_nop 0
buffer_load_dwordx4 v16, s[12:15], s57 offen lds
ds_read_b64_tr_b16 v[184:185], v10 offset:20480
ds_read_b64_tr_b16 v[186:187], v10 offset:20992
s_waitcnt lgkmcnt(12)
v_mfma_f32_16x16x32_bf16 a[0:3], v[192:195], a[80:83], a[0:3]
v_mfma_f32_16x16x32_bf16 a[36:39], v[192:195], a[152:155], a[36:39]
ds_read_b64_tr_b16 v[188:189], v11 offset:20480
ds_read_b64_tr_b16 v[190:191], v11 offset:20992
s_waitcnt lgkmcnt(12)
v_mfma_f32_16x16x32_bf16 a[4:7], v[196:199], a[80:83], a[4:7]
s_add_u32 s57, s86, 903168
s_add_u32 m0, s56, 26624
s_nop 0
buffer_load_dwordx4 v16, s[12:15], s57 offen lds
v_mfma_f32_16x16x32_bf16 a[40:43], v[196:199], a[152:155], a[40:43]
ds_read_b64_tr_b16 v[192:193], v8 offset:32768
ds_read_b64_tr_b16 v[194:195], v8 offset:33280
s_waitcnt lgkmcnt(12)
v_mfma_f32_16x16x32_bf16 a[8:11], v[200:203], a[80:83], a[8:11]
v_mfma_f32_16x16x32_bf16 a[44:47], v[200:203], a[152:155], a[44:47]
s_waitcnt vmcnt(15)
s_barrier
v_add_u32 v8, 36864, v8
v_add_u32 v9, 36864, v9
v_add_u32 v10, 36864, v10
v_add_u32 v11, 36864, v11
ds_read_b64_tr_b16 v[196:197], v8 offset:0
ds_read_b64_tr_b16 v[198:199], v8 offset:512
s_waitcnt lgkmcnt(12)
v_mfma_f32_16x16x32_bf16 a[12:15], v[204:207], a[80:83], a[12:15]
v_mfma_f32_16x16x32_bf16 a[48:51], v[204:207], a[152:155], a[48:51]
ds_read_b64_tr_b16 v[200:201], v9 offset:0
ds_read_b64_tr_b16 v[202:203], v9 offset:512
s_waitcnt lgkmcnt(12)
v_mfma_f32_16x16x32_bf16 a[16:19], v[176:179], a[80:83], a[16:19]
v_mfma_f32_16x16x32_bf16 a[52:55], v[176:179], a[152:155], a[52:55]
ds_read_b64_tr_b16 v[204:205], v10 offset:0
ds_read_b64_tr_b16 v[206:207], v10 offset:512
s_waitcnt lgkmcnt(12)
v_mfma_f32_16x16x32_bf16 a[20:23], v[180:183], a[80:83], a[20:23]
v_mfma_f32_16x16x32_bf16 a[56:59], v[180:183], a[152:155], a[56:59]
ds_read_b64_tr_b16 v[176:177], v11 offset:0
ds_read_b64_tr_b16 v[178:179], v11 offset:512
s_waitcnt lgkmcnt(12)
v_mfma_f32_16x16x32_bf16 a[24:27], v[184:187], a[80:83], a[24:27]
v_mfma_f32_16x16x32_bf16 a[60:63], v[184:187], a[152:155], a[60:63]
ds_read_b64_tr_b16 v[180:181], v8 offset:12288
ds_read_b64_tr_b16 v[182:183], v8 offset:12800
s_waitcnt lgkmcnt(12)
v_mfma_f32_16x16x32_bf16 a[28:31], v[188:191], a[80:83], a[28:31]
v_mfma_f32_16x16x32_bf16 a[64:67], v[188:191], a[152:155], a[64:67]
ds_read_b64_tr_b16 v[184:185], v9 offset:12288
ds_read_b64_tr_b16 v[186:187], v9 offset:12800
s_waitcnt lgkmcnt(12)
v_mfma_f32_16x16x32_bf16 a[32:35], v[192:195], a[80:83], a[32:35]
v_mfma_f32_16x16x32_bf16 a[68:71], v[192:195], a[152:155], a[68:71]
ds_read_b64_tr_b16 v[188:189], v10 offset:12288
ds_read_b64_tr_b16 v[190:191], v10 offset:12800
s_waitcnt lgkmcnt(12)
v_mfma_f32_16x16x32_bf16 a[0:3], v[196:199], a[84:87], a[0:3]
s_add_u32 s78, s73, 24576
buffer_load_dwordx4 a[108:111], v27, s[16:19], s78 offen offset:3072
v_mfma_f32_16x16x32_bf16 a[36:39], v[196:199], a[156:159], a[36:39]
ds_read_b64_tr_b16 v[192:193], v11 offset:12288
ds_read_b64_tr_b16 v[194:195], v11 offset:12800
s_waitcnt lgkmcnt(12)
v_mfma_f32_16x16x32_bf16 a[4:7], v[200:203], a[84:87], a[4:7]
v_mfma_f32_16x16x32_bf16 a[40:43], v[200:203], a[156:159], a[40:43]
s_add_u32 s78, s73, 172032
buffer_load_dwordx4 a[180:183], v27, s[16:19], s78 offen offset:3072
ds_read_b64_tr_b16 v[196:197], v8 offset:24576
ds_read_b64_tr_b16 v[198:199], v8 offset:25088
s_waitcnt lgkmcnt(12)
v_mfma_f32_16x16x32_bf16 a[8:11], v[204:207], a[84:87], a[8:11]
v_mfma_f32_16x16x32_bf16 a[44:47], v[204:207], a[156:159], a[44:47]
ds_read_b64_tr_b16 v[200:201], v8 offset:4096
ds_read_b64_tr_b16 v[202:203], v8 offset:4608
s_waitcnt lgkmcnt(12)
v_mfma_f32_16x16x32_bf16 a[12:15], v[176:179], a[84:87], a[12:15]
s_add_u32 s78, s73, 28672
buffer_load_dwordx4 a[112:115], v27, s[16:19], s78 offen offset:0
v_mfma_f32_16x16x32_bf16 a[48:51], v[176:179], a[156:159], a[48:51]
ds_read_b64_tr_b16 v[204:205], v9 offset:4096
ds_read_b64_tr_b16 v[206:207], v9 offset:4608
s_waitcnt lgkmcnt(12)
v_mfma_f32_16x16x32_bf16 a[16:19], v[180:183], a[84:87], a[16:19]
s_add_u32 s78, s73, 176128
buffer_load_dwordx4 a[184:187], v27, s[16:19], s78 offen offset:0
v_mfma_f32_16x16x32_bf16 a[52:55], v[180:183], a[156:159], a[52:55]
ds_read_b64_tr_b16 v[176:177], v10 offset:4096
ds_read_b64_tr_b16 v[178:179], v10 offset:4608
s_waitcnt lgkmcnt(12)
v_mfma_f32_16x16x32_bf16 a[20:23], v[184:187], a[84:87], a[20:23]
v_mfma_f32_16x16x32_bf16 a[56:59], v[184:187], a[156:159], a[56:59]
s_add_u32 s78, s73, 28672
buffer_load_dwordx4 a[116:119], v27, s[16:19], s78 offen offset:1024
ds_read_b64_tr_b16 v[180:181], v11 offset:4096
ds_read_b64_tr_b16 v[182:183], v11 offset:4608
s_waitcnt lgkmcnt(12)
v_mfma_f32_16x16x32_bf16 a[24:27], v[188:191], a[84:87], a[24:27]
v_mfma_f32_16x16x32_bf16 a[60:63], v[188:191], a[156:159], a[60:63]
ds_read_b64_tr_b16 v[184:185], v8 offset:16384
ds_read_b64_tr_b16 v[186:187], v8 offset:16896
s_waitcnt lgkmcnt(12)
v_mfma_f32_16x16x32_bf16 a[28:31], v[192:195], a[84:87], a[28:31]
s_add_u32 s78, s73, 176128
buffer_load_dwordx4 a[188:191], v27, s[16:19], s78 offen offset:1024
v_mfma_f32_16x16x32_bf16 a[64:67], v[192:195], a[156:159], a[64:67]
ds_read_b64_tr_b16 v[188:189], v9 offset:16384
ds_read_b64_tr_b16 v[190:191], v9 offset:16896
s_waitcnt lgkmcnt(12)
v_mfma_f32_16x16x32_bf16 a[32:35], v[196:199], a[84:87], a[32:35]
s_add_u32 s57, s84, 995328
s_add_u32 m0, s56, 36864
s_nop 0
buffer_load_dwordx4 v16, s[12:15], s57 offen lds
v_mfma_f32_16x16x32_bf16 a[68:71], v[196:199], a[156:159], a[68:71]
ds_read_b64_tr_b16 v[192:193], v10 offset:16384
ds_read_b64_tr_b16 v[194:195], v10 offset:16896
s_waitcnt lgkmcnt(12)
v_mfma_f32_16x16x32_bf16 a[0:3], v[200:203], a[88:91], a[0:3]
v_mfma_f32_16x16x32_bf16 a[36:39], v[200:203], a[160:163], a[36:39]
s_add_u32 s57, s85, 995328
s_add_u32 m0, s56, 49152
s_nop 0
buffer_load_dwordx4 v16, s[12:15], s57 offen lds
ds_read_b64_tr_b16 v[196:197], v11 offset:16384
ds_read_b64_tr_b16 v[198:199], v11 offset:16896
s_waitcnt lgkmcnt(12)
v_mfma_f32_16x16x32_bf16 a[4:7], v[204:207], a[88:91], a[4:7]
v_mfma_f32_16x16x32_bf16 a[40:43], v[204:207], a[160:163], a[40:43]
ds_read_b64_tr_b16 v[200:201], v8 offset:28672
ds_read_b64_tr_b16 v[202:203], v8 offset:29184
s_waitcnt lgkmcnt(12)
v_mfma_f32_16x16x32_bf16 a[8:11], v[176:179], a[88:91], a[8:11]
s_add_u32 s57, s86, 995328
s_add_u32 m0, s56, 61440
s_nop 0
buffer_load_dwordx4 v16, s[12:15], s57 offen lds
v_mfma_f32_16x16x32_bf16 a[44:47], v[176:179], a[160:163], a[44:47]
ds_read_b64_tr_b16 v[204:205], v8 offset:8192
ds_read_b64_tr_b16 v[206:207], v8 offset:8704
s_waitcnt lgkmcnt(12)
v_mfma_f32_16x16x32_bf16 a[12:15], v[180:183], a[88:91], a[12:15]
s_add_u32 s57, s84, 1004544
s_add_u32 m0, s56, 37888
s_nop 0
buffer_load_dwordx4 v17, s[12:15], s57 offen lds
v_mfma_f32_16x16x32_bf16 a[48:51], v[180:183], a[160:163], a[48:51]
ds_read_b64_tr_b16 v[176:177], v9 offset:8192
ds_read_b64_tr_b16 v[178:179], v9 offset:8704
s_waitcnt lgkmcnt(12)
v_mfma_f32_16x16x32_bf16 a[16:19], v[184:187], a[88:91], a[16:19]
v_mfma_f32_16x16x32_bf16 a[52:55], v[184:187], a[160:163], a[52:55]
s_add_u32 s57, s85, 1004544
s_add_u32 m0, s56, 50176
s_nop 0
buffer_load_dwordx4 v17, s[12:15], s57 offen lds
ds_read_b64_tr_b16 v[180:181], v10 offset:8192
ds_read_b64_tr_b16 v[182:183], v10 offset:8704
s_waitcnt lgkmcnt(12)
v_mfma_f32_16x16x32_bf16 a[20:23], v[188:191], a[88:91], a[20:23]
v_mfma_f32_16x16x32_bf16 a[56:59], v[188:191], a[160:163], a[56:59]
ds_read_b64_tr_b16 v[184:185], v11 offset:8192
ds_read_b64_tr_b16 v[186:187], v11 offset:8704
s_waitcnt lgkmcnt(12)
v_mfma_f32_16x16x32_bf16 a[24:27], v[192:195], a[88:91], a[24:27]
s_add_u32 s57, s86, 1004544
s_add_u32 m0, s56, 62464
s_nop 0
buffer_load_dwordx4 v17, s[12:15], s57 offen lds
v_mfma_f32_16x16x32_bf16 a[60:63], v[192:195], a[160:163], a[60:63]
ds_read_b64_tr_b16 v[188:189], v8 offset:20480
ds_read_b64_tr_b16 v[190:191], v8 offset:20992
s_waitcnt lgkmcnt(12)
v_mfma_f32_16x16x32_bf16 a[28:31], v[196:199], a[88:91], a[28:31]
s_add_u32 s57, s84, 1013760
s_add_u32 m0, s56, 38912
s_nop 0
buffer_load_dwordx4 v16, s[12:15], s57 offen lds
v_mfma_f32_16x16x32_bf16 a[64:67], v[196:199], a[160:163], a[64:67]
ds_read_b64_tr_b16 v[192:193], v9 offset:20480
ds_read_b64_tr_b16 v[194:195], v9 offset:20992
s_waitcnt lgkmcnt(12)
v_mfma_f32_16x16x32_bf16 a[32:35], v[200:203], a[88:91], a[32:35]
v_mfma_f32_16x16x32_bf16 a[68:71], v[200:203], a[160:163], a[68:71]
s_add_u32 s57, s85, 1013760
s_add_u32 m0, s56, 51200
s_nop 0
buffer_load_dwordx4 v16, s[12:15], s57 offen lds
ds_read_b64_tr_b16 v[196:197], v10 offset:20480
ds_read_b64_tr_b16 v[198:199], v10 offset:20992
s_waitcnt lgkmcnt(12)
v_mfma_f32_16x16x32_bf16 a[0:3], v[204:207], a[92:95], a[0:3]
v_mfma_f32_16x16x32_bf16 a[36:39], v[204:207], a[164:167], a[36:39]
ds_read_b64_tr_b16 v[200:201], v11 offset:20480
ds_read_b64_tr_b16 v[202:203], v11 offset:20992
s_waitcnt lgkmcnt(12)
v_mfma_f32_16x16x32_bf16 a[4:7], v[176:179], a[92:95], a[4:7]
s_add_u32 s57, s86, 1013760
s_add_u32 m0, s56, 63488
s_nop 0
buffer_load_dwordx4 v16, s[12:15], s57 offen lds
v_mfma_f32_16x16x32_bf16 a[40:43], v[176:179], a[164:167], a[40:43]
ds_read_b64_tr_b16 v[204:205], v8 offset:32768
ds_read_b64_tr_b16 v[206:207], v8 offset:33280
s_waitcnt lgkmcnt(12)
v_mfma_f32_16x16x32_bf16 a[8:11], v[180:183], a[92:95], a[8:11]
v_mfma_f32_16x16x32_bf16 a[44:47], v[180:183], a[164:167], a[44:47]
s_waitcnt vmcnt(15)
s_barrier
v_subrev_u32 v8, 110592, v8
v_subrev_u32 v9, 110592, v9
v_subrev_u32 v10, 110592, v10
v_subrev_u32 v11, 110592, v11
ds_read_b64_tr_b16 v[176:177], v8 offset:0
ds_read_b64_tr_b16 v[178:179], v8 offset:512
s_waitcnt lgkmcnt(12)
v_mfma_f32_16x16x32_bf16 a[12:15], v[184:187], a[92:95], a[12:15]
v_mfma_f32_16x16x32_bf16 a[48:51], v[184:187], a[164:167], a[48:51]
ds_read_b64_tr_b16 v[180:181], v9 offset:0
ds_read_b64_tr_b16 v[182:183], v9 offset:512
s_waitcnt lgkmcnt(12)
v_mfma_f32_16x16x32_bf16 a[16:19], v[188:191], a[92:95], a[16:19]
v_mfma_f32_16x16x32_bf16 a[52:55], v[188:191], a[164:167], a[52:55]
ds_read_b64_tr_b16 v[184:185], v10 offset:0
ds_read_b64_tr_b16 v[186:187], v10 offset:512
s_waitcnt lgkmcnt(12)
v_mfma_f32_16x16x32_bf16 a[20:23], v[192:195], a[92:95], a[20:23]
v_mfma_f32_16x16x32_bf16 a[56:59], v[192:195], a[164:167], a[56:59]
ds_read_b64_tr_b16 v[188:189], v11 offset:0
ds_read_b64_tr_b16 v[190:191], v11 offset:512
s_waitcnt lgkmcnt(12)
v_mfma_f32_16x16x32_bf16 a[24:27], v[196:199], a[92:95], a[24:27]
v_mfma_f32_16x16x32_bf16 a[60:63], v[196:199], a[164:167], a[60:63]
ds_read_b64_tr_b16 v[192:193], v8 offset:12288
ds_read_b64_tr_b16 v[194:195], v8 offset:12800
s_waitcnt lgkmcnt(12)
v_mfma_f32_16x16x32_bf16 a[28:31], v[200:203], a[92:95], a[28:31]
v_mfma_f32_16x16x32_bf16 a[64:67], v[200:203], a[164:167], a[64:67]
ds_read_b64_tr_b16 v[196:197], v9 offset:12288
ds_read_b64_tr_b16 v[198:199], v9 offset:12800
s_waitcnt lgkmcnt(12)
v_mfma_f32_16x16x32_bf16 a[32:35], v[204:207], a[92:95], a[32:35]
v_mfma_f32_16x16x32_bf16 a[68:71], v[204:207], a[164:167], a[68:71]
ds_read_b64_tr_b16 v[200:201], v10 offset:12288
ds_read_b64_tr_b16 v[202:203], v10 offset:12800
s_waitcnt lgkmcnt(12)
v_mfma_f32_16x16x32_bf16 a[0:3], v[176:179], a[96:99], a[0:3]
s_add_u32 s78, s73, 28672
buffer_load_dwordx4 a[120:123], v27, s[16:19], s78 offen offset:2048
v_mfma_f32_16x16x32_bf16 a[36:39], v[176:179], a[168:171], a[36:39]
ds_read_b64_tr_b16 v[204:205], v11 offset:12288
ds_read_b64_tr_b16 v[206:207], v11 offset:12800
s_waitcnt lgkmcnt(12)
v_mfma_f32_16x16x32_bf16 a[4:7], v[180:183], a[96:99], a[4:7]
v_mfma_f32_16x16x32_bf16 a[40:43], v[180:183], a[168:171], a[40:43]
s_add_u32 s78, s73, 176128
buffer_load_dwordx4 a[192:195], v27, s[16:19], s78 offen offset:2048
ds_read_b64_tr_b16 v[176:177], v8 offset:24576
ds_read_b64_tr_b16 v[178:179], v8 offset:25088
s_waitcnt lgkmcnt(12)
v_mfma_f32_16x16x32_bf16 a[8:11], v[184:187], a[96:99], a[8:11]
v_mfma_f32_16x16x32_bf16 a[44:47], v[184:187], a[168:171], a[44:47]
ds_read_b64_tr_b16 v[180:181], v8 offset:4096
ds_read_b64_tr_b16 v[182:183], v8 offset:4608
s_waitcnt lgkmcnt(12)
v_mfma_f32_16x16x32_bf16 a[12:15], v[188:191], a[96:99], a[12:15]
s_add_u32 s78, s73, 28672
buffer_load_dwordx4 a[124:127], v27, s[16:19], s78 offen offset:3072
v_mfma_f32_16x16x32_bf16 a[48:51], v[188:191], a[168:171], a[48:51]
ds_read_b64_tr_b16 v[184:185], v9 offset:4096
ds_read_b64_tr_b16 v[186:187], v9 offset:4608
s_waitcnt lgkmcnt(12)
v_mfma_f32_16x16x32_bf16 a[16:19], v[192:195], a[96:99], a[16:19]
s_add_u32 s78, s73, 176128
buffer_load_dwordx4 a[196:199], v27, s[16:19], s78 offen offset:3072
v_mfma_f32_16x16x32_bf16 a[52:55], v[192:195], a[168:171], a[52:55]
ds_read_b64_tr_b16 v[188:189], v10 offset:4096
ds_read_b64_tr_b16 v[190:191], v10 offset:4608
s_waitcnt lgkmcnt(12)
v_mfma_f32_16x16x32_bf16 a[20:23], v[196:199], a[96:99], a[20:23]
v_mfma_f32_16x16x32_bf16 a[56:59], v[196:199], a[168:171], a[56:59]
s_add_u32 s78, s73, 32768
buffer_load_dwordx4 a[128:131], v27, s[16:19], s78 offen offset:0
ds_read_b64_tr_b16 v[192:193], v11 offset:4096
ds_read_b64_tr_b16 v[194:195], v11 offset:4608
s_waitcnt lgkmcnt(12)
v_mfma_f32_16x16x32_bf16 a[24:27], v[200:203], a[96:99], a[24:27]
v_mfma_f32_16x16x32_bf16 a[60:63], v[200:203], a[168:171], a[60:63]
ds_read_b64_tr_b16 v[196:197], v8 offset:16384
ds_read_b64_tr_b16 v[198:199], v8 offset:16896
s_waitcnt lgkmcnt(12)
v_mfma_f32_16x16x32_bf16 a[28:31], v[204:207], a[96:99], a[28:31]
s_add_u32 s78, s73, 180224
buffer_load_dwordx4 a[200:203], v27, s[16:19], s78 offen offset:0
v_mfma_f32_16x16x32_bf16 a[64:67], v[204:207], a[168:171], a[64:67]
ds_read_b64_tr_b16 v[200:201], v9 offset:16384
ds_read_b64_tr_b16 v[202:203], v9 offset:16896
s_waitcnt lgkmcnt(12)
v_mfma_f32_16x16x32_bf16 a[32:35], v[176:179], a[96:99], a[32:35]
s_add_u32 s57, s84, 1105920
s_add_u32 m0, s56, 73728
s_nop 0
buffer_load_dwordx4 v16, s[12:15], s57 offen lds
v_mfma_f32_16x16x32_bf16 a[68:71], v[176:179], a[168:171], a[68:71]
ds_read_b64_tr_b16 v[204:205], v10 offset:16384
ds_read_b64_tr_b16 v[206:207], v10 offset:16896
s_waitcnt lgkmcnt(12)
v_mfma_f32_16x16x32_bf16 a[0:3], v[180:183], a[100:103], a[0:3]
v_mfma_f32_16x16x32_bf16 a[36:39], v[180:183], a[172:175], a[36:39]
s_add_u32 s57, s85, 1105920
s_add_u32 m0, s56, 86016
s_nop 0
buffer_load_dwordx4 v16, s[12:15], s57 offen lds
ds_read_b64_tr_b16 v[176:177], v11 offset:16384
ds_read_b64_tr_b16 v[178:179], v11 offset:16896
s_waitcnt lgkmcnt(12)
v_mfma_f32_16x16x32_bf16 a[4:7], v[184:187], a[100:103], a[4:7]
v_mfma_f32_16x16x32_bf16 a[40:43], v[184:187], a[172:175], a[40:43]
ds_read_b64_tr_b16 v[180:181], v8 offset:28672
ds_read_b64_tr_b16 v[182:183], v8 offset:29184
s_waitcnt lgkmcnt(12)
v_mfma_f32_16x16x32_bf16 a[8:11], v[188:191], a[100:103], a[8:11]
s_add_u32 s57, s86, 1105920
s_add_u32 m0, s56, 98304
s_nop 0
buffer_load_dwordx4 v16, s[12:15], s57 offen lds
v_mfma_f32_16x16x32_bf16 a[44:47], v[188:191], a[172:175], a[44:47]
ds_read_b64_tr_b16 v[184:185], v8 offset:8192
ds_read_b64_tr_b16 v[186:187], v8 offset:8704
s_waitcnt lgkmcnt(12)
v_mfma_f32_16x16x32_bf16 a[12:15], v[192:195], a[100:103], a[12:15]
s_add_u32 s57, s84, 1115136
s_add_u32 m0, s56, 74752
s_nop 0
buffer_load_dwordx4 v17, s[12:15], s57 offen lds
v_mfma_f32_16x16x32_bf16 a[48:51], v[192:195], a[172:175], a[48:51]
ds_read_b64_tr_b16 v[188:189], v9 offset:8192
ds_read_b64_tr_b16 v[190:191], v9 offset:8704
s_waitcnt lgkmcnt(12)
v_mfma_f32_16x16x32_bf16 a[16:19], v[196:199], a[100:103], a[16:19]
v_mfma_f32_16x16x32_bf16 a[52:55], v[196:199], a[172:175], a[52:55]
s_add_u32 s57, s85, 1115136
s_add_u32 m0, s56, 87040
s_nop 0
buffer_load_dwordx4 v17, s[12:15], s57 offen lds
ds_read_b64_tr_b16 v[192:193], v10 offset:8192
ds_read_b64_tr_b16 v[194:195], v10 offset:8704
s_waitcnt lgkmcnt(12)
v_mfma_f32_16x16x32_bf16 a[20:23], v[200:203], a[100:103], a[20:23]
v_mfma_f32_16x16x32_bf16 a[56:59], v[200:203], a[172:175], a[56:59]
ds_read_b64_tr_b16 v[196:197], v11 offset:8192
ds_read_b64_tr_b16 v[198:199], v11 offset:8704
s_waitcnt lgkmcnt(12)
v_mfma_f32_16x16x32_bf16 a[24:27], v[204:207], a[100:103], a[24:27]
s_add_u32 s57, s86, 1115136
s_add_u32 m0, s56, 99328
s_nop 0
buffer_load_dwordx4 v17, s[12:15], s57 offen lds
v_mfma_f32_16x16x32_bf16 a[60:63], v[204:207], a[172:175], a[60:63]
ds_read_b64_tr_b16 v[200:201], v8 offset:20480
ds_read_b64_tr_b16 v[202:203], v8 offset:20992
s_waitcnt lgkmcnt(12)
v_mfma_f32_16x16x32_bf16 a[28:31], v[176:179], a[100:103], a[28:31]
s_add_u32 s57, s84, 1124352
s_add_u32 m0, s56, 75776
s_nop 0
buffer_load_dwordx4 v16, s[12:15], s57 offen lds
v_mfma_f32_16x16x32_bf16 a[64:67], v[176:179], a[172:175], a[64:67]
ds_read_b64_tr_b16 v[204:205], v9 offset:20480
ds_read_b64_tr_b16 v[206:207], v9 offset:20992
s_waitcnt lgkmcnt(12)
v_mfma_f32_16x16x32_bf16 a[32:35], v[180:183], a[100:103], a[32:35]
v_mfma_f32_16x16x32_bf16 a[68:71], v[180:183], a[172:175], a[68:71]
s_add_u32 s57, s85, 1124352
s_add_u32 m0, s56, 88064
s_nop 0
buffer_load_dwordx4 v16, s[12:15], s57 offen lds
ds_read_b64_tr_b16 v[176:177], v10 offset:20480
ds_read_b64_tr_b16 v[178:179], v10 offset:20992
s_waitcnt lgkmcnt(12)
v_mfma_f32_16x16x32_bf16 a[0:3], v[184:187], a[104:107], a[0:3]
v_mfma_f32_16x16x32_bf16 a[36:39], v[184:187], a[176:179], a[36:39]
ds_read_b64_tr_b16 v[180:181], v11 offset:20480
ds_read_b64_tr_b16 v[182:183], v11 offset:20992
s_waitcnt lgkmcnt(12)
v_mfma_f32_16x16x32_bf16 a[4:7], v[188:191], a[104:107], a[4:7]
s_add_u32 s57, s86, 1124352
s_add_u32 m0, s56, 100352
s_nop 0
buffer_load_dwordx4 v16, s[12:15], s57 offen lds
v_mfma_f32_16x16x32_bf16 a[40:43], v[188:191], a[176:179], a[40:43]
ds_read_b64_tr_b16 v[184:185], v8 offset:32768
ds_read_b64_tr_b16 v[186:187], v8 offset:33280
s_waitcnt lgkmcnt(12)
v_mfma_f32_16x16x32_bf16 a[8:11], v[192:195], a[104:107], a[8:11]
v_mfma_f32_16x16x32_bf16 a[44:47], v[192:195], a[176:179], a[44:47]
s_waitcnt vmcnt(15)
s_barrier
v_add_u32 v8, 36864, v8
v_add_u32 v9, 36864, v9
v_add_u32 v10, 36864, v10
v_add_u32 v11, 36864, v11
ds_read_b64_tr_b16 v[188:189], v8 offset:0
ds_read_b64_tr_b16 v[190:191], v8 offset:512
s_waitcnt lgkmcnt(12)
v_mfma_f32_16x16x32_bf16 a[12:15], v[196:199], a[104:107], a[12:15]
v_mfma_f32_16x16x32_bf16 a[48:51], v[196:199], a[176:179], a[48:51]
ds_read_b64_tr_b16 v[192:193], v9 offset:0
ds_read_b64_tr_b16 v[194:195], v9 offset:512
s_waitcnt lgkmcnt(12)
v_mfma_f32_16x16x32_bf16 a[16:19], v[200:203], a[104:107], a[16:19]
v_mfma_f32_16x16x32_bf16 a[52:55], v[200:203], a[176:179], a[52:55]
ds_read_b64_tr_b16 v[196:197], v10 offset:0
ds_read_b64_tr_b16 v[198:199], v10 offset:512
s_waitcnt lgkmcnt(12)
v_mfma_f32_16x16x32_bf16 a[20:23], v[204:207], a[104:107], a[20:23]
v_mfma_f32_16x16x32_bf16 a[56:59], v[204:207], a[176:179], a[56:59]
ds_read_b64_tr_b16 v[200:201], v11 offset:0
ds_read_b64_tr_b16 v[202:203], v11 offset:512
s_waitcnt lgkmcnt(12)
v_mfma_f32_16x16x32_bf16 a[24:27], v[176:179], a[104:107], a[24:27]
v_mfma_f32_16x16x32_bf16 a[60:63], v[176:179], a[176:179], a[60:63]
ds_read_b64_tr_b16 v[204:205], v8 offset:12288
ds_read_b64_tr_b16 v[206:207], v8 offset:12800
s_waitcnt lgkmcnt(12)
v_mfma_f32_16x16x32_bf16 a[28:31], v[180:183], a[104:107], a[28:31]
v_mfma_f32_16x16x32_bf16 a[64:67], v[180:183], a[176:179], a[64:67]
ds_read_b64_tr_b16 v[176:177], v9 offset:12288
ds_read_b64_tr_b16 v[178:179], v9 offset:12800
s_waitcnt lgkmcnt(12)
v_mfma_f32_16x16x32_bf16 a[32:35], v[184:187], a[104:107], a[32:35]
v_mfma_f32_16x16x32_bf16 a[68:71], v[184:187], a[176:179], a[68:71]
ds_read_b64_tr_b16 v[180:181], v10 offset:12288
ds_read_b64_tr_b16 v[182:183], v10 offset:12800
s_waitcnt lgkmcnt(12)
v_mfma_f32_16x16x32_bf16 a[0:3], v[188:191], a[108:111], a[0:3]
s_add_u32 s78, s73, 32768
buffer_load_dwordx4 a[132:135], v27, s[16:19], s78 offen offset:1024
v_mfma_f32_16x16x32_bf16 a[36:39], v[188:191], a[180:183], a[36:39]
ds_read_b64_tr_b16 v[184:185], v11 offset:12288
ds_read_b64_tr_b16 v[186:187], v11 offset:12800
s_waitcnt lgkmcnt(12)
v_mfma_f32_16x16x32_bf16 a[4:7], v[192:195], a[108:111], a[4:7]
v_mfma_f32_16x16x32_bf16 a[40:43], v[192:195], a[180:183], a[40:43]
s_add_u32 s78, s73, 180224
buffer_load_dwordx4 a[204:207], v27, s[16:19], s78 offen offset:1024
ds_read_b64_tr_b16 v[188:189], v8 offset:24576
ds_read_b64_tr_b16 v[190:191], v8 offset:25088
s_waitcnt lgkmcnt(12)
v_mfma_f32_16x16x32_bf16 a[8:11], v[196:199], a[108:111], a[8:11]
v_mfma_f32_16x16x32_bf16 a[44:47], v[196:199], a[180:183], a[44:47]
ds_read_b64_tr_b16 v[192:193], v8 offset:4096
ds_read_b64_tr_b16 v[194:195], v8 offset:4608
s_waitcnt lgkmcnt(12)
v_mfma_f32_16x16x32_bf16 a[12:15], v[200:203], a[108:111], a[12:15]
s_add_u32 s78, s73, 32768
buffer_load_dwordx4 a[136:139], v27, s[16:19], s78 offen offset:2048
v_mfma_f32_16x16x32_bf16 a[48:51], v[200:203], a[180:183], a[48:51]
ds_read_b64_tr_b16 v[196:197], v9 offset:4096
ds_read_b64_tr_b16 v[198:199], v9 offset:4608
s_waitcnt lgkmcnt(12)
v_mfma_f32_16x16x32_bf16 a[16:19], v[204:207], a[108:111], a[16:19]
s_add_u32 s78, s73, 180224
buffer_load_dwordx4 a[208:211], v27, s[16:19], s78 offen offset:2048
v_mfma_f32_16x16x32_bf16 a[52:55], v[204:207], a[180:183], a[52:55]
ds_read_b64_tr_b16 v[200:201], v10 offset:4096
ds_read_b64_tr_b16 v[202:203], v10 offset:4608
s_waitcnt lgkmcnt(12)
v_mfma_f32_16x16x32_bf16 a[20:23], v[176:179], a[108:111], a[20:23]
v_mfma_f32_16x16x32_bf16 a[56:59], v[176:179], a[180:183], a[56:59]
s_add_u32 s78, s73, 32768
buffer_load_dwordx4 a[140:143], v27, s[16:19], s78 offen offset:3072
ds_read_b64_tr_b16 v[204:205], v11 offset:4096
ds_read_b64_tr_b16 v[206:207], v11 offset:4608
s_waitcnt lgkmcnt(12)
v_mfma_f32_16x16x32_bf16 a[24:27], v[180:183], a[108:111], a[24:27]
v_mfma_f32_16x16x32_bf16 a[60:63], v[180:183], a[180:183], a[60:63]
ds_read_b64_tr_b16 v[176:177], v8 offset:16384
ds_read_b64_tr_b16 v[178:179], v8 offset:16896
s_waitcnt lgkmcnt(12)
v_mfma_f32_16x16x32_bf16 a[28:31], v[184:187], a[108:111], a[28:31]
s_add_u32 s78, s73, 180224
buffer_load_dwordx4 a[212:215], v27, s[16:19], s78 offen offset:3072
v_mfma_f32_16x16x32_bf16 a[64:67], v[184:187], a[180:183], a[64:67]
ds_read_b64_tr_b16 v[180:181], v9 offset:16384
ds_read_b64_tr_b16 v[182:183], v9 offset:16896
s_waitcnt lgkmcnt(12)
v_mfma_f32_16x16x32_bf16 a[32:35], v[188:191], a[108:111], a[32:35]
s_add_u32 s57, s84, 1216512
s_add_u32 m0, s56, 110592
s_nop 0
buffer_load_dwordx4 v16, s[12:15], s57 offen lds
v_mfma_f32_16x16x32_bf16 a[68:71], v[188:191], a[180:183], a[68:71]
ds_read_b64_tr_b16 v[184:185], v10 offset:16384
ds_read_b64_tr_b16 v[186:187], v10 offset:16896
s_waitcnt lgkmcnt(12)
v_mfma_f32_16x16x32_bf16 a[0:3], v[192:195], a[112:115], a[0:3]
v_mfma_f32_16x16x32_bf16 a[36:39], v[192:195], a[184:187], a[36:39]
s_add_u32 s57, s85, 1216512
s_add_u32 m0, s56, 122880
s_nop 0
buffer_load_dwordx4 v16, s[12:15], s57 offen lds
ds_read_b64_tr_b16 v[188:189], v11 offset:16384
ds_read_b64_tr_b16 v[190:191], v11 offset:16896
s_waitcnt lgkmcnt(12)
v_mfma_f32_16x16x32_bf16 a[4:7], v[196:199], a[112:115], a[4:7]
v_mfma_f32_16x16x32_bf16 a[40:43], v[196:199], a[184:187], a[40:43]
ds_read_b64_tr_b16 v[192:193], v8 offset:28672
ds_read_b64_tr_b16 v[194:195], v8 offset:29184
s_waitcnt lgkmcnt(12)
v_mfma_f32_16x16x32_bf16 a[8:11], v[200:203], a[112:115], a[8:11]
s_add_u32 s57, s86, 1216512
s_add_u32 m0, s56, 135168
s_nop 0
buffer_load_dwordx4 v16, s[12:15], s57 offen lds
v_mfma_f32_16x16x32_bf16 a[44:47], v[200:203], a[184:187], a[44:47]
ds_read_b64_tr_b16 v[196:197], v8 offset:8192
ds_read_b64_tr_b16 v[198:199], v8 offset:8704
s_waitcnt lgkmcnt(12)
v_mfma_f32_16x16x32_bf16 a[12:15], v[204:207], a[112:115], a[12:15]
s_add_u32 s57, s84, 1225728
s_add_u32 m0, s56, 111616
s_nop 0
buffer_load_dwordx4 v17, s[12:15], s57 offen lds
v_mfma_f32_16x16x32_bf16 a[48:51], v[204:207], a[184:187], a[48:51]
ds_read_b64_tr_b16 v[200:201], v9 offset:8192
ds_read_b64_tr_b16 v[202:203], v9 offset:8704
s_waitcnt lgkmcnt(12)
v_mfma_f32_16x16x32_bf16 a[16:19], v[176:179], a[112:115], a[16:19]
v_mfma_f32_16x16x32_bf16 a[52:55], v[176:179], a[184:187], a[52:55]
s_add_u32 s57, s85, 1225728
s_add_u32 m0, s56, 123904
s_nop 0
buffer_load_dwordx4 v17, s[12:15], s57 offen lds
ds_read_b64_tr_b16 v[204:205], v10 offset:8192
ds_read_b64_tr_b16 v[206:207], v10 offset:8704
s_waitcnt lgkmcnt(12)
v_mfma_f32_16x16x32_bf16 a[20:23], v[180:183], a[112:115], a[20:23]
v_mfma_f32_16x16x32_bf16 a[56:59], v[180:183], a[184:187], a[56:59]
ds_read_b64_tr_b16 v[176:177], v11 offset:8192
ds_read_b64_tr_b16 v[178:179], v11 offset:8704
s_waitcnt lgkmcnt(12)
v_mfma_f32_16x16x32_bf16 a[24:27], v[184:187], a[112:115], a[24:27]
s_add_u32 s57, s86, 1225728
s_add_u32 m0, s56, 136192
s_nop 0
buffer_load_dwordx4 v17, s[12:15], s57 offen lds
v_mfma_f32_16x16x32_bf16 a[60:63], v[184:187], a[184:187], a[60:63]
ds_read_b64_tr_b16 v[180:181], v8 offset:20480
ds_read_b64_tr_b16 v[182:183], v8 offset:20992
s_waitcnt lgkmcnt(12)
v_mfma_f32_16x16x32_bf16 a[28:31], v[188:191], a[112:115], a[28:31]
s_add_u32 s57, s84, 1234944
s_add_u32 m0, s56, 112640
s_nop 0
buffer_load_dwordx4 v16, s[12:15], s57 offen lds
v_mfma_f32_16x16x32_bf16 a[64:67], v[188:191], a[184:187], a[64:67]
ds_read_b64_tr_b16 v[184:185], v9 offset:20480
ds_read_b64_tr_b16 v[186:187], v9 offset:20992
s_waitcnt lgkmcnt(12)
v_mfma_f32_16x16x32_bf16 a[32:35], v[192:195], a[112:115], a[32:35]
v_mfma_f32_16x16x32_bf16 a[68:71], v[192:195], a[184:187], a[68:71]
s_add_u32 s57, s85, 1234944
s_add_u32 m0, s56, 124928
s_nop 0
buffer_load_dwordx4 v16, s[12:15], s57 offen lds
ds_read_b64_tr_b16 v[188:189], v10 offset:20480
ds_read_b64_tr_b16 v[190:191], v10 offset:20992
s_waitcnt lgkmcnt(12)
v_mfma_f32_16x16x32_bf16 a[0:3], v[196:199], a[116:119], a[0:3]
v_mfma_f32_16x16x32_bf16 a[36:39], v[196:199], a[188:191], a[36:39]
ds_read_b64_tr_b16 v[192:193], v11 offset:20480
ds_read_b64_tr_b16 v[194:195], v11 offset:20992
s_waitcnt lgkmcnt(12)
v_mfma_f32_16x16x32_bf16 a[4:7], v[200:203], a[116:119], a[4:7]
s_add_u32 s57, s86, 1234944
s_add_u32 m0, s56, 137216
s_nop 0
buffer_load_dwordx4 v16, s[12:15], s57 offen lds
v_mfma_f32_16x16x32_bf16 a[40:43], v[200:203], a[188:191], a[40:43]
ds_read_b64_tr_b16 v[196:197], v8 offset:32768
ds_read_b64_tr_b16 v[198:199], v8 offset:33280
s_waitcnt lgkmcnt(12)
v_mfma_f32_16x16x32_bf16 a[8:11], v[204:207], a[116:119], a[8:11]
v_mfma_f32_16x16x32_bf16 a[44:47], v[204:207], a[188:191], a[44:47]
s_waitcnt vmcnt(15)
s_barrier
v_add_u32 v8, 36864, v8
v_add_u32 v9, 36864, v9
v_add_u32 v10, 36864, v10
v_add_u32 v11, 36864, v11
ds_read_b64_tr_b16 v[200:201], v8 offset:0
ds_read_b64_tr_b16 v[202:203], v8 offset:512
s_waitcnt lgkmcnt(12)
v_mfma_f32_16x16x32_bf16 a[12:15], v[176:179], a[116:119], a[12:15]
v_mfma_f32_16x16x32_bf16 a[48:51], v[176:179], a[188:191], a[48:51]
ds_read_b64_tr_b16 v[204:205], v9 offset:0
ds_read_b64_tr_b16 v[206:207], v9 offset:512
s_waitcnt lgkmcnt(12)
v_mfma_f32_16x16x32_bf16 a[16:19], v[180:183], a[116:119], a[16:19]
v_mfma_f32_16x16x32_bf16 a[52:55], v[180:183], a[188:191], a[52:55]
ds_read_b64_tr_b16 v[176:177], v10 offset:0
ds_read_b64_tr_b16 v[178:179], v10 offset:512
s_waitcnt lgkmcnt(12)
v_mfma_f32_16x16x32_bf16 a[20:23], v[184:187], a[116:119], a[20:23]
v_mfma_f32_16x16x32_bf16 a[56:59], v[184:187], a[188:191], a[56:59]
ds_read_b64_tr_b16 v[180:181], v11 offset:0
ds_read_b64_tr_b16 v[182:183], v11 offset:512
s_waitcnt lgkmcnt(12)
v_mfma_f32_16x16x32_bf16 a[24:27], v[188:191], a[116:119], a[24:27]
v_mfma_f32_16x16x32_bf16 a[60:63], v[188:191], a[188:191], a[60:63]
ds_read_b64_tr_b16 v[184:185], v8 offset:12288
ds_read_b64_tr_b16 v[186:187], v8 offset:12800
s_waitcnt lgkmcnt(12)
v_mfma_f32_16x16x32_bf16 a[28:31], v[192:195], a[116:119], a[28:31]
v_mfma_f32_16x16x32_bf16 a[64:67], v[192:195], a[188:191], a[64:67]
ds_read_b64_tr_b16 v[188:189], v9 offset:12288
ds_read_b64_tr_b16 v[190:191], v9 offset:12800
s_waitcnt lgkmcnt(12)
v_mfma_f32_16x16x32_bf16 a[32:35], v[196:199], a[116:119], a[32:35]
v_mfma_f32_16x16x32_bf16 a[68:71], v[196:199], a[188:191], a[68:71]
ds_read_b64_tr_b16 v[192:193], v10 offset:12288
ds_read_b64_tr_b16 v[194:195], v10 offset:12800
s_waitcnt lgkmcnt(12)
v_mfma_f32_16x16x32_bf16 a[0:3], v[200:203], a[120:123], a[0:3]
v_mfma_f32_16x16x32_bf16 a[36:39], v[200:203], a[192:195], a[36:39]
ds_read_b64_tr_b16 v[196:197], v11 offset:12288
ds_read_b64_tr_b16 v[198:199], v11 offset:12800
s_waitcnt lgkmcnt(12)
v_mfma_f32_16x16x32_bf16 a[4:7], v[204:207], a[120:123], a[4:7]
v_mfma_f32_16x16x32_bf16 a[40:43], v[204:207], a[192:195], a[40:43]
ds_read_b64_tr_b16 v[200:201], v8 offset:24576
ds_read_b64_tr_b16 v[202:203], v8 offset:25088
s_waitcnt lgkmcnt(12)
v_mfma_f32_16x16x32_bf16 a[8:11], v[176:179], a[120:123], a[8:11]
v_mfma_f32_16x16x32_bf16 a[44:47], v[176:179], a[192:195], a[44:47]
ds_read_b64_tr_b16 v[204:205], v8 offset:4096
ds_read_b64_tr_b16 v[206:207], v8 offset:4608
s_waitcnt lgkmcnt(12)
v_mfma_f32_16x16x32_bf16 a[12:15], v[180:183], a[120:123], a[12:15]
v_mfma_f32_16x16x32_bf16 a[48:51], v[180:183], a[192:195], a[48:51]
ds_read_b64_tr_b16 v[176:177], v9 offset:4096
ds_read_b64_tr_b16 v[178:179], v9 offset:4608
s_waitcnt lgkmcnt(12)
v_mfma_f32_16x16x32_bf16 a[16:19], v[184:187], a[120:123], a[16:19]
v_mfma_f32_16x16x32_bf16 a[52:55], v[184:187], a[192:195], a[52:55]
ds_read_b64_tr_b16 v[180:181], v10 offset:4096
ds_read_b64_tr_b16 v[182:183], v10 offset:4608
s_waitcnt lgkmcnt(12)
v_mfma_f32_16x16x32_bf16 a[20:23], v[188:191], a[120:123], a[20:23]
v_mfma_f32_16x16x32_bf16 a[56:59], v[188:191], a[192:195], a[56:59]
ds_read_b64_tr_b16 v[184:185], v11 offset:4096
ds_read_b64_tr_b16 v[186:187], v11 offset:4608
s_waitcnt lgkmcnt(12)
v_mfma_f32_16x16x32_bf16 a[24:27], v[192:195], a[120:123], a[24:27]
v_mfma_f32_16x16x32_bf16 a[60:63], v[192:195], a[192:195], a[60:63]
ds_read_b64_tr_b16 v[188:189], v8 offset:16384
ds_read_b64_tr_b16 v[190:191], v8 offset:16896
s_waitcnt lgkmcnt(12)
v_mfma_f32_16x16x32_bf16 a[28:31], v[196:199], a[120:123], a[28:31]
v_mfma_f32_16x16x32_bf16 a[64:67], v[196:199], a[192:195], a[64:67]
ds_read_b64_tr_b16 v[192:193], v9 offset:16384
ds_read_b64_tr_b16 v[194:195], v9 offset:16896
s_waitcnt lgkmcnt(12)
v_mfma_f32_16x16x32_bf16 a[32:35], v[200:203], a[120:123], a[32:35]
v_mfma_f32_16x16x32_bf16 a[68:71], v[200:203], a[192:195], a[68:71]
ds_read_b64_tr_b16 v[196:197], v10 offset:16384
ds_read_b64_tr_b16 v[198:199], v10 offset:16896
s_waitcnt lgkmcnt(12)
v_mfma_f32_16x16x32_bf16 a[0:3], v[204:207], a[124:127], a[0:3]
v_mfma_f32_16x16x32_bf16 a[36:39], v[204:207], a[196:199], a[36:39]
ds_read_b64_tr_b16 v[200:201], v11 offset:16384
ds_read_b64_tr_b16 v[202:203], v11 offset:16896
s_waitcnt lgkmcnt(12)
v_mfma_f32_16x16x32_bf16 a[4:7], v[176:179], a[124:127], a[4:7]
v_mfma_f32_16x16x32_bf16 a[40:43], v[176:179], a[196:199], a[40:43]
ds_read_b64_tr_b16 v[204:205], v8 offset:28672
ds_read_b64_tr_b16 v[206:207], v8 offset:29184
s_waitcnt lgkmcnt(12)
v_mfma_f32_16x16x32_bf16 a[8:11], v[180:183], a[124:127], a[8:11]
v_mfma_f32_16x16x32_bf16 a[44:47], v[180:183], a[196:199], a[44:47]
ds_read_b64_tr_b16 v[176:177], v8 offset:8192
ds_read_b64_tr_b16 v[178:179], v8 offset:8704
s_waitcnt lgkmcnt(12)
v_mfma_f32_16x16x32_bf16 a[12:15], v[184:187], a[124:127], a[12:15]
v_mfma_f32_16x16x32_bf16 a[48:51], v[184:187], a[196:199], a[48:51]
ds_read_b64_tr_b16 v[180:181], v9 offset:8192
ds_read_b64_tr_b16 v[182:183], v9 offset:8704
s_waitcnt lgkmcnt(12)
v_mfma_f32_16x16x32_bf16 a[16:19], v[188:191], a[124:127], a[16:19]
v_mfma_f32_16x16x32_bf16 a[52:55], v[188:191], a[196:199], a[52:55]
ds_read_b64_tr_b16 v[184:185], v10 offset:8192
ds_read_b64_tr_b16 v[186:187], v10 offset:8704
s_waitcnt lgkmcnt(12)
v_mfma_f32_16x16x32_bf16 a[20:23], v[192:195], a[124:127], a[20:23]
v_mfma_f32_16x16x32_bf16 a[56:59], v[192:195], a[196:199], a[56:59]
ds_read_b64_tr_b16 v[188:189], v11 offset:8192
ds_read_b64_tr_b16 v[190:191], v11 offset:8704
s_waitcnt lgkmcnt(12)
v_mfma_f32_16x16x32_bf16 a[24:27], v[196:199], a[124:127], a[24:27]
v_mfma_f32_16x16x32_bf16 a[60:63], v[196:199], a[196:199], a[60:63]
ds_read_b64_tr_b16 v[192:193], v8 offset:20480
ds_read_b64_tr_b16 v[194:195], v8 offset:20992
s_waitcnt lgkmcnt(12)
v_mfma_f32_16x16x32_bf16 a[28:31], v[200:203], a[124:127], a[28:31]
v_mfma_f32_16x16x32_bf16 a[64:67], v[200:203], a[196:199], a[64:67]
ds_read_b64_tr_b16 v[196:197], v9 offset:20480
ds_read_b64_tr_b16 v[198:199], v9 offset:20992
s_waitcnt lgkmcnt(12)
v_mfma_f32_16x16x32_bf16 a[32:35], v[204:207], a[124:127], a[32:35]
v_mfma_f32_16x16x32_bf16 a[68:71], v[204:207], a[196:199], a[68:71]
ds_read_b64_tr_b16 v[200:201], v10 offset:20480
ds_read_b64_tr_b16 v[202:203], v10 offset:20992
s_waitcnt lgkmcnt(12)
v_mfma_f32_16x16x32_bf16 a[0:3], v[176:179], a[128:131], a[0:3]
v_mfma_f32_16x16x32_bf16 a[36:39], v[176:179], a[200:203], a[36:39]
ds_read_b64_tr_b16 v[204:205], v11 offset:20480
ds_read_b64_tr_b16 v[206:207], v11 offset:20992
s_waitcnt lgkmcnt(12)
v_mfma_f32_16x16x32_bf16 a[4:7], v[180:183], a[128:131], a[4:7]
v_mfma_f32_16x16x32_bf16 a[40:43], v[180:183], a[200:203], a[40:43]
ds_read_b64_tr_b16 v[176:177], v8 offset:32768
ds_read_b64_tr_b16 v[178:179], v8 offset:33280
s_waitcnt lgkmcnt(12)
v_mfma_f32_16x16x32_bf16 a[8:11], v[184:187], a[128:131], a[8:11]
v_mfma_f32_16x16x32_bf16 a[44:47], v[184:187], a[200:203], a[44:47]
s_waitcnt vmcnt(0)
s_barrier
v_add_u32 v8, 36864, v8
v_add_u32 v9, 36864, v9
v_add_u32 v10, 36864, v10
v_add_u32 v11, 36864, v11
ds_read_b64_tr_b16 v[180:181], v8 offset:0
ds_read_b64_tr_b16 v[182:183], v8 offset:512
s_waitcnt lgkmcnt(12)
v_mfma_f32_16x16x32_bf16 a[12:15], v[188:191], a[128:131], a[12:15]
v_mfma_f32_16x16x32_bf16 a[48:51], v[188:191], a[200:203], a[48:51]
ds_read_b64_tr_b16 v[184:185], v9 offset:0
ds_read_b64_tr_b16 v[186:187], v9 offset:512
s_waitcnt lgkmcnt(12)
v_mfma_f32_16x16x32_bf16 a[16:19], v[192:195], a[128:131], a[16:19]
v_mfma_f32_16x16x32_bf16 a[52:55], v[192:195], a[200:203], a[52:55]
ds_read_b64_tr_b16 v[188:189], v10 offset:0
ds_read_b64_tr_b16 v[190:191], v10 offset:512
s_waitcnt lgkmcnt(12)
v_mfma_f32_16x16x32_bf16 a[20:23], v[196:199], a[128:131], a[20:23]
v_mfma_f32_16x16x32_bf16 a[56:59], v[196:199], a[200:203], a[56:59]
ds_read_b64_tr_b16 v[192:193], v11 offset:0
ds_read_b64_tr_b16 v[194:195], v11 offset:512
s_waitcnt lgkmcnt(12)
v_mfma_f32_16x16x32_bf16 a[24:27], v[200:203], a[128:131], a[24:27]
v_mfma_f32_16x16x32_bf16 a[60:63], v[200:203], a[200:203], a[60:63]
ds_read_b64_tr_b16 v[196:197], v8 offset:12288
ds_read_b64_tr_b16 v[198:199], v8 offset:12800
s_waitcnt lgkmcnt(12)
v_mfma_f32_16x16x32_bf16 a[28:31], v[204:207], a[128:131], a[28:31]
v_mfma_f32_16x16x32_bf16 a[64:67], v[204:207], a[200:203], a[64:67]
ds_read_b64_tr_b16 v[200:201], v9 offset:12288
ds_read_b64_tr_b16 v[202:203], v9 offset:12800
s_waitcnt lgkmcnt(12)
v_mfma_f32_16x16x32_bf16 a[32:35], v[176:179], a[128:131], a[32:35]
v_mfma_f32_16x16x32_bf16 a[68:71], v[176:179], a[200:203], a[68:71]
ds_read_b64_tr_b16 v[204:205], v10 offset:12288
ds_read_b64_tr_b16 v[206:207], v10 offset:12800
s_waitcnt lgkmcnt(12)
v_mfma_f32_16x16x32_bf16 a[0:3], v[180:183], a[132:135], a[0:3]
v_mfma_f32_16x16x32_bf16 a[36:39], v[180:183], a[204:207], a[36:39]
ds_read_b64_tr_b16 v[176:177], v11 offset:12288
ds_read_b64_tr_b16 v[178:179], v11 offset:12800
s_waitcnt lgkmcnt(12)
v_mfma_f32_16x16x32_bf16 a[4:7], v[184:187], a[132:135], a[4:7]
v_mfma_f32_16x16x32_bf16 a[40:43], v[184:187], a[204:207], a[40:43]
ds_read_b64_tr_b16 v[180:181], v8 offset:24576
ds_read_b64_tr_b16 v[182:183], v8 offset:25088
s_waitcnt lgkmcnt(12)
v_mfma_f32_16x16x32_bf16 a[8:11], v[188:191], a[132:135], a[8:11]
v_mfma_f32_16x16x32_bf16 a[44:47], v[188:191], a[204:207], a[44:47]
ds_read_b64_tr_b16 v[184:185], v8 offset:4096
ds_read_b64_tr_b16 v[186:187], v8 offset:4608
s_waitcnt lgkmcnt(12)
v_mfma_f32_16x16x32_bf16 a[12:15], v[192:195], a[132:135], a[12:15]
v_mfma_f32_16x16x32_bf16 a[48:51], v[192:195], a[204:207], a[48:51]
ds_read_b64_tr_b16 v[188:189], v9 offset:4096
ds_read_b64_tr_b16 v[190:191], v9 offset:4608
s_waitcnt lgkmcnt(12)
v_mfma_f32_16x16x32_bf16 a[16:19], v[196:199], a[132:135], a[16:19]
v_mfma_f32_16x16x32_bf16 a[52:55], v[196:199], a[204:207], a[52:55]
ds_read_b64_tr_b16 v[192:193], v10 offset:4096
ds_read_b64_tr_b16 v[194:195], v10 offset:4608
s_waitcnt lgkmcnt(12)
v_mfma_f32_16x16x32_bf16 a[20:23], v[200:203], a[132:135], a[20:23]
v_mfma_f32_16x16x32_bf16 a[56:59], v[200:203], a[204:207], a[56:59]
ds_read_b64_tr_b16 v[196:197], v11 offset:4096
ds_read_b64_tr_b16 v[198:199], v11 offset:4608
s_waitcnt lgkmcnt(12)
v_mfma_f32_16x16x32_bf16 a[24:27], v[204:207], a[132:135], a[24:27]
v_mfma_f32_16x16x32_bf16 a[60:63], v[204:207], a[204:207], a[60:63]
ds_read_b64_tr_b16 v[200:201], v8 offset:16384
ds_read_b64_tr_b16 v[202:203], v8 offset:16896
s_waitcnt lgkmcnt(12)
v_mfma_f32_16x16x32_bf16 a[28:31], v[176:179], a[132:135], a[28:31]
v_mfma_f32_16x16x32_bf16 a[64:67], v[176:179], a[204:207], a[64:67]
ds_read_b64_tr_b16 v[204:205], v9 offset:16384
ds_read_b64_tr_b16 v[206:207], v9 offset:16896
s_waitcnt lgkmcnt(12)
v_mfma_f32_16x16x32_bf16 a[32:35], v[180:183], a[132:135], a[32:35]
v_mfma_f32_16x16x32_bf16 a[68:71], v[180:183], a[204:207], a[68:71]
ds_read_b64_tr_b16 v[176:177], v10 offset:16384
ds_read_b64_tr_b16 v[178:179], v10 offset:16896
s_waitcnt lgkmcnt(12)
v_mfma_f32_16x16x32_bf16 a[0:3], v[184:187], a[136:139], a[0:3]
v_mfma_f32_16x16x32_bf16 a[36:39], v[184:187], a[208:211], a[36:39]
ds_read_b64_tr_b16 v[180:181], v11 offset:16384
ds_read_b64_tr_b16 v[182:183], v11 offset:16896
s_waitcnt lgkmcnt(12)
v_mfma_f32_16x16x32_bf16 a[4:7], v[188:191], a[136:139], a[4:7]
v_mfma_f32_16x16x32_bf16 a[40:43], v[188:191], a[208:211], a[40:43]
ds_read_b64_tr_b16 v[184:185], v8 offset:28672
ds_read_b64_tr_b16 v[186:187], v8 offset:29184
s_waitcnt lgkmcnt(12)
v_mfma_f32_16x16x32_bf16 a[8:11], v[192:195], a[136:139], a[8:11]
v_mfma_f32_16x16x32_bf16 a[44:47], v[192:195], a[208:211], a[44:47]
ds_read_b64_tr_b16 v[188:189], v8 offset:8192
ds_read_b64_tr_b16 v[190:191], v8 offset:8704
s_waitcnt lgkmcnt(12)
v_mfma_f32_16x16x32_bf16 a[12:15], v[196:199], a[136:139], a[12:15]
v_mfma_f32_16x16x32_bf16 a[48:51], v[196:199], a[208:211], a[48:51]
ds_read_b64_tr_b16 v[192:193], v9 offset:8192
ds_read_b64_tr_b16 v[194:195], v9 offset:8704
s_waitcnt lgkmcnt(12)
v_mfma_f32_16x16x32_bf16 a[16:19], v[200:203], a[136:139], a[16:19]
v_mfma_f32_16x16x32_bf16 a[52:55], v[200:203], a[208:211], a[52:55]
ds_read_b64_tr_b16 v[196:197], v10 offset:8192
ds_read_b64_tr_b16 v[198:199], v10 offset:8704
s_waitcnt lgkmcnt(12)
v_mfma_f32_16x16x32_bf16 a[20:23], v[204:207], a[136:139], a[20:23]
v_mfma_f32_16x16x32_bf16 a[56:59], v[204:207], a[208:211], a[56:59]
ds_read_b64_tr_b16 v[200:201], v11 offset:8192
ds_read_b64_tr_b16 v[202:203], v11 offset:8704
s_waitcnt lgkmcnt(12)
v_mfma_f32_16x16x32_bf16 a[24:27], v[176:179], a[136:139], a[24:27]
v_mfma_f32_16x16x32_bf16 a[60:63], v[176:179], a[208:211], a[60:63]
ds_read_b64_tr_b16 v[204:205], v8 offset:20480
ds_read_b64_tr_b16 v[206:207], v8 offset:20992
s_waitcnt lgkmcnt(12)
v_mfma_f32_16x16x32_bf16 a[28:31], v[180:183], a[136:139], a[28:31]
v_mfma_f32_16x16x32_bf16 a[64:67], v[180:183], a[208:211], a[64:67]
ds_read_b64_tr_b16 v[176:177], v9 offset:20480
ds_read_b64_tr_b16 v[178:179], v9 offset:20992
s_waitcnt lgkmcnt(12)
v_mfma_f32_16x16x32_bf16 a[32:35], v[184:187], a[136:139], a[32:35]
v_mfma_f32_16x16x32_bf16 a[68:71], v[184:187], a[208:211], a[68:71]
ds_read_b64_tr_b16 v[180:181], v10 offset:20480
ds_read_b64_tr_b16 v[182:183], v10 offset:20992
s_waitcnt lgkmcnt(12)
v_mfma_f32_16x16x32_bf16 a[0:3], v[188:191], a[140:143], a[0:3]
v_mfma_f32_16x16x32_bf16 a[36:39], v[188:191], a[212:215], a[36:39]
ds_read_b64_tr_b16 v[184:185], v11 offset:20480
ds_read_b64_tr_b16 v[186:187], v11 offset:20992
s_waitcnt lgkmcnt(12)
v_mfma_f32_16x16x32_bf16 a[4:7], v[192:195], a[140:143], a[4:7]
v_mfma_f32_16x16x32_bf16 a[40:43], v[192:195], a[212:215], a[40:43]
ds_read_b64_tr_b16 v[188:189], v8 offset:32768
ds_read_b64_tr_b16 v[190:191], v8 offset:33280
s_waitcnt lgkmcnt(12)
v_mfma_f32_16x16x32_bf16 a[8:11], v[196:199], a[140:143], a[8:11]
v_mfma_f32_16x16x32_bf16 a[44:47], v[196:199], a[212:215], a[44:47]
s_waitcnt lgkmcnt(10)
v_mfma_f32_16x16x32_bf16 a[12:15], v[200:203], a[140:143], a[12:15]
v_mfma_f32_16x16x32_bf16 a[48:51], v[200:203], a[212:215], a[48:51]
s_waitcnt lgkmcnt(8)
v_mfma_f32_16x16x32_bf16 a[16:19], v[204:207], a[140:143], a[16:19]
v_mfma_f32_16x16x32_bf16 a[52:55], v[204:207], a[212:215], a[52:55]
s_waitcnt lgkmcnt(6)
v_mfma_f32_16x16x32_bf16 a[20:23], v[176:179], a[140:143], a[20:23]
v_mfma_f32_16x16x32_bf16 a[56:59], v[176:179], a[212:215], a[56:59]
s_waitcnt lgkmcnt(4)
v_mfma_f32_16x16x32_bf16 a[24:27], v[180:183], a[140:143], a[24:27]
v_mfma_f32_16x16x32_bf16 a[60:63], v[180:183], a[212:215], a[60:63]
s_waitcnt lgkmcnt(2)
v_mfma_f32_16x16x32_bf16 a[28:31], v[184:187], a[140:143], a[28:31]
v_mfma_f32_16x16x32_bf16 a[64:67], v[184:187], a[212:215], a[64:67]
s_waitcnt lgkmcnt(0)
v_mfma_f32_16x16x32_bf16 a[32:35], v[188:191], a[140:143], a[32:35]
v_mfma_f32_16x16x32_bf16 a[68:71], v[188:191], a[212:215], a[68:71]
s_nop 7
s_mul_i32 s74, s60, 2359296
s_mul_i32 s75, s70, 18432
s_add_u32 s74, s74, s75
s_mul_i32 s75, s59, 9216
s_add_u32 s74, s74, s75
s_add_u32 s74, s74, 41943040
v_lshlrev_b32 v5, 4, v1
v_accvgpr_read_b32 v36, a0
v_accvgpr_read_b32 v37, a1
v_accvgpr_read_b32 v38, a2
v_accvgpr_read_b32 v39, a3
v_accvgpr_read_b32 v40, a36
v_accvgpr_read_b32 v41, a37
v_accvgpr_read_b32 v42, a38
v_accvgpr_read_b32 v43, a39
v_cvt_pk_bf16_f32 v32, v36, v37
v_cvt_pk_bf16_f32 v33, v38, v39
v_cvt_pk_bf16_f32 v34, v40, v41
v_cvt_pk_bf16_f32 v35, v42, v43
s_add_u32 s77, s74, 0
buffer_store_dwordx4 v[32:35], v5, s[16:19], s77 offen offset:0 sc1
v_accvgpr_read_b32 v52, a4
v_accvgpr_read_b32 v53, a5
v_accvgpr_read_b32 v54, a6
v_accvgpr_read_b32 v55, a7
v_accvgpr_read_b32 v56, a40
v_accvgpr_read_b32 v57, a41
v_accvgpr_read_b32 v58, a42
v_accvgpr_read_b32 v59, a43
v_cvt_pk_bf16_f32 v48, v52, v53
v_cvt_pk_bf16_f32 v49, v54, v55
v_cvt_pk_bf16_f32 v50, v56, v57
v_cvt_pk_bf16_f32 v51, v58, v59
s_add_u32 s77, s74, 0
buffer_store_dwordx4 v[48:51], v5, s[16:19], s77 offen offset:1024 sc1
v_accvgpr_read_b32 v36, a8
v_accvgpr_read_b32 v37, a9
v_accvgpr_read_b32 v38, a10
v_accvgpr_read_b32 v39, a11
v_accvgpr_read_b32 v40, a44
v_accvgpr_read_b32 v41, a45
v_accvgpr_read_b32 v42, a46
v_accvgpr_read_b32 v43, a47
v_cvt_pk_bf16_f32 v32, v36, v37
v_cvt_pk_bf16_f32 v33, v38, v39
v_cvt_pk_bf16_f32 v34, v40, v41
v_cvt_pk_bf16_f32 v35, v42, v43
s_add_u32 s77, s74, 0
buffer_store_dwordx4 v[32:35], v5, s[16:19], s77 offen offset:2048 sc1
v_accvgpr_read_b32 v52, a12
v_accvgpr_read_b32 v53, a13
v_accvgpr_read_b32 v54, a14
v_accvgpr_read_b32 v55, a15
v_accvgpr_read_b32 v56, a48
v_accvgpr_read_b32 v57, a49
v_accvgpr_read_b32 v58, a50
v_accvgpr_read_b32 v59, a51
v_cvt_pk_bf16_f32 v48, v52, v53
v_cvt_pk_bf16_f32 v49, v54, v55
v_cvt_pk_bf16_f32 v50, v56, v57
v_cvt_pk_bf16_f32 v51, v58, v59
s_add_u32 s77, s74, 0
buffer_store_dwordx4 v[48:51], v5, s[16:19], s77 offen offset:3072 sc1
v_accvgpr_read_b32 v36, a16
v_accvgpr_read_b32 v37, a17
v_accvgpr_read_b32 v38, a18
v_accvgpr_read_b32 v39, a19
v_accvgpr_read_b32 v40, a52
v_accvgpr_read_b32 v41, a53
v_accvgpr_read_b32 v42, a54
v_accvgpr_read_b32 v43, a55
v_cvt_pk_bf16_f32 v32, v36, v37
v_cvt_pk_bf16_f32 v33, v38, v39
v_cvt_pk_bf16_f32 v34, v40, v41
v_cvt_pk_bf16_f32 v35, v42, v43
s_add_u32 s77, s74, 4096
buffer_store_dwordx4 v[32:35], v5, s[16:19], s77 offen offset:0 sc1
v_accvgpr_read_b32 v52, a20
v_accvgpr_read_b32 v53, a21
v_accvgpr_read_b32 v54, a22
v_accvgpr_read_b32 v55, a23
v_accvgpr_read_b32 v56, a56
v_accvgpr_read_b32 v57, a57
v_accvgpr_read_b32 v58, a58
v_accvgpr_read_b32 v59, a59
v_cvt_pk_bf16_f32 v48, v52, v53
v_cvt_pk_bf16_f32 v49, v54, v55
v_cvt_pk_bf16_f32 v50, v56, v57
v_cvt_pk_bf16_f32 v51, v58, v59
s_add_u32 s77, s74, 4096
buffer_store_dwordx4 v[48:51], v5, s[16:19], s77 offen offset:1024 sc1
v_accvgpr_read_b32 v36, a24
v_accvgpr_read_b32 v37, a25
v_accvgpr_read_b32 v38, a26
v_accvgpr_read_b32 v39, a27
v_accvgpr_read_b32 v40, a60
v_accvgpr_read_b32 v41, a61
v_accvgpr_read_b32 v42, a62
v_accvgpr_read_b32 v43, a63
v_cvt_pk_bf16_f32 v32, v36, v37
v_cvt_pk_bf16_f32 v33, v38, v39
v_cvt_pk_bf16_f32 v34, v40, v41
v_cvt_pk_bf16_f32 v35, v42, v43
s_add_u32 s77, s74, 4096
buffer_store_dwordx4 v[32:35], v5, s[16:19], s77 offen offset:2048 sc1
v_accvgpr_read_b32 v52, a28
v_accvgpr_read_b32 v53, a29
v_accvgpr_read_b32 v54, a30
v_accvgpr_read_b32 v55, a31
v_accvgpr_read_b32 v56, a64
v_accvgpr_read_b32 v57, a65
v_accvgpr_read_b32 v58, a66
v_accvgpr_read_b32 v59, a67
v_cvt_pk_bf16_f32 v48, v52, v53
v_cvt_pk_bf16_f32 v49, v54, v55
v_cvt_pk_bf16_f32 v50, v56, v57
v_cvt_pk_bf16_f32 v51, v58, v59
s_add_u32 s77, s74, 4096
buffer_store_dwordx4 v[48:51], v5, s[16:19], s77 offen offset:3072 sc1
v_accvgpr_read_b32 v36, a32
v_accvgpr_read_b32 v37, a33
v_accvgpr_read_b32 v38, a34
v_accvgpr_read_b32 v39, a35
v_accvgpr_read_b32 v40, a68
v_accvgpr_read_b32 v41, a69
v_accvgpr_read_b32 v42, a70
v_accvgpr_read_b32 v43, a71
v_cvt_pk_bf16_f32 v32, v36, v37
v_cvt_pk_bf16_f32 v33, v38, v39
v_cvt_pk_bf16_f32 v34, v40, v41
v_cvt_pk_bf16_f32 v35, v42, v43
s_add_u32 s77, s74, 8192
buffer_store_dwordx4 v[32:35], v5, s[16:19], s77 offen offset:0 sc1
k4_end:
s_endpgm

.globl k4r_l0_kernel
.p2align 8
.type k4r_l0_kernel,@function
k4r_l0_kernel:
s_mov_b32 s92, 0
s_branch k4r_body
.globl k4r_l1_kernel
.p2align 8
.type k4r_l1_kernel,@function
k4r_l1_kernel:
s_mov_b32 s92, 1
s_branch k4r_body
.p2align 6
k4r_body:
s_cmp_ge_u32 s2, 576
s_cbranch_scc1 k4r_end
s_load_dwordx16 s[32:47], s[0:1], 0
s_load_dwordx8 s[48:55], s[0:1], 64
v_and_b32 v1, 63, v0
v_lshrrev_b32 v2, 4, v1
v_and_b32 v3, 15, v1
v_lshrrev_b32 v4, 6, v0
s_nop 0
v_readfirstlane_b32 s3, v4
v_lshrrev_b32 v5, 1, v2
v_lshlrev_b32 v5, 8, v5
v_lshl_add_u32 v5, v3, 4, v5
v_and_b32 v6, 1, v2
v_lshl_add_u32 v26, v6, 3, v5
s_waitcnt lgkmcnt(0)
s_mov_b32 s16, s54
s_and_b32 s17, s55, 0xffff
s_mov_b32 s18, 67108864
s_mov_b32 s19, 0x20000
s_mov_b32 s12, s48
s_and_b32 s13, s49, 0xffff
s_mov_b32 s14, 1152
s_mov_b32 s15, 0x20000
s_add_u32 s64, s54, 14680064
s_addc_u32 s65, s55, 0
s_add_u32 s66, s50, 0
s_addc_u32 s67, s51, 0
s_cmp_eq_u32 s92, 0
s_cselect_b32 s24, s64, s66
s_cselect_b32 s25, s65, s67
s_and_b32 s25, s25, 0xffff
s_mov_b32 s26, 2359296
s_mov_b32 s27, 0x20000
s_lshl_b32 s64, s2, 2
s_add_u32 s64, s64, s3
s_mov_b32 s65, 0x71c71c8
s_mul_hi_u32 s66, s64, s65
s_mul_i32 s67, s66, 36
s_sub_u32 s67, s64, s67
v_lshlrev_b32 v5, 4, v1
s_lshl_b32 s68, s64, 10
s_add_u32 s69, s68, 41943040
buffer_load_dwordx4 v[32:35], v5, s[16:19], s69 offen
s_add_u32 s69, s68, 44302336
buffer_load_dwordx4 v[36:39], v5, s[16:19], s69 offen
s_add_u32 s69, s68, 46661632
buffer_load_dwordx4 v[40:43], v5, s[16:19], s69 offen
s_add_u32 s69, s68, 49020928
buffer_load_dwordx4 v[44:47], v5, s[16:19], s69 offen
s_mul_i32 s70, s66, 36864
s_lshl_b32 s71, s67, 9
s_add_u32 s70, s70, s71
s_cmp_eq_u32 s92, 0
s_mov_b32 s72, 17825792
s_cselect_b32 s72, 11534336, s72
s_add_u32 s72, s72, s70
s_add_u32 s75, s72, 18432
buffer_load_dwordx2 v[48:49], v26, s[16:19], s72 offen
buffer_load_dwordx2 v[50:51], v26, s[16:19], s75 offen
v_lshlrev_b32 v6, 3, v2
s_lshl_b32 s73, s67, 5
buffer_load_dwordx2 v[52:53], v6, s[12:15], s73 offen
v_mul_u32_u24 v7, 1152, v3
v_add_u32 v7, v7, v6
s_mul_i32 s74, s66, 36864
s_add_u32 s74, s74, s73
s_cmp_eq_u32 s92, 0
s_cselect_b32 s74, s70, s74
s_cselect_b64 s[76:77], -1, 0
v_cndmask_b32 v7, v7, v26, s[76:77]
s_add_u32 s75, s74, 18432
s_waitcnt vmcnt(0)
v_lshlrev_b32 v64, 16, v52
v_and_b32 v65, 0xffff0000, v52
v_lshlrev_b32 v66, 16, v53
v_and_b32 v67, 0xffff0000, v53
v_mov_b32 v68, v64
v_mov_b32 v69, v65
v_mov_b32 v70, v66
v_mov_b32 v71, v67
v_lshlrev_b32 v72, 16, v32
v_and_b32 v73, 0xffff0000, v32
v_lshlrev_b32 v74, 16, v33
v_and_b32 v75, 0xffff0000, v33
v_add_f32 v64, v64, v72
v_add_f32 v65, v65, v73
v_add_f32 v66, v66, v74
v_add_f32 v67, v67, v75
v_lshlrev_b32 v72, 16, v34
v_and_b32 v73, 0xffff0000, v34
v_lshlrev_b32 v74, 16, v35
v_and_b32 v75, 0xffff0000, v35
v_add_f32 v68, v68, v72
v_add_f32 v69, v69, v73
v_add_f32 v70, v70, v74
v_add_f32 v71, v71, v75
v_lshlrev_b32 v72, 16, v36
v_and_b32 v73, 0xffff0000, v36
v_lshlrev_b32 v74, 16, v37
v_and_b32 v75, 0xffff0000, v37
v_add_f32 v64, v64, v72
v_add_f32 v65, v65, v73
v_add_f32 v66, v66, v74
v_add_f32 v67, v67, v75
v_lshlrev_b32 v72, 16, v38
v_and_b32 v73, 0xffff0000, v38
v_lshlrev_b32 v74, 16, v39
v_and_b32 v75, 0xffff0000, v39
v_add_f32 v68, v68, v72
v_add_f32 v69, v69, v73
v_add_f32 v70, v70, v74
v_add_f32 v71, v71, v75
v_lshlrev_b32 v72, 16, v40
v_and_b32 v73, 0xffff0000, v40
v_lshlrev_b32 v74, 16, v41
v_and_b32 v75, 0xffff0000, v41
v_add_f32 v64, v64, v72
v_add_f32 v65, v65, v73
v_add_f32 v66, v66, v74
v_add_f32 v67, v67, v75
v_lshlrev_b32 v72, 16, v42
v_and_b32 v73, 0xffff0000, v42
v_lshlrev_b32 v74, 16, v43
v_and_b32 v75, 0xffff0000, v43
v_add_f32 v68, v68, v72
v_add_f32 v69, v69, v73
v_add_f32 v70, v70, v74
v_add_f32 v71, v71, v75
v_lshlrev_b32 v72, 16, v44
v_and_b32 v73, 0xffff0000, v44
v_lshlrev_b32 v74, 16, v45
v_and_b32 v75, 0xffff0000, v45
v_add_f32 v64, v64, v72
v_add_f32 v65, v65, v73
v_add_f32 v66, v66, v74
v_add_f32 v67, v67, v75
v_lshlrev_b32 v72, 16, v46
v_and_b32 v73, 0xffff0000, v46
v_lshlrev_b32 v74, 16, v47
v_and_b32 v75, 0xffff0000, v47
v_add_f32 v68, v68, v72
v_add_f32 v69, v69, v73
v_add_f32 v70, v70, v74
v_add_f32 v71, v71, v75
v_lshlrev_b32 v72, 16, v48
v_and_b32 v73, 0xffff0000, v48
v_lshlrev_b32 v74, 16, v49
v_and_b32 v75, 0xffff0000, v49
v_add_f32 v64, v64, v72
v_add_f32 v65, v65, v73
v_add_f32 v66, v66, v74
v_add_f32 v67, v67, v75
v_lshlrev_b32 v72, 16, v50
v_and_b32 v73, 0xffff0000, v50
v_lshlrev_b32 v74, 16, v51
v_and_b32 v75, 0xffff0000, v51
v_add_f32 v68, v68, v72
v_add_f32 v69, v69, v73
v_add_f32 v70, v70, v74
v_add_f32 v71, v71, v75
v_cvt_pk_bf16_f32 v76, v64, v65
v_cvt_pk_bf16_f32 v77, v66, v67
buffer_store_dwordx2 v[76:77], v7, s[24:27], s74 offen
v_cvt_pk_bf16_f32 v78, v68, v69
v_cvt_pk_bf16_f32 v79, v70, v71
buffer_store_dwordx2 v[78:79], v7, s[24:27], s75 offen
k4r_end:
s_endpgm

text_end:
s_endpgm
.fill 512, 4, 0xBF800000
.section .rodata,"a"
.p2align 6
.amdhsa_kernel k1_l0_kernel
  .amdhsa_next_free_vgpr 364
  .amdhsa_next_free_sgpr 102
  .amdhsa_accum_offset 256
  .amdhsa_group_segment_fixed_size 0
  .amdhsa_kernarg_size 96
  .amdhsa_user_sgpr_count 2
  .amdhsa_user_sgpr_kernarg_segment_ptr 1
  .amdhsa_system_sgpr_workgroup_id_x 1
.end_amdhsa_kernel
.p2align 6
.amdhsa_kernel k1_l1_kernel
  .amdhsa_next_free_vgpr 364
  .amdhsa_next_free_sgpr 102
  .amdhsa_accum_offset 256
  .amdhsa_group_segment_fixed_size 0
  .amdhsa_kernarg_size 96
  .amdhsa_user_sgpr_count 2
  .amdhsa_user_sgpr_kernarg_segment_ptr 1
  .amdhsa_system_sgpr_workgroup_id_x 1
.end_amdhsa_kernel
.p2align 6
.amdhsa_kernel ko_l0_kernel
  .amdhsa_next_free_vgpr 480
  .amdhsa_next_free_sgpr 102
  .amdhsa_accum_offset 256
  .amdhsa_group_segment_fixed_size 0
  .amdhsa_kernarg_size 96
  .amdhsa_user_sgpr_count 2
  .amdhsa_user_sgpr_kernarg_segment_ptr 1
  .amdhsa_system_sgpr_workgroup_id_x 1
.end_amdhsa_kernel
.p2align 6
.amdhsa_kernel ko_l1_kernel
  .amdhsa_next_free_vgpr 480
  .amdhsa_next_free_sgpr 102
  .amdhsa_accum_offset 256
  .amdhsa_group_segment_fixed_size 0
  .amdhsa_kernarg_size 96
  .amdhsa_user_sgpr_count 2
  .amdhsa_user_sgpr_kernarg_segment_ptr 1
  .amdhsa_system_sgpr_workgroup_id_x 1
.end_amdhsa_kernel
.p2align 6
.amdhsa_kernel k2_l0_kernel
  .amdhsa_next_free_vgpr 328
  .amdhsa_next_free_sgpr 102
  .amdhsa_accum_offset 256
  .amdhsa_group_segment_fixed_size 0
  .amdhsa_kernarg_size 96
  .amdhsa_user_sgpr_count 2
  .amdhsa_user_sgpr_kernarg_segment_ptr 1
  .amdhsa_system_sgpr_workgroup_id_x 1
.end_amdhsa_kernel
.p2align 6
.amdhsa_kernel k2_l1_kernel
  .amdhsa_next_free_vgpr 328
  .amdhsa_next_free_sgpr 102
  .amdhsa_accum_offset 256
  .amdhsa_group_segment_fixed_size 0
  .amdhsa_kernarg_size 96
  .amdhsa_user_sgpr_count 2
  .amdhsa_user_sgpr_kernarg_segment_ptr 1
  .amdhsa_system_sgpr_workgroup_id_x 1
.end_amdhsa_kernel
.p2align 6
.amdhsa_kernel k3_l0_kernel
  .amdhsa_next_free_vgpr 508
  .amdhsa_next_free_sgpr 102
  .amdhsa_accum_offset 256
  .amdhsa_group_segment_fixed_size 0
  .amdhsa_kernarg_size 96
  .amdhsa_user_sgpr_count 2
  .amdhsa_user_sgpr_kernarg_segment_ptr 1
  .amdhsa_system_sgpr_workgroup_id_x 1
.end_amdhsa_kernel
.p2align 6
.amdhsa_kernel k3_l1_kernel
  .amdhsa_next_free_vgpr 508
  .amdhsa_next_free_sgpr 102
  .amdhsa_accum_offset 256
  .amdhsa_group_segment_fixed_size 0
  .amdhsa_kernarg_size 96
  .amdhsa_user_sgpr_count 2
  .amdhsa_user_sgpr_kernarg_segment_ptr 1
  .amdhsa_system_sgpr_workgroup_id_x 1
.end_amdhsa_kernel
.p2align 6
.amdhsa_kernel k4_l0_kernel
  .amdhsa_next_free_vgpr 472
  .amdhsa_next_free_sgpr 102
  .amdhsa_accum_offset 256
  .amdhsa_group_segment_fixed_size 0
  .amdhsa_kernarg_size 96
  .amdhsa_user_sgpr_count 2
  .amdhsa_user_sgpr_kernarg_segment_ptr 1
  .amdhsa_system_sgpr_workgroup_id_x 1
.end_amdhsa_kernel
.p2align 6
.amdhsa_kernel k4_l1_kernel
  .amdhsa_next_free_vgpr 472
  .amdhsa_next_free_sgpr 102
  .amdhsa_accum_offset 256
  .amdhsa_group_segment_fixed_size 0
  .amdhsa_kernarg_size 96
  .amdhsa_user_sgpr_count 2
  .amdhsa_user_sgpr_kernarg_segment_ptr 1
  .amdhsa_system_sgpr_workgroup_id_x 1
.end_amdhsa_kernel
.p2align 6
.amdhsa_kernel k4r_l0_kernel
  .amdhsa_next_free_vgpr 80
  .amdhsa_next_free_sgpr 102
  .amdhsa_accum_offset 80
  .amdhsa_group_segment_fixed_size 0
  .amdhsa_kernarg_size 96
  .amdhsa_user_sgpr_count 2
  .amdhsa_user_sgpr_kernarg_segment_ptr 1
  .amdhsa_system_sgpr_workgroup_id_x 1
.end_amdhsa_kernel
.p2align 6
.amdhsa_kernel k4r_l1_kernel
  .amdhsa_next_free_vgpr 80
  .amdhsa_next_free_sgpr 102
  .amdhsa_accum_offset 80
  .amdhsa_group_segment_fixed_size 0
  .amdhsa_kernarg_size 96
  .amdhsa_user_sgpr_count 2
  .amdhsa_user_sgpr_kernarg_segment_ptr 1
  .amdhsa_system_sgpr_workgroup_id_x 1
.end_amdhsa_kernel
```
